```python
import torch

def _softmax(x, axis=-1):
    return torch.softmax(x, dim=axis)
def _gelu(x):
    return torch.nn.functional.gelu(x, approximate="tanh")
def _silu(x):
    return torch.nn.functional.silu(x)
def _sigmoid(x):
    return torch.sigmoid(x)
def _layernorm(x, axis=-1, eps=1e-5):
    m = x.mean(dim=axis, keepdim=True)
    v = x.var(dim=axis, keepdim=True, unbiased=False)
    return (x - m) / torch.sqrt(v + eps)
def _scatter_add(tgt, idx, src, axis=0):
    return tgt.clone().index_add_(axis, idx, src)
def _segment_sum(src, seg, n):
    out = torch.zeros((n,) + src.shape[1:], dtype=src.dtype)
    return out.index_add_(0, seg, src)
def _pad(x, pw):
    flat = tuple(v for pair in reversed(pw) for v in pair)
    return torch.nn.functional.pad(x, flat)

kernel_name = 'standalone__gqa_block_cached__near_ridge'

def setup_inputs():

    _w = (lambda a: (lambda t: t.to(torch.bfloat16) if t.is_floating_point() else t)(torch.as_tensor(a)))
    B, Sq, D = 16, 80, 512
    Hq, Hkv, Sk, Dh = 32, 8, 1024, 128
    assert Hq % Hkv == 0, (Hq, Hkv)
    return {
        "x": _w((lambda *s: torch.randn(*s, dtype=torch.bfloat16) * 0.8)(B, Sq, D)),
        "k_cache": _w((lambda *s: torch.randn(*s, dtype=torch.bfloat16) * 0.8)(B, Hkv, Sk, Dh)),
        "v_cache": _w((lambda *s: torch.randn(*s, dtype=torch.bfloat16) * 0.05)(B, Hkv, Sk, Dh)),
        "wq": _w((lambda *s: torch.randn(*s, dtype=torch.bfloat16) * 0.8)(D, Hq * Dh) * (D ** -0.5)),
        "wo": _w((lambda *s: torch.randn(*s, dtype=torch.bfloat16) * 0.05)(Hq * Dh, D) * ((Hq * Dh) ** -0.5)),
    }

def reference(x, k_cache, v_cache, wq, wo):
    B, Sq, D = x.shape
    Hq, Dh = 32, 128
    Hkv = k_cache.shape[1]
    rep = Hq // Hkv
    q = (lambda x, *d: x.permute(*d))((x @ wq).reshape(B, Sq, Hq, Dh), 0, 2, 1, 3)
    k = (lambda x, n, axis: torch.repeat_interleave(x, n, dim=axis))(k_cache, rep, axis=1)
    v = (lambda x, n, axis: torch.repeat_interleave(x, n, dim=axis))(v_cache, rep, axis=1)
    scores = torch.einsum("bhqd,bhkd->bhqk", q, k) * (Dh ** -0.5)
    p = _softmax(scores, axis=-1)
    o = torch.einsum("bhqk,bhkd->bhqd", p, v)
    return (lambda x, *d: x.permute(*d))(o, 0, 2, 1, 3).reshape(B, Sq, Hq * Dh) @ wo
```

```asm
; @launch kernel=k0_kernel grid=(256,1,1) block=(256,1,1) lds=149504
; @launch kernel=k1_kernel grid=(256,1,1) block=(256,1,1) lds=141312
; @launch kernel=k2_kernel grid=(640,1,1) block=(256,1,1) lds=0
.amdgcn_target "amdgcn-amd-amdhsa--gfx950"
.text
.globl k0_kernel
.p2align 8
.type k0_kernel,@function
k0_kernel:

    s_cmp_ge_u32 s2, 256
    s_cbranch_scc1 k0_kernel_done
    s_load_dwordx2 s[4:5], s[0:1], 0
    s_load_dwordx2 s[6:7], s[0:1], 24
    s_load_dwordx2 s[8:9], s[0:1], 56
    s_and_b32 s29, s2, 7
    s_lshr_b32 s28, s2, 3
    s_and_b32 s30, s28, 1
    s_lshr_b32 s28, s28, 1
    v_and_b32 v1, 63, v0
    v_lshrrev_b32 v2, 6, v0
    s_nop 0
    v_readfirstlane_b32 s31, v2
    s_waitcnt lgkmcnt(0)
    s_mov_b32 s16, s4
    s_mov_b32 s17, s5
    s_mov_b32 s18, 1310720
    s_mov_b32 s19, 0x00020000
    s_mov_b32 s20, s6
    s_mov_b32 s21, s7
    s_mov_b32 s22, 4194304
    s_mov_b32 s23, 0x00020000
    s_mov_b32 s24, s8
    s_mov_b32 s25, s9
    s_mov_b32 s26, 10485760
    s_mov_b32 s27, 0x00020000

    v_lshlrev_b32 v3, 4, v1
    s_mul_i32 s32, s31, 20
    s_mul_i32 s33, s28, 80
    s_add_u32 s33, s33, s32
    s_lshl_b32 s33, s33, 10
    s_mul_i32 s34, s32, 1040
    s_mov_b32 m0, s34
    s_nop 0
    buffer_load_dwordx4 v3, s[16:19], s33 offen lds
    s_add_u32 s33, s33, 1024
    s_add_u32 s34, s34, 1040
    s_mov_b32 m0, s34
    s_nop 0
    buffer_load_dwordx4 v3, s[16:19], s33 offen lds
    s_add_u32 s33, s33, 1024
    s_add_u32 s34, s34, 1040
    s_mov_b32 m0, s34
    s_nop 0
    buffer_load_dwordx4 v3, s[16:19], s33 offen lds
    s_add_u32 s33, s33, 1024
    s_add_u32 s34, s34, 1040
    s_mov_b32 m0, s34
    s_nop 0
    buffer_load_dwordx4 v3, s[16:19], s33 offen lds
    s_add_u32 s33, s33, 1024
    s_add_u32 s34, s34, 1040
    s_mov_b32 m0, s34
    s_nop 0
    buffer_load_dwordx4 v3, s[16:19], s33 offen lds
    s_add_u32 s33, s33, 1024
    s_add_u32 s34, s34, 1040
    s_mov_b32 m0, s34
    s_nop 0
    buffer_load_dwordx4 v3, s[16:19], s33 offen lds
    s_add_u32 s33, s33, 1024
    s_add_u32 s34, s34, 1040
    s_mov_b32 m0, s34
    s_nop 0
    buffer_load_dwordx4 v3, s[16:19], s33 offen lds
    s_add_u32 s33, s33, 1024
    s_add_u32 s34, s34, 1040
    s_mov_b32 m0, s34
    s_nop 0
    buffer_load_dwordx4 v3, s[16:19], s33 offen lds
    s_add_u32 s33, s33, 1024
    s_add_u32 s34, s34, 1040
    s_mov_b32 m0, s34
    s_nop 0
    buffer_load_dwordx4 v3, s[16:19], s33 offen lds
    s_add_u32 s33, s33, 1024
    s_add_u32 s34, s34, 1040
    s_mov_b32 m0, s34
    s_nop 0
    buffer_load_dwordx4 v3, s[16:19], s33 offen lds
    s_add_u32 s33, s33, 1024
    s_add_u32 s34, s34, 1040
    s_mov_b32 m0, s34
    s_nop 0
    buffer_load_dwordx4 v3, s[16:19], s33 offen lds
    s_add_u32 s33, s33, 1024
    s_add_u32 s34, s34, 1040
    s_mov_b32 m0, s34
    s_nop 0
    buffer_load_dwordx4 v3, s[16:19], s33 offen lds
    s_add_u32 s33, s33, 1024
    s_add_u32 s34, s34, 1040
    s_mov_b32 m0, s34
    s_nop 0
    buffer_load_dwordx4 v3, s[16:19], s33 offen lds
    s_add_u32 s33, s33, 1024
    s_add_u32 s34, s34, 1040
    s_mov_b32 m0, s34
    s_nop 0
    buffer_load_dwordx4 v3, s[16:19], s33 offen lds
    s_add_u32 s33, s33, 1024
    s_add_u32 s34, s34, 1040
    s_mov_b32 m0, s34
    s_nop 0
    buffer_load_dwordx4 v3, s[16:19], s33 offen lds
    s_add_u32 s33, s33, 1024
    s_add_u32 s34, s34, 1040
    s_mov_b32 m0, s34
    s_nop 0
    buffer_load_dwordx4 v3, s[16:19], s33 offen lds
    s_add_u32 s33, s33, 1024
    s_add_u32 s34, s34, 1040
    s_mov_b32 m0, s34
    s_nop 0
    buffer_load_dwordx4 v3, s[16:19], s33 offen lds
    s_add_u32 s33, s33, 1024
    s_add_u32 s34, s34, 1040
    s_mov_b32 m0, s34
    s_nop 0
    buffer_load_dwordx4 v3, s[16:19], s33 offen lds
    s_add_u32 s33, s33, 1024
    s_add_u32 s34, s34, 1040
    s_mov_b32 m0, s34
    s_nop 0
    buffer_load_dwordx4 v3, s[16:19], s33 offen lds
    s_add_u32 s33, s33, 1024
    s_add_u32 s34, s34, 1040
    s_mov_b32 m0, s34
    s_nop 0
    buffer_load_dwordx4 v3, s[16:19], s33 offen lds
    s_add_u32 s33, s33, 1024
    s_add_u32 s34, s34, 1040
    v_lshrrev_b32 v4, 3, v1
    v_lshlrev_b32 v4, 13, v4
    v_and_b32 v5, 7, v1
    v_lshrrev_b32 v5, 1, v5
    v_lshrrev_b32 v6, 4, v1
    v_xor_b32 v5, v5, v6
    v_lshlrev_b32 v5, 5, v5
    v_add_u32 v4, v4, v5
    v_and_b32 v5, 1, v1
    v_lshlrev_b32 v5, 4, v5
    v_add_u32 v4, v4, v5

    s_lshl_b32 s35, s29, 2
    s_lshl_b32 s36, s30, 1
    s_add_u32 s35, s35, s36
    s_lshl_b32 s35, s35, 8
    s_lshl_b32 s36, s31, 7
    s_add_u32 s35, s35, s36

    s_lshl_b32 s36, s31, 14
    s_add_u32 s36, s36, 83968
    s_add_u32 s37, s36, 0
    s_mov_b32 m0, s37
    s_add_u32 s38, s35, 0
    buffer_load_dwordx4 v4, s[20:23], s38 offen lds
    s_add_u32 s37, s36, 1024
    s_mov_b32 m0, s37
    s_add_u32 s38, s35, 65536
    buffer_load_dwordx4 v4, s[20:23], s38 offen lds
    s_add_u32 s37, s36, 2048
    s_mov_b32 m0, s37
    s_add_u32 s38, s35, 131072
    buffer_load_dwordx4 v4, s[20:23], s38 offen lds
    s_add_u32 s37, s36, 3072
    s_mov_b32 m0, s37
    s_add_u32 s38, s35, 196608
    buffer_load_dwordx4 v4, s[20:23], s38 offen lds
    s_add_u32 s37, s36, 4096
    s_mov_b32 m0, s37
    s_add_u32 s38, s35, 262144
    buffer_load_dwordx4 v4, s[20:23], s38 offen lds
    s_add_u32 s37, s36, 5120
    s_mov_b32 m0, s37
    s_add_u32 s38, s35, 327680
    buffer_load_dwordx4 v4, s[20:23], s38 offen lds
    s_add_u32 s37, s36, 6144
    s_mov_b32 m0, s37
    s_add_u32 s38, s35, 393216
    buffer_load_dwordx4 v4, s[20:23], s38 offen lds
    s_add_u32 s37, s36, 7168
    s_mov_b32 m0, s37
    s_add_u32 s38, s35, 458752
    buffer_load_dwordx4 v4, s[20:23], s38 offen lds
    s_add_u32 s37, s36, 8192
    s_mov_b32 m0, s37
    s_add_u32 s38, s35, 524288
    buffer_load_dwordx4 v4, s[20:23], s38 offen lds
    s_add_u32 s37, s36, 9216
    s_mov_b32 m0, s37
    s_add_u32 s38, s35, 589824
    buffer_load_dwordx4 v4, s[20:23], s38 offen lds
    s_add_u32 s37, s36, 10240
    s_mov_b32 m0, s37
    s_add_u32 s38, s35, 655360
    buffer_load_dwordx4 v4, s[20:23], s38 offen lds
    s_add_u32 s37, s36, 11264
    s_mov_b32 m0, s37
    s_add_u32 s38, s35, 720896
    buffer_load_dwordx4 v4, s[20:23], s38 offen lds
    v_lshrrev_b32 v5, 4, v1
    v_and_b32 v6, 15, v1
    v_lshrrev_b32 v7, 2, v6
    v_and_b32 v12, 3, v6
    v_lshlrev_b32 v13, 2, v5
    v_add_u32 v13, v13, v7
    v_lshrrev_b32 v14, 1, v13
    v_and_b32 v14, 3, v14
    v_lshlrev_b32 v13, 7, v13
    v_lshlrev_b32 v12, 3, v12
    v_add_u32 v13, v13, v12
    v_lshlrev_b32 v14, 5, v14
    v_add_u32 v13, v13, v14
    v_add_u32 v8, s36, v13
    v_xor_b32 v9, 32, v8
    v_xor_b32 v10, 64, v8
    v_xor_b32 v11, 96, v8

    v_mov_b32 v15, 1040
    v_mul_lo_u32 v16, v6, v15
    v_lshlrev_b32 v12, 3, v5
    v_add_u32 v16, v16, v12
    v_add_u32 v17, 16640, v16
    v_add_u32 v18, 33280, v16
    v_add_u32 v19, 49920, v16
    v_add_u32 v20, 66560, v16

    v_mov_b32 v128, 0
    v_mov_b32 v129, 0
    v_mov_b32 v130, 0
    v_mov_b32 v131, 0
    v_mov_b32 v132, 0
    v_mov_b32 v133, 0
    v_mov_b32 v134, 0
    v_mov_b32 v135, 0
    v_mov_b32 v136, 0
    v_mov_b32 v137, 0
    v_mov_b32 v138, 0
    v_mov_b32 v139, 0
    v_mov_b32 v140, 0
    v_mov_b32 v141, 0
    v_mov_b32 v142, 0
    v_mov_b32 v143, 0
    v_mov_b32 v144, 0
    v_mov_b32 v145, 0
    v_mov_b32 v146, 0
    v_mov_b32 v147, 0
    v_mov_b32 v148, 0
    v_mov_b32 v149, 0
    v_mov_b32 v150, 0
    v_mov_b32 v151, 0
    v_mov_b32 v152, 0
    v_mov_b32 v153, 0
    v_mov_b32 v154, 0
    v_mov_b32 v155, 0
    v_mov_b32 v156, 0
    v_mov_b32 v157, 0
    v_mov_b32 v158, 0
    v_mov_b32 v159, 0
    v_mov_b32 v160, 0
    v_mov_b32 v161, 0
    v_mov_b32 v162, 0
    v_mov_b32 v163, 0
    v_mov_b32 v164, 0
    v_mov_b32 v165, 0
    v_mov_b32 v166, 0
    v_mov_b32 v167, 0
    v_mov_b32 v168, 0
    v_mov_b32 v169, 0
    v_mov_b32 v170, 0
    v_mov_b32 v171, 0
    v_mov_b32 v172, 0
    v_mov_b32 v173, 0
    v_mov_b32 v174, 0
    v_mov_b32 v175, 0
    v_mov_b32 v176, 0
    v_mov_b32 v177, 0
    v_mov_b32 v178, 0
    v_mov_b32 v179, 0
    v_mov_b32 v180, 0
    v_mov_b32 v181, 0
    v_mov_b32 v182, 0
    v_mov_b32 v183, 0
    v_mov_b32 v184, 0
    v_mov_b32 v185, 0
    v_mov_b32 v186, 0
    v_mov_b32 v187, 0
    v_mov_b32 v188, 0
    v_mov_b32 v189, 0
    v_mov_b32 v190, 0
    v_mov_b32 v191, 0
    v_mov_b32 v192, 0
    v_mov_b32 v193, 0
    v_mov_b32 v194, 0
    v_mov_b32 v195, 0
    v_mov_b32 v196, 0
    v_mov_b32 v197, 0
    v_mov_b32 v198, 0
    v_mov_b32 v199, 0
    v_mov_b32 v200, 0
    v_mov_b32 v201, 0
    v_mov_b32 v202, 0
    v_mov_b32 v203, 0
    v_mov_b32 v204, 0
    v_mov_b32 v205, 0
    v_mov_b32 v206, 0
    v_mov_b32 v207, 0
    s_waitcnt vmcnt(8)
    s_barrier
    ds_read_b64_tr_b16 v[32:33], v8 offset:0
    ds_read_b64_tr_b16 v[34:35], v8 offset:2048
    ds_read_b64_tr_b16 v[36:37], v9 offset:0
    ds_read_b64_tr_b16 v[38:39], v9 offset:2048
    ds_read_b64_tr_b16 v[40:41], v10 offset:0
    ds_read_b64_tr_b16 v[42:43], v10 offset:2048
    ds_read_b64_tr_b16 v[44:45], v11 offset:0
    ds_read_b64_tr_b16 v[46:47], v11 offset:2048
    ds_read2_b64 v[64:67], v16 offset0:0 offset1:4
    ds_read2_b64 v[68:71], v17 offset0:0 offset1:4
    ds_read2_b64 v[72:75], v18 offset0:0 offset1:4
    ds_read2_b64 v[76:79], v19 offset0:0 offset1:4
    ds_read2_b64 v[80:83], v20 offset0:0 offset1:4
    s_waitcnt vmcnt(4)
    ds_read_b64_tr_b16 v[48:49], v8 offset:4096
    ds_read_b64_tr_b16 v[50:51], v8 offset:6144
    ds_read_b64_tr_b16 v[52:53], v9 offset:4096
    ds_read_b64_tr_b16 v[54:55], v9 offset:6144
    ds_read_b64_tr_b16 v[56:57], v10 offset:4096
    ds_read_b64_tr_b16 v[58:59], v10 offset:6144
    ds_read_b64_tr_b16 v[60:61], v11 offset:4096
    ds_read_b64_tr_b16 v[62:63], v11 offset:6144
    ds_read2_b64 v[84:87], v16 offset0:8 offset1:12
    ds_read2_b64 v[88:91], v17 offset0:8 offset1:12
    ds_read2_b64 v[92:95], v18 offset0:8 offset1:12
    ds_read2_b64 v[96:99], v19 offset0:8 offset1:12
    ds_read2_b64 v[100:103], v20 offset0:8 offset1:12
    s_waitcnt lgkmcnt(13)
    s_add_u32 s37, s36, 12288
    s_mov_b32 m0, s37
    s_add_u32 s38, s35, 786432
    buffer_load_dwordx4 v4, s[20:23], s38 offen lds
    s_add_u32 s37, s36, 13312
    s_mov_b32 m0, s37
    s_add_u32 s38, s35, 851968
    buffer_load_dwordx4 v4, s[20:23], s38 offen lds
    s_add_u32 s37, s36, 14336
    s_mov_b32 m0, s37
    s_add_u32 s38, s35, 917504
    buffer_load_dwordx4 v4, s[20:23], s38 offen lds
    s_add_u32 s37, s36, 15360
    s_mov_b32 m0, s37
    s_add_u32 s38, s35, 983040
    buffer_load_dwordx4 v4, s[20:23], s38 offen lds
    v_mfma_f32_16x16x32_bf16 v[128:131], v[32:35], v[64:67], v[128:131]
    v_mfma_f32_16x16x32_bf16 v[132:135], v[32:35], v[68:71], v[132:135]
    v_mfma_f32_16x16x32_bf16 v[136:139], v[32:35], v[72:75], v[136:139]
    v_mfma_f32_16x16x32_bf16 v[140:143], v[32:35], v[76:79], v[140:143]
    v_mfma_f32_16x16x32_bf16 v[144:147], v[32:35], v[80:83], v[144:147]
    v_mfma_f32_16x16x32_bf16 v[148:151], v[36:39], v[64:67], v[148:151]
    v_mfma_f32_16x16x32_bf16 v[152:155], v[36:39], v[68:71], v[152:155]
    v_mfma_f32_16x16x32_bf16 v[156:159], v[36:39], v[72:75], v[156:159]
    v_mfma_f32_16x16x32_bf16 v[160:163], v[36:39], v[76:79], v[160:163]
    v_mfma_f32_16x16x32_bf16 v[164:167], v[36:39], v[80:83], v[164:167]
    v_mfma_f32_16x16x32_bf16 v[168:171], v[40:43], v[64:67], v[168:171]
    v_mfma_f32_16x16x32_bf16 v[172:175], v[40:43], v[68:71], v[172:175]
    v_mfma_f32_16x16x32_bf16 v[176:179], v[40:43], v[72:75], v[176:179]
    v_mfma_f32_16x16x32_bf16 v[180:183], v[40:43], v[76:79], v[180:183]
    v_mfma_f32_16x16x32_bf16 v[184:187], v[40:43], v[80:83], v[184:187]
    v_mfma_f32_16x16x32_bf16 v[188:191], v[44:47], v[64:67], v[188:191]
    v_mfma_f32_16x16x32_bf16 v[192:195], v[44:47], v[68:71], v[192:195]
    v_mfma_f32_16x16x32_bf16 v[196:199], v[44:47], v[72:75], v[196:199]
    v_mfma_f32_16x16x32_bf16 v[200:203], v[44:47], v[76:79], v[200:203]
    v_mfma_f32_16x16x32_bf16 v[204:207], v[44:47], v[80:83], v[204:207]
    s_waitcnt vmcnt(4)
    ds_read_b64_tr_b16 v[32:33], v8 offset:8192
    ds_read_b64_tr_b16 v[34:35], v8 offset:10240
    ds_read_b64_tr_b16 v[36:37], v9 offset:8192
    ds_read_b64_tr_b16 v[38:39], v9 offset:10240
    ds_read_b64_tr_b16 v[40:41], v10 offset:8192
    ds_read_b64_tr_b16 v[42:43], v10 offset:10240
    ds_read_b64_tr_b16 v[44:45], v11 offset:8192
    ds_read_b64_tr_b16 v[46:47], v11 offset:10240
    ds_read2_b64 v[64:67], v16 offset0:16 offset1:20
    ds_read2_b64 v[68:71], v17 offset0:16 offset1:20
    ds_read2_b64 v[72:75], v18 offset0:16 offset1:20
    ds_read2_b64 v[76:79], v19 offset0:16 offset1:20
    ds_read2_b64 v[80:83], v20 offset0:16 offset1:20
    s_waitcnt lgkmcnt(13)
    s_add_u32 s37, s36, 0
    s_mov_b32 m0, s37
    s_add_u32 s38, s35, 1048576
    buffer_load_dwordx4 v4, s[20:23], s38 offen lds
    s_add_u32 s37, s36, 1024
    s_mov_b32 m0, s37
    s_add_u32 s38, s35, 1114112
    buffer_load_dwordx4 v4, s[20:23], s38 offen lds
    s_add_u32 s37, s36, 2048
    s_mov_b32 m0, s37
    s_add_u32 s38, s35, 1179648
    buffer_load_dwordx4 v4, s[20:23], s38 offen lds
    s_add_u32 s37, s36, 3072
    s_mov_b32 m0, s37
    s_add_u32 s38, s35, 1245184
    buffer_load_dwordx4 v4, s[20:23], s38 offen lds
    v_mfma_f32_16x16x32_bf16 v[128:131], v[48:51], v[84:87], v[128:131]
    v_mfma_f32_16x16x32_bf16 v[132:135], v[48:51], v[88:91], v[132:135]
    v_mfma_f32_16x16x32_bf16 v[136:139], v[48:51], v[92:95], v[136:139]
    v_mfma_f32_16x16x32_bf16 v[140:143], v[48:51], v[96:99], v[140:143]
    v_mfma_f32_16x16x32_bf16 v[144:147], v[48:51], v[100:103], v[144:147]
    v_mfma_f32_16x16x32_bf16 v[148:151], v[52:55], v[84:87], v[148:151]
    v_mfma_f32_16x16x32_bf16 v[152:155], v[52:55], v[88:91], v[152:155]
    v_mfma_f32_16x16x32_bf16 v[156:159], v[52:55], v[92:95], v[156:159]
    v_mfma_f32_16x16x32_bf16 v[160:163], v[52:55], v[96:99], v[160:163]
    v_mfma_f32_16x16x32_bf16 v[164:167], v[52:55], v[100:103], v[164:167]
    v_mfma_f32_16x16x32_bf16 v[168:171], v[56:59], v[84:87], v[168:171]
    v_mfma_f32_16x16x32_bf16 v[172:175], v[56:59], v[88:91], v[172:175]
    v_mfma_f32_16x16x32_bf16 v[176:179], v[56:59], v[92:95], v[176:179]
    v_mfma_f32_16x16x32_bf16 v[180:183], v[56:59], v[96:99], v[180:183]
    v_mfma_f32_16x16x32_bf16 v[184:187], v[56:59], v[100:103], v[184:187]
    v_mfma_f32_16x16x32_bf16 v[188:191], v[60:63], v[84:87], v[188:191]
    v_mfma_f32_16x16x32_bf16 v[192:195], v[60:63], v[88:91], v[192:195]
    v_mfma_f32_16x16x32_bf16 v[196:199], v[60:63], v[92:95], v[196:199]
    v_mfma_f32_16x16x32_bf16 v[200:203], v[60:63], v[96:99], v[200:203]
    v_mfma_f32_16x16x32_bf16 v[204:207], v[60:63], v[100:103], v[204:207]
    s_waitcnt vmcnt(4)
    ds_read_b64_tr_b16 v[48:49], v8 offset:12288
    ds_read_b64_tr_b16 v[50:51], v8 offset:14336
    ds_read_b64_tr_b16 v[52:53], v9 offset:12288
    ds_read_b64_tr_b16 v[54:55], v9 offset:14336
    ds_read_b64_tr_b16 v[56:57], v10 offset:12288
    ds_read_b64_tr_b16 v[58:59], v10 offset:14336
    ds_read_b64_tr_b16 v[60:61], v11 offset:12288
    ds_read_b64_tr_b16 v[62:63], v11 offset:14336
    ds_read2_b64 v[84:87], v16 offset0:24 offset1:28
    ds_read2_b64 v[88:91], v17 offset0:24 offset1:28
    ds_read2_b64 v[92:95], v18 offset0:24 offset1:28
    ds_read2_b64 v[96:99], v19 offset0:24 offset1:28
    ds_read2_b64 v[100:103], v20 offset0:24 offset1:28
    s_waitcnt lgkmcnt(13)
    s_add_u32 s37, s36, 4096
    s_mov_b32 m0, s37
    s_add_u32 s38, s35, 1310720
    buffer_load_dwordx4 v4, s[20:23], s38 offen lds
    s_add_u32 s37, s36, 5120
    s_mov_b32 m0, s37
    s_add_u32 s38, s35, 1376256
    buffer_load_dwordx4 v4, s[20:23], s38 offen lds
    s_add_u32 s37, s36, 6144
    s_mov_b32 m0, s37
    s_add_u32 s38, s35, 1441792
    buffer_load_dwordx4 v4, s[20:23], s38 offen lds
    s_add_u32 s37, s36, 7168
    s_mov_b32 m0, s37
    s_add_u32 s38, s35, 1507328
    buffer_load_dwordx4 v4, s[20:23], s38 offen lds
    v_mfma_f32_16x16x32_bf16 v[128:131], v[32:35], v[64:67], v[128:131]
    v_mfma_f32_16x16x32_bf16 v[132:135], v[32:35], v[68:71], v[132:135]
    v_mfma_f32_16x16x32_bf16 v[136:139], v[32:35], v[72:75], v[136:139]
    v_mfma_f32_16x16x32_bf16 v[140:143], v[32:35], v[76:79], v[140:143]
    v_mfma_f32_16x16x32_bf16 v[144:147], v[32:35], v[80:83], v[144:147]
    v_mfma_f32_16x16x32_bf16 v[148:151], v[36:39], v[64:67], v[148:151]
    v_mfma_f32_16x16x32_bf16 v[152:155], v[36:39], v[68:71], v[152:155]
    v_mfma_f32_16x16x32_bf16 v[156:159], v[36:39], v[72:75], v[156:159]
    v_mfma_f32_16x16x32_bf16 v[160:163], v[36:39], v[76:79], v[160:163]
    v_mfma_f32_16x16x32_bf16 v[164:167], v[36:39], v[80:83], v[164:167]
    v_mfma_f32_16x16x32_bf16 v[168:171], v[40:43], v[64:67], v[168:171]
    v_mfma_f32_16x16x32_bf16 v[172:175], v[40:43], v[68:71], v[172:175]
    v_mfma_f32_16x16x32_bf16 v[176:179], v[40:43], v[72:75], v[176:179]
    v_mfma_f32_16x16x32_bf16 v[180:183], v[40:43], v[76:79], v[180:183]
    v_mfma_f32_16x16x32_bf16 v[184:187], v[40:43], v[80:83], v[184:187]
    v_mfma_f32_16x16x32_bf16 v[188:191], v[44:47], v[64:67], v[188:191]
    v_mfma_f32_16x16x32_bf16 v[192:195], v[44:47], v[68:71], v[192:195]
    v_mfma_f32_16x16x32_bf16 v[196:199], v[44:47], v[72:75], v[196:199]
    v_mfma_f32_16x16x32_bf16 v[200:203], v[44:47], v[76:79], v[200:203]
    v_mfma_f32_16x16x32_bf16 v[204:207], v[44:47], v[80:83], v[204:207]
    s_waitcnt vmcnt(4)
    ds_read_b64_tr_b16 v[32:33], v8 offset:0
    ds_read_b64_tr_b16 v[34:35], v8 offset:2048
    ds_read_b64_tr_b16 v[36:37], v9 offset:0
    ds_read_b64_tr_b16 v[38:39], v9 offset:2048
    ds_read_b64_tr_b16 v[40:41], v10 offset:0
    ds_read_b64_tr_b16 v[42:43], v10 offset:2048
    ds_read_b64_tr_b16 v[44:45], v11 offset:0
    ds_read_b64_tr_b16 v[46:47], v11 offset:2048
    ds_read2_b64 v[64:67], v16 offset0:32 offset1:36
    ds_read2_b64 v[68:71], v17 offset0:32 offset1:36
    ds_read2_b64 v[72:75], v18 offset0:32 offset1:36
    ds_read2_b64 v[76:79], v19 offset0:32 offset1:36
    ds_read2_b64 v[80:83], v20 offset0:32 offset1:36
    s_waitcnt lgkmcnt(13)
    s_add_u32 s37, s36, 8192
    s_mov_b32 m0, s37
    s_add_u32 s38, s35, 1572864
    buffer_load_dwordx4 v4, s[20:23], s38 offen lds
    s_add_u32 s37, s36, 9216
    s_mov_b32 m0, s37
    s_add_u32 s38, s35, 1638400
    buffer_load_dwordx4 v4, s[20:23], s38 offen lds
    s_add_u32 s37, s36, 10240
    s_mov_b32 m0, s37
    s_add_u32 s38, s35, 1703936
    buffer_load_dwordx4 v4, s[20:23], s38 offen lds
    s_add_u32 s37, s36, 11264
    s_mov_b32 m0, s37
    s_add_u32 s38, s35, 1769472
    buffer_load_dwordx4 v4, s[20:23], s38 offen lds
    v_mfma_f32_16x16x32_bf16 v[128:131], v[48:51], v[84:87], v[128:131]
    v_mfma_f32_16x16x32_bf16 v[132:135], v[48:51], v[88:91], v[132:135]
    v_mfma_f32_16x16x32_bf16 v[136:139], v[48:51], v[92:95], v[136:139]
    v_mfma_f32_16x16x32_bf16 v[140:143], v[48:51], v[96:99], v[140:143]
    v_mfma_f32_16x16x32_bf16 v[144:147], v[48:51], v[100:103], v[144:147]
    v_mfma_f32_16x16x32_bf16 v[148:151], v[52:55], v[84:87], v[148:151]
    v_mfma_f32_16x16x32_bf16 v[152:155], v[52:55], v[88:91], v[152:155]
    v_mfma_f32_16x16x32_bf16 v[156:159], v[52:55], v[92:95], v[156:159]
    v_mfma_f32_16x16x32_bf16 v[160:163], v[52:55], v[96:99], v[160:163]
    v_mfma_f32_16x16x32_bf16 v[164:167], v[52:55], v[100:103], v[164:167]
    v_mfma_f32_16x16x32_bf16 v[168:171], v[56:59], v[84:87], v[168:171]
    v_mfma_f32_16x16x32_bf16 v[172:175], v[56:59], v[88:91], v[172:175]
    v_mfma_f32_16x16x32_bf16 v[176:179], v[56:59], v[92:95], v[176:179]
    v_mfma_f32_16x16x32_bf16 v[180:183], v[56:59], v[96:99], v[180:183]
    v_mfma_f32_16x16x32_bf16 v[184:187], v[56:59], v[100:103], v[184:187]
    v_mfma_f32_16x16x32_bf16 v[188:191], v[60:63], v[84:87], v[188:191]
    v_mfma_f32_16x16x32_bf16 v[192:195], v[60:63], v[88:91], v[192:195]
    v_mfma_f32_16x16x32_bf16 v[196:199], v[60:63], v[92:95], v[196:199]
    v_mfma_f32_16x16x32_bf16 v[200:203], v[60:63], v[96:99], v[200:203]
    v_mfma_f32_16x16x32_bf16 v[204:207], v[60:63], v[100:103], v[204:207]
    s_waitcnt vmcnt(4)
    ds_read_b64_tr_b16 v[48:49], v8 offset:4096
    ds_read_b64_tr_b16 v[50:51], v8 offset:6144
    ds_read_b64_tr_b16 v[52:53], v9 offset:4096
    ds_read_b64_tr_b16 v[54:55], v9 offset:6144
    ds_read_b64_tr_b16 v[56:57], v10 offset:4096
    ds_read_b64_tr_b16 v[58:59], v10 offset:6144
    ds_read_b64_tr_b16 v[60:61], v11 offset:4096
    ds_read_b64_tr_b16 v[62:63], v11 offset:6144
    ds_read2_b64 v[84:87], v16 offset0:40 offset1:44
    ds_read2_b64 v[88:91], v17 offset0:40 offset1:44
    ds_read2_b64 v[92:95], v18 offset0:40 offset1:44
    ds_read2_b64 v[96:99], v19 offset0:40 offset1:44
    ds_read2_b64 v[100:103], v20 offset0:40 offset1:44
    s_waitcnt lgkmcnt(13)
    s_add_u32 s37, s36, 12288
    s_mov_b32 m0, s37
    s_add_u32 s38, s35, 1835008
    buffer_load_dwordx4 v4, s[20:23], s38 offen lds
    s_add_u32 s37, s36, 13312
    s_mov_b32 m0, s37
    s_add_u32 s38, s35, 1900544
    buffer_load_dwordx4 v4, s[20:23], s38 offen lds
    s_add_u32 s37, s36, 14336
    s_mov_b32 m0, s37
    s_add_u32 s38, s35, 1966080
    buffer_load_dwordx4 v4, s[20:23], s38 offen lds
    s_add_u32 s37, s36, 15360
    s_mov_b32 m0, s37
    s_add_u32 s38, s35, 2031616
    buffer_load_dwordx4 v4, s[20:23], s38 offen lds
    v_mfma_f32_16x16x32_bf16 v[128:131], v[32:35], v[64:67], v[128:131]
    v_mfma_f32_16x16x32_bf16 v[132:135], v[32:35], v[68:71], v[132:135]
    v_mfma_f32_16x16x32_bf16 v[136:139], v[32:35], v[72:75], v[136:139]
    v_mfma_f32_16x16x32_bf16 v[140:143], v[32:35], v[76:79], v[140:143]
    v_mfma_f32_16x16x32_bf16 v[144:147], v[32:35], v[80:83], v[144:147]
    v_mfma_f32_16x16x32_bf16 v[148:151], v[36:39], v[64:67], v[148:151]
    v_mfma_f32_16x16x32_bf16 v[152:155], v[36:39], v[68:71], v[152:155]
    v_mfma_f32_16x16x32_bf16 v[156:159], v[36:39], v[72:75], v[156:159]
    v_mfma_f32_16x16x32_bf16 v[160:163], v[36:39], v[76:79], v[160:163]
    v_mfma_f32_16x16x32_bf16 v[164:167], v[36:39], v[80:83], v[164:167]
    v_mfma_f32_16x16x32_bf16 v[168:171], v[40:43], v[64:67], v[168:171]
    v_mfma_f32_16x16x32_bf16 v[172:175], v[40:43], v[68:71], v[172:175]
    v_mfma_f32_16x16x32_bf16 v[176:179], v[40:43], v[72:75], v[176:179]
    v_mfma_f32_16x16x32_bf16 v[180:183], v[40:43], v[76:79], v[180:183]
    v_mfma_f32_16x16x32_bf16 v[184:187], v[40:43], v[80:83], v[184:187]
    v_mfma_f32_16x16x32_bf16 v[188:191], v[44:47], v[64:67], v[188:191]
    v_mfma_f32_16x16x32_bf16 v[192:195], v[44:47], v[68:71], v[192:195]
    v_mfma_f32_16x16x32_bf16 v[196:199], v[44:47], v[72:75], v[196:199]
    v_mfma_f32_16x16x32_bf16 v[200:203], v[44:47], v[76:79], v[200:203]
    v_mfma_f32_16x16x32_bf16 v[204:207], v[44:47], v[80:83], v[204:207]
    s_waitcnt vmcnt(4)
    ds_read_b64_tr_b16 v[32:33], v8 offset:8192
    ds_read_b64_tr_b16 v[34:35], v8 offset:10240
    ds_read_b64_tr_b16 v[36:37], v9 offset:8192
    ds_read_b64_tr_b16 v[38:39], v9 offset:10240
    ds_read_b64_tr_b16 v[40:41], v10 offset:8192
    ds_read_b64_tr_b16 v[42:43], v10 offset:10240
    ds_read_b64_tr_b16 v[44:45], v11 offset:8192
    ds_read_b64_tr_b16 v[46:47], v11 offset:10240
    ds_read2_b64 v[64:67], v16 offset0:48 offset1:52
    ds_read2_b64 v[68:71], v17 offset0:48 offset1:52
    ds_read2_b64 v[72:75], v18 offset0:48 offset1:52
    ds_read2_b64 v[76:79], v19 offset0:48 offset1:52
    ds_read2_b64 v[80:83], v20 offset0:48 offset1:52
    s_waitcnt lgkmcnt(13)
    s_add_u32 s37, s36, 0
    s_mov_b32 m0, s37
    s_add_u32 s38, s35, 2097152
    buffer_load_dwordx4 v4, s[20:23], s38 offen lds
    s_add_u32 s37, s36, 1024
    s_mov_b32 m0, s37
    s_add_u32 s38, s35, 2162688
    buffer_load_dwordx4 v4, s[20:23], s38 offen lds
    s_add_u32 s37, s36, 2048
    s_mov_b32 m0, s37
    s_add_u32 s38, s35, 2228224
    buffer_load_dwordx4 v4, s[20:23], s38 offen lds
    s_add_u32 s37, s36, 3072
    s_mov_b32 m0, s37
    s_add_u32 s38, s35, 2293760
    buffer_load_dwordx4 v4, s[20:23], s38 offen lds
    v_mfma_f32_16x16x32_bf16 v[128:131], v[48:51], v[84:87], v[128:131]
    v_mfma_f32_16x16x32_bf16 v[132:135], v[48:51], v[88:91], v[132:135]
    v_mfma_f32_16x16x32_bf16 v[136:139], v[48:51], v[92:95], v[136:139]
    v_mfma_f32_16x16x32_bf16 v[140:143], v[48:51], v[96:99], v[140:143]
    v_mfma_f32_16x16x32_bf16 v[144:147], v[48:51], v[100:103], v[144:147]
    v_mfma_f32_16x16x32_bf16 v[148:151], v[52:55], v[84:87], v[148:151]
    v_mfma_f32_16x16x32_bf16 v[152:155], v[52:55], v[88:91], v[152:155]
    v_mfma_f32_16x16x32_bf16 v[156:159], v[52:55], v[92:95], v[156:159]
    v_mfma_f32_16x16x32_bf16 v[160:163], v[52:55], v[96:99], v[160:163]
    v_mfma_f32_16x16x32_bf16 v[164:167], v[52:55], v[100:103], v[164:167]
    v_mfma_f32_16x16x32_bf16 v[168:171], v[56:59], v[84:87], v[168:171]
    v_mfma_f32_16x16x32_bf16 v[172:175], v[56:59], v[88:91], v[172:175]
    v_mfma_f32_16x16x32_bf16 v[176:179], v[56:59], v[92:95], v[176:179]
    v_mfma_f32_16x16x32_bf16 v[180:183], v[56:59], v[96:99], v[180:183]
    v_mfma_f32_16x16x32_bf16 v[184:187], v[56:59], v[100:103], v[184:187]
    v_mfma_f32_16x16x32_bf16 v[188:191], v[60:63], v[84:87], v[188:191]
    v_mfma_f32_16x16x32_bf16 v[192:195], v[60:63], v[88:91], v[192:195]
    v_mfma_f32_16x16x32_bf16 v[196:199], v[60:63], v[92:95], v[196:199]
    v_mfma_f32_16x16x32_bf16 v[200:203], v[60:63], v[96:99], v[200:203]
    v_mfma_f32_16x16x32_bf16 v[204:207], v[60:63], v[100:103], v[204:207]
    s_waitcnt vmcnt(4)
    ds_read_b64_tr_b16 v[48:49], v8 offset:12288
    ds_read_b64_tr_b16 v[50:51], v8 offset:14336
    ds_read_b64_tr_b16 v[52:53], v9 offset:12288
    ds_read_b64_tr_b16 v[54:55], v9 offset:14336
    ds_read_b64_tr_b16 v[56:57], v10 offset:12288
    ds_read_b64_tr_b16 v[58:59], v10 offset:14336
    ds_read_b64_tr_b16 v[60:61], v11 offset:12288
    ds_read_b64_tr_b16 v[62:63], v11 offset:14336
    ds_read2_b64 v[84:87], v16 offset0:56 offset1:60
    ds_read2_b64 v[88:91], v17 offset0:56 offset1:60
    ds_read2_b64 v[92:95], v18 offset0:56 offset1:60
    ds_read2_b64 v[96:99], v19 offset0:56 offset1:60
    ds_read2_b64 v[100:103], v20 offset0:56 offset1:60
    s_waitcnt lgkmcnt(13)
    s_add_u32 s37, s36, 4096
    s_mov_b32 m0, s37
    s_add_u32 s38, s35, 2359296
    buffer_load_dwordx4 v4, s[20:23], s38 offen lds
    s_add_u32 s37, s36, 5120
    s_mov_b32 m0, s37
    s_add_u32 s38, s35, 2424832
    buffer_load_dwordx4 v4, s[20:23], s38 offen lds
    s_add_u32 s37, s36, 6144
    s_mov_b32 m0, s37
    s_add_u32 s38, s35, 2490368
    buffer_load_dwordx4 v4, s[20:23], s38 offen lds
    s_add_u32 s37, s36, 7168
    s_mov_b32 m0, s37
    s_add_u32 s38, s35, 2555904
    buffer_load_dwordx4 v4, s[20:23], s38 offen lds
    v_mfma_f32_16x16x32_bf16 v[128:131], v[32:35], v[64:67], v[128:131]
    v_mfma_f32_16x16x32_bf16 v[132:135], v[32:35], v[68:71], v[132:135]
    v_mfma_f32_16x16x32_bf16 v[136:139], v[32:35], v[72:75], v[136:139]
    v_mfma_f32_16x16x32_bf16 v[140:143], v[32:35], v[76:79], v[140:143]
    v_mfma_f32_16x16x32_bf16 v[144:147], v[32:35], v[80:83], v[144:147]
    v_mfma_f32_16x16x32_bf16 v[148:151], v[36:39], v[64:67], v[148:151]
    v_mfma_f32_16x16x32_bf16 v[152:155], v[36:39], v[68:71], v[152:155]
    v_mfma_f32_16x16x32_bf16 v[156:159], v[36:39], v[72:75], v[156:159]
    v_mfma_f32_16x16x32_bf16 v[160:163], v[36:39], v[76:79], v[160:163]
    v_mfma_f32_16x16x32_bf16 v[164:167], v[36:39], v[80:83], v[164:167]
    v_mfma_f32_16x16x32_bf16 v[168:171], v[40:43], v[64:67], v[168:171]
    v_mfma_f32_16x16x32_bf16 v[172:175], v[40:43], v[68:71], v[172:175]
    v_mfma_f32_16x16x32_bf16 v[176:179], v[40:43], v[72:75], v[176:179]
    v_mfma_f32_16x16x32_bf16 v[180:183], v[40:43], v[76:79], v[180:183]
    v_mfma_f32_16x16x32_bf16 v[184:187], v[40:43], v[80:83], v[184:187]
    v_mfma_f32_16x16x32_bf16 v[188:191], v[44:47], v[64:67], v[188:191]
    v_mfma_f32_16x16x32_bf16 v[192:195], v[44:47], v[68:71], v[192:195]
    v_mfma_f32_16x16x32_bf16 v[196:199], v[44:47], v[72:75], v[196:199]
    v_mfma_f32_16x16x32_bf16 v[200:203], v[44:47], v[76:79], v[200:203]
    v_mfma_f32_16x16x32_bf16 v[204:207], v[44:47], v[80:83], v[204:207]
    s_waitcnt vmcnt(4)
    ds_read_b64_tr_b16 v[32:33], v8 offset:0
    ds_read_b64_tr_b16 v[34:35], v8 offset:2048
    ds_read_b64_tr_b16 v[36:37], v9 offset:0
    ds_read_b64_tr_b16 v[38:39], v9 offset:2048
    ds_read_b64_tr_b16 v[40:41], v10 offset:0
    ds_read_b64_tr_b16 v[42:43], v10 offset:2048
    ds_read_b64_tr_b16 v[44:45], v11 offset:0
    ds_read_b64_tr_b16 v[46:47], v11 offset:2048
    ds_read2_b64 v[64:67], v16 offset0:64 offset1:68
    ds_read2_b64 v[68:71], v17 offset0:64 offset1:68
    ds_read2_b64 v[72:75], v18 offset0:64 offset1:68
    ds_read2_b64 v[76:79], v19 offset0:64 offset1:68
    ds_read2_b64 v[80:83], v20 offset0:64 offset1:68
    s_waitcnt lgkmcnt(13)
    s_add_u32 s37, s36, 8192
    s_mov_b32 m0, s37
    s_add_u32 s38, s35, 2621440
    buffer_load_dwordx4 v4, s[20:23], s38 offen lds
    s_add_u32 s37, s36, 9216
    s_mov_b32 m0, s37
    s_add_u32 s38, s35, 2686976
    buffer_load_dwordx4 v4, s[20:23], s38 offen lds
    s_add_u32 s37, s36, 10240
    s_mov_b32 m0, s37
    s_add_u32 s38, s35, 2752512
    buffer_load_dwordx4 v4, s[20:23], s38 offen lds
    s_add_u32 s37, s36, 11264
    s_mov_b32 m0, s37
    s_add_u32 s38, s35, 2818048
    buffer_load_dwordx4 v4, s[20:23], s38 offen lds
    v_mfma_f32_16x16x32_bf16 v[128:131], v[48:51], v[84:87], v[128:131]
    v_mfma_f32_16x16x32_bf16 v[132:135], v[48:51], v[88:91], v[132:135]
    v_mfma_f32_16x16x32_bf16 v[136:139], v[48:51], v[92:95], v[136:139]
    v_mfma_f32_16x16x32_bf16 v[140:143], v[48:51], v[96:99], v[140:143]
    v_mfma_f32_16x16x32_bf16 v[144:147], v[48:51], v[100:103], v[144:147]
    v_mfma_f32_16x16x32_bf16 v[148:151], v[52:55], v[84:87], v[148:151]
    v_mfma_f32_16x16x32_bf16 v[152:155], v[52:55], v[88:91], v[152:155]
    v_mfma_f32_16x16x32_bf16 v[156:159], v[52:55], v[92:95], v[156:159]
    v_mfma_f32_16x16x32_bf16 v[160:163], v[52:55], v[96:99], v[160:163]
    v_mfma_f32_16x16x32_bf16 v[164:167], v[52:55], v[100:103], v[164:167]
    v_mfma_f32_16x16x32_bf16 v[168:171], v[56:59], v[84:87], v[168:171]
    v_mfma_f32_16x16x32_bf16 v[172:175], v[56:59], v[88:91], v[172:175]
    v_mfma_f32_16x16x32_bf16 v[176:179], v[56:59], v[92:95], v[176:179]
    v_mfma_f32_16x16x32_bf16 v[180:183], v[56:59], v[96:99], v[180:183]
    v_mfma_f32_16x16x32_bf16 v[184:187], v[56:59], v[100:103], v[184:187]
    v_mfma_f32_16x16x32_bf16 v[188:191], v[60:63], v[84:87], v[188:191]
    v_mfma_f32_16x16x32_bf16 v[192:195], v[60:63], v[88:91], v[192:195]
    v_mfma_f32_16x16x32_bf16 v[196:199], v[60:63], v[92:95], v[196:199]
    v_mfma_f32_16x16x32_bf16 v[200:203], v[60:63], v[96:99], v[200:203]
    v_mfma_f32_16x16x32_bf16 v[204:207], v[60:63], v[100:103], v[204:207]
    s_waitcnt vmcnt(4)
    ds_read_b64_tr_b16 v[48:49], v8 offset:4096
    ds_read_b64_tr_b16 v[50:51], v8 offset:6144
    ds_read_b64_tr_b16 v[52:53], v9 offset:4096
    ds_read_b64_tr_b16 v[54:55], v9 offset:6144
    ds_read_b64_tr_b16 v[56:57], v10 offset:4096
    ds_read_b64_tr_b16 v[58:59], v10 offset:6144
    ds_read_b64_tr_b16 v[60:61], v11 offset:4096
    ds_read_b64_tr_b16 v[62:63], v11 offset:6144
    ds_read2_b64 v[84:87], v16 offset0:72 offset1:76
    ds_read2_b64 v[88:91], v17 offset0:72 offset1:76
    ds_read2_b64 v[92:95], v18 offset0:72 offset1:76
    ds_read2_b64 v[96:99], v19 offset0:72 offset1:76
    ds_read2_b64 v[100:103], v20 offset0:72 offset1:76
    s_waitcnt lgkmcnt(13)
    s_add_u32 s37, s36, 12288
    s_mov_b32 m0, s37
    s_add_u32 s38, s35, 2883584
    buffer_load_dwordx4 v4, s[20:23], s38 offen lds
    s_add_u32 s37, s36, 13312
    s_mov_b32 m0, s37
    s_add_u32 s38, s35, 2949120
    buffer_load_dwordx4 v4, s[20:23], s38 offen lds
    s_add_u32 s37, s36, 14336
    s_mov_b32 m0, s37
    s_add_u32 s38, s35, 3014656
    buffer_load_dwordx4 v4, s[20:23], s38 offen lds
    s_add_u32 s37, s36, 15360
    s_mov_b32 m0, s37
    s_add_u32 s38, s35, 3080192
    buffer_load_dwordx4 v4, s[20:23], s38 offen lds
    v_mfma_f32_16x16x32_bf16 v[128:131], v[32:35], v[64:67], v[128:131]
    v_mfma_f32_16x16x32_bf16 v[132:135], v[32:35], v[68:71], v[132:135]
    v_mfma_f32_16x16x32_bf16 v[136:139], v[32:35], v[72:75], v[136:139]
    v_mfma_f32_16x16x32_bf16 v[140:143], v[32:35], v[76:79], v[140:143]
    v_mfma_f32_16x16x32_bf16 v[144:147], v[32:35], v[80:83], v[144:147]
    v_mfma_f32_16x16x32_bf16 v[148:151], v[36:39], v[64:67], v[148:151]
    v_mfma_f32_16x16x32_bf16 v[152:155], v[36:39], v[68:71], v[152:155]
    v_mfma_f32_16x16x32_bf16 v[156:159], v[36:39], v[72:75], v[156:159]
    v_mfma_f32_16x16x32_bf16 v[160:163], v[36:39], v[76:79], v[160:163]
    v_mfma_f32_16x16x32_bf16 v[164:167], v[36:39], v[80:83], v[164:167]
    v_mfma_f32_16x16x32_bf16 v[168:171], v[40:43], v[64:67], v[168:171]
    v_mfma_f32_16x16x32_bf16 v[172:175], v[40:43], v[68:71], v[172:175]
    v_mfma_f32_16x16x32_bf16 v[176:179], v[40:43], v[72:75], v[176:179]
    v_mfma_f32_16x16x32_bf16 v[180:183], v[40:43], v[76:79], v[180:183]
    v_mfma_f32_16x16x32_bf16 v[184:187], v[40:43], v[80:83], v[184:187]
    v_mfma_f32_16x16x32_bf16 v[188:191], v[44:47], v[64:67], v[188:191]
    v_mfma_f32_16x16x32_bf16 v[192:195], v[44:47], v[68:71], v[192:195]
    v_mfma_f32_16x16x32_bf16 v[196:199], v[44:47], v[72:75], v[196:199]
    v_mfma_f32_16x16x32_bf16 v[200:203], v[44:47], v[76:79], v[200:203]
    v_mfma_f32_16x16x32_bf16 v[204:207], v[44:47], v[80:83], v[204:207]
    s_waitcnt vmcnt(4)
    ds_read_b64_tr_b16 v[32:33], v8 offset:8192
    ds_read_b64_tr_b16 v[34:35], v8 offset:10240
    ds_read_b64_tr_b16 v[36:37], v9 offset:8192
    ds_read_b64_tr_b16 v[38:39], v9 offset:10240
    ds_read_b64_tr_b16 v[40:41], v10 offset:8192
    ds_read_b64_tr_b16 v[42:43], v10 offset:10240
    ds_read_b64_tr_b16 v[44:45], v11 offset:8192
    ds_read_b64_tr_b16 v[46:47], v11 offset:10240
    ds_read2_b64 v[64:67], v16 offset0:80 offset1:84
    ds_read2_b64 v[68:71], v17 offset0:80 offset1:84
    ds_read2_b64 v[72:75], v18 offset0:80 offset1:84
    ds_read2_b64 v[76:79], v19 offset0:80 offset1:84
    ds_read2_b64 v[80:83], v20 offset0:80 offset1:84
    s_waitcnt lgkmcnt(13)
    s_add_u32 s37, s36, 0
    s_mov_b32 m0, s37
    s_add_u32 s38, s35, 3145728
    buffer_load_dwordx4 v4, s[20:23], s38 offen lds
    s_add_u32 s37, s36, 1024
    s_mov_b32 m0, s37
    s_add_u32 s38, s35, 3211264
    buffer_load_dwordx4 v4, s[20:23], s38 offen lds
    s_add_u32 s37, s36, 2048
    s_mov_b32 m0, s37
    s_add_u32 s38, s35, 3276800
    buffer_load_dwordx4 v4, s[20:23], s38 offen lds
    s_add_u32 s37, s36, 3072
    s_mov_b32 m0, s37
    s_add_u32 s38, s35, 3342336
    buffer_load_dwordx4 v4, s[20:23], s38 offen lds
    v_mfma_f32_16x16x32_bf16 v[128:131], v[48:51], v[84:87], v[128:131]
    v_mfma_f32_16x16x32_bf16 v[132:135], v[48:51], v[88:91], v[132:135]
    v_mfma_f32_16x16x32_bf16 v[136:139], v[48:51], v[92:95], v[136:139]
    v_mfma_f32_16x16x32_bf16 v[140:143], v[48:51], v[96:99], v[140:143]
    v_mfma_f32_16x16x32_bf16 v[144:147], v[48:51], v[100:103], v[144:147]
    v_mfma_f32_16x16x32_bf16 v[148:151], v[52:55], v[84:87], v[148:151]
    v_mfma_f32_16x16x32_bf16 v[152:155], v[52:55], v[88:91], v[152:155]
    v_mfma_f32_16x16x32_bf16 v[156:159], v[52:55], v[92:95], v[156:159]
    v_mfma_f32_16x16x32_bf16 v[160:163], v[52:55], v[96:99], v[160:163]
    v_mfma_f32_16x16x32_bf16 v[164:167], v[52:55], v[100:103], v[164:167]
    v_mfma_f32_16x16x32_bf16 v[168:171], v[56:59], v[84:87], v[168:171]
    v_mfma_f32_16x16x32_bf16 v[172:175], v[56:59], v[88:91], v[172:175]
    v_mfma_f32_16x16x32_bf16 v[176:179], v[56:59], v[92:95], v[176:179]
    v_mfma_f32_16x16x32_bf16 v[180:183], v[56:59], v[96:99], v[180:183]
    v_mfma_f32_16x16x32_bf16 v[184:187], v[56:59], v[100:103], v[184:187]
    v_mfma_f32_16x16x32_bf16 v[188:191], v[60:63], v[84:87], v[188:191]
    v_mfma_f32_16x16x32_bf16 v[192:195], v[60:63], v[88:91], v[192:195]
    v_mfma_f32_16x16x32_bf16 v[196:199], v[60:63], v[92:95], v[196:199]
    v_mfma_f32_16x16x32_bf16 v[200:203], v[60:63], v[96:99], v[200:203]
    v_mfma_f32_16x16x32_bf16 v[204:207], v[60:63], v[100:103], v[204:207]
    s_waitcnt vmcnt(4)
    ds_read_b64_tr_b16 v[48:49], v8 offset:12288
    ds_read_b64_tr_b16 v[50:51], v8 offset:14336
    ds_read_b64_tr_b16 v[52:53], v9 offset:12288
    ds_read_b64_tr_b16 v[54:55], v9 offset:14336
    ds_read_b64_tr_b16 v[56:57], v10 offset:12288
    ds_read_b64_tr_b16 v[58:59], v10 offset:14336
    ds_read_b64_tr_b16 v[60:61], v11 offset:12288
    ds_read_b64_tr_b16 v[62:63], v11 offset:14336
    ds_read2_b64 v[84:87], v16 offset0:88 offset1:92
    ds_read2_b64 v[88:91], v17 offset0:88 offset1:92
    ds_read2_b64 v[92:95], v18 offset0:88 offset1:92
    ds_read2_b64 v[96:99], v19 offset0:88 offset1:92
    ds_read2_b64 v[100:103], v20 offset0:88 offset1:92
    s_waitcnt lgkmcnt(13)
    s_add_u32 s37, s36, 4096
    s_mov_b32 m0, s37
    s_add_u32 s38, s35, 3407872
    buffer_load_dwordx4 v4, s[20:23], s38 offen lds
    s_add_u32 s37, s36, 5120
    s_mov_b32 m0, s37
    s_add_u32 s38, s35, 3473408
    buffer_load_dwordx4 v4, s[20:23], s38 offen lds
    s_add_u32 s37, s36, 6144
    s_mov_b32 m0, s37
    s_add_u32 s38, s35, 3538944
    buffer_load_dwordx4 v4, s[20:23], s38 offen lds
    s_add_u32 s37, s36, 7168
    s_mov_b32 m0, s37
    s_add_u32 s38, s35, 3604480
    buffer_load_dwordx4 v4, s[20:23], s38 offen lds
    v_mfma_f32_16x16x32_bf16 v[128:131], v[32:35], v[64:67], v[128:131]
    v_mfma_f32_16x16x32_bf16 v[132:135], v[32:35], v[68:71], v[132:135]
    v_mfma_f32_16x16x32_bf16 v[136:139], v[32:35], v[72:75], v[136:139]
    v_mfma_f32_16x16x32_bf16 v[140:143], v[32:35], v[76:79], v[140:143]
    v_mfma_f32_16x16x32_bf16 v[144:147], v[32:35], v[80:83], v[144:147]
    v_mfma_f32_16x16x32_bf16 v[148:151], v[36:39], v[64:67], v[148:151]
    v_mfma_f32_16x16x32_bf16 v[152:155], v[36:39], v[68:71], v[152:155]
    v_mfma_f32_16x16x32_bf16 v[156:159], v[36:39], v[72:75], v[156:159]
    v_mfma_f32_16x16x32_bf16 v[160:163], v[36:39], v[76:79], v[160:163]
    v_mfma_f32_16x16x32_bf16 v[164:167], v[36:39], v[80:83], v[164:167]
    v_mfma_f32_16x16x32_bf16 v[168:171], v[40:43], v[64:67], v[168:171]
    v_mfma_f32_16x16x32_bf16 v[172:175], v[40:43], v[68:71], v[172:175]
    v_mfma_f32_16x16x32_bf16 v[176:179], v[40:43], v[72:75], v[176:179]
    v_mfma_f32_16x16x32_bf16 v[180:183], v[40:43], v[76:79], v[180:183]
    v_mfma_f32_16x16x32_bf16 v[184:187], v[40:43], v[80:83], v[184:187]
    v_mfma_f32_16x16x32_bf16 v[188:191], v[44:47], v[64:67], v[188:191]
    v_mfma_f32_16x16x32_bf16 v[192:195], v[44:47], v[68:71], v[192:195]
    v_mfma_f32_16x16x32_bf16 v[196:199], v[44:47], v[72:75], v[196:199]
    v_mfma_f32_16x16x32_bf16 v[200:203], v[44:47], v[76:79], v[200:203]
    v_mfma_f32_16x16x32_bf16 v[204:207], v[44:47], v[80:83], v[204:207]
    s_waitcnt vmcnt(4)
    ds_read_b64_tr_b16 v[32:33], v8 offset:0
    ds_read_b64_tr_b16 v[34:35], v8 offset:2048
    ds_read_b64_tr_b16 v[36:37], v9 offset:0
    ds_read_b64_tr_b16 v[38:39], v9 offset:2048
    ds_read_b64_tr_b16 v[40:41], v10 offset:0
    ds_read_b64_tr_b16 v[42:43], v10 offset:2048
    ds_read_b64_tr_b16 v[44:45], v11 offset:0
    ds_read_b64_tr_b16 v[46:47], v11 offset:2048
    ds_read2_b64 v[64:67], v16 offset0:96 offset1:100
    ds_read2_b64 v[68:71], v17 offset0:96 offset1:100
    ds_read2_b64 v[72:75], v18 offset0:96 offset1:100
    ds_read2_b64 v[76:79], v19 offset0:96 offset1:100
    ds_read2_b64 v[80:83], v20 offset0:96 offset1:100
    s_waitcnt lgkmcnt(13)
    s_add_u32 s37, s36, 8192
    s_mov_b32 m0, s37
    s_add_u32 s38, s35, 3670016
    buffer_load_dwordx4 v4, s[20:23], s38 offen lds
    s_add_u32 s37, s36, 9216
    s_mov_b32 m0, s37
    s_add_u32 s38, s35, 3735552
    buffer_load_dwordx4 v4, s[20:23], s38 offen lds
    s_add_u32 s37, s36, 10240
    s_mov_b32 m0, s37
    s_add_u32 s38, s35, 3801088
    buffer_load_dwordx4 v4, s[20:23], s38 offen lds
    s_add_u32 s37, s36, 11264
    s_mov_b32 m0, s37
    s_add_u32 s38, s35, 3866624
    buffer_load_dwordx4 v4, s[20:23], s38 offen lds
    v_mfma_f32_16x16x32_bf16 v[128:131], v[48:51], v[84:87], v[128:131]
    v_mfma_f32_16x16x32_bf16 v[132:135], v[48:51], v[88:91], v[132:135]
    v_mfma_f32_16x16x32_bf16 v[136:139], v[48:51], v[92:95], v[136:139]
    v_mfma_f32_16x16x32_bf16 v[140:143], v[48:51], v[96:99], v[140:143]
    v_mfma_f32_16x16x32_bf16 v[144:147], v[48:51], v[100:103], v[144:147]
    v_mfma_f32_16x16x32_bf16 v[148:151], v[52:55], v[84:87], v[148:151]
    v_mfma_f32_16x16x32_bf16 v[152:155], v[52:55], v[88:91], v[152:155]
    v_mfma_f32_16x16x32_bf16 v[156:159], v[52:55], v[92:95], v[156:159]
    v_mfma_f32_16x16x32_bf16 v[160:163], v[52:55], v[96:99], v[160:163]
    v_mfma_f32_16x16x32_bf16 v[164:167], v[52:55], v[100:103], v[164:167]
    v_mfma_f32_16x16x32_bf16 v[168:171], v[56:59], v[84:87], v[168:171]
    v_mfma_f32_16x16x32_bf16 v[172:175], v[56:59], v[88:91], v[172:175]
    v_mfma_f32_16x16x32_bf16 v[176:179], v[56:59], v[92:95], v[176:179]
    v_mfma_f32_16x16x32_bf16 v[180:183], v[56:59], v[96:99], v[180:183]
    v_mfma_f32_16x16x32_bf16 v[184:187], v[56:59], v[100:103], v[184:187]
    v_mfma_f32_16x16x32_bf16 v[188:191], v[60:63], v[84:87], v[188:191]
    v_mfma_f32_16x16x32_bf16 v[192:195], v[60:63], v[88:91], v[192:195]
    v_mfma_f32_16x16x32_bf16 v[196:199], v[60:63], v[92:95], v[196:199]
    v_mfma_f32_16x16x32_bf16 v[200:203], v[60:63], v[96:99], v[200:203]
    v_mfma_f32_16x16x32_bf16 v[204:207], v[60:63], v[100:103], v[204:207]
    s_waitcnt vmcnt(4)
    ds_read_b64_tr_b16 v[48:49], v8 offset:4096
    ds_read_b64_tr_b16 v[50:51], v8 offset:6144
    ds_read_b64_tr_b16 v[52:53], v9 offset:4096
    ds_read_b64_tr_b16 v[54:55], v9 offset:6144
    ds_read_b64_tr_b16 v[56:57], v10 offset:4096
    ds_read_b64_tr_b16 v[58:59], v10 offset:6144
    ds_read_b64_tr_b16 v[60:61], v11 offset:4096
    ds_read_b64_tr_b16 v[62:63], v11 offset:6144
    ds_read2_b64 v[84:87], v16 offset0:104 offset1:108
    ds_read2_b64 v[88:91], v17 offset0:104 offset1:108
    ds_read2_b64 v[92:95], v18 offset0:104 offset1:108
    ds_read2_b64 v[96:99], v19 offset0:104 offset1:108
    ds_read2_b64 v[100:103], v20 offset0:104 offset1:108
    s_waitcnt lgkmcnt(13)
    s_add_u32 s37, s36, 12288
    s_mov_b32 m0, s37
    s_add_u32 s38, s35, 3932160
    buffer_load_dwordx4 v4, s[20:23], s38 offen lds
    s_add_u32 s37, s36, 13312
    s_mov_b32 m0, s37
    s_add_u32 s38, s35, 3997696
    buffer_load_dwordx4 v4, s[20:23], s38 offen lds
    s_add_u32 s37, s36, 14336
    s_mov_b32 m0, s37
    s_add_u32 s38, s35, 4063232
    buffer_load_dwordx4 v4, s[20:23], s38 offen lds
    s_add_u32 s37, s36, 15360
    s_mov_b32 m0, s37
    s_add_u32 s38, s35, 4128768
    buffer_load_dwordx4 v4, s[20:23], s38 offen lds
    v_mfma_f32_16x16x32_bf16 v[128:131], v[32:35], v[64:67], v[128:131]
    v_mfma_f32_16x16x32_bf16 v[132:135], v[32:35], v[68:71], v[132:135]
    v_mfma_f32_16x16x32_bf16 v[136:139], v[32:35], v[72:75], v[136:139]
    v_mfma_f32_16x16x32_bf16 v[140:143], v[32:35], v[76:79], v[140:143]
    v_mfma_f32_16x16x32_bf16 v[144:147], v[32:35], v[80:83], v[144:147]
    v_mfma_f32_16x16x32_bf16 v[148:151], v[36:39], v[64:67], v[148:151]
    v_mfma_f32_16x16x32_bf16 v[152:155], v[36:39], v[68:71], v[152:155]
    v_mfma_f32_16x16x32_bf16 v[156:159], v[36:39], v[72:75], v[156:159]
    v_mfma_f32_16x16x32_bf16 v[160:163], v[36:39], v[76:79], v[160:163]
    v_mfma_f32_16x16x32_bf16 v[164:167], v[36:39], v[80:83], v[164:167]
    v_mfma_f32_16x16x32_bf16 v[168:171], v[40:43], v[64:67], v[168:171]
    v_mfma_f32_16x16x32_bf16 v[172:175], v[40:43], v[68:71], v[172:175]
    v_mfma_f32_16x16x32_bf16 v[176:179], v[40:43], v[72:75], v[176:179]
    v_mfma_f32_16x16x32_bf16 v[180:183], v[40:43], v[76:79], v[180:183]
    v_mfma_f32_16x16x32_bf16 v[184:187], v[40:43], v[80:83], v[184:187]
    v_mfma_f32_16x16x32_bf16 v[188:191], v[44:47], v[64:67], v[188:191]
    v_mfma_f32_16x16x32_bf16 v[192:195], v[44:47], v[68:71], v[192:195]
    v_mfma_f32_16x16x32_bf16 v[196:199], v[44:47], v[72:75], v[196:199]
    v_mfma_f32_16x16x32_bf16 v[200:203], v[44:47], v[76:79], v[200:203]
    v_mfma_f32_16x16x32_bf16 v[204:207], v[44:47], v[80:83], v[204:207]
    s_waitcnt vmcnt(4)
    ds_read_b64_tr_b16 v[32:33], v8 offset:8192
    ds_read_b64_tr_b16 v[34:35], v8 offset:10240
    ds_read_b64_tr_b16 v[36:37], v9 offset:8192
    ds_read_b64_tr_b16 v[38:39], v9 offset:10240
    ds_read_b64_tr_b16 v[40:41], v10 offset:8192
    ds_read_b64_tr_b16 v[42:43], v10 offset:10240
    ds_read_b64_tr_b16 v[44:45], v11 offset:8192
    ds_read_b64_tr_b16 v[46:47], v11 offset:10240
    ds_read2_b64 v[64:67], v16 offset0:112 offset1:116
    ds_read2_b64 v[68:71], v17 offset0:112 offset1:116
    ds_read2_b64 v[72:75], v18 offset0:112 offset1:116
    ds_read2_b64 v[76:79], v19 offset0:112 offset1:116
    ds_read2_b64 v[80:83], v20 offset0:112 offset1:116
    s_waitcnt lgkmcnt(13)
    v_mfma_f32_16x16x32_bf16 v[128:131], v[48:51], v[84:87], v[128:131]
    v_mfma_f32_16x16x32_bf16 v[132:135], v[48:51], v[88:91], v[132:135]
    v_mfma_f32_16x16x32_bf16 v[136:139], v[48:51], v[92:95], v[136:139]
    v_mfma_f32_16x16x32_bf16 v[140:143], v[48:51], v[96:99], v[140:143]
    v_mfma_f32_16x16x32_bf16 v[144:147], v[48:51], v[100:103], v[144:147]
    v_mfma_f32_16x16x32_bf16 v[148:151], v[52:55], v[84:87], v[148:151]
    v_mfma_f32_16x16x32_bf16 v[152:155], v[52:55], v[88:91], v[152:155]
    v_mfma_f32_16x16x32_bf16 v[156:159], v[52:55], v[92:95], v[156:159]
    v_mfma_f32_16x16x32_bf16 v[160:163], v[52:55], v[96:99], v[160:163]
    v_mfma_f32_16x16x32_bf16 v[164:167], v[52:55], v[100:103], v[164:167]
    v_mfma_f32_16x16x32_bf16 v[168:171], v[56:59], v[84:87], v[168:171]
    v_mfma_f32_16x16x32_bf16 v[172:175], v[56:59], v[88:91], v[172:175]
    v_mfma_f32_16x16x32_bf16 v[176:179], v[56:59], v[92:95], v[176:179]
    v_mfma_f32_16x16x32_bf16 v[180:183], v[56:59], v[96:99], v[180:183]
    v_mfma_f32_16x16x32_bf16 v[184:187], v[56:59], v[100:103], v[184:187]
    v_mfma_f32_16x16x32_bf16 v[188:191], v[60:63], v[84:87], v[188:191]
    v_mfma_f32_16x16x32_bf16 v[192:195], v[60:63], v[88:91], v[192:195]
    v_mfma_f32_16x16x32_bf16 v[196:199], v[60:63], v[92:95], v[196:199]
    v_mfma_f32_16x16x32_bf16 v[200:203], v[60:63], v[96:99], v[200:203]
    v_mfma_f32_16x16x32_bf16 v[204:207], v[60:63], v[100:103], v[204:207]
    s_waitcnt vmcnt(0)
    ds_read_b64_tr_b16 v[48:49], v8 offset:12288
    ds_read_b64_tr_b16 v[50:51], v8 offset:14336
    ds_read_b64_tr_b16 v[52:53], v9 offset:12288
    ds_read_b64_tr_b16 v[54:55], v9 offset:14336
    ds_read_b64_tr_b16 v[56:57], v10 offset:12288
    ds_read_b64_tr_b16 v[58:59], v10 offset:14336
    ds_read_b64_tr_b16 v[60:61], v11 offset:12288
    ds_read_b64_tr_b16 v[62:63], v11 offset:14336
    ds_read2_b64 v[84:87], v16 offset0:120 offset1:124
    ds_read2_b64 v[88:91], v17 offset0:120 offset1:124
    ds_read2_b64 v[92:95], v18 offset0:120 offset1:124
    ds_read2_b64 v[96:99], v19 offset0:120 offset1:124
    ds_read2_b64 v[100:103], v20 offset0:120 offset1:124
    s_waitcnt lgkmcnt(13)
    v_mfma_f32_16x16x32_bf16 v[128:131], v[32:35], v[64:67], v[128:131]
    v_mfma_f32_16x16x32_bf16 v[132:135], v[32:35], v[68:71], v[132:135]
    v_mfma_f32_16x16x32_bf16 v[136:139], v[32:35], v[72:75], v[136:139]
    v_mfma_f32_16x16x32_bf16 v[140:143], v[32:35], v[76:79], v[140:143]
    v_mfma_f32_16x16x32_bf16 v[144:147], v[32:35], v[80:83], v[144:147]
    v_mfma_f32_16x16x32_bf16 v[148:151], v[36:39], v[64:67], v[148:151]
    v_mfma_f32_16x16x32_bf16 v[152:155], v[36:39], v[68:71], v[152:155]
    v_mfma_f32_16x16x32_bf16 v[156:159], v[36:39], v[72:75], v[156:159]
    v_mfma_f32_16x16x32_bf16 v[160:163], v[36:39], v[76:79], v[160:163]
    v_mfma_f32_16x16x32_bf16 v[164:167], v[36:39], v[80:83], v[164:167]
    v_mfma_f32_16x16x32_bf16 v[168:171], v[40:43], v[64:67], v[168:171]
    v_mfma_f32_16x16x32_bf16 v[172:175], v[40:43], v[68:71], v[172:175]
    v_mfma_f32_16x16x32_bf16 v[176:179], v[40:43], v[72:75], v[176:179]
    v_mfma_f32_16x16x32_bf16 v[180:183], v[40:43], v[76:79], v[180:183]
    v_mfma_f32_16x16x32_bf16 v[184:187], v[40:43], v[80:83], v[184:187]
    v_mfma_f32_16x16x32_bf16 v[188:191], v[44:47], v[64:67], v[188:191]
    v_mfma_f32_16x16x32_bf16 v[192:195], v[44:47], v[68:71], v[192:195]
    v_mfma_f32_16x16x32_bf16 v[196:199], v[44:47], v[72:75], v[196:199]
    v_mfma_f32_16x16x32_bf16 v[200:203], v[44:47], v[76:79], v[200:203]
    v_mfma_f32_16x16x32_bf16 v[204:207], v[44:47], v[80:83], v[204:207]
    s_waitcnt lgkmcnt(0)
    v_mfma_f32_16x16x32_bf16 v[128:131], v[48:51], v[84:87], v[128:131]
    v_mfma_f32_16x16x32_bf16 v[132:135], v[48:51], v[88:91], v[132:135]
    v_mfma_f32_16x16x32_bf16 v[136:139], v[48:51], v[92:95], v[136:139]
    v_mfma_f32_16x16x32_bf16 v[140:143], v[48:51], v[96:99], v[140:143]
    v_mfma_f32_16x16x32_bf16 v[144:147], v[48:51], v[100:103], v[144:147]
    v_mfma_f32_16x16x32_bf16 v[148:151], v[52:55], v[84:87], v[148:151]
    v_mfma_f32_16x16x32_bf16 v[152:155], v[52:55], v[88:91], v[152:155]
    v_mfma_f32_16x16x32_bf16 v[156:159], v[52:55], v[92:95], v[156:159]
    v_mfma_f32_16x16x32_bf16 v[160:163], v[52:55], v[96:99], v[160:163]
    v_mfma_f32_16x16x32_bf16 v[164:167], v[52:55], v[100:103], v[164:167]
    v_mfma_f32_16x16x32_bf16 v[168:171], v[56:59], v[84:87], v[168:171]
    v_mfma_f32_16x16x32_bf16 v[172:175], v[56:59], v[88:91], v[172:175]
    v_mfma_f32_16x16x32_bf16 v[176:179], v[56:59], v[92:95], v[176:179]
    v_mfma_f32_16x16x32_bf16 v[180:183], v[56:59], v[96:99], v[180:183]
    v_mfma_f32_16x16x32_bf16 v[184:187], v[56:59], v[100:103], v[184:187]
    v_mfma_f32_16x16x32_bf16 v[188:191], v[60:63], v[84:87], v[188:191]
    v_mfma_f32_16x16x32_bf16 v[192:195], v[60:63], v[88:91], v[192:195]
    v_mfma_f32_16x16x32_bf16 v[196:199], v[60:63], v[92:95], v[196:199]
    v_mfma_f32_16x16x32_bf16 v[200:203], v[60:63], v[96:99], v[200:203]
    v_mfma_f32_16x16x32_bf16 v[204:207], v[60:63], v[100:103], v[204:207]
    s_nop 7
    s_nop 7
    s_mov_b32 s40, 0x3e0293ee
    s_lshl_b32 s41, s29, 2
    s_lshl_b32 s42, s30, 1
    s_add_u32 s41, s41, s42
    s_lshr_b32 s42, s31, 1
    s_add_u32 s41, s41, s42
    s_lshl_b32 s42, s28, 5
    s_add_u32 s41, s41, s42
    s_mul_i32 s41, s41, 20480
    s_and_b32 s42, s31, 1
    s_lshl_b32 s42, s42, 7
    s_add_u32 s41, s41, s42

    s_add_u32 s41, s41, 0
    s_add_u32 s44, s41, 0
    s_add_u32 s45, s41, 4096
    s_add_u32 s46, s41, 8192
    s_add_u32 s47, s41, 12288
    s_add_u32 s48, s41, 16384
    v_lshlrev_b32 v21, 8, v6
    v_lshlrev_b32 v22, 3, v5
    v_add_u32 v21, v21, v22

    v_mul_f32 v128, s40, v128
    v_mul_f32 v129, s40, v129
    v_mul_f32 v130, s40, v130
    v_mul_f32 v131, s40, v131
    v_cvt_pk_bf16_f32 v24, v128, v129
    v_cvt_pk_bf16_f32 v25, v130, v131
    buffer_store_dwordx2 v[24:25], v21, s[24:27], s44 offen offset:0
    v_mul_f32 v132, s40, v132
    v_mul_f32 v133, s40, v133
    v_mul_f32 v134, s40, v134
    v_mul_f32 v135, s40, v135
    v_cvt_pk_bf16_f32 v26, v132, v133
    v_cvt_pk_bf16_f32 v27, v134, v135
    buffer_store_dwordx2 v[26:27], v21, s[24:27], s45 offen offset:0
    v_mul_f32 v136, s40, v136
    v_mul_f32 v137, s40, v137
    v_mul_f32 v138, s40, v138
    v_mul_f32 v139, s40, v139
    v_cvt_pk_bf16_f32 v28, v136, v137
    v_cvt_pk_bf16_f32 v29, v138, v139
    buffer_store_dwordx2 v[28:29], v21, s[24:27], s46 offen offset:0
    v_mul_f32 v140, s40, v140
    v_mul_f32 v141, s40, v141
    v_mul_f32 v142, s40, v142
    v_mul_f32 v143, s40, v143
    v_cvt_pk_bf16_f32 v30, v140, v141
    v_cvt_pk_bf16_f32 v31, v142, v143
    buffer_store_dwordx2 v[30:31], v21, s[24:27], s47 offen offset:0
    v_mul_f32 v144, s40, v144
    v_mul_f32 v145, s40, v145
    v_mul_f32 v146, s40, v146
    v_mul_f32 v147, s40, v147
    v_cvt_pk_bf16_f32 v24, v144, v145
    v_cvt_pk_bf16_f32 v25, v146, v147
    buffer_store_dwordx2 v[24:25], v21, s[24:27], s48 offen offset:0
    v_mul_f32 v148, s40, v148
    v_mul_f32 v149, s40, v149
    v_mul_f32 v150, s40, v150
    v_mul_f32 v151, s40, v151
    v_cvt_pk_bf16_f32 v26, v148, v149
    v_cvt_pk_bf16_f32 v27, v150, v151
    buffer_store_dwordx2 v[26:27], v21, s[24:27], s44 offen offset:32
    v_mul_f32 v152, s40, v152
    v_mul_f32 v153, s40, v153
    v_mul_f32 v154, s40, v154
    v_mul_f32 v155, s40, v155
    v_cvt_pk_bf16_f32 v28, v152, v153
    v_cvt_pk_bf16_f32 v29, v154, v155
    buffer_store_dwordx2 v[28:29], v21, s[24:27], s45 offen offset:32
    v_mul_f32 v156, s40, v156
    v_mul_f32 v157, s40, v157
    v_mul_f32 v158, s40, v158
    v_mul_f32 v159, s40, v159
    v_cvt_pk_bf16_f32 v30, v156, v157
    v_cvt_pk_bf16_f32 v31, v158, v159
    buffer_store_dwordx2 v[30:31], v21, s[24:27], s46 offen offset:32
    v_mul_f32 v160, s40, v160
    v_mul_f32 v161, s40, v161
    v_mul_f32 v162, s40, v162
    v_mul_f32 v163, s40, v163
    v_cvt_pk_bf16_f32 v24, v160, v161
    v_cvt_pk_bf16_f32 v25, v162, v163
    buffer_store_dwordx2 v[24:25], v21, s[24:27], s47 offen offset:32
    v_mul_f32 v164, s40, v164
    v_mul_f32 v165, s40, v165
    v_mul_f32 v166, s40, v166
    v_mul_f32 v167, s40, v167
    v_cvt_pk_bf16_f32 v26, v164, v165
    v_cvt_pk_bf16_f32 v27, v166, v167
    buffer_store_dwordx2 v[26:27], v21, s[24:27], s48 offen offset:32
    v_mul_f32 v168, s40, v168
    v_mul_f32 v169, s40, v169
    v_mul_f32 v170, s40, v170
    v_mul_f32 v171, s40, v171
    v_cvt_pk_bf16_f32 v28, v168, v169
    v_cvt_pk_bf16_f32 v29, v170, v171
    buffer_store_dwordx2 v[28:29], v21, s[24:27], s44 offen offset:64
    v_mul_f32 v172, s40, v172
    v_mul_f32 v173, s40, v173
    v_mul_f32 v174, s40, v174
    v_mul_f32 v175, s40, v175
    v_cvt_pk_bf16_f32 v30, v172, v173
    v_cvt_pk_bf16_f32 v31, v174, v175
    buffer_store_dwordx2 v[30:31], v21, s[24:27], s45 offen offset:64
    v_mul_f32 v176, s40, v176
    v_mul_f32 v177, s40, v177
    v_mul_f32 v178, s40, v178
    v_mul_f32 v179, s40, v179
    v_cvt_pk_bf16_f32 v24, v176, v177
    v_cvt_pk_bf16_f32 v25, v178, v179
    buffer_store_dwordx2 v[24:25], v21, s[24:27], s46 offen offset:64
    v_mul_f32 v180, s40, v180
    v_mul_f32 v181, s40, v181
    v_mul_f32 v182, s40, v182
    v_mul_f32 v183, s40, v183
    v_cvt_pk_bf16_f32 v26, v180, v181
    v_cvt_pk_bf16_f32 v27, v182, v183
    buffer_store_dwordx2 v[26:27], v21, s[24:27], s47 offen offset:64
    v_mul_f32 v184, s40, v184
    v_mul_f32 v185, s40, v185
    v_mul_f32 v186, s40, v186
    v_mul_f32 v187, s40, v187
    v_cvt_pk_bf16_f32 v28, v184, v185
    v_cvt_pk_bf16_f32 v29, v186, v187
    buffer_store_dwordx2 v[28:29], v21, s[24:27], s48 offen offset:64
    v_mul_f32 v188, s40, v188
    v_mul_f32 v189, s40, v189
    v_mul_f32 v190, s40, v190
    v_mul_f32 v191, s40, v191
    v_cvt_pk_bf16_f32 v30, v188, v189
    v_cvt_pk_bf16_f32 v31, v190, v191
    buffer_store_dwordx2 v[30:31], v21, s[24:27], s44 offen offset:96
    v_mul_f32 v192, s40, v192
    v_mul_f32 v193, s40, v193
    v_mul_f32 v194, s40, v194
    v_mul_f32 v195, s40, v195
    v_cvt_pk_bf16_f32 v24, v192, v193
    v_cvt_pk_bf16_f32 v25, v194, v195
    buffer_store_dwordx2 v[24:25], v21, s[24:27], s45 offen offset:96
    v_mul_f32 v196, s40, v196
    v_mul_f32 v197, s40, v197
    v_mul_f32 v198, s40, v198
    v_mul_f32 v199, s40, v199
    v_cvt_pk_bf16_f32 v26, v196, v197
    v_cvt_pk_bf16_f32 v27, v198, v199
    buffer_store_dwordx2 v[26:27], v21, s[24:27], s46 offen offset:96
    v_mul_f32 v200, s40, v200
    v_mul_f32 v201, s40, v201
    v_mul_f32 v202, s40, v202
    v_mul_f32 v203, s40, v203
    v_cvt_pk_bf16_f32 v28, v200, v201
    v_cvt_pk_bf16_f32 v29, v202, v203
    buffer_store_dwordx2 v[28:29], v21, s[24:27], s47 offen offset:96
    v_mul_f32 v204, s40, v204
    v_mul_f32 v205, s40, v205
    v_mul_f32 v206, s40, v206
    v_mul_f32 v207, s40, v207
    v_cvt_pk_bf16_f32 v30, v204, v205
    v_cvt_pk_bf16_f32 v31, v206, v207
    buffer_store_dwordx2 v[30:31], v21, s[24:27], s48 offen offset:96
    s_waitcnt vmcnt(0)
k0_kernel_done:
    s_endpgm
.text
.globl k1_kernel
.p2align 8
.type k1_kernel,@function
k1_kernel:

    s_cmp_ge_u32 s2, 256
    s_cbranch_scc1 k1_kernel_done
    s_load_dwordx2 s[4:5], s[0:1], 8
    s_load_dwordx2 s[6:7], s[0:1], 16
    s_load_dwordx2 s[8:9], s[0:1], 32
    s_load_dwordx2 s[10:11], s[0:1], 56
    s_and_b32 s37, s2, 7
    s_lshr_b32 s36, s2, 3
    s_and_b32 s38, s36, 1
    s_lshr_b32 s36, s36, 1
    v_and_b32 v1, 63, v0
    v_lshrrev_b32 v2, 6, v0
    s_nop 0
    v_readfirstlane_b32 s39, v2
    s_waitcnt lgkmcnt(0)
    s_and_b32 s40, s39, 1
    s_lshr_b32 s41, s39, 1
    s_mov_b32 s16, s4
    s_mov_b32 s17, s5
    s_mov_b32 s18, 33554432
    s_mov_b32 s19, 0x00020000
    s_mov_b32 s20, s6
    s_mov_b32 s21, s7
    s_mov_b32 s22, 33554432
    s_mov_b32 s23, 0x00020000
    s_mov_b32 s24, s8
    s_mov_b32 s25, s9
    s_mov_b32 s26, 4194304
    s_mov_b32 s27, 0x00020000
    s_mov_b32 s28, s10
    s_mov_b32 s29, s11
    s_mov_b32 s30, 52428800
    s_mov_b32 s31, 0x00020000

    s_lshl_b32 s43, s41, 13
    s_cmp_eq_u32 s40, 0
    s_cselect_b32 s32, s16, s20
    s_cselect_b32 s33, s17, s21
    s_mov_b32 s34, s18
    s_mov_b32 s35, s19
    s_cselect_b32 s47, 0, 65536
    s_add_u32 s43, s43, s47
    s_lshl_b32 s42, s36, 3
    s_add_u32 s42, s42, s37
    s_lshl_b32 s42, s42, 18
    s_lshl_b32 s47, s41, 17
    s_add_u32 s42, s42, s47

    v_lshrrev_b32 v2, 4, v1
    v_and_b32 v3, 15, v1

    s_lshl_b32 s47, s37, 2
    s_lshl_b32 s48, s38, 1
    s_add_u32 s47, s47, s48
    s_add_u32 s47, s47, s40
    s_lshl_b32 s48, s36, 5
    s_add_u32 s47, s47, s48
    s_mul_i32 s47, s47, 20480
    s_add_u32 s47, s47, 0
    v_lshlrev_b32 v20, 8, v3
    v_lshlrev_b32 v21, 4, v2
    v_add_u32 v20, v20, v21

    s_add_u32 s48, s47, 0
    buffer_load_dwordx4 a[160:163], v20, s[28:31], s48 offen offset:0
    buffer_load_dwordx4 a[164:167], v20, s[28:31], s48 offen offset:64
    buffer_load_dwordx4 a[168:171], v20, s[28:31], s48 offen offset:128
    buffer_load_dwordx4 a[172:175], v20, s[28:31], s48 offen offset:192
    s_add_u32 s48, s47, 4096
    buffer_load_dwordx4 a[176:179], v20, s[28:31], s48 offen offset:0
    buffer_load_dwordx4 a[180:183], v20, s[28:31], s48 offen offset:64
    buffer_load_dwordx4 a[184:187], v20, s[28:31], s48 offen offset:128
    buffer_load_dwordx4 a[188:191], v20, s[28:31], s48 offen offset:192
    s_add_u32 s48, s47, 8192
    buffer_load_dwordx4 a[192:195], v20, s[28:31], s48 offen offset:0
    buffer_load_dwordx4 a[196:199], v20, s[28:31], s48 offen offset:64
    buffer_load_dwordx4 a[200:203], v20, s[28:31], s48 offen offset:128
    buffer_load_dwordx4 a[204:207], v20, s[28:31], s48 offen offset:192
    s_add_u32 s48, s47, 12288
    buffer_load_dwordx4 a[208:211], v20, s[28:31], s48 offen offset:0
    buffer_load_dwordx4 a[212:215], v20, s[28:31], s48 offen offset:64
    buffer_load_dwordx4 a[216:219], v20, s[28:31], s48 offen offset:128
    buffer_load_dwordx4 a[220:223], v20, s[28:31], s48 offen offset:192
    s_add_u32 s48, s47, 16384
    buffer_load_dwordx4 a[224:227], v20, s[28:31], s48 offen offset:0
    buffer_load_dwordx4 a[228:231], v20, s[28:31], s48 offen offset:64
    buffer_load_dwordx4 a[232:235], v20, s[28:31], s48 offen offset:128
    buffer_load_dwordx4 a[236:239], v20, s[28:31], s48 offen offset:192
    v_lshlrev_b32 v20, 8, v2
    v_xor_b32 v21, v3, v2
    v_lshlrev_b32 v22, 1, v2
    v_xor_b32 v22, v3, v22

    v_cmp_eq_u32 vcc, 0, s40
    s_nop 1
    v_cndmask_b32 v21, v22, v21, vcc
    s_cmp_eq_u32 s40, 0
    s_cselect_b32 s47, 4, 8
    s_cselect_b32 s48, 8, 0
    s_cselect_b32 s49, 12, 8
    v_lshlrev_b32 v4, 4, v21
    v_add_u32 v4, v4, v20
    v_xor_b32 v22, s47, v21
    v_lshlrev_b32 v5, 4, v22
    v_add_u32 v5, v5, v20
    v_xor_b32 v22, s48, v21
    v_lshlrev_b32 v6, 4, v22
    v_add_u32 v6, v6, v20
    v_xor_b32 v22, s49, v21
    v_lshlrev_b32 v7, 4, v22
    v_add_u32 v7, v7, v20

    v_xor_b32 v20, v2, v3
    v_lshlrev_b32 v20, 4, v20
    v_lshlrev_b32 v21, 8, v3
    v_add_u32 v20, v20, v21
    s_lshl_b32 s47, s41, 13
    s_add_u32 s48, s47, 0
    v_add_u32 v8, s48, v20
    v_xor_b32 v9, 64, v8
    v_xor_b32 v10, 128, v8
    v_xor_b32 v11, 192, v8

    v_lshrrev_b32 v20, 2, v3
    v_and_b32 v21, 3, v3
    v_lshlrev_b32 v22, 2, v2
    v_add_u32 v20, v20, v22
    v_and_b32 v22, 7, v20
    v_lshlrev_b32 v22, 5, v22
    v_lshlrev_b32 v20, 8, v20
    v_add_u32 v20, v20, v22
    v_lshlrev_b32 v21, 3, v21
    v_add_u32 v20, v20, v21
    s_add_u32 s48, s47, 65536
    v_add_u32 v12, s48, v20

    v_xor_b32 v13, 32, v12
    v_xor_b32 v14, 64, v12
    v_xor_b32 v15, 96, v12
    v_xor_b32 v16, 128, v12
    v_xor_b32 v17, 160, v12
    v_xor_b32 v18, 192, v12
    v_xor_b32 v19, 224, v12
    v_accvgpr_write_b32 a0, 0
    v_accvgpr_write_b32 a1, 0
    v_accvgpr_write_b32 a2, 0
    v_accvgpr_write_b32 a3, 0
    v_accvgpr_write_b32 a4, 0
    v_accvgpr_write_b32 a5, 0
    v_accvgpr_write_b32 a6, 0
    v_accvgpr_write_b32 a7, 0
    v_accvgpr_write_b32 a8, 0
    v_accvgpr_write_b32 a9, 0
    v_accvgpr_write_b32 a10, 0
    v_accvgpr_write_b32 a11, 0
    v_accvgpr_write_b32 a12, 0
    v_accvgpr_write_b32 a13, 0
    v_accvgpr_write_b32 a14, 0
    v_accvgpr_write_b32 a15, 0
    v_accvgpr_write_b32 a16, 0
    v_accvgpr_write_b32 a17, 0
    v_accvgpr_write_b32 a18, 0
    v_accvgpr_write_b32 a19, 0
    v_accvgpr_write_b32 a20, 0
    v_accvgpr_write_b32 a21, 0
    v_accvgpr_write_b32 a22, 0
    v_accvgpr_write_b32 a23, 0
    v_accvgpr_write_b32 a24, 0
    v_accvgpr_write_b32 a25, 0
    v_accvgpr_write_b32 a26, 0
    v_accvgpr_write_b32 a27, 0
    v_accvgpr_write_b32 a28, 0
    v_accvgpr_write_b32 a29, 0
    v_accvgpr_write_b32 a30, 0
    v_accvgpr_write_b32 a31, 0
    v_accvgpr_write_b32 a32, 0
    v_accvgpr_write_b32 a33, 0
    v_accvgpr_write_b32 a34, 0
    v_accvgpr_write_b32 a35, 0
    v_accvgpr_write_b32 a36, 0
    v_accvgpr_write_b32 a37, 0
    v_accvgpr_write_b32 a38, 0
    v_accvgpr_write_b32 a39, 0
    v_accvgpr_write_b32 a40, 0
    v_accvgpr_write_b32 a41, 0
    v_accvgpr_write_b32 a42, 0
    v_accvgpr_write_b32 a43, 0
    v_accvgpr_write_b32 a44, 0
    v_accvgpr_write_b32 a45, 0
    v_accvgpr_write_b32 a46, 0
    v_accvgpr_write_b32 a47, 0
    v_accvgpr_write_b32 a48, 0
    v_accvgpr_write_b32 a49, 0
    v_accvgpr_write_b32 a50, 0
    v_accvgpr_write_b32 a51, 0
    v_accvgpr_write_b32 a52, 0
    v_accvgpr_write_b32 a53, 0
    v_accvgpr_write_b32 a54, 0
    v_accvgpr_write_b32 a55, 0
    v_accvgpr_write_b32 a56, 0
    v_accvgpr_write_b32 a57, 0
    v_accvgpr_write_b32 a58, 0
    v_accvgpr_write_b32 a59, 0
    v_accvgpr_write_b32 a60, 0
    v_accvgpr_write_b32 a61, 0
    v_accvgpr_write_b32 a62, 0
    v_accvgpr_write_b32 a63, 0
    v_accvgpr_write_b32 a64, 0
    v_accvgpr_write_b32 a65, 0
    v_accvgpr_write_b32 a66, 0
    v_accvgpr_write_b32 a67, 0
    v_accvgpr_write_b32 a68, 0
    v_accvgpr_write_b32 a69, 0
    v_accvgpr_write_b32 a70, 0
    v_accvgpr_write_b32 a71, 0
    v_accvgpr_write_b32 a72, 0
    v_accvgpr_write_b32 a73, 0
    v_accvgpr_write_b32 a74, 0
    v_accvgpr_write_b32 a75, 0
    v_accvgpr_write_b32 a76, 0
    v_accvgpr_write_b32 a77, 0
    v_accvgpr_write_b32 a78, 0
    v_accvgpr_write_b32 a79, 0
    v_accvgpr_write_b32 a80, 0
    v_accvgpr_write_b32 a81, 0
    v_accvgpr_write_b32 a82, 0
    v_accvgpr_write_b32 a83, 0
    v_accvgpr_write_b32 a84, 0
    v_accvgpr_write_b32 a85, 0
    v_accvgpr_write_b32 a86, 0
    v_accvgpr_write_b32 a87, 0
    v_accvgpr_write_b32 a88, 0
    v_accvgpr_write_b32 a89, 0
    v_accvgpr_write_b32 a90, 0
    v_accvgpr_write_b32 a91, 0
    v_accvgpr_write_b32 a92, 0
    v_accvgpr_write_b32 a93, 0
    v_accvgpr_write_b32 a94, 0
    v_accvgpr_write_b32 a95, 0
    v_accvgpr_write_b32 a96, 0
    v_accvgpr_write_b32 a97, 0
    v_accvgpr_write_b32 a98, 0
    v_accvgpr_write_b32 a99, 0
    v_accvgpr_write_b32 a100, 0
    v_accvgpr_write_b32 a101, 0
    v_accvgpr_write_b32 a102, 0
    v_accvgpr_write_b32 a103, 0
    v_accvgpr_write_b32 a104, 0
    v_accvgpr_write_b32 a105, 0
    v_accvgpr_write_b32 a106, 0
    v_accvgpr_write_b32 a107, 0
    v_accvgpr_write_b32 a108, 0
    v_accvgpr_write_b32 a109, 0
    v_accvgpr_write_b32 a110, 0
    v_accvgpr_write_b32 a111, 0
    v_accvgpr_write_b32 a112, 0
    v_accvgpr_write_b32 a113, 0
    v_accvgpr_write_b32 a114, 0
    v_accvgpr_write_b32 a115, 0
    v_accvgpr_write_b32 a116, 0
    v_accvgpr_write_b32 a117, 0
    v_accvgpr_write_b32 a118, 0
    v_accvgpr_write_b32 a119, 0
    v_accvgpr_write_b32 a120, 0
    v_accvgpr_write_b32 a121, 0
    v_accvgpr_write_b32 a122, 0
    v_accvgpr_write_b32 a123, 0
    v_accvgpr_write_b32 a124, 0
    v_accvgpr_write_b32 a125, 0
    v_accvgpr_write_b32 a126, 0
    v_accvgpr_write_b32 a127, 0
    v_accvgpr_write_b32 a128, 0
    v_accvgpr_write_b32 a129, 0
    v_accvgpr_write_b32 a130, 0
    v_accvgpr_write_b32 a131, 0
    v_accvgpr_write_b32 a132, 0
    v_accvgpr_write_b32 a133, 0
    v_accvgpr_write_b32 a134, 0
    v_accvgpr_write_b32 a135, 0
    v_accvgpr_write_b32 a136, 0
    v_accvgpr_write_b32 a137, 0
    v_accvgpr_write_b32 a138, 0
    v_accvgpr_write_b32 a139, 0
    v_accvgpr_write_b32 a140, 0
    v_accvgpr_write_b32 a141, 0
    v_accvgpr_write_b32 a142, 0
    v_accvgpr_write_b32 a143, 0
    v_accvgpr_write_b32 a144, 0
    v_accvgpr_write_b32 a145, 0
    v_accvgpr_write_b32 a146, 0
    v_accvgpr_write_b32 a147, 0
    v_accvgpr_write_b32 a148, 0
    v_accvgpr_write_b32 a149, 0
    v_accvgpr_write_b32 a150, 0
    v_accvgpr_write_b32 a151, 0
    v_accvgpr_write_b32 a152, 0
    v_accvgpr_write_b32 a153, 0
    v_accvgpr_write_b32 a154, 0
    v_accvgpr_write_b32 a155, 0
    v_accvgpr_write_b32 a156, 0
    v_accvgpr_write_b32 a157, 0
    v_accvgpr_write_b32 a158, 0
    v_accvgpr_write_b32 a159, 0
    v_mov_b32 v196, 0
    v_mov_b32 v197, 0
    v_mov_b32 v198, 0
    v_mov_b32 v199, 0
    v_mov_b32 v200, 0
    v_mov_b32 v201, 0
    v_mov_b32 v202, 0
    v_mov_b32 v203, 0
    v_mov_b32 v204, 0
    v_mov_b32 v205, 0
    v_mov_b32 v206, 0
    v_mov_b32 v207, 0
    v_mov_b32 v208, 0
    v_mov_b32 v209, 0
    v_mov_b32 v210, 0
    v_mov_b32 v211, 0
    v_mov_b32 v212, 0
    v_mov_b32 v213, 0
    v_mov_b32 v214, 0
    v_mov_b32 v215, 0
    v_mov_b32 v216, 0
    v_mov_b32 v221, 0
    v_mov_b32 v217, 0
    v_mov_b32 v222, 0
    v_mov_b32 v218, 0
    v_mov_b32 v223, 0
    v_mov_b32 v219, 0
    v_mov_b32 v224, 0
    v_mov_b32 v220, 0
    v_mov_b32 v225, 0
    s_mov_b32 s50, 0xff800000
    s_mov_b32 s51, 0xff800000
    s_cmp_eq_u32 s40, 0
    s_cselect_b32 s44, 0, 0
    s_lshl_b32 s45, s44, 13
    s_add_u32 s45, s45, s42
    s_and_b32 s46, s44, 3
    s_lshl_b32 s46, s46, 14
    s_add_u32 s46, s46, s43
    s_add_u32 s47, s46, 0
    s_mov_b32 m0, s47
    s_add_u32 s48, s45, 0
    buffer_load_dwordx4 v4, s[32:35], s48 offen lds
    s_add_u32 s47, s46, 1024
    s_mov_b32 m0, s47
    s_add_u32 s48, s45, 1024
    buffer_load_dwordx4 v5, s[32:35], s48 offen lds
    s_add_u32 s47, s46, 2048
    s_mov_b32 m0, s47
    s_add_u32 s48, s45, 2048
    buffer_load_dwordx4 v6, s[32:35], s48 offen lds
    s_add_u32 s47, s46, 3072
    s_mov_b32 m0, s47
    s_add_u32 s48, s45, 3072
    buffer_load_dwordx4 v7, s[32:35], s48 offen lds
    s_add_u32 s47, s46, 4096
    s_mov_b32 m0, s47
    s_add_u32 s48, s45, 4096
    buffer_load_dwordx4 v4, s[32:35], s48 offen lds
    s_add_u32 s47, s46, 5120
    s_mov_b32 m0, s47
    s_add_u32 s48, s45, 5120
    buffer_load_dwordx4 v5, s[32:35], s48 offen lds
    s_add_u32 s47, s46, 6144
    s_mov_b32 m0, s47
    s_add_u32 s48, s45, 6144
    buffer_load_dwordx4 v6, s[32:35], s48 offen lds
    s_add_u32 s47, s46, 7168
    s_mov_b32 m0, s47
    s_add_u32 s48, s45, 7168
    buffer_load_dwordx4 v7, s[32:35], s48 offen lds
    s_cmp_eq_u32 s40, 0
    s_cselect_b32 s44, 1, 1
    s_lshl_b32 s45, s44, 13
    s_add_u32 s45, s45, s42
    s_and_b32 s46, s44, 3
    s_lshl_b32 s46, s46, 14
    s_add_u32 s46, s46, s43
    s_add_u32 s47, s46, 0
    s_mov_b32 m0, s47
    s_add_u32 s48, s45, 0
    buffer_load_dwordx4 v4, s[32:35], s48 offen lds
    s_add_u32 s47, s46, 1024
    s_mov_b32 m0, s47
    s_add_u32 s48, s45, 1024
    buffer_load_dwordx4 v5, s[32:35], s48 offen lds
    s_add_u32 s47, s46, 2048
    s_mov_b32 m0, s47
    s_add_u32 s48, s45, 2048
    buffer_load_dwordx4 v6, s[32:35], s48 offen lds
    s_add_u32 s47, s46, 3072
    s_mov_b32 m0, s47
    s_add_u32 s48, s45, 3072
    buffer_load_dwordx4 v7, s[32:35], s48 offen lds
    s_add_u32 s47, s46, 4096
    s_mov_b32 m0, s47
    s_add_u32 s48, s45, 4096
    buffer_load_dwordx4 v4, s[32:35], s48 offen lds
    s_add_u32 s47, s46, 5120
    s_mov_b32 m0, s47
    s_add_u32 s48, s45, 5120
    buffer_load_dwordx4 v5, s[32:35], s48 offen lds
    s_add_u32 s47, s46, 6144
    s_mov_b32 m0, s47
    s_add_u32 s48, s45, 6144
    buffer_load_dwordx4 v6, s[32:35], s48 offen lds
    s_add_u32 s47, s46, 7168
    s_mov_b32 m0, s47
    s_add_u32 s48, s45, 7168
    buffer_load_dwordx4 v7, s[32:35], s48 offen lds
    s_cmp_eq_u32 s40, 0
    s_cselect_b32 s44, 2, 2
    s_lshl_b32 s45, s44, 13
    s_add_u32 s45, s45, s42
    s_and_b32 s46, s44, 3
    s_lshl_b32 s46, s46, 14
    s_add_u32 s46, s46, s43
    s_add_u32 s47, s46, 0
    s_mov_b32 m0, s47
    s_add_u32 s48, s45, 0
    buffer_load_dwordx4 v4, s[32:35], s48 offen lds
    s_add_u32 s47, s46, 1024
    s_mov_b32 m0, s47
    s_add_u32 s48, s45, 1024
    buffer_load_dwordx4 v5, s[32:35], s48 offen lds
    s_add_u32 s47, s46, 2048
    s_mov_b32 m0, s47
    s_add_u32 s48, s45, 2048
    buffer_load_dwordx4 v6, s[32:35], s48 offen lds
    s_add_u32 s47, s46, 3072
    s_mov_b32 m0, s47
    s_add_u32 s48, s45, 3072
    buffer_load_dwordx4 v7, s[32:35], s48 offen lds
    s_add_u32 s47, s46, 4096
    s_mov_b32 m0, s47
    s_add_u32 s48, s45, 4096
    buffer_load_dwordx4 v4, s[32:35], s48 offen lds
    s_add_u32 s47, s46, 5120
    s_mov_b32 m0, s47
    s_add_u32 s48, s45, 5120
    buffer_load_dwordx4 v5, s[32:35], s48 offen lds
    s_add_u32 s47, s46, 6144
    s_mov_b32 m0, s47
    s_add_u32 s48, s45, 6144
    buffer_load_dwordx4 v6, s[32:35], s48 offen lds
    s_add_u32 s47, s46, 7168
    s_mov_b32 m0, s47
    s_add_u32 s48, s45, 7168
    buffer_load_dwordx4 v7, s[32:35], s48 offen lds
    s_cmp_eq_u32 s40, 1
    s_cbranch_scc1 k1_kernel_L1
    s_cmp_eq_u32 s40, 0
    s_cselect_b32 s44, 3, 0
    s_lshl_b32 s45, s44, 13
    s_add_u32 s45, s45, s42
    s_and_b32 s46, s44, 3
    s_lshl_b32 s46, s46, 14
    s_add_u32 s46, s46, s43
    s_add_u32 s47, s46, 0
    s_mov_b32 m0, s47
    s_add_u32 s48, s45, 0
    buffer_load_dwordx4 v4, s[32:35], s48 offen lds
    s_add_u32 s47, s46, 1024
    s_mov_b32 m0, s47
    s_add_u32 s48, s45, 1024
    buffer_load_dwordx4 v5, s[32:35], s48 offen lds
    s_add_u32 s47, s46, 2048
    s_mov_b32 m0, s47
    s_add_u32 s48, s45, 2048
    buffer_load_dwordx4 v6, s[32:35], s48 offen lds
    s_add_u32 s47, s46, 3072
    s_mov_b32 m0, s47
    s_add_u32 s48, s45, 3072
    buffer_load_dwordx4 v7, s[32:35], s48 offen lds
    s_add_u32 s47, s46, 4096
    s_mov_b32 m0, s47
    s_add_u32 s48, s45, 4096
    buffer_load_dwordx4 v4, s[32:35], s48 offen lds
    s_add_u32 s47, s46, 5120
    s_mov_b32 m0, s47
    s_add_u32 s48, s45, 5120
    buffer_load_dwordx4 v5, s[32:35], s48 offen lds
    s_add_u32 s47, s46, 6144
    s_mov_b32 m0, s47
    s_add_u32 s48, s45, 6144
    buffer_load_dwordx4 v6, s[32:35], s48 offen lds
    s_add_u32 s47, s46, 7168
    s_mov_b32 m0, s47
    s_add_u32 s48, s45, 7168
    buffer_load_dwordx4 v7, s[32:35], s48 offen lds
k1_kernel_L1:
    s_waitcnt vmcnt(24)
    s_barrier
    ds_read_b128 v[132:135], v8 offset:0
    ds_read_b128 v[136:139], v9 offset:0
    ds_read_b128 v[140:143], v10 offset:0
    ds_read_b128 v[144:147], v11 offset:0
    ds_read_b128 v[148:151], v8 offset:4096
    ds_read_b128 v[152:155], v9 offset:4096
    ds_read_b128 v[156:159], v10 offset:4096
    ds_read_b128 v[160:163], v11 offset:4096
    s_waitcnt lgkmcnt(0)
    v_mfma_f32_16x16x32_bf16 v[32:35], v[132:135], a[160:163], v[196:199]
    v_mfma_f32_16x16x32_bf16 v[36:39], v[132:135], a[176:179], v[200:203]
    v_mfma_f32_16x16x32_bf16 v[40:43], v[132:135], a[192:195], v[204:207]
    v_mfma_f32_16x16x32_bf16 v[44:47], v[132:135], a[208:211], v[208:211]
    v_mfma_f32_16x16x32_bf16 v[48:51], v[132:135], a[224:227], v[212:215]
    v_mfma_f32_16x16x32_bf16 v[52:55], v[148:151], a[160:163], v[196:199]
    v_mfma_f32_16x16x32_bf16 v[56:59], v[148:151], a[176:179], v[200:203]
    v_mfma_f32_16x16x32_bf16 v[60:63], v[148:151], a[192:195], v[204:207]
    v_mfma_f32_16x16x32_bf16 v[64:67], v[148:151], a[208:211], v[208:211]
    v_mfma_f32_16x16x32_bf16 v[68:71], v[148:151], a[224:227], v[212:215]
    v_mfma_f32_16x16x32_bf16 v[32:35], v[136:139], a[164:167], v[32:35]
    v_mfma_f32_16x16x32_bf16 v[36:39], v[136:139], a[180:183], v[36:39]
    v_mfma_f32_16x16x32_bf16 v[40:43], v[136:139], a[196:199], v[40:43]
    v_mfma_f32_16x16x32_bf16 v[44:47], v[136:139], a[212:215], v[44:47]
    v_mfma_f32_16x16x32_bf16 v[48:51], v[136:139], a[228:231], v[48:51]
    v_mfma_f32_16x16x32_bf16 v[52:55], v[152:155], a[164:167], v[52:55]
    v_mfma_f32_16x16x32_bf16 v[56:59], v[152:155], a[180:183], v[56:59]
    v_mfma_f32_16x16x32_bf16 v[60:63], v[152:155], a[196:199], v[60:63]
    v_mfma_f32_16x16x32_bf16 v[64:67], v[152:155], a[212:215], v[64:67]
    v_mfma_f32_16x16x32_bf16 v[68:71], v[152:155], a[228:231], v[68:71]
    v_mfma_f32_16x16x32_bf16 v[32:35], v[140:143], a[168:171], v[32:35]
    v_mfma_f32_16x16x32_bf16 v[36:39], v[140:143], a[184:187], v[36:39]
    v_mfma_f32_16x16x32_bf16 v[40:43], v[140:143], a[200:203], v[40:43]
    v_mfma_f32_16x16x32_bf16 v[44:47], v[140:143], a[216:219], v[44:47]
    v_mfma_f32_16x16x32_bf16 v[48:51], v[140:143], a[232:235], v[48:51]
    v_mfma_f32_16x16x32_bf16 v[52:55], v[156:159], a[168:171], v[52:55]
    v_mfma_f32_16x16x32_bf16 v[56:59], v[156:159], a[184:187], v[56:59]
    v_mfma_f32_16x16x32_bf16 v[60:63], v[156:159], a[200:203], v[60:63]
    v_mfma_f32_16x16x32_bf16 v[64:67], v[156:159], a[216:219], v[64:67]
    v_mfma_f32_16x16x32_bf16 v[68:71], v[156:159], a[232:235], v[68:71]
    v_mfma_f32_16x16x32_bf16 v[32:35], v[144:147], a[172:175], v[32:35]
    v_mfma_f32_16x16x32_bf16 v[36:39], v[144:147], a[188:191], v[36:39]
    v_mfma_f32_16x16x32_bf16 v[40:43], v[144:147], a[204:207], v[40:43]
    v_mfma_f32_16x16x32_bf16 v[44:47], v[144:147], a[220:223], v[44:47]
    v_mfma_f32_16x16x32_bf16 v[48:51], v[144:147], a[236:239], v[48:51]
    v_mfma_f32_16x16x32_bf16 v[52:55], v[160:163], a[172:175], v[52:55]
    v_mfma_f32_16x16x32_bf16 v[56:59], v[160:163], a[188:191], v[56:59]
    v_mfma_f32_16x16x32_bf16 v[60:63], v[160:163], a[204:207], v[60:63]
    v_mfma_f32_16x16x32_bf16 v[64:67], v[160:163], a[220:223], v[64:67]
    v_mfma_f32_16x16x32_bf16 v[68:71], v[160:163], a[236:239], v[68:71]
    s_waitcnt vmcnt(16)
    s_barrier
    s_cmp_eq_u32 s40, 1
    s_cbranch_scc1 k1_kernel_L2
    s_cmp_eq_u32 s40, 0
    s_cselect_b32 s44, 4, 0
    s_lshl_b32 s45, s44, 13
    s_add_u32 s45, s45, s42
    s_and_b32 s46, s44, 3
    s_lshl_b32 s46, s46, 14
    s_add_u32 s46, s46, s43
    s_add_u32 s47, s46, 0
    s_mov_b32 m0, s47
    s_add_u32 s48, s45, 0
    buffer_load_dwordx4 v4, s[32:35], s48 offen lds
    s_add_u32 s47, s46, 1024
    s_mov_b32 m0, s47
    s_add_u32 s48, s45, 1024
    buffer_load_dwordx4 v5, s[32:35], s48 offen lds
    s_add_u32 s47, s46, 2048
    s_mov_b32 m0, s47
    s_add_u32 s48, s45, 2048
    buffer_load_dwordx4 v6, s[32:35], s48 offen lds
    s_add_u32 s47, s46, 3072
    s_mov_b32 m0, s47
    s_add_u32 s48, s45, 3072
    buffer_load_dwordx4 v7, s[32:35], s48 offen lds
    s_add_u32 s47, s46, 4096
    s_mov_b32 m0, s47
    s_add_u32 s48, s45, 4096
    buffer_load_dwordx4 v4, s[32:35], s48 offen lds
    s_add_u32 s47, s46, 5120
    s_mov_b32 m0, s47
    s_add_u32 s48, s45, 5120
    buffer_load_dwordx4 v5, s[32:35], s48 offen lds
    s_add_u32 s47, s46, 6144
    s_mov_b32 m0, s47
    s_add_u32 s48, s45, 6144
    buffer_load_dwordx4 v6, s[32:35], s48 offen lds
    s_add_u32 s47, s46, 7168
    s_mov_b32 m0, s47
    s_add_u32 s48, s45, 7168
    buffer_load_dwordx4 v7, s[32:35], s48 offen lds
k1_kernel_L2:
    ds_read_b128 v[132:135], v8 offset:16384
    ds_read_b128 v[136:139], v9 offset:16384
    ds_read_b128 v[140:143], v10 offset:16384
    ds_read_b128 v[144:147], v11 offset:16384
    ds_read_b128 v[148:151], v8 offset:20480
    ds_read_b128 v[152:155], v9 offset:20480
    ds_read_b128 v[156:159], v10 offset:20480
    ds_read_b128 v[160:163], v11 offset:20480
    s_nop 4
    v_max3_f32 v226, v32, v33, v34
    v_max3_f32 v226, v226, v35, v36
    v_max3_f32 v226, v226, v37, v38
    v_max3_f32 v226, v226, v39, v40
    v_max3_f32 v226, v226, v41, v42
    v_max3_f32 v226, v226, v43, v44
    v_max3_f32 v226, v226, v45, v46
    v_max3_f32 v226, v226, v47, v48
    v_max3_f32 v226, v226, v49, v50
    v_max3_f32 v226, v226, v51, v52
    v_max3_f32 v226, v226, v53, v54
    v_max3_f32 v226, v226, v55, v56
    v_max3_f32 v226, v226, v57, v58
    v_max3_f32 v226, v226, v59, v60
    v_max3_f32 v226, v226, v61, v62
    v_max3_f32 v226, v226, v63, v64
    v_max3_f32 v226, v226, v65, v66
    v_max3_f32 v226, v226, v67, v68
    v_max3_f32 v226, v226, v69, v70
    v_max_f32 v226, v226, v71
    s_nop 0
    v_cmp_lt_f32 vcc, s50, v226
    s_nop 1
    s_cbranch_vccnz k1_kernel_L3
k1_kernel_L4:
    s_waitcnt vmcnt(16)
    s_barrier
    s_cmp_eq_u32 s40, 0
    s_cselect_b32 s44, 5, 3
    s_lshl_b32 s45, s44, 13
    s_add_u32 s45, s45, s42
    s_and_b32 s46, s44, 3
    s_lshl_b32 s46, s46, 14
    s_add_u32 s46, s46, s43
    s_add_u32 s47, s46, 0
    s_mov_b32 m0, s47
    s_add_u32 s48, s45, 0
    buffer_load_dwordx4 v4, s[32:35], s48 offen lds
    s_add_u32 s47, s46, 1024
    s_mov_b32 m0, s47
    s_add_u32 s48, s45, 1024
    buffer_load_dwordx4 v5, s[32:35], s48 offen lds
    s_add_u32 s47, s46, 2048
    s_mov_b32 m0, s47
    s_add_u32 s48, s45, 2048
    buffer_load_dwordx4 v6, s[32:35], s48 offen lds
    s_add_u32 s47, s46, 3072
    s_mov_b32 m0, s47
    s_add_u32 s48, s45, 3072
    buffer_load_dwordx4 v7, s[32:35], s48 offen lds
    s_add_u32 s47, s46, 4096
    s_mov_b32 m0, s47
    s_add_u32 s48, s45, 4096
    buffer_load_dwordx4 v4, s[32:35], s48 offen lds
    s_add_u32 s47, s46, 5120
    s_mov_b32 m0, s47
    s_add_u32 s48, s45, 5120
    buffer_load_dwordx4 v5, s[32:35], s48 offen lds
    s_add_u32 s47, s46, 6144
    s_mov_b32 m0, s47
    s_add_u32 s48, s45, 6144
    buffer_load_dwordx4 v6, s[32:35], s48 offen lds
    s_add_u32 s47, s46, 7168
    s_mov_b32 m0, s47
    s_add_u32 s48, s45, 7168
    buffer_load_dwordx4 v7, s[32:35], s48 offen lds
    s_waitcnt lgkmcnt(0)
    v_mfma_f32_16x16x32_bf16 v[72:75], v[132:135], a[160:163], v[196:199]
    ds_read_b64_tr_b16 v[164:165], v12 offset:0
    v_mfma_f32_16x16x32_bf16 v[76:79], v[132:135], a[176:179], v[200:203]
    ds_read_b64_tr_b16 v[166:167], v12 offset:4096
    ds_read_b64_tr_b16 v[168:169], v13 offset:0
    v_mfma_f32_16x16x32_bf16 v[80:83], v[132:135], a[192:195], v[204:207]
    ds_read_b64_tr_b16 v[170:171], v13 offset:4096
    ds_read_b64_tr_b16 v[172:173], v14 offset:0
    v_mfma_f32_16x16x32_bf16 v[84:87], v[132:135], a[208:211], v[208:211]
    ds_read_b64_tr_b16 v[174:175], v14 offset:4096
    ds_read_b64_tr_b16 v[176:177], v15 offset:0
    v_mfma_f32_16x16x32_bf16 v[88:91], v[132:135], a[224:227], v[212:215]
    ds_read_b64_tr_b16 v[178:179], v15 offset:4096
    ds_read_b64_tr_b16 v[180:181], v16 offset:0
    v_mfma_f32_16x16x32_bf16 v[92:95], v[148:151], a[160:163], v[196:199]
    ds_read_b64_tr_b16 v[182:183], v16 offset:4096
    ds_read_b64_tr_b16 v[184:185], v17 offset:0
    v_mfma_f32_16x16x32_bf16 v[96:99], v[148:151], a[176:179], v[200:203]
    ds_read_b64_tr_b16 v[186:187], v17 offset:4096
    ds_read_b64_tr_b16 v[188:189], v18 offset:0
    v_mfma_f32_16x16x32_bf16 v[100:103], v[148:151], a[192:195], v[204:207]
    ds_read_b64_tr_b16 v[190:191], v18 offset:4096
    ds_read_b64_tr_b16 v[192:193], v19 offset:0
    v_mfma_f32_16x16x32_bf16 v[104:107], v[148:151], a[208:211], v[208:211]
    ds_read_b64_tr_b16 v[194:195], v19 offset:4096
    v_exp_f32 v32, v32
    v_mfma_f32_16x16x32_bf16 v[108:111], v[148:151], a[224:227], v[212:215]
    v_exp_f32 v33, v33
    v_exp_f32 v34, v34
    v_mfma_f32_16x16x32_bf16 v[72:75], v[136:139], a[164:167], v[72:75]
    v_exp_f32 v35, v35
    v_mfma_f32_16x16x32_bf16 v[76:79], v[136:139], a[180:183], v[76:79]
    v_cvt_pk_bf16_f32 v112, v32, v33
    v_cvt_pk_bf16_f32 v113, v34, v35
    v_mfma_f32_16x16x32_bf16 v[80:83], v[136:139], a[196:199], v[80:83]
    v_exp_f32 v52, v52
    v_exp_f32 v53, v53
    v_mfma_f32_16x16x32_bf16 v[84:87], v[136:139], a[212:215], v[84:87]
    v_exp_f32 v54, v54
    v_exp_f32 v55, v55
    v_mfma_f32_16x16x32_bf16 v[88:91], v[136:139], a[228:231], v[88:91]
    v_cvt_pk_bf16_f32 v114, v52, v53
    v_cvt_pk_bf16_f32 v115, v54, v55
    v_mfma_f32_16x16x32_bf16 v[92:95], v[152:155], a[164:167], v[92:95]
    v_exp_f32 v36, v36
    v_exp_f32 v37, v37
    v_mfma_f32_16x16x32_bf16 v[96:99], v[152:155], a[180:183], v[96:99]
    v_exp_f32 v38, v38
    v_exp_f32 v39, v39
    v_mfma_f32_16x16x32_bf16 v[100:103], v[152:155], a[196:199], v[100:103]
    v_cvt_pk_bf16_f32 v116, v36, v37
    v_cvt_pk_bf16_f32 v117, v38, v39
    v_mfma_f32_16x16x32_bf16 v[104:107], v[152:155], a[212:215], v[104:107]
    v_exp_f32 v56, v56
    v_exp_f32 v57, v57
    v_mfma_f32_16x16x32_bf16 v[108:111], v[152:155], a[228:231], v[108:111]
    v_exp_f32 v58, v58
    v_exp_f32 v59, v59
    v_mfma_f32_16x16x32_bf16 v[72:75], v[140:143], a[168:171], v[72:75]
    v_cvt_pk_bf16_f32 v118, v56, v57
    v_mfma_f32_16x16x32_bf16 v[76:79], v[140:143], a[184:187], v[76:79]
    v_cvt_pk_bf16_f32 v119, v58, v59
    v_exp_f32 v40, v40
    v_mfma_f32_16x16x32_bf16 v[80:83], v[140:143], a[200:203], v[80:83]
    v_exp_f32 v41, v41
    v_exp_f32 v42, v42
    v_mfma_f32_16x16x32_bf16 v[84:87], v[140:143], a[216:219], v[84:87]
    v_exp_f32 v43, v43
    v_cvt_pk_bf16_f32 v120, v40, v41
    v_mfma_f32_16x16x32_bf16 v[88:91], v[140:143], a[232:235], v[88:91]
    v_cvt_pk_bf16_f32 v121, v42, v43
    v_exp_f32 v60, v60
    v_mfma_f32_16x16x32_bf16 v[92:95], v[156:159], a[168:171], v[92:95]
    v_exp_f32 v61, v61
    v_exp_f32 v62, v62
    v_mfma_f32_16x16x32_bf16 v[96:99], v[156:159], a[184:187], v[96:99]
    v_exp_f32 v63, v63
    v_cvt_pk_bf16_f32 v122, v60, v61
    v_mfma_f32_16x16x32_bf16 v[100:103], v[156:159], a[200:203], v[100:103]
    v_cvt_pk_bf16_f32 v123, v62, v63
    v_exp_f32 v44, v44
    v_mfma_f32_16x16x32_bf16 v[104:107], v[156:159], a[216:219], v[104:107]
    v_exp_f32 v45, v45
    v_exp_f32 v46, v46
    v_mfma_f32_16x16x32_bf16 v[108:111], v[156:159], a[232:235], v[108:111]
    v_exp_f32 v47, v47
    v_cvt_pk_bf16_f32 v124, v44, v45
    v_mfma_f32_16x16x32_bf16 v[72:75], v[144:147], a[172:175], v[72:75]
    v_cvt_pk_bf16_f32 v125, v46, v47
    v_mfma_f32_16x16x32_bf16 v[76:79], v[144:147], a[188:191], v[76:79]
    v_exp_f32 v64, v64
    v_exp_f32 v65, v65
    v_mfma_f32_16x16x32_bf16 v[80:83], v[144:147], a[204:207], v[80:83]
    v_exp_f32 v66, v66
    v_exp_f32 v67, v67
    v_mfma_f32_16x16x32_bf16 v[84:87], v[144:147], a[220:223], v[84:87]
    v_cvt_pk_bf16_f32 v126, v64, v65
    v_cvt_pk_bf16_f32 v127, v66, v67
    v_mfma_f32_16x16x32_bf16 v[88:91], v[144:147], a[236:239], v[88:91]
    v_exp_f32 v48, v48
    v_exp_f32 v49, v49
    v_mfma_f32_16x16x32_bf16 v[92:95], v[160:163], a[172:175], v[92:95]
    v_exp_f32 v50, v50
    v_exp_f32 v51, v51
    v_mfma_f32_16x16x32_bf16 v[96:99], v[160:163], a[188:191], v[96:99]
    v_cvt_pk_bf16_f32 v128, v48, v49
    v_cvt_pk_bf16_f32 v129, v50, v51
    v_mfma_f32_16x16x32_bf16 v[100:103], v[160:163], a[204:207], v[100:103]
    v_exp_f32 v68, v68
    v_exp_f32 v69, v69
    v_mfma_f32_16x16x32_bf16 v[104:107], v[160:163], a[220:223], v[104:107]
    v_exp_f32 v70, v70
    v_exp_f32 v71, v71
    v_mfma_f32_16x16x32_bf16 v[108:111], v[160:163], a[236:239], v[108:111]
    v_cvt_pk_bf16_f32 v130, v68, v69
    v_cvt_pk_bf16_f32 v131, v70, v71
    s_waitcnt lgkmcnt(0)
    s_nop 1
    v_mfma_f32_16x16x32_bf16 a[0:3], v[164:167], v[112:115], a[0:3]
    v_mfma_f32_16x16x32_bf16 a[4:7], v[164:167], v[116:119], a[4:7]
    v_mfma_f32_16x16x32_bf16 a[8:11], v[164:167], v[120:123], a[8:11]
    v_mfma_f32_16x16x32_bf16 a[12:15], v[164:167], v[124:127], a[12:15]
    ds_read_b128 v[132:135], v8 offset:32768
    v_mfma_f32_16x16x32_bf16 a[16:19], v[164:167], v[128:131], a[16:19]
    ds_read_b128 v[136:139], v9 offset:32768
    ds_read_b128 v[140:143], v10 offset:32768
    v_mfma_f32_16x16x32_bf16 a[20:23], v[168:171], v[112:115], a[20:23]
    ds_read_b128 v[144:147], v11 offset:32768
    ds_read_b128 v[148:151], v8 offset:36864
    v_mfma_f32_16x16x32_bf16 a[24:27], v[168:171], v[116:119], a[24:27]
    ds_read_b128 v[152:155], v9 offset:36864
    ds_read_b128 v[156:159], v10 offset:36864
    v_mfma_f32_16x16x32_bf16 a[28:31], v[168:171], v[120:123], a[28:31]
    ds_read_b128 v[160:163], v11 offset:36864
    v_add_f32 v216, v216, v32
    v_mfma_f32_16x16x32_bf16 a[32:35], v[168:171], v[124:127], a[32:35]
    v_add_f32 v217, v217, v36
    v_add_f32 v218, v218, v40
    v_mfma_f32_16x16x32_bf16 a[36:39], v[168:171], v[128:131], a[36:39]
    v_add_f32 v219, v219, v44
    v_mfma_f32_16x16x32_bf16 a[40:43], v[172:175], v[112:115], a[40:43]
    v_add_f32 v220, v220, v48
    v_add_f32 v216, v216, v33
    v_mfma_f32_16x16x32_bf16 a[44:47], v[172:175], v[116:119], a[44:47]
    v_add_f32 v217, v217, v37
    v_add_f32 v218, v218, v41
    v_mfma_f32_16x16x32_bf16 a[48:51], v[172:175], v[120:123], a[48:51]
    v_add_f32 v219, v219, v45
    v_add_f32 v220, v220, v49
    v_mfma_f32_16x16x32_bf16 a[52:55], v[172:175], v[124:127], a[52:55]
    v_add_f32 v216, v216, v34
    v_add_f32 v217, v217, v38
    v_mfma_f32_16x16x32_bf16 a[56:59], v[172:175], v[128:131], a[56:59]
    v_add_f32 v218, v218, v42
    v_add_f32 v219, v219, v46
    v_mfma_f32_16x16x32_bf16 a[60:63], v[176:179], v[112:115], a[60:63]
    v_add_f32 v220, v220, v50
    v_mfma_f32_16x16x32_bf16 a[64:67], v[176:179], v[116:119], a[64:67]
    v_add_f32 v216, v216, v35
    v_add_f32 v217, v217, v39
    v_mfma_f32_16x16x32_bf16 a[68:71], v[176:179], v[120:123], a[68:71]
    v_add_f32 v218, v218, v43
    v_add_f32 v219, v219, v47
    v_mfma_f32_16x16x32_bf16 a[72:75], v[176:179], v[124:127], a[72:75]
    v_add_f32 v220, v220, v51
    v_add_f32 v216, v216, v52
    v_mfma_f32_16x16x32_bf16 a[76:79], v[176:179], v[128:131], a[76:79]
    v_add_f32 v217, v217, v56
    v_add_f32 v218, v218, v60
    v_mfma_f32_16x16x32_bf16 a[80:83], v[180:183], v[112:115], a[80:83]
    v_add_f32 v219, v219, v64
    v_add_f32 v220, v220, v68
    v_mfma_f32_16x16x32_bf16 a[84:87], v[180:183], v[116:119], a[84:87]
    v_add_f32 v216, v216, v53
    v_mfma_f32_16x16x32_bf16 a[88:91], v[180:183], v[120:123], a[88:91]
    v_add_f32 v217, v217, v57
    v_add_f32 v218, v218, v61
    v_mfma_f32_16x16x32_bf16 a[92:95], v[180:183], v[124:127], a[92:95]
    v_add_f32 v219, v219, v65
    v_add_f32 v220, v220, v69
    v_mfma_f32_16x16x32_bf16 a[96:99], v[180:183], v[128:131], a[96:99]
    v_add_f32 v216, v216, v54
    v_add_f32 v217, v217, v58
    v_mfma_f32_16x16x32_bf16 a[100:103], v[184:187], v[112:115], a[100:103]
    v_add_f32 v218, v218, v62
    v_add_f32 v219, v219, v66
    v_mfma_f32_16x16x32_bf16 a[104:107], v[184:187], v[116:119], a[104:107]
    v_add_f32 v220, v220, v70
    v_add_f32 v216, v216, v55
    v_mfma_f32_16x16x32_bf16 a[108:111], v[184:187], v[120:123], a[108:111]
    v_add_f32 v217, v217, v59
    v_mfma_f32_16x16x32_bf16 a[112:115], v[184:187], v[124:127], a[112:115]
    v_add_f32 v218, v218, v63
    v_add_f32 v219, v219, v67
    v_mfma_f32_16x16x32_bf16 a[116:119], v[184:187], v[128:131], a[116:119]
    v_add_f32 v220, v220, v71
    v_max3_f32 v226, v72, v73, v74
    v_mfma_f32_16x16x32_bf16 a[120:123], v[188:191], v[112:115], a[120:123]
    v_max3_f32 v226, v226, v75, v76
    v_max3_f32 v226, v226, v77, v78
    v_mfma_f32_16x16x32_bf16 a[124:127], v[188:191], v[116:119], a[124:127]
    v_max3_f32 v226, v226, v79, v80
    v_max3_f32 v226, v226, v81, v82
    v_mfma_f32_16x16x32_bf16 a[128:131], v[188:191], v[120:123], a[128:131]
    v_max3_f32 v226, v226, v83, v84
    v_max3_f32 v226, v226, v85, v86
    v_mfma_f32_16x16x32_bf16 a[132:135], v[188:191], v[124:127], a[132:135]
    v_max3_f32 v226, v226, v87, v88
    v_mfma_f32_16x16x32_bf16 a[136:139], v[188:191], v[128:131], a[136:139]
    v_max3_f32 v226, v226, v89, v90
    v_max3_f32 v226, v226, v91, v92
    v_mfma_f32_16x16x32_bf16 a[140:143], v[192:195], v[112:115], a[140:143]
    v_max3_f32 v226, v226, v93, v94
    v_max3_f32 v226, v226, v95, v96
    v_mfma_f32_16x16x32_bf16 a[144:147], v[192:195], v[116:119], a[144:147]
    v_max3_f32 v226, v226, v97, v98
    v_max3_f32 v226, v226, v99, v100
    v_mfma_f32_16x16x32_bf16 a[148:151], v[192:195], v[120:123], a[148:151]
    v_max3_f32 v226, v226, v101, v102
    v_max3_f32 v226, v226, v103, v104
    v_mfma_f32_16x16x32_bf16 a[152:155], v[192:195], v[124:127], a[152:155]
    v_max3_f32 v226, v226, v105, v106
    v_max3_f32 v226, v226, v107, v108
    v_mfma_f32_16x16x32_bf16 a[156:159], v[192:195], v[128:131], a[156:159]
    v_max3_f32 v226, v226, v109, v110
    v_max_f32 v226, v226, v111
    s_nop 0
    v_cmp_lt_f32 vcc, s50, v226
    s_nop 1
    s_cbranch_vccnz k1_kernel_L5
k1_kernel_L6:
    s_waitcnt vmcnt(16)
    s_barrier
    s_cmp_eq_u32 s40, 0
    s_cselect_b32 s44, 6, 4
    s_lshl_b32 s45, s44, 13
    s_add_u32 s45, s45, s42
    s_and_b32 s46, s44, 3
    s_lshl_b32 s46, s46, 14
    s_add_u32 s46, s46, s43
    s_add_u32 s47, s46, 0
    s_mov_b32 m0, s47
    s_add_u32 s48, s45, 0
    buffer_load_dwordx4 v4, s[32:35], s48 offen lds
    s_add_u32 s47, s46, 1024
    s_mov_b32 m0, s47
    s_add_u32 s48, s45, 1024
    buffer_load_dwordx4 v5, s[32:35], s48 offen lds
    s_add_u32 s47, s46, 2048
    s_mov_b32 m0, s47
    s_add_u32 s48, s45, 2048
    buffer_load_dwordx4 v6, s[32:35], s48 offen lds
    s_add_u32 s47, s46, 3072
    s_mov_b32 m0, s47
    s_add_u32 s48, s45, 3072
    buffer_load_dwordx4 v7, s[32:35], s48 offen lds
    s_add_u32 s47, s46, 4096
    s_mov_b32 m0, s47
    s_add_u32 s48, s45, 4096
    buffer_load_dwordx4 v4, s[32:35], s48 offen lds
    s_add_u32 s47, s46, 5120
    s_mov_b32 m0, s47
    s_add_u32 s48, s45, 5120
    buffer_load_dwordx4 v5, s[32:35], s48 offen lds
    s_add_u32 s47, s46, 6144
    s_mov_b32 m0, s47
    s_add_u32 s48, s45, 6144
    buffer_load_dwordx4 v6, s[32:35], s48 offen lds
    s_add_u32 s47, s46, 7168
    s_mov_b32 m0, s47
    s_add_u32 s48, s45, 7168
    buffer_load_dwordx4 v7, s[32:35], s48 offen lds
    s_waitcnt lgkmcnt(0)
    v_mfma_f32_16x16x32_bf16 v[32:35], v[132:135], a[160:163], v[196:199]
    ds_read_b64_tr_b16 v[164:165], v12 offset:16384
    v_mfma_f32_16x16x32_bf16 v[36:39], v[132:135], a[176:179], v[200:203]
    ds_read_b64_tr_b16 v[166:167], v12 offset:20480
    ds_read_b64_tr_b16 v[168:169], v13 offset:16384
    v_mfma_f32_16x16x32_bf16 v[40:43], v[132:135], a[192:195], v[204:207]
    ds_read_b64_tr_b16 v[170:171], v13 offset:20480
    ds_read_b64_tr_b16 v[172:173], v14 offset:16384
    v_mfma_f32_16x16x32_bf16 v[44:47], v[132:135], a[208:211], v[208:211]
    ds_read_b64_tr_b16 v[174:175], v14 offset:20480
    ds_read_b64_tr_b16 v[176:177], v15 offset:16384
    v_mfma_f32_16x16x32_bf16 v[48:51], v[132:135], a[224:227], v[212:215]
    ds_read_b64_tr_b16 v[178:179], v15 offset:20480
    ds_read_b64_tr_b16 v[180:181], v16 offset:16384
    v_mfma_f32_16x16x32_bf16 v[52:55], v[148:151], a[160:163], v[196:199]
    ds_read_b64_tr_b16 v[182:183], v16 offset:20480
    ds_read_b64_tr_b16 v[184:185], v17 offset:16384
    v_mfma_f32_16x16x32_bf16 v[56:59], v[148:151], a[176:179], v[200:203]
    ds_read_b64_tr_b16 v[186:187], v17 offset:20480
    ds_read_b64_tr_b16 v[188:189], v18 offset:16384
    v_mfma_f32_16x16x32_bf16 v[60:63], v[148:151], a[192:195], v[204:207]
    ds_read_b64_tr_b16 v[190:191], v18 offset:20480
    ds_read_b64_tr_b16 v[192:193], v19 offset:16384
    v_mfma_f32_16x16x32_bf16 v[64:67], v[148:151], a[208:211], v[208:211]
    ds_read_b64_tr_b16 v[194:195], v19 offset:20480
    v_exp_f32 v72, v72
    v_mfma_f32_16x16x32_bf16 v[68:71], v[148:151], a[224:227], v[212:215]
    v_exp_f32 v73, v73
    v_exp_f32 v74, v74
    v_mfma_f32_16x16x32_bf16 v[32:35], v[136:139], a[164:167], v[32:35]
    v_exp_f32 v75, v75
    v_mfma_f32_16x16x32_bf16 v[36:39], v[136:139], a[180:183], v[36:39]
    v_cvt_pk_bf16_f32 v112, v72, v73
    v_cvt_pk_bf16_f32 v113, v74, v75
    v_mfma_f32_16x16x32_bf16 v[40:43], v[136:139], a[196:199], v[40:43]
    v_exp_f32 v92, v92
    v_exp_f32 v93, v93
    v_mfma_f32_16x16x32_bf16 v[44:47], v[136:139], a[212:215], v[44:47]
    v_exp_f32 v94, v94
    v_exp_f32 v95, v95
    v_mfma_f32_16x16x32_bf16 v[48:51], v[136:139], a[228:231], v[48:51]
    v_cvt_pk_bf16_f32 v114, v92, v93
    v_cvt_pk_bf16_f32 v115, v94, v95
    v_mfma_f32_16x16x32_bf16 v[52:55], v[152:155], a[164:167], v[52:55]
    v_exp_f32 v76, v76
    v_exp_f32 v77, v77
    v_mfma_f32_16x16x32_bf16 v[56:59], v[152:155], a[180:183], v[56:59]
    v_exp_f32 v78, v78
    v_exp_f32 v79, v79
    v_mfma_f32_16x16x32_bf16 v[60:63], v[152:155], a[196:199], v[60:63]
    v_cvt_pk_bf16_f32 v116, v76, v77
    v_cvt_pk_bf16_f32 v117, v78, v79
    v_mfma_f32_16x16x32_bf16 v[64:67], v[152:155], a[212:215], v[64:67]
    v_exp_f32 v96, v96
    v_exp_f32 v97, v97
    v_mfma_f32_16x16x32_bf16 v[68:71], v[152:155], a[228:231], v[68:71]
    v_exp_f32 v98, v98
    v_exp_f32 v99, v99
    v_mfma_f32_16x16x32_bf16 v[32:35], v[140:143], a[168:171], v[32:35]
    v_cvt_pk_bf16_f32 v118, v96, v97
    v_mfma_f32_16x16x32_bf16 v[36:39], v[140:143], a[184:187], v[36:39]
    v_cvt_pk_bf16_f32 v119, v98, v99
    v_exp_f32 v80, v80
    v_mfma_f32_16x16x32_bf16 v[40:43], v[140:143], a[200:203], v[40:43]
    v_exp_f32 v81, v81
    v_exp_f32 v82, v82
    v_mfma_f32_16x16x32_bf16 v[44:47], v[140:143], a[216:219], v[44:47]
    v_exp_f32 v83, v83
    v_cvt_pk_bf16_f32 v120, v80, v81
    v_mfma_f32_16x16x32_bf16 v[48:51], v[140:143], a[232:235], v[48:51]
    v_cvt_pk_bf16_f32 v121, v82, v83
    v_exp_f32 v100, v100
    v_mfma_f32_16x16x32_bf16 v[52:55], v[156:159], a[168:171], v[52:55]
    v_exp_f32 v101, v101
    v_exp_f32 v102, v102
    v_mfma_f32_16x16x32_bf16 v[56:59], v[156:159], a[184:187], v[56:59]
    v_exp_f32 v103, v103
    v_cvt_pk_bf16_f32 v122, v100, v101
    v_mfma_f32_16x16x32_bf16 v[60:63], v[156:159], a[200:203], v[60:63]
    v_cvt_pk_bf16_f32 v123, v102, v103
    v_exp_f32 v84, v84
    v_mfma_f32_16x16x32_bf16 v[64:67], v[156:159], a[216:219], v[64:67]
    v_exp_f32 v85, v85
    v_exp_f32 v86, v86
    v_mfma_f32_16x16x32_bf16 v[68:71], v[156:159], a[232:235], v[68:71]
    v_exp_f32 v87, v87
    v_cvt_pk_bf16_f32 v124, v84, v85
    v_mfma_f32_16x16x32_bf16 v[32:35], v[144:147], a[172:175], v[32:35]
    v_cvt_pk_bf16_f32 v125, v86, v87
    v_mfma_f32_16x16x32_bf16 v[36:39], v[144:147], a[188:191], v[36:39]
    v_exp_f32 v104, v104
    v_exp_f32 v105, v105
    v_mfma_f32_16x16x32_bf16 v[40:43], v[144:147], a[204:207], v[40:43]
    v_exp_f32 v106, v106
    v_exp_f32 v107, v107
    v_mfma_f32_16x16x32_bf16 v[44:47], v[144:147], a[220:223], v[44:47]
    v_cvt_pk_bf16_f32 v126, v104, v105
    v_cvt_pk_bf16_f32 v127, v106, v107
    v_mfma_f32_16x16x32_bf16 v[48:51], v[144:147], a[236:239], v[48:51]
    v_exp_f32 v88, v88
    v_exp_f32 v89, v89
    v_mfma_f32_16x16x32_bf16 v[52:55], v[160:163], a[172:175], v[52:55]
    v_exp_f32 v90, v90
    v_exp_f32 v91, v91
    v_mfma_f32_16x16x32_bf16 v[56:59], v[160:163], a[188:191], v[56:59]
    v_cvt_pk_bf16_f32 v128, v88, v89
    v_cvt_pk_bf16_f32 v129, v90, v91
    v_mfma_f32_16x16x32_bf16 v[60:63], v[160:163], a[204:207], v[60:63]
    v_exp_f32 v108, v108
    v_exp_f32 v109, v109
    v_mfma_f32_16x16x32_bf16 v[64:67], v[160:163], a[220:223], v[64:67]
    v_exp_f32 v110, v110
    v_exp_f32 v111, v111
    v_mfma_f32_16x16x32_bf16 v[68:71], v[160:163], a[236:239], v[68:71]
    v_cvt_pk_bf16_f32 v130, v108, v109
    v_cvt_pk_bf16_f32 v131, v110, v111
    s_waitcnt lgkmcnt(0)
    s_nop 1
    v_mfma_f32_16x16x32_bf16 a[0:3], v[164:167], v[112:115], a[0:3]
    v_mfma_f32_16x16x32_bf16 a[4:7], v[164:167], v[116:119], a[4:7]
    v_mfma_f32_16x16x32_bf16 a[8:11], v[164:167], v[120:123], a[8:11]
    v_mfma_f32_16x16x32_bf16 a[12:15], v[164:167], v[124:127], a[12:15]
    ds_read_b128 v[132:135], v8 offset:49152
    v_mfma_f32_16x16x32_bf16 a[16:19], v[164:167], v[128:131], a[16:19]
    ds_read_b128 v[136:139], v9 offset:49152
    ds_read_b128 v[140:143], v10 offset:49152
    v_mfma_f32_16x16x32_bf16 a[20:23], v[168:171], v[112:115], a[20:23]
    ds_read_b128 v[144:147], v11 offset:49152
    ds_read_b128 v[148:151], v8 offset:53248
    v_mfma_f32_16x16x32_bf16 a[24:27], v[168:171], v[116:119], a[24:27]
    ds_read_b128 v[152:155], v9 offset:53248
    ds_read_b128 v[156:159], v10 offset:53248
    v_mfma_f32_16x16x32_bf16 a[28:31], v[168:171], v[120:123], a[28:31]
    ds_read_b128 v[160:163], v11 offset:53248
    v_add_f32 v216, v216, v72
    v_mfma_f32_16x16x32_bf16 a[32:35], v[168:171], v[124:127], a[32:35]
    v_add_f32 v217, v217, v76
    v_add_f32 v218, v218, v80
    v_mfma_f32_16x16x32_bf16 a[36:39], v[168:171], v[128:131], a[36:39]
    v_add_f32 v219, v219, v84
    v_mfma_f32_16x16x32_bf16 a[40:43], v[172:175], v[112:115], a[40:43]
    v_add_f32 v220, v220, v88
    v_add_f32 v216, v216, v73
    v_mfma_f32_16x16x32_bf16 a[44:47], v[172:175], v[116:119], a[44:47]
    v_add_f32 v217, v217, v77
    v_add_f32 v218, v218, v81
    v_mfma_f32_16x16x32_bf16 a[48:51], v[172:175], v[120:123], a[48:51]
    v_add_f32 v219, v219, v85
    v_add_f32 v220, v220, v89
    v_mfma_f32_16x16x32_bf16 a[52:55], v[172:175], v[124:127], a[52:55]
    v_add_f32 v216, v216, v74
    v_add_f32 v217, v217, v78
    v_mfma_f32_16x16x32_bf16 a[56:59], v[172:175], v[128:131], a[56:59]
    v_add_f32 v218, v218, v82
    v_add_f32 v219, v219, v86
    v_mfma_f32_16x16x32_bf16 a[60:63], v[176:179], v[112:115], a[60:63]
    v_add_f32 v220, v220, v90
    v_mfma_f32_16x16x32_bf16 a[64:67], v[176:179], v[116:119], a[64:67]
    v_add_f32 v216, v216, v75
    v_add_f32 v217, v217, v79
    v_mfma_f32_16x16x32_bf16 a[68:71], v[176:179], v[120:123], a[68:71]
    v_add_f32 v218, v218, v83
    v_add_f32 v219, v219, v87
    v_mfma_f32_16x16x32_bf16 a[72:75], v[176:179], v[124:127], a[72:75]
    v_add_f32 v220, v220, v91
    v_add_f32 v216, v216, v92
    v_mfma_f32_16x16x32_bf16 a[76:79], v[176:179], v[128:131], a[76:79]
    v_add_f32 v217, v217, v96
    v_add_f32 v218, v218, v100
    v_mfma_f32_16x16x32_bf16 a[80:83], v[180:183], v[112:115], a[80:83]
    v_add_f32 v219, v219, v104
    v_add_f32 v220, v220, v108
    v_mfma_f32_16x16x32_bf16 a[84:87], v[180:183], v[116:119], a[84:87]
    v_add_f32 v216, v216, v93
    v_mfma_f32_16x16x32_bf16 a[88:91], v[180:183], v[120:123], a[88:91]
    v_add_f32 v217, v217, v97
    v_add_f32 v218, v218, v101
    v_mfma_f32_16x16x32_bf16 a[92:95], v[180:183], v[124:127], a[92:95]
    v_add_f32 v219, v219, v105
    v_add_f32 v220, v220, v109
    v_mfma_f32_16x16x32_bf16 a[96:99], v[180:183], v[128:131], a[96:99]
    v_add_f32 v216, v216, v94
    v_add_f32 v217, v217, v98
    v_mfma_f32_16x16x32_bf16 a[100:103], v[184:187], v[112:115], a[100:103]
    v_add_f32 v218, v218, v102
    v_add_f32 v219, v219, v106
    v_mfma_f32_16x16x32_bf16 a[104:107], v[184:187], v[116:119], a[104:107]
    v_add_f32 v220, v220, v110
    v_add_f32 v216, v216, v95
    v_mfma_f32_16x16x32_bf16 a[108:111], v[184:187], v[120:123], a[108:111]
    v_add_f32 v217, v217, v99
    v_mfma_f32_16x16x32_bf16 a[112:115], v[184:187], v[124:127], a[112:115]
    v_add_f32 v218, v218, v103
    v_add_f32 v219, v219, v107
    v_mfma_f32_16x16x32_bf16 a[116:119], v[184:187], v[128:131], a[116:119]
    v_add_f32 v220, v220, v111
    v_max3_f32 v226, v32, v33, v34
    v_mfma_f32_16x16x32_bf16 a[120:123], v[188:191], v[112:115], a[120:123]
    v_max3_f32 v226, v226, v35, v36
    v_max3_f32 v226, v226, v37, v38
    v_mfma_f32_16x16x32_bf16 a[124:127], v[188:191], v[116:119], a[124:127]
    v_max3_f32 v226, v226, v39, v40
    v_max3_f32 v226, v226, v41, v42
    v_mfma_f32_16x16x32_bf16 a[128:131], v[188:191], v[120:123], a[128:131]
    v_max3_f32 v226, v226, v43, v44
    v_max3_f32 v226, v226, v45, v46
    v_mfma_f32_16x16x32_bf16 a[132:135], v[188:191], v[124:127], a[132:135]
    v_max3_f32 v226, v226, v47, v48
    v_mfma_f32_16x16x32_bf16 a[136:139], v[188:191], v[128:131], a[136:139]
    v_max3_f32 v226, v226, v49, v50
    v_max3_f32 v226, v226, v51, v52
    v_mfma_f32_16x16x32_bf16 a[140:143], v[192:195], v[112:115], a[140:143]
    v_max3_f32 v226, v226, v53, v54
    v_max3_f32 v226, v226, v55, v56
    v_mfma_f32_16x16x32_bf16 a[144:147], v[192:195], v[116:119], a[144:147]
    v_max3_f32 v226, v226, v57, v58
    v_max3_f32 v226, v226, v59, v60
    v_mfma_f32_16x16x32_bf16 a[148:151], v[192:195], v[120:123], a[148:151]
    v_max3_f32 v226, v226, v61, v62
    v_max3_f32 v226, v226, v63, v64
    v_mfma_f32_16x16x32_bf16 a[152:155], v[192:195], v[124:127], a[152:155]
    v_max3_f32 v226, v226, v65, v66
    v_max3_f32 v226, v226, v67, v68
    v_mfma_f32_16x16x32_bf16 a[156:159], v[192:195], v[128:131], a[156:159]
    v_max3_f32 v226, v226, v69, v70
    v_max_f32 v226, v226, v71
    s_nop 0
    v_cmp_lt_f32 vcc, s50, v226
    s_nop 1
    s_cbranch_vccnz k1_kernel_L7
k1_kernel_L8:
    s_waitcnt vmcnt(16)
    s_barrier
    s_cmp_eq_u32 s40, 0
    s_cselect_b32 s44, 7, 5
    s_lshl_b32 s45, s44, 13
    s_add_u32 s45, s45, s42
    s_and_b32 s46, s44, 3
    s_lshl_b32 s46, s46, 14
    s_add_u32 s46, s46, s43
    s_add_u32 s47, s46, 0
    s_mov_b32 m0, s47
    s_add_u32 s48, s45, 0
    buffer_load_dwordx4 v4, s[32:35], s48 offen lds
    s_add_u32 s47, s46, 1024
    s_mov_b32 m0, s47
    s_add_u32 s48, s45, 1024
    buffer_load_dwordx4 v5, s[32:35], s48 offen lds
    s_add_u32 s47, s46, 2048
    s_mov_b32 m0, s47
    s_add_u32 s48, s45, 2048
    buffer_load_dwordx4 v6, s[32:35], s48 offen lds
    s_add_u32 s47, s46, 3072
    s_mov_b32 m0, s47
    s_add_u32 s48, s45, 3072
    buffer_load_dwordx4 v7, s[32:35], s48 offen lds
    s_add_u32 s47, s46, 4096
    s_mov_b32 m0, s47
    s_add_u32 s48, s45, 4096
    buffer_load_dwordx4 v4, s[32:35], s48 offen lds
    s_add_u32 s47, s46, 5120
    s_mov_b32 m0, s47
    s_add_u32 s48, s45, 5120
    buffer_load_dwordx4 v5, s[32:35], s48 offen lds
    s_add_u32 s47, s46, 6144
    s_mov_b32 m0, s47
    s_add_u32 s48, s45, 6144
    buffer_load_dwordx4 v6, s[32:35], s48 offen lds
    s_add_u32 s47, s46, 7168
    s_mov_b32 m0, s47
    s_add_u32 s48, s45, 7168
    buffer_load_dwordx4 v7, s[32:35], s48 offen lds
    s_waitcnt lgkmcnt(0)
    v_mfma_f32_16x16x32_bf16 v[72:75], v[132:135], a[160:163], v[196:199]
    ds_read_b64_tr_b16 v[164:165], v12 offset:32768
    v_mfma_f32_16x16x32_bf16 v[76:79], v[132:135], a[176:179], v[200:203]
    ds_read_b64_tr_b16 v[166:167], v12 offset:36864
    ds_read_b64_tr_b16 v[168:169], v13 offset:32768
    v_mfma_f32_16x16x32_bf16 v[80:83], v[132:135], a[192:195], v[204:207]
    ds_read_b64_tr_b16 v[170:171], v13 offset:36864
    ds_read_b64_tr_b16 v[172:173], v14 offset:32768
    v_mfma_f32_16x16x32_bf16 v[84:87], v[132:135], a[208:211], v[208:211]
    ds_read_b64_tr_b16 v[174:175], v14 offset:36864
    ds_read_b64_tr_b16 v[176:177], v15 offset:32768
    v_mfma_f32_16x16x32_bf16 v[88:91], v[132:135], a[224:227], v[212:215]
    ds_read_b64_tr_b16 v[178:179], v15 offset:36864
    ds_read_b64_tr_b16 v[180:181], v16 offset:32768
    v_mfma_f32_16x16x32_bf16 v[92:95], v[148:151], a[160:163], v[196:199]
    ds_read_b64_tr_b16 v[182:183], v16 offset:36864
    ds_read_b64_tr_b16 v[184:185], v17 offset:32768
    v_mfma_f32_16x16x32_bf16 v[96:99], v[148:151], a[176:179], v[200:203]
    ds_read_b64_tr_b16 v[186:187], v17 offset:36864
    ds_read_b64_tr_b16 v[188:189], v18 offset:32768
    v_mfma_f32_16x16x32_bf16 v[100:103], v[148:151], a[192:195], v[204:207]
    ds_read_b64_tr_b16 v[190:191], v18 offset:36864
    ds_read_b64_tr_b16 v[192:193], v19 offset:32768
    v_mfma_f32_16x16x32_bf16 v[104:107], v[148:151], a[208:211], v[208:211]
    ds_read_b64_tr_b16 v[194:195], v19 offset:36864
    v_exp_f32 v32, v32
    v_mfma_f32_16x16x32_bf16 v[108:111], v[148:151], a[224:227], v[212:215]
    v_exp_f32 v33, v33
    v_exp_f32 v34, v34
    v_mfma_f32_16x16x32_bf16 v[72:75], v[136:139], a[164:167], v[72:75]
    v_exp_f32 v35, v35
    v_mfma_f32_16x16x32_bf16 v[76:79], v[136:139], a[180:183], v[76:79]
    v_cvt_pk_bf16_f32 v112, v32, v33
    v_cvt_pk_bf16_f32 v113, v34, v35
    v_mfma_f32_16x16x32_bf16 v[80:83], v[136:139], a[196:199], v[80:83]
    v_exp_f32 v52, v52
    v_exp_f32 v53, v53
    v_mfma_f32_16x16x32_bf16 v[84:87], v[136:139], a[212:215], v[84:87]
    v_exp_f32 v54, v54
    v_exp_f32 v55, v55
    v_mfma_f32_16x16x32_bf16 v[88:91], v[136:139], a[228:231], v[88:91]
    v_cvt_pk_bf16_f32 v114, v52, v53
    v_cvt_pk_bf16_f32 v115, v54, v55
    v_mfma_f32_16x16x32_bf16 v[92:95], v[152:155], a[164:167], v[92:95]
    v_exp_f32 v36, v36
    v_exp_f32 v37, v37
    v_mfma_f32_16x16x32_bf16 v[96:99], v[152:155], a[180:183], v[96:99]
    v_exp_f32 v38, v38
    v_exp_f32 v39, v39
    v_mfma_f32_16x16x32_bf16 v[100:103], v[152:155], a[196:199], v[100:103]
    v_cvt_pk_bf16_f32 v116, v36, v37
    v_cvt_pk_bf16_f32 v117, v38, v39
    v_mfma_f32_16x16x32_bf16 v[104:107], v[152:155], a[212:215], v[104:107]
    v_exp_f32 v56, v56
    v_exp_f32 v57, v57
    v_mfma_f32_16x16x32_bf16 v[108:111], v[152:155], a[228:231], v[108:111]
    v_exp_f32 v58, v58
    v_exp_f32 v59, v59
    v_mfma_f32_16x16x32_bf16 v[72:75], v[140:143], a[168:171], v[72:75]
    v_cvt_pk_bf16_f32 v118, v56, v57
    v_mfma_f32_16x16x32_bf16 v[76:79], v[140:143], a[184:187], v[76:79]
    v_cvt_pk_bf16_f32 v119, v58, v59
    v_exp_f32 v40, v40
    v_mfma_f32_16x16x32_bf16 v[80:83], v[140:143], a[200:203], v[80:83]
    v_exp_f32 v41, v41
    v_exp_f32 v42, v42
    v_mfma_f32_16x16x32_bf16 v[84:87], v[140:143], a[216:219], v[84:87]
    v_exp_f32 v43, v43
    v_cvt_pk_bf16_f32 v120, v40, v41
    v_mfma_f32_16x16x32_bf16 v[88:91], v[140:143], a[232:235], v[88:91]
    v_cvt_pk_bf16_f32 v121, v42, v43
    v_exp_f32 v60, v60
    v_mfma_f32_16x16x32_bf16 v[92:95], v[156:159], a[168:171], v[92:95]
    v_exp_f32 v61, v61
    v_exp_f32 v62, v62
    v_mfma_f32_16x16x32_bf16 v[96:99], v[156:159], a[184:187], v[96:99]
    v_exp_f32 v63, v63
    v_cvt_pk_bf16_f32 v122, v60, v61
    v_mfma_f32_16x16x32_bf16 v[100:103], v[156:159], a[200:203], v[100:103]
    v_cvt_pk_bf16_f32 v123, v62, v63
    v_exp_f32 v44, v44
    v_mfma_f32_16x16x32_bf16 v[104:107], v[156:159], a[216:219], v[104:107]
    v_exp_f32 v45, v45
    v_exp_f32 v46, v46
    v_mfma_f32_16x16x32_bf16 v[108:111], v[156:159], a[232:235], v[108:111]
    v_exp_f32 v47, v47
    v_cvt_pk_bf16_f32 v124, v44, v45
    v_mfma_f32_16x16x32_bf16 v[72:75], v[144:147], a[172:175], v[72:75]
    v_cvt_pk_bf16_f32 v125, v46, v47
    v_mfma_f32_16x16x32_bf16 v[76:79], v[144:147], a[188:191], v[76:79]
    v_exp_f32 v64, v64
    v_exp_f32 v65, v65
    v_mfma_f32_16x16x32_bf16 v[80:83], v[144:147], a[204:207], v[80:83]
    v_exp_f32 v66, v66
    v_exp_f32 v67, v67
    v_mfma_f32_16x16x32_bf16 v[84:87], v[144:147], a[220:223], v[84:87]
    v_cvt_pk_bf16_f32 v126, v64, v65
    v_cvt_pk_bf16_f32 v127, v66, v67
    v_mfma_f32_16x16x32_bf16 v[88:91], v[144:147], a[236:239], v[88:91]
    v_exp_f32 v48, v48
    v_exp_f32 v49, v49
    v_mfma_f32_16x16x32_bf16 v[92:95], v[160:163], a[172:175], v[92:95]
    v_exp_f32 v50, v50
    v_exp_f32 v51, v51
    v_mfma_f32_16x16x32_bf16 v[96:99], v[160:163], a[188:191], v[96:99]
    v_cvt_pk_bf16_f32 v128, v48, v49
    v_cvt_pk_bf16_f32 v129, v50, v51
    v_mfma_f32_16x16x32_bf16 v[100:103], v[160:163], a[204:207], v[100:103]
    v_exp_f32 v68, v68
    v_exp_f32 v69, v69
    v_mfma_f32_16x16x32_bf16 v[104:107], v[160:163], a[220:223], v[104:107]
    v_exp_f32 v70, v70
    v_exp_f32 v71, v71
    v_mfma_f32_16x16x32_bf16 v[108:111], v[160:163], a[236:239], v[108:111]
    v_cvt_pk_bf16_f32 v130, v68, v69
    v_cvt_pk_bf16_f32 v131, v70, v71
    s_waitcnt lgkmcnt(0)
    s_nop 1
    v_mfma_f32_16x16x32_bf16 a[0:3], v[164:167], v[112:115], a[0:3]
    v_mfma_f32_16x16x32_bf16 a[4:7], v[164:167], v[116:119], a[4:7]
    v_mfma_f32_16x16x32_bf16 a[8:11], v[164:167], v[120:123], a[8:11]
    v_mfma_f32_16x16x32_bf16 a[12:15], v[164:167], v[124:127], a[12:15]
    ds_read_b128 v[132:135], v8 offset:0
    v_mfma_f32_16x16x32_bf16 a[16:19], v[164:167], v[128:131], a[16:19]
    ds_read_b128 v[136:139], v9 offset:0
    ds_read_b128 v[140:143], v10 offset:0
    v_mfma_f32_16x16x32_bf16 a[20:23], v[168:171], v[112:115], a[20:23]
    ds_read_b128 v[144:147], v11 offset:0
    ds_read_b128 v[148:151], v8 offset:4096
    v_mfma_f32_16x16x32_bf16 a[24:27], v[168:171], v[116:119], a[24:27]
    ds_read_b128 v[152:155], v9 offset:4096
    ds_read_b128 v[156:159], v10 offset:4096
    v_mfma_f32_16x16x32_bf16 a[28:31], v[168:171], v[120:123], a[28:31]
    ds_read_b128 v[160:163], v11 offset:4096
    v_add_f32 v216, v216, v32
    v_mfma_f32_16x16x32_bf16 a[32:35], v[168:171], v[124:127], a[32:35]
    v_add_f32 v217, v217, v36
    v_add_f32 v218, v218, v40
    v_mfma_f32_16x16x32_bf16 a[36:39], v[168:171], v[128:131], a[36:39]
    v_add_f32 v219, v219, v44
    v_mfma_f32_16x16x32_bf16 a[40:43], v[172:175], v[112:115], a[40:43]
    v_add_f32 v220, v220, v48
    v_add_f32 v216, v216, v33
    v_mfma_f32_16x16x32_bf16 a[44:47], v[172:175], v[116:119], a[44:47]
    v_add_f32 v217, v217, v37
    v_add_f32 v218, v218, v41
    v_mfma_f32_16x16x32_bf16 a[48:51], v[172:175], v[120:123], a[48:51]
    v_add_f32 v219, v219, v45
    v_add_f32 v220, v220, v49
    v_mfma_f32_16x16x32_bf16 a[52:55], v[172:175], v[124:127], a[52:55]
    v_add_f32 v216, v216, v34
    v_add_f32 v217, v217, v38
    v_mfma_f32_16x16x32_bf16 a[56:59], v[172:175], v[128:131], a[56:59]
    v_add_f32 v218, v218, v42
    v_add_f32 v219, v219, v46
    v_mfma_f32_16x16x32_bf16 a[60:63], v[176:179], v[112:115], a[60:63]
    v_add_f32 v220, v220, v50
    v_mfma_f32_16x16x32_bf16 a[64:67], v[176:179], v[116:119], a[64:67]
    v_add_f32 v216, v216, v35
    v_add_f32 v217, v217, v39
    v_mfma_f32_16x16x32_bf16 a[68:71], v[176:179], v[120:123], a[68:71]
    v_add_f32 v218, v218, v43
    v_add_f32 v219, v219, v47
    v_mfma_f32_16x16x32_bf16 a[72:75], v[176:179], v[124:127], a[72:75]
    v_add_f32 v220, v220, v51
    v_add_f32 v216, v216, v52
    v_mfma_f32_16x16x32_bf16 a[76:79], v[176:179], v[128:131], a[76:79]
    v_add_f32 v217, v217, v56
    v_add_f32 v218, v218, v60
    v_mfma_f32_16x16x32_bf16 a[80:83], v[180:183], v[112:115], a[80:83]
    v_add_f32 v219, v219, v64
    v_add_f32 v220, v220, v68
    v_mfma_f32_16x16x32_bf16 a[84:87], v[180:183], v[116:119], a[84:87]
    v_add_f32 v216, v216, v53
    v_mfma_f32_16x16x32_bf16 a[88:91], v[180:183], v[120:123], a[88:91]
    v_add_f32 v217, v217, v57
    v_add_f32 v218, v218, v61
    v_mfma_f32_16x16x32_bf16 a[92:95], v[180:183], v[124:127], a[92:95]
    v_add_f32 v219, v219, v65
    v_add_f32 v220, v220, v69
    v_mfma_f32_16x16x32_bf16 a[96:99], v[180:183], v[128:131], a[96:99]
    v_add_f32 v216, v216, v54
    v_add_f32 v217, v217, v58
    v_mfma_f32_16x16x32_bf16 a[100:103], v[184:187], v[112:115], a[100:103]
    v_add_f32 v218, v218, v62
    v_add_f32 v219, v219, v66
    v_mfma_f32_16x16x32_bf16 a[104:107], v[184:187], v[116:119], a[104:107]
    v_add_f32 v220, v220, v70
    v_add_f32 v216, v216, v55
    v_mfma_f32_16x16x32_bf16 a[108:111], v[184:187], v[120:123], a[108:111]
    v_add_f32 v217, v217, v59
    v_mfma_f32_16x16x32_bf16 a[112:115], v[184:187], v[124:127], a[112:115]
    v_add_f32 v218, v218, v63
    v_add_f32 v219, v219, v67
    v_mfma_f32_16x16x32_bf16 a[116:119], v[184:187], v[128:131], a[116:119]
    v_add_f32 v220, v220, v71
    v_max3_f32 v226, v72, v73, v74
    v_mfma_f32_16x16x32_bf16 a[120:123], v[188:191], v[112:115], a[120:123]
    v_max3_f32 v226, v226, v75, v76
    v_max3_f32 v226, v226, v77, v78
    v_mfma_f32_16x16x32_bf16 a[124:127], v[188:191], v[116:119], a[124:127]
    v_max3_f32 v226, v226, v79, v80
    v_max3_f32 v226, v226, v81, v82
    v_mfma_f32_16x16x32_bf16 a[128:131], v[188:191], v[120:123], a[128:131]
    v_max3_f32 v226, v226, v83, v84
    v_max3_f32 v226, v226, v85, v86
    v_mfma_f32_16x16x32_bf16 a[132:135], v[188:191], v[124:127], a[132:135]
    v_max3_f32 v226, v226, v87, v88
    v_mfma_f32_16x16x32_bf16 a[136:139], v[188:191], v[128:131], a[136:139]
    v_max3_f32 v226, v226, v89, v90
    v_max3_f32 v226, v226, v91, v92
    v_mfma_f32_16x16x32_bf16 a[140:143], v[192:195], v[112:115], a[140:143]
    v_max3_f32 v226, v226, v93, v94
    v_max3_f32 v226, v226, v95, v96
    v_mfma_f32_16x16x32_bf16 a[144:147], v[192:195], v[116:119], a[144:147]
    v_max3_f32 v226, v226, v97, v98
    v_max3_f32 v226, v226, v99, v100
    v_mfma_f32_16x16x32_bf16 a[148:151], v[192:195], v[120:123], a[148:151]
    v_max3_f32 v226, v226, v101, v102
    v_max3_f32 v226, v226, v103, v104
    v_mfma_f32_16x16x32_bf16 a[152:155], v[192:195], v[124:127], a[152:155]
    v_max3_f32 v226, v226, v105, v106
    v_max3_f32 v226, v226, v107, v108
    v_mfma_f32_16x16x32_bf16 a[156:159], v[192:195], v[128:131], a[156:159]
    v_max3_f32 v226, v226, v109, v110
    v_max_f32 v226, v226, v111
    s_nop 0
    v_cmp_lt_f32 vcc, s50, v226
    s_nop 1
    s_cbranch_vccnz k1_kernel_L9
k1_kernel_L10:
    s_waitcnt vmcnt(16)
    s_barrier
    s_cmp_eq_u32 s40, 0
    s_cselect_b32 s44, 8, 6
    s_lshl_b32 s45, s44, 13
    s_add_u32 s45, s45, s42
    s_and_b32 s46, s44, 3
    s_lshl_b32 s46, s46, 14
    s_add_u32 s46, s46, s43
    s_add_u32 s47, s46, 0
    s_mov_b32 m0, s47
    s_add_u32 s48, s45, 0
    buffer_load_dwordx4 v4, s[32:35], s48 offen lds
    s_add_u32 s47, s46, 1024
    s_mov_b32 m0, s47
    s_add_u32 s48, s45, 1024
    buffer_load_dwordx4 v5, s[32:35], s48 offen lds
    s_add_u32 s47, s46, 2048
    s_mov_b32 m0, s47
    s_add_u32 s48, s45, 2048
    buffer_load_dwordx4 v6, s[32:35], s48 offen lds
    s_add_u32 s47, s46, 3072
    s_mov_b32 m0, s47
    s_add_u32 s48, s45, 3072
    buffer_load_dwordx4 v7, s[32:35], s48 offen lds
    s_add_u32 s47, s46, 4096
    s_mov_b32 m0, s47
    s_add_u32 s48, s45, 4096
    buffer_load_dwordx4 v4, s[32:35], s48 offen lds
    s_add_u32 s47, s46, 5120
    s_mov_b32 m0, s47
    s_add_u32 s48, s45, 5120
    buffer_load_dwordx4 v5, s[32:35], s48 offen lds
    s_add_u32 s47, s46, 6144
    s_mov_b32 m0, s47
    s_add_u32 s48, s45, 6144
    buffer_load_dwordx4 v6, s[32:35], s48 offen lds
    s_add_u32 s47, s46, 7168
    s_mov_b32 m0, s47
    s_add_u32 s48, s45, 7168
    buffer_load_dwordx4 v7, s[32:35], s48 offen lds
    s_waitcnt lgkmcnt(0)
    v_mfma_f32_16x16x32_bf16 v[32:35], v[132:135], a[160:163], v[196:199]
    ds_read_b64_tr_b16 v[164:165], v12 offset:49152
    v_mfma_f32_16x16x32_bf16 v[36:39], v[132:135], a[176:179], v[200:203]
    ds_read_b64_tr_b16 v[166:167], v12 offset:53248
    ds_read_b64_tr_b16 v[168:169], v13 offset:49152
    v_mfma_f32_16x16x32_bf16 v[40:43], v[132:135], a[192:195], v[204:207]
    ds_read_b64_tr_b16 v[170:171], v13 offset:53248
    ds_read_b64_tr_b16 v[172:173], v14 offset:49152
    v_mfma_f32_16x16x32_bf16 v[44:47], v[132:135], a[208:211], v[208:211]
    ds_read_b64_tr_b16 v[174:175], v14 offset:53248
    ds_read_b64_tr_b16 v[176:177], v15 offset:49152
    v_mfma_f32_16x16x32_bf16 v[48:51], v[132:135], a[224:227], v[212:215]
    ds_read_b64_tr_b16 v[178:179], v15 offset:53248
    ds_read_b64_tr_b16 v[180:181], v16 offset:49152
    v_mfma_f32_16x16x32_bf16 v[52:55], v[148:151], a[160:163], v[196:199]
    ds_read_b64_tr_b16 v[182:183], v16 offset:53248
    ds_read_b64_tr_b16 v[184:185], v17 offset:49152
    v_mfma_f32_16x16x32_bf16 v[56:59], v[148:151], a[176:179], v[200:203]
    ds_read_b64_tr_b16 v[186:187], v17 offset:53248
    ds_read_b64_tr_b16 v[188:189], v18 offset:49152
    v_mfma_f32_16x16x32_bf16 v[60:63], v[148:151], a[192:195], v[204:207]
    ds_read_b64_tr_b16 v[190:191], v18 offset:53248
    ds_read_b64_tr_b16 v[192:193], v19 offset:49152
    v_mfma_f32_16x16x32_bf16 v[64:67], v[148:151], a[208:211], v[208:211]
    ds_read_b64_tr_b16 v[194:195], v19 offset:53248
    v_exp_f32 v72, v72
    v_mfma_f32_16x16x32_bf16 v[68:71], v[148:151], a[224:227], v[212:215]
    v_exp_f32 v73, v73
    v_exp_f32 v74, v74
    v_mfma_f32_16x16x32_bf16 v[32:35], v[136:139], a[164:167], v[32:35]
    v_exp_f32 v75, v75
    v_mfma_f32_16x16x32_bf16 v[36:39], v[136:139], a[180:183], v[36:39]
    v_cvt_pk_bf16_f32 v112, v72, v73
    v_cvt_pk_bf16_f32 v113, v74, v75
    v_mfma_f32_16x16x32_bf16 v[40:43], v[136:139], a[196:199], v[40:43]
    v_exp_f32 v92, v92
    v_exp_f32 v93, v93
    v_mfma_f32_16x16x32_bf16 v[44:47], v[136:139], a[212:215], v[44:47]
    v_exp_f32 v94, v94
    v_exp_f32 v95, v95
    v_mfma_f32_16x16x32_bf16 v[48:51], v[136:139], a[228:231], v[48:51]
    v_cvt_pk_bf16_f32 v114, v92, v93
    v_cvt_pk_bf16_f32 v115, v94, v95
    v_mfma_f32_16x16x32_bf16 v[52:55], v[152:155], a[164:167], v[52:55]
    v_exp_f32 v76, v76
    v_exp_f32 v77, v77
    v_mfma_f32_16x16x32_bf16 v[56:59], v[152:155], a[180:183], v[56:59]
    v_exp_f32 v78, v78
    v_exp_f32 v79, v79
    v_mfma_f32_16x16x32_bf16 v[60:63], v[152:155], a[196:199], v[60:63]
    v_cvt_pk_bf16_f32 v116, v76, v77
    v_cvt_pk_bf16_f32 v117, v78, v79
    v_mfma_f32_16x16x32_bf16 v[64:67], v[152:155], a[212:215], v[64:67]
    v_exp_f32 v96, v96
    v_exp_f32 v97, v97
    v_mfma_f32_16x16x32_bf16 v[68:71], v[152:155], a[228:231], v[68:71]
    v_exp_f32 v98, v98
    v_exp_f32 v99, v99
    v_mfma_f32_16x16x32_bf16 v[32:35], v[140:143], a[168:171], v[32:35]
    v_cvt_pk_bf16_f32 v118, v96, v97
    v_mfma_f32_16x16x32_bf16 v[36:39], v[140:143], a[184:187], v[36:39]
    v_cvt_pk_bf16_f32 v119, v98, v99
    v_exp_f32 v80, v80
    v_mfma_f32_16x16x32_bf16 v[40:43], v[140:143], a[200:203], v[40:43]
    v_exp_f32 v81, v81
    v_exp_f32 v82, v82
    v_mfma_f32_16x16x32_bf16 v[44:47], v[140:143], a[216:219], v[44:47]
    v_exp_f32 v83, v83
    v_cvt_pk_bf16_f32 v120, v80, v81
    v_mfma_f32_16x16x32_bf16 v[48:51], v[140:143], a[232:235], v[48:51]
    v_cvt_pk_bf16_f32 v121, v82, v83
    v_exp_f32 v100, v100
    v_mfma_f32_16x16x32_bf16 v[52:55], v[156:159], a[168:171], v[52:55]
    v_exp_f32 v101, v101
    v_exp_f32 v102, v102
    v_mfma_f32_16x16x32_bf16 v[56:59], v[156:159], a[184:187], v[56:59]
    v_exp_f32 v103, v103
    v_cvt_pk_bf16_f32 v122, v100, v101
    v_mfma_f32_16x16x32_bf16 v[60:63], v[156:159], a[200:203], v[60:63]
    v_cvt_pk_bf16_f32 v123, v102, v103
    v_exp_f32 v84, v84
    v_mfma_f32_16x16x32_bf16 v[64:67], v[156:159], a[216:219], v[64:67]
    v_exp_f32 v85, v85
    v_exp_f32 v86, v86
    v_mfma_f32_16x16x32_bf16 v[68:71], v[156:159], a[232:235], v[68:71]
    v_exp_f32 v87, v87
    v_cvt_pk_bf16_f32 v124, v84, v85
    v_mfma_f32_16x16x32_bf16 v[32:35], v[144:147], a[172:175], v[32:35]
    v_cvt_pk_bf16_f32 v125, v86, v87
    v_mfma_f32_16x16x32_bf16 v[36:39], v[144:147], a[188:191], v[36:39]
    v_exp_f32 v104, v104
    v_exp_f32 v105, v105
    v_mfma_f32_16x16x32_bf16 v[40:43], v[144:147], a[204:207], v[40:43]
    v_exp_f32 v106, v106
    v_exp_f32 v107, v107
    v_mfma_f32_16x16x32_bf16 v[44:47], v[144:147], a[220:223], v[44:47]
    v_cvt_pk_bf16_f32 v126, v104, v105
    v_cvt_pk_bf16_f32 v127, v106, v107
    v_mfma_f32_16x16x32_bf16 v[48:51], v[144:147], a[236:239], v[48:51]
    v_exp_f32 v88, v88
    v_exp_f32 v89, v89
    v_mfma_f32_16x16x32_bf16 v[52:55], v[160:163], a[172:175], v[52:55]
    v_exp_f32 v90, v90
    v_exp_f32 v91, v91
    v_mfma_f32_16x16x32_bf16 v[56:59], v[160:163], a[188:191], v[56:59]
    v_cvt_pk_bf16_f32 v128, v88, v89
    v_cvt_pk_bf16_f32 v129, v90, v91
    v_mfma_f32_16x16x32_bf16 v[60:63], v[160:163], a[204:207], v[60:63]
    v_exp_f32 v108, v108
    v_exp_f32 v109, v109
    v_mfma_f32_16x16x32_bf16 v[64:67], v[160:163], a[220:223], v[64:67]
    v_exp_f32 v110, v110
    v_exp_f32 v111, v111
    v_mfma_f32_16x16x32_bf16 v[68:71], v[160:163], a[236:239], v[68:71]
    v_cvt_pk_bf16_f32 v130, v108, v109
    v_cvt_pk_bf16_f32 v131, v110, v111
    s_waitcnt lgkmcnt(0)
    s_nop 1
    v_mfma_f32_16x16x32_bf16 a[0:3], v[164:167], v[112:115], a[0:3]
    v_mfma_f32_16x16x32_bf16 a[4:7], v[164:167], v[116:119], a[4:7]
    v_mfma_f32_16x16x32_bf16 a[8:11], v[164:167], v[120:123], a[8:11]
    v_mfma_f32_16x16x32_bf16 a[12:15], v[164:167], v[124:127], a[12:15]
    ds_read_b128 v[132:135], v8 offset:16384
    v_mfma_f32_16x16x32_bf16 a[16:19], v[164:167], v[128:131], a[16:19]
    ds_read_b128 v[136:139], v9 offset:16384
    ds_read_b128 v[140:143], v10 offset:16384
    v_mfma_f32_16x16x32_bf16 a[20:23], v[168:171], v[112:115], a[20:23]
    ds_read_b128 v[144:147], v11 offset:16384
    ds_read_b128 v[148:151], v8 offset:20480
    v_mfma_f32_16x16x32_bf16 a[24:27], v[168:171], v[116:119], a[24:27]
    ds_read_b128 v[152:155], v9 offset:20480
    ds_read_b128 v[156:159], v10 offset:20480
    v_mfma_f32_16x16x32_bf16 a[28:31], v[168:171], v[120:123], a[28:31]
    ds_read_b128 v[160:163], v11 offset:20480
    v_add_f32 v216, v216, v72
    v_mfma_f32_16x16x32_bf16 a[32:35], v[168:171], v[124:127], a[32:35]
    v_add_f32 v217, v217, v76
    v_add_f32 v218, v218, v80
    v_mfma_f32_16x16x32_bf16 a[36:39], v[168:171], v[128:131], a[36:39]
    v_add_f32 v219, v219, v84
    v_mfma_f32_16x16x32_bf16 a[40:43], v[172:175], v[112:115], a[40:43]
    v_add_f32 v220, v220, v88
    v_add_f32 v216, v216, v73
    v_mfma_f32_16x16x32_bf16 a[44:47], v[172:175], v[116:119], a[44:47]
    v_add_f32 v217, v217, v77
    v_add_f32 v218, v218, v81
    v_mfma_f32_16x16x32_bf16 a[48:51], v[172:175], v[120:123], a[48:51]
    v_add_f32 v219, v219, v85
    v_add_f32 v220, v220, v89
    v_mfma_f32_16x16x32_bf16 a[52:55], v[172:175], v[124:127], a[52:55]
    v_add_f32 v216, v216, v74
    v_add_f32 v217, v217, v78
    v_mfma_f32_16x16x32_bf16 a[56:59], v[172:175], v[128:131], a[56:59]
    v_add_f32 v218, v218, v82
    v_add_f32 v219, v219, v86
    v_mfma_f32_16x16x32_bf16 a[60:63], v[176:179], v[112:115], a[60:63]
    v_add_f32 v220, v220, v90
    v_mfma_f32_16x16x32_bf16 a[64:67], v[176:179], v[116:119], a[64:67]
    v_add_f32 v216, v216, v75
    v_add_f32 v217, v217, v79
    v_mfma_f32_16x16x32_bf16 a[68:71], v[176:179], v[120:123], a[68:71]
    v_add_f32 v218, v218, v83
    v_add_f32 v219, v219, v87
    v_mfma_f32_16x16x32_bf16 a[72:75], v[176:179], v[124:127], a[72:75]
    v_add_f32 v220, v220, v91
    v_add_f32 v216, v216, v92
    v_mfma_f32_16x16x32_bf16 a[76:79], v[176:179], v[128:131], a[76:79]
    v_add_f32 v217, v217, v96
    v_add_f32 v218, v218, v100
    v_mfma_f32_16x16x32_bf16 a[80:83], v[180:183], v[112:115], a[80:83]
    v_add_f32 v219, v219, v104
    v_add_f32 v220, v220, v108
    v_mfma_f32_16x16x32_bf16 a[84:87], v[180:183], v[116:119], a[84:87]
    v_add_f32 v216, v216, v93
    v_mfma_f32_16x16x32_bf16 a[88:91], v[180:183], v[120:123], a[88:91]
    v_add_f32 v217, v217, v97
    v_add_f32 v218, v218, v101
    v_mfma_f32_16x16x32_bf16 a[92:95], v[180:183], v[124:127], a[92:95]
    v_add_f32 v219, v219, v105
    v_add_f32 v220, v220, v109
    v_mfma_f32_16x16x32_bf16 a[96:99], v[180:183], v[128:131], a[96:99]
    v_add_f32 v216, v216, v94
    v_add_f32 v217, v217, v98
    v_mfma_f32_16x16x32_bf16 a[100:103], v[184:187], v[112:115], a[100:103]
    v_add_f32 v218, v218, v102
    v_add_f32 v219, v219, v106
    v_mfma_f32_16x16x32_bf16 a[104:107], v[184:187], v[116:119], a[104:107]
    v_add_f32 v220, v220, v110
    v_add_f32 v216, v216, v95
    v_mfma_f32_16x16x32_bf16 a[108:111], v[184:187], v[120:123], a[108:111]
    v_add_f32 v217, v217, v99
    v_mfma_f32_16x16x32_bf16 a[112:115], v[184:187], v[124:127], a[112:115]
    v_add_f32 v218, v218, v103
    v_add_f32 v219, v219, v107
    v_mfma_f32_16x16x32_bf16 a[116:119], v[184:187], v[128:131], a[116:119]
    v_add_f32 v220, v220, v111
    v_max3_f32 v226, v32, v33, v34
    v_mfma_f32_16x16x32_bf16 a[120:123], v[188:191], v[112:115], a[120:123]
    v_max3_f32 v226, v226, v35, v36
    v_max3_f32 v226, v226, v37, v38
    v_mfma_f32_16x16x32_bf16 a[124:127], v[188:191], v[116:119], a[124:127]
    v_max3_f32 v226, v226, v39, v40
    v_max3_f32 v226, v226, v41, v42
    v_mfma_f32_16x16x32_bf16 a[128:131], v[188:191], v[120:123], a[128:131]
    v_max3_f32 v226, v226, v43, v44
    v_max3_f32 v226, v226, v45, v46
    v_mfma_f32_16x16x32_bf16 a[132:135], v[188:191], v[124:127], a[132:135]
    v_max3_f32 v226, v226, v47, v48
    v_mfma_f32_16x16x32_bf16 a[136:139], v[188:191], v[128:131], a[136:139]
    v_max3_f32 v226, v226, v49, v50
    v_max3_f32 v226, v226, v51, v52
    v_mfma_f32_16x16x32_bf16 a[140:143], v[192:195], v[112:115], a[140:143]
    v_max3_f32 v226, v226, v53, v54
    v_max3_f32 v226, v226, v55, v56
    v_mfma_f32_16x16x32_bf16 a[144:147], v[192:195], v[116:119], a[144:147]
    v_max3_f32 v226, v226, v57, v58
    v_max3_f32 v226, v226, v59, v60
    v_mfma_f32_16x16x32_bf16 a[148:151], v[192:195], v[120:123], a[148:151]
    v_max3_f32 v226, v226, v61, v62
    v_max3_f32 v226, v226, v63, v64
    v_mfma_f32_16x16x32_bf16 a[152:155], v[192:195], v[124:127], a[152:155]
    v_max3_f32 v226, v226, v65, v66
    v_max3_f32 v226, v226, v67, v68
    v_mfma_f32_16x16x32_bf16 a[156:159], v[192:195], v[128:131], a[156:159]
    v_max3_f32 v226, v226, v69, v70
    v_max_f32 v226, v226, v71
    s_nop 0
    v_cmp_lt_f32 vcc, s50, v226
    s_nop 1
    s_cbranch_vccnz k1_kernel_L11
k1_kernel_L12:
    s_waitcnt vmcnt(16)
    s_barrier
    s_cmp_eq_u32 s40, 0
    s_cselect_b32 s44, 9, 7
    s_lshl_b32 s45, s44, 13
    s_add_u32 s45, s45, s42
    s_and_b32 s46, s44, 3
    s_lshl_b32 s46, s46, 14
    s_add_u32 s46, s46, s43
    s_add_u32 s47, s46, 0
    s_mov_b32 m0, s47
    s_add_u32 s48, s45, 0
    buffer_load_dwordx4 v4, s[32:35], s48 offen lds
    s_add_u32 s47, s46, 1024
    s_mov_b32 m0, s47
    s_add_u32 s48, s45, 1024
    buffer_load_dwordx4 v5, s[32:35], s48 offen lds
    s_add_u32 s47, s46, 2048
    s_mov_b32 m0, s47
    s_add_u32 s48, s45, 2048
    buffer_load_dwordx4 v6, s[32:35], s48 offen lds
    s_add_u32 s47, s46, 3072
    s_mov_b32 m0, s47
    s_add_u32 s48, s45, 3072
    buffer_load_dwordx4 v7, s[32:35], s48 offen lds
    s_add_u32 s47, s46, 4096
    s_mov_b32 m0, s47
    s_add_u32 s48, s45, 4096
    buffer_load_dwordx4 v4, s[32:35], s48 offen lds
    s_add_u32 s47, s46, 5120
    s_mov_b32 m0, s47
    s_add_u32 s48, s45, 5120
    buffer_load_dwordx4 v5, s[32:35], s48 offen lds
    s_add_u32 s47, s46, 6144
    s_mov_b32 m0, s47
    s_add_u32 s48, s45, 6144
    buffer_load_dwordx4 v6, s[32:35], s48 offen lds
    s_add_u32 s47, s46, 7168
    s_mov_b32 m0, s47
    s_add_u32 s48, s45, 7168
    buffer_load_dwordx4 v7, s[32:35], s48 offen lds
    s_waitcnt lgkmcnt(0)
    v_mfma_f32_16x16x32_bf16 v[72:75], v[132:135], a[160:163], v[196:199]
    ds_read_b64_tr_b16 v[164:165], v12 offset:0
    v_mfma_f32_16x16x32_bf16 v[76:79], v[132:135], a[176:179], v[200:203]
    ds_read_b64_tr_b16 v[166:167], v12 offset:4096
    ds_read_b64_tr_b16 v[168:169], v13 offset:0
    v_mfma_f32_16x16x32_bf16 v[80:83], v[132:135], a[192:195], v[204:207]
    ds_read_b64_tr_b16 v[170:171], v13 offset:4096
    ds_read_b64_tr_b16 v[172:173], v14 offset:0
    v_mfma_f32_16x16x32_bf16 v[84:87], v[132:135], a[208:211], v[208:211]
    ds_read_b64_tr_b16 v[174:175], v14 offset:4096
    ds_read_b64_tr_b16 v[176:177], v15 offset:0
    v_mfma_f32_16x16x32_bf16 v[88:91], v[132:135], a[224:227], v[212:215]
    ds_read_b64_tr_b16 v[178:179], v15 offset:4096
    ds_read_b64_tr_b16 v[180:181], v16 offset:0
    v_mfma_f32_16x16x32_bf16 v[92:95], v[148:151], a[160:163], v[196:199]
    ds_read_b64_tr_b16 v[182:183], v16 offset:4096
    ds_read_b64_tr_b16 v[184:185], v17 offset:0
    v_mfma_f32_16x16x32_bf16 v[96:99], v[148:151], a[176:179], v[200:203]
    ds_read_b64_tr_b16 v[186:187], v17 offset:4096
    ds_read_b64_tr_b16 v[188:189], v18 offset:0
    v_mfma_f32_16x16x32_bf16 v[100:103], v[148:151], a[192:195], v[204:207]
    ds_read_b64_tr_b16 v[190:191], v18 offset:4096
    ds_read_b64_tr_b16 v[192:193], v19 offset:0
    v_mfma_f32_16x16x32_bf16 v[104:107], v[148:151], a[208:211], v[208:211]
    ds_read_b64_tr_b16 v[194:195], v19 offset:4096
    v_exp_f32 v32, v32
    v_mfma_f32_16x16x32_bf16 v[108:111], v[148:151], a[224:227], v[212:215]
    v_exp_f32 v33, v33
    v_exp_f32 v34, v34
    v_mfma_f32_16x16x32_bf16 v[72:75], v[136:139], a[164:167], v[72:75]
    v_exp_f32 v35, v35
    v_mfma_f32_16x16x32_bf16 v[76:79], v[136:139], a[180:183], v[76:79]
    v_cvt_pk_bf16_f32 v112, v32, v33
    v_cvt_pk_bf16_f32 v113, v34, v35
    v_mfma_f32_16x16x32_bf16 v[80:83], v[136:139], a[196:199], v[80:83]
    v_exp_f32 v52, v52
    v_exp_f32 v53, v53
    v_mfma_f32_16x16x32_bf16 v[84:87], v[136:139], a[212:215], v[84:87]
    v_exp_f32 v54, v54
    v_exp_f32 v55, v55
    v_mfma_f32_16x16x32_bf16 v[88:91], v[136:139], a[228:231], v[88:91]
    v_cvt_pk_bf16_f32 v114, v52, v53
    v_cvt_pk_bf16_f32 v115, v54, v55
    v_mfma_f32_16x16x32_bf16 v[92:95], v[152:155], a[164:167], v[92:95]
    v_exp_f32 v36, v36
    v_exp_f32 v37, v37
    v_mfma_f32_16x16x32_bf16 v[96:99], v[152:155], a[180:183], v[96:99]
    v_exp_f32 v38, v38
    v_exp_f32 v39, v39
    v_mfma_f32_16x16x32_bf16 v[100:103], v[152:155], a[196:199], v[100:103]
    v_cvt_pk_bf16_f32 v116, v36, v37
    v_cvt_pk_bf16_f32 v117, v38, v39
    v_mfma_f32_16x16x32_bf16 v[104:107], v[152:155], a[212:215], v[104:107]
    v_exp_f32 v56, v56
    v_exp_f32 v57, v57
    v_mfma_f32_16x16x32_bf16 v[108:111], v[152:155], a[228:231], v[108:111]
    v_exp_f32 v58, v58
    v_exp_f32 v59, v59
    v_mfma_f32_16x16x32_bf16 v[72:75], v[140:143], a[168:171], v[72:75]
    v_cvt_pk_bf16_f32 v118, v56, v57
    v_mfma_f32_16x16x32_bf16 v[76:79], v[140:143], a[184:187], v[76:79]
    v_cvt_pk_bf16_f32 v119, v58, v59
    v_exp_f32 v40, v40
    v_mfma_f32_16x16x32_bf16 v[80:83], v[140:143], a[200:203], v[80:83]
    v_exp_f32 v41, v41
    v_exp_f32 v42, v42
    v_mfma_f32_16x16x32_bf16 v[84:87], v[140:143], a[216:219], v[84:87]
    v_exp_f32 v43, v43
    v_cvt_pk_bf16_f32 v120, v40, v41
    v_mfma_f32_16x16x32_bf16 v[88:91], v[140:143], a[232:235], v[88:91]
    v_cvt_pk_bf16_f32 v121, v42, v43
    v_exp_f32 v60, v60
    v_mfma_f32_16x16x32_bf16 v[92:95], v[156:159], a[168:171], v[92:95]
    v_exp_f32 v61, v61
    v_exp_f32 v62, v62
    v_mfma_f32_16x16x32_bf16 v[96:99], v[156:159], a[184:187], v[96:99]
    v_exp_f32 v63, v63
    v_cvt_pk_bf16_f32 v122, v60, v61
    v_mfma_f32_16x16x32_bf16 v[100:103], v[156:159], a[200:203], v[100:103]
    v_cvt_pk_bf16_f32 v123, v62, v63
    v_exp_f32 v44, v44
    v_mfma_f32_16x16x32_bf16 v[104:107], v[156:159], a[216:219], v[104:107]
    v_exp_f32 v45, v45
    v_exp_f32 v46, v46
    v_mfma_f32_16x16x32_bf16 v[108:111], v[156:159], a[232:235], v[108:111]
    v_exp_f32 v47, v47
    v_cvt_pk_bf16_f32 v124, v44, v45
    v_mfma_f32_16x16x32_bf16 v[72:75], v[144:147], a[172:175], v[72:75]
    v_cvt_pk_bf16_f32 v125, v46, v47
    v_mfma_f32_16x16x32_bf16 v[76:79], v[144:147], a[188:191], v[76:79]
    v_exp_f32 v64, v64
    v_exp_f32 v65, v65
    v_mfma_f32_16x16x32_bf16 v[80:83], v[144:147], a[204:207], v[80:83]
    v_exp_f32 v66, v66
    v_exp_f32 v67, v67
    v_mfma_f32_16x16x32_bf16 v[84:87], v[144:147], a[220:223], v[84:87]
    v_cvt_pk_bf16_f32 v126, v64, v65
    v_cvt_pk_bf16_f32 v127, v66, v67
    v_mfma_f32_16x16x32_bf16 v[88:91], v[144:147], a[236:239], v[88:91]
    v_exp_f32 v48, v48
    v_exp_f32 v49, v49
    v_mfma_f32_16x16x32_bf16 v[92:95], v[160:163], a[172:175], v[92:95]
    v_exp_f32 v50, v50
    v_exp_f32 v51, v51
    v_mfma_f32_16x16x32_bf16 v[96:99], v[160:163], a[188:191], v[96:99]
    v_cvt_pk_bf16_f32 v128, v48, v49
    v_cvt_pk_bf16_f32 v129, v50, v51
    v_mfma_f32_16x16x32_bf16 v[100:103], v[160:163], a[204:207], v[100:103]
    v_exp_f32 v68, v68
    v_exp_f32 v69, v69
    v_mfma_f32_16x16x32_bf16 v[104:107], v[160:163], a[220:223], v[104:107]
    v_exp_f32 v70, v70
    v_exp_f32 v71, v71
    v_mfma_f32_16x16x32_bf16 v[108:111], v[160:163], a[236:239], v[108:111]
    v_cvt_pk_bf16_f32 v130, v68, v69
    v_cvt_pk_bf16_f32 v131, v70, v71
    s_waitcnt lgkmcnt(0)
    s_nop 1
    v_mfma_f32_16x16x32_bf16 a[0:3], v[164:167], v[112:115], a[0:3]
    v_mfma_f32_16x16x32_bf16 a[4:7], v[164:167], v[116:119], a[4:7]
    v_mfma_f32_16x16x32_bf16 a[8:11], v[164:167], v[120:123], a[8:11]
    v_mfma_f32_16x16x32_bf16 a[12:15], v[164:167], v[124:127], a[12:15]
    ds_read_b128 v[132:135], v8 offset:32768
    v_mfma_f32_16x16x32_bf16 a[16:19], v[164:167], v[128:131], a[16:19]
    ds_read_b128 v[136:139], v9 offset:32768
    ds_read_b128 v[140:143], v10 offset:32768
    v_mfma_f32_16x16x32_bf16 a[20:23], v[168:171], v[112:115], a[20:23]
    ds_read_b128 v[144:147], v11 offset:32768
    ds_read_b128 v[148:151], v8 offset:36864
    v_mfma_f32_16x16x32_bf16 a[24:27], v[168:171], v[116:119], a[24:27]
    ds_read_b128 v[152:155], v9 offset:36864
    ds_read_b128 v[156:159], v10 offset:36864
    v_mfma_f32_16x16x32_bf16 a[28:31], v[168:171], v[120:123], a[28:31]
    ds_read_b128 v[160:163], v11 offset:36864
    v_add_f32 v216, v216, v32
    v_mfma_f32_16x16x32_bf16 a[32:35], v[168:171], v[124:127], a[32:35]
    v_add_f32 v217, v217, v36
    v_add_f32 v218, v218, v40
    v_mfma_f32_16x16x32_bf16 a[36:39], v[168:171], v[128:131], a[36:39]
    v_add_f32 v219, v219, v44
    v_mfma_f32_16x16x32_bf16 a[40:43], v[172:175], v[112:115], a[40:43]
    v_add_f32 v220, v220, v48
    v_add_f32 v216, v216, v33
    v_mfma_f32_16x16x32_bf16 a[44:47], v[172:175], v[116:119], a[44:47]
    v_add_f32 v217, v217, v37
    v_add_f32 v218, v218, v41
    v_mfma_f32_16x16x32_bf16 a[48:51], v[172:175], v[120:123], a[48:51]
    v_add_f32 v219, v219, v45
    v_add_f32 v220, v220, v49
    v_mfma_f32_16x16x32_bf16 a[52:55], v[172:175], v[124:127], a[52:55]
    v_add_f32 v216, v216, v34
    v_add_f32 v217, v217, v38
    v_mfma_f32_16x16x32_bf16 a[56:59], v[172:175], v[128:131], a[56:59]
    v_add_f32 v218, v218, v42
    v_add_f32 v219, v219, v46
    v_mfma_f32_16x16x32_bf16 a[60:63], v[176:179], v[112:115], a[60:63]
    v_add_f32 v220, v220, v50
    v_mfma_f32_16x16x32_bf16 a[64:67], v[176:179], v[116:119], a[64:67]
    v_add_f32 v216, v216, v35
    v_add_f32 v217, v217, v39
    v_mfma_f32_16x16x32_bf16 a[68:71], v[176:179], v[120:123], a[68:71]
    v_add_f32 v218, v218, v43
    v_add_f32 v219, v219, v47
    v_mfma_f32_16x16x32_bf16 a[72:75], v[176:179], v[124:127], a[72:75]
    v_add_f32 v220, v220, v51
    v_add_f32 v216, v216, v52
    v_mfma_f32_16x16x32_bf16 a[76:79], v[176:179], v[128:131], a[76:79]
    v_add_f32 v217, v217, v56
    v_add_f32 v218, v218, v60
    v_mfma_f32_16x16x32_bf16 a[80:83], v[180:183], v[112:115], a[80:83]
    v_add_f32 v219, v219, v64
    v_add_f32 v220, v220, v68
    v_mfma_f32_16x16x32_bf16 a[84:87], v[180:183], v[116:119], a[84:87]
    v_add_f32 v216, v216, v53
    v_mfma_f32_16x16x32_bf16 a[88:91], v[180:183], v[120:123], a[88:91]
    v_add_f32 v217, v217, v57
    v_add_f32 v218, v218, v61
    v_mfma_f32_16x16x32_bf16 a[92:95], v[180:183], v[124:127], a[92:95]
    v_add_f32 v219, v219, v65
    v_add_f32 v220, v220, v69
    v_mfma_f32_16x16x32_bf16 a[96:99], v[180:183], v[128:131], a[96:99]
    v_add_f32 v216, v216, v54
    v_add_f32 v217, v217, v58
    v_mfma_f32_16x16x32_bf16 a[100:103], v[184:187], v[112:115], a[100:103]
    v_add_f32 v218, v218, v62
    v_add_f32 v219, v219, v66
    v_mfma_f32_16x16x32_bf16 a[104:107], v[184:187], v[116:119], a[104:107]
    v_add_f32 v220, v220, v70
    v_add_f32 v216, v216, v55
    v_mfma_f32_16x16x32_bf16 a[108:111], v[184:187], v[120:123], a[108:111]
    v_add_f32 v217, v217, v59
    v_mfma_f32_16x16x32_bf16 a[112:115], v[184:187], v[124:127], a[112:115]
    v_add_f32 v218, v218, v63
    v_add_f32 v219, v219, v67
    v_mfma_f32_16x16x32_bf16 a[116:119], v[184:187], v[128:131], a[116:119]
    v_add_f32 v220, v220, v71
    v_max3_f32 v226, v72, v73, v74
    v_mfma_f32_16x16x32_bf16 a[120:123], v[188:191], v[112:115], a[120:123]
    v_max3_f32 v226, v226, v75, v76
    v_max3_f32 v226, v226, v77, v78
    v_mfma_f32_16x16x32_bf16 a[124:127], v[188:191], v[116:119], a[124:127]
    v_max3_f32 v226, v226, v79, v80
    v_max3_f32 v226, v226, v81, v82
    v_mfma_f32_16x16x32_bf16 a[128:131], v[188:191], v[120:123], a[128:131]
    v_max3_f32 v226, v226, v83, v84
    v_max3_f32 v226, v226, v85, v86
    v_mfma_f32_16x16x32_bf16 a[132:135], v[188:191], v[124:127], a[132:135]
    v_max3_f32 v226, v226, v87, v88
    v_mfma_f32_16x16x32_bf16 a[136:139], v[188:191], v[128:131], a[136:139]
    v_max3_f32 v226, v226, v89, v90
    v_max3_f32 v226, v226, v91, v92
    v_mfma_f32_16x16x32_bf16 a[140:143], v[192:195], v[112:115], a[140:143]
    v_max3_f32 v226, v226, v93, v94
    v_max3_f32 v226, v226, v95, v96
    v_mfma_f32_16x16x32_bf16 a[144:147], v[192:195], v[116:119], a[144:147]
    v_max3_f32 v226, v226, v97, v98
    v_max3_f32 v226, v226, v99, v100
    v_mfma_f32_16x16x32_bf16 a[148:151], v[192:195], v[120:123], a[148:151]
    v_max3_f32 v226, v226, v101, v102
    v_max3_f32 v226, v226, v103, v104
    v_mfma_f32_16x16x32_bf16 a[152:155], v[192:195], v[124:127], a[152:155]
    v_max3_f32 v226, v226, v105, v106
    v_max3_f32 v226, v226, v107, v108
    v_mfma_f32_16x16x32_bf16 a[156:159], v[192:195], v[128:131], a[156:159]
    v_max3_f32 v226, v226, v109, v110
    v_max_f32 v226, v226, v111
    s_nop 0
    v_cmp_lt_f32 vcc, s50, v226
    s_nop 1
    s_cbranch_vccnz k1_kernel_L13
k1_kernel_L14:
    s_waitcnt vmcnt(16)
    s_barrier
    s_cmp_eq_u32 s40, 0
    s_cselect_b32 s44, 10, 8
    s_lshl_b32 s45, s44, 13
    s_add_u32 s45, s45, s42
    s_and_b32 s46, s44, 3
    s_lshl_b32 s46, s46, 14
    s_add_u32 s46, s46, s43
    s_add_u32 s47, s46, 0
    s_mov_b32 m0, s47
    s_add_u32 s48, s45, 0
    buffer_load_dwordx4 v4, s[32:35], s48 offen lds
    s_add_u32 s47, s46, 1024
    s_mov_b32 m0, s47
    s_add_u32 s48, s45, 1024
    buffer_load_dwordx4 v5, s[32:35], s48 offen lds
    s_add_u32 s47, s46, 2048
    s_mov_b32 m0, s47
    s_add_u32 s48, s45, 2048
    buffer_load_dwordx4 v6, s[32:35], s48 offen lds
    s_add_u32 s47, s46, 3072
    s_mov_b32 m0, s47
    s_add_u32 s48, s45, 3072
    buffer_load_dwordx4 v7, s[32:35], s48 offen lds
    s_add_u32 s47, s46, 4096
    s_mov_b32 m0, s47
    s_add_u32 s48, s45, 4096
    buffer_load_dwordx4 v4, s[32:35], s48 offen lds
    s_add_u32 s47, s46, 5120
    s_mov_b32 m0, s47
    s_add_u32 s48, s45, 5120
    buffer_load_dwordx4 v5, s[32:35], s48 offen lds
    s_add_u32 s47, s46, 6144
    s_mov_b32 m0, s47
    s_add_u32 s48, s45, 6144
    buffer_load_dwordx4 v6, s[32:35], s48 offen lds
    s_add_u32 s47, s46, 7168
    s_mov_b32 m0, s47
    s_add_u32 s48, s45, 7168
    buffer_load_dwordx4 v7, s[32:35], s48 offen lds
    s_waitcnt lgkmcnt(0)
    v_mfma_f32_16x16x32_bf16 v[32:35], v[132:135], a[160:163], v[196:199]
    ds_read_b64_tr_b16 v[164:165], v12 offset:16384
    v_mfma_f32_16x16x32_bf16 v[36:39], v[132:135], a[176:179], v[200:203]
    ds_read_b64_tr_b16 v[166:167], v12 offset:20480
    ds_read_b64_tr_b16 v[168:169], v13 offset:16384
    v_mfma_f32_16x16x32_bf16 v[40:43], v[132:135], a[192:195], v[204:207]
    ds_read_b64_tr_b16 v[170:171], v13 offset:20480
    ds_read_b64_tr_b16 v[172:173], v14 offset:16384
    v_mfma_f32_16x16x32_bf16 v[44:47], v[132:135], a[208:211], v[208:211]
    ds_read_b64_tr_b16 v[174:175], v14 offset:20480
    ds_read_b64_tr_b16 v[176:177], v15 offset:16384
    v_mfma_f32_16x16x32_bf16 v[48:51], v[132:135], a[224:227], v[212:215]
    ds_read_b64_tr_b16 v[178:179], v15 offset:20480
    ds_read_b64_tr_b16 v[180:181], v16 offset:16384
    v_mfma_f32_16x16x32_bf16 v[52:55], v[148:151], a[160:163], v[196:199]
    ds_read_b64_tr_b16 v[182:183], v16 offset:20480
    ds_read_b64_tr_b16 v[184:185], v17 offset:16384
    v_mfma_f32_16x16x32_bf16 v[56:59], v[148:151], a[176:179], v[200:203]
    ds_read_b64_tr_b16 v[186:187], v17 offset:20480
    ds_read_b64_tr_b16 v[188:189], v18 offset:16384
    v_mfma_f32_16x16x32_bf16 v[60:63], v[148:151], a[192:195], v[204:207]
    ds_read_b64_tr_b16 v[190:191], v18 offset:20480
    ds_read_b64_tr_b16 v[192:193], v19 offset:16384
    v_mfma_f32_16x16x32_bf16 v[64:67], v[148:151], a[208:211], v[208:211]
    ds_read_b64_tr_b16 v[194:195], v19 offset:20480
    v_exp_f32 v72, v72
    v_mfma_f32_16x16x32_bf16 v[68:71], v[148:151], a[224:227], v[212:215]
    v_exp_f32 v73, v73
    v_exp_f32 v74, v74
    v_mfma_f32_16x16x32_bf16 v[32:35], v[136:139], a[164:167], v[32:35]
    v_exp_f32 v75, v75
    v_mfma_f32_16x16x32_bf16 v[36:39], v[136:139], a[180:183], v[36:39]
    v_cvt_pk_bf16_f32 v112, v72, v73
    v_cvt_pk_bf16_f32 v113, v74, v75
    v_mfma_f32_16x16x32_bf16 v[40:43], v[136:139], a[196:199], v[40:43]
    v_exp_f32 v92, v92
    v_exp_f32 v93, v93
    v_mfma_f32_16x16x32_bf16 v[44:47], v[136:139], a[212:215], v[44:47]
    v_exp_f32 v94, v94
    v_exp_f32 v95, v95
    v_mfma_f32_16x16x32_bf16 v[48:51], v[136:139], a[228:231], v[48:51]
    v_cvt_pk_bf16_f32 v114, v92, v93
    v_cvt_pk_bf16_f32 v115, v94, v95
    v_mfma_f32_16x16x32_bf16 v[52:55], v[152:155], a[164:167], v[52:55]
    v_exp_f32 v76, v76
    v_exp_f32 v77, v77
    v_mfma_f32_16x16x32_bf16 v[56:59], v[152:155], a[180:183], v[56:59]
    v_exp_f32 v78, v78
    v_exp_f32 v79, v79
    v_mfma_f32_16x16x32_bf16 v[60:63], v[152:155], a[196:199], v[60:63]
    v_cvt_pk_bf16_f32 v116, v76, v77
    v_cvt_pk_bf16_f32 v117, v78, v79
    v_mfma_f32_16x16x32_bf16 v[64:67], v[152:155], a[212:215], v[64:67]
    v_exp_f32 v96, v96
    v_exp_f32 v97, v97
    v_mfma_f32_16x16x32_bf16 v[68:71], v[152:155], a[228:231], v[68:71]
    v_exp_f32 v98, v98
    v_exp_f32 v99, v99
    v_mfma_f32_16x16x32_bf16 v[32:35], v[140:143], a[168:171], v[32:35]
    v_cvt_pk_bf16_f32 v118, v96, v97
    v_mfma_f32_16x16x32_bf16 v[36:39], v[140:143], a[184:187], v[36:39]
    v_cvt_pk_bf16_f32 v119, v98, v99
    v_exp_f32 v80, v80
    v_mfma_f32_16x16x32_bf16 v[40:43], v[140:143], a[200:203], v[40:43]
    v_exp_f32 v81, v81
    v_exp_f32 v82, v82
    v_mfma_f32_16x16x32_bf16 v[44:47], v[140:143], a[216:219], v[44:47]
    v_exp_f32 v83, v83
    v_cvt_pk_bf16_f32 v120, v80, v81
    v_mfma_f32_16x16x32_bf16 v[48:51], v[140:143], a[232:235], v[48:51]
    v_cvt_pk_bf16_f32 v121, v82, v83
    v_exp_f32 v100, v100
    v_mfma_f32_16x16x32_bf16 v[52:55], v[156:159], a[168:171], v[52:55]
    v_exp_f32 v101, v101
    v_exp_f32 v102, v102
    v_mfma_f32_16x16x32_bf16 v[56:59], v[156:159], a[184:187], v[56:59]
    v_exp_f32 v103, v103
    v_cvt_pk_bf16_f32 v122, v100, v101
    v_mfma_f32_16x16x32_bf16 v[60:63], v[156:159], a[200:203], v[60:63]
    v_cvt_pk_bf16_f32 v123, v102, v103
    v_exp_f32 v84, v84
    v_mfma_f32_16x16x32_bf16 v[64:67], v[156:159], a[216:219], v[64:67]
    v_exp_f32 v85, v85
    v_exp_f32 v86, v86
    v_mfma_f32_16x16x32_bf16 v[68:71], v[156:159], a[232:235], v[68:71]
    v_exp_f32 v87, v87
    v_cvt_pk_bf16_f32 v124, v84, v85
    v_mfma_f32_16x16x32_bf16 v[32:35], v[144:147], a[172:175], v[32:35]
    v_cvt_pk_bf16_f32 v125, v86, v87
    v_mfma_f32_16x16x32_bf16 v[36:39], v[144:147], a[188:191], v[36:39]
    v_exp_f32 v104, v104
    v_exp_f32 v105, v105
    v_mfma_f32_16x16x32_bf16 v[40:43], v[144:147], a[204:207], v[40:43]
    v_exp_f32 v106, v106
    v_exp_f32 v107, v107
    v_mfma_f32_16x16x32_bf16 v[44:47], v[144:147], a[220:223], v[44:47]
    v_cvt_pk_bf16_f32 v126, v104, v105
    v_cvt_pk_bf16_f32 v127, v106, v107
    v_mfma_f32_16x16x32_bf16 v[48:51], v[144:147], a[236:239], v[48:51]
    v_exp_f32 v88, v88
    v_exp_f32 v89, v89
    v_mfma_f32_16x16x32_bf16 v[52:55], v[160:163], a[172:175], v[52:55]
    v_exp_f32 v90, v90
    v_exp_f32 v91, v91
    v_mfma_f32_16x16x32_bf16 v[56:59], v[160:163], a[188:191], v[56:59]
    v_cvt_pk_bf16_f32 v128, v88, v89
    v_cvt_pk_bf16_f32 v129, v90, v91
    v_mfma_f32_16x16x32_bf16 v[60:63], v[160:163], a[204:207], v[60:63]
    v_exp_f32 v108, v108
    v_exp_f32 v109, v109
    v_mfma_f32_16x16x32_bf16 v[64:67], v[160:163], a[220:223], v[64:67]
    v_exp_f32 v110, v110
    v_exp_f32 v111, v111
    v_mfma_f32_16x16x32_bf16 v[68:71], v[160:163], a[236:239], v[68:71]
    v_cvt_pk_bf16_f32 v130, v108, v109
    v_cvt_pk_bf16_f32 v131, v110, v111
    s_waitcnt lgkmcnt(0)
    s_nop 1
    v_mfma_f32_16x16x32_bf16 a[0:3], v[164:167], v[112:115], a[0:3]
    v_mfma_f32_16x16x32_bf16 a[4:7], v[164:167], v[116:119], a[4:7]
    v_mfma_f32_16x16x32_bf16 a[8:11], v[164:167], v[120:123], a[8:11]
    v_mfma_f32_16x16x32_bf16 a[12:15], v[164:167], v[124:127], a[12:15]
    ds_read_b128 v[132:135], v8 offset:49152
    v_mfma_f32_16x16x32_bf16 a[16:19], v[164:167], v[128:131], a[16:19]
    ds_read_b128 v[136:139], v9 offset:49152
    ds_read_b128 v[140:143], v10 offset:49152
    v_mfma_f32_16x16x32_bf16 a[20:23], v[168:171], v[112:115], a[20:23]
    ds_read_b128 v[144:147], v11 offset:49152
    ds_read_b128 v[148:151], v8 offset:53248
    v_mfma_f32_16x16x32_bf16 a[24:27], v[168:171], v[116:119], a[24:27]
    ds_read_b128 v[152:155], v9 offset:53248
    ds_read_b128 v[156:159], v10 offset:53248
    v_mfma_f32_16x16x32_bf16 a[28:31], v[168:171], v[120:123], a[28:31]
    ds_read_b128 v[160:163], v11 offset:53248
    v_add_f32 v216, v216, v72
    v_mfma_f32_16x16x32_bf16 a[32:35], v[168:171], v[124:127], a[32:35]
    v_add_f32 v217, v217, v76
    v_add_f32 v218, v218, v80
    v_mfma_f32_16x16x32_bf16 a[36:39], v[168:171], v[128:131], a[36:39]
    v_add_f32 v219, v219, v84
    v_mfma_f32_16x16x32_bf16 a[40:43], v[172:175], v[112:115], a[40:43]
    v_add_f32 v220, v220, v88
    v_add_f32 v216, v216, v73
    v_mfma_f32_16x16x32_bf16 a[44:47], v[172:175], v[116:119], a[44:47]
    v_add_f32 v217, v217, v77
    v_add_f32 v218, v218, v81
    v_mfma_f32_16x16x32_bf16 a[48:51], v[172:175], v[120:123], a[48:51]
    v_add_f32 v219, v219, v85
    v_add_f32 v220, v220, v89
    v_mfma_f32_16x16x32_bf16 a[52:55], v[172:175], v[124:127], a[52:55]
    v_add_f32 v216, v216, v74
    v_add_f32 v217, v217, v78
    v_mfma_f32_16x16x32_bf16 a[56:59], v[172:175], v[128:131], a[56:59]
    v_add_f32 v218, v218, v82
    v_add_f32 v219, v219, v86
    v_mfma_f32_16x16x32_bf16 a[60:63], v[176:179], v[112:115], a[60:63]
    v_add_f32 v220, v220, v90
    v_mfma_f32_16x16x32_bf16 a[64:67], v[176:179], v[116:119], a[64:67]
    v_add_f32 v216, v216, v75
    v_add_f32 v217, v217, v79
    v_mfma_f32_16x16x32_bf16 a[68:71], v[176:179], v[120:123], a[68:71]
    v_add_f32 v218, v218, v83
    v_add_f32 v219, v219, v87
    v_mfma_f32_16x16x32_bf16 a[72:75], v[176:179], v[124:127], a[72:75]
    v_add_f32 v220, v220, v91
    v_add_f32 v216, v216, v92
    v_mfma_f32_16x16x32_bf16 a[76:79], v[176:179], v[128:131], a[76:79]
    v_add_f32 v217, v217, v96
    v_add_f32 v218, v218, v100
    v_mfma_f32_16x16x32_bf16 a[80:83], v[180:183], v[112:115], a[80:83]
    v_add_f32 v219, v219, v104
    v_add_f32 v220, v220, v108
    v_mfma_f32_16x16x32_bf16 a[84:87], v[180:183], v[116:119], a[84:87]
    v_add_f32 v216, v216, v93
    v_mfma_f32_16x16x32_bf16 a[88:91], v[180:183], v[120:123], a[88:91]
    v_add_f32 v217, v217, v97
    v_add_f32 v218, v218, v101
    v_mfma_f32_16x16x32_bf16 a[92:95], v[180:183], v[124:127], a[92:95]
    v_add_f32 v219, v219, v105
    v_add_f32 v220, v220, v109
    v_mfma_f32_16x16x32_bf16 a[96:99], v[180:183], v[128:131], a[96:99]
    v_add_f32 v216, v216, v94
    v_add_f32 v217, v217, v98
    v_mfma_f32_16x16x32_bf16 a[100:103], v[184:187], v[112:115], a[100:103]
    v_add_f32 v218, v218, v102
    v_add_f32 v219, v219, v106
    v_mfma_f32_16x16x32_bf16 a[104:107], v[184:187], v[116:119], a[104:107]
    v_add_f32 v220, v220, v110
    v_add_f32 v216, v216, v95
    v_mfma_f32_16x16x32_bf16 a[108:111], v[184:187], v[120:123], a[108:111]
    v_add_f32 v217, v217, v99
    v_mfma_f32_16x16x32_bf16 a[112:115], v[184:187], v[124:127], a[112:115]
    v_add_f32 v218, v218, v103
    v_add_f32 v219, v219, v107
    v_mfma_f32_16x16x32_bf16 a[116:119], v[184:187], v[128:131], a[116:119]
    v_add_f32 v220, v220, v111
    v_max3_f32 v226, v32, v33, v34
    v_mfma_f32_16x16x32_bf16 a[120:123], v[188:191], v[112:115], a[120:123]
    v_max3_f32 v226, v226, v35, v36
    v_max3_f32 v226, v226, v37, v38
    v_mfma_f32_16x16x32_bf16 a[124:127], v[188:191], v[116:119], a[124:127]
    v_max3_f32 v226, v226, v39, v40
    v_max3_f32 v226, v226, v41, v42
    v_mfma_f32_16x16x32_bf16 a[128:131], v[188:191], v[120:123], a[128:131]
    v_max3_f32 v226, v226, v43, v44
    v_max3_f32 v226, v226, v45, v46
    v_mfma_f32_16x16x32_bf16 a[132:135], v[188:191], v[124:127], a[132:135]
    v_max3_f32 v226, v226, v47, v48
    v_mfma_f32_16x16x32_bf16 a[136:139], v[188:191], v[128:131], a[136:139]
    v_max3_f32 v226, v226, v49, v50
    v_max3_f32 v226, v226, v51, v52
    v_mfma_f32_16x16x32_bf16 a[140:143], v[192:195], v[112:115], a[140:143]
    v_max3_f32 v226, v226, v53, v54
    v_max3_f32 v226, v226, v55, v56
    v_mfma_f32_16x16x32_bf16 a[144:147], v[192:195], v[116:119], a[144:147]
    v_max3_f32 v226, v226, v57, v58
    v_max3_f32 v226, v226, v59, v60
    v_mfma_f32_16x16x32_bf16 a[148:151], v[192:195], v[120:123], a[148:151]
    v_max3_f32 v226, v226, v61, v62
    v_max3_f32 v226, v226, v63, v64
    v_mfma_f32_16x16x32_bf16 a[152:155], v[192:195], v[124:127], a[152:155]
    v_max3_f32 v226, v226, v65, v66
    v_max3_f32 v226, v226, v67, v68
    v_mfma_f32_16x16x32_bf16 a[156:159], v[192:195], v[128:131], a[156:159]
    v_max3_f32 v226, v226, v69, v70
    v_max_f32 v226, v226, v71
    s_nop 0
    v_cmp_lt_f32 vcc, s50, v226
    s_nop 1
    s_cbranch_vccnz k1_kernel_L15
k1_kernel_L16:
    s_waitcnt vmcnt(16)
    s_barrier
    s_cmp_eq_u32 s40, 0
    s_cselect_b32 s44, 11, 9
    s_lshl_b32 s45, s44, 13
    s_add_u32 s45, s45, s42
    s_and_b32 s46, s44, 3
    s_lshl_b32 s46, s46, 14
    s_add_u32 s46, s46, s43
    s_add_u32 s47, s46, 0
    s_mov_b32 m0, s47
    s_add_u32 s48, s45, 0
    buffer_load_dwordx4 v4, s[32:35], s48 offen lds
    s_add_u32 s47, s46, 1024
    s_mov_b32 m0, s47
    s_add_u32 s48, s45, 1024
    buffer_load_dwordx4 v5, s[32:35], s48 offen lds
    s_add_u32 s47, s46, 2048
    s_mov_b32 m0, s47
    s_add_u32 s48, s45, 2048
    buffer_load_dwordx4 v6, s[32:35], s48 offen lds
    s_add_u32 s47, s46, 3072
    s_mov_b32 m0, s47
    s_add_u32 s48, s45, 3072
    buffer_load_dwordx4 v7, s[32:35], s48 offen lds
    s_add_u32 s47, s46, 4096
    s_mov_b32 m0, s47
    s_add_u32 s48, s45, 4096
    buffer_load_dwordx4 v4, s[32:35], s48 offen lds
    s_add_u32 s47, s46, 5120
    s_mov_b32 m0, s47
    s_add_u32 s48, s45, 5120
    buffer_load_dwordx4 v5, s[32:35], s48 offen lds
    s_add_u32 s47, s46, 6144
    s_mov_b32 m0, s47
    s_add_u32 s48, s45, 6144
    buffer_load_dwordx4 v6, s[32:35], s48 offen lds
    s_add_u32 s47, s46, 7168
    s_mov_b32 m0, s47
    s_add_u32 s48, s45, 7168
    buffer_load_dwordx4 v7, s[32:35], s48 offen lds
    s_waitcnt lgkmcnt(0)
    v_mfma_f32_16x16x32_bf16 v[72:75], v[132:135], a[160:163], v[196:199]
    ds_read_b64_tr_b16 v[164:165], v12 offset:32768
    v_mfma_f32_16x16x32_bf16 v[76:79], v[132:135], a[176:179], v[200:203]
    ds_read_b64_tr_b16 v[166:167], v12 offset:36864
    ds_read_b64_tr_b16 v[168:169], v13 offset:32768
    v_mfma_f32_16x16x32_bf16 v[80:83], v[132:135], a[192:195], v[204:207]
    ds_read_b64_tr_b16 v[170:171], v13 offset:36864
    ds_read_b64_tr_b16 v[172:173], v14 offset:32768
    v_mfma_f32_16x16x32_bf16 v[84:87], v[132:135], a[208:211], v[208:211]
    ds_read_b64_tr_b16 v[174:175], v14 offset:36864
    ds_read_b64_tr_b16 v[176:177], v15 offset:32768
    v_mfma_f32_16x16x32_bf16 v[88:91], v[132:135], a[224:227], v[212:215]
    ds_read_b64_tr_b16 v[178:179], v15 offset:36864
    ds_read_b64_tr_b16 v[180:181], v16 offset:32768
    v_mfma_f32_16x16x32_bf16 v[92:95], v[148:151], a[160:163], v[196:199]
    ds_read_b64_tr_b16 v[182:183], v16 offset:36864
    ds_read_b64_tr_b16 v[184:185], v17 offset:32768
    v_mfma_f32_16x16x32_bf16 v[96:99], v[148:151], a[176:179], v[200:203]
    ds_read_b64_tr_b16 v[186:187], v17 offset:36864
    ds_read_b64_tr_b16 v[188:189], v18 offset:32768
    v_mfma_f32_16x16x32_bf16 v[100:103], v[148:151], a[192:195], v[204:207]
    ds_read_b64_tr_b16 v[190:191], v18 offset:36864
    ds_read_b64_tr_b16 v[192:193], v19 offset:32768
    v_mfma_f32_16x16x32_bf16 v[104:107], v[148:151], a[208:211], v[208:211]
    ds_read_b64_tr_b16 v[194:195], v19 offset:36864
    v_exp_f32 v32, v32
    v_mfma_f32_16x16x32_bf16 v[108:111], v[148:151], a[224:227], v[212:215]
    v_exp_f32 v33, v33
    v_exp_f32 v34, v34
    v_mfma_f32_16x16x32_bf16 v[72:75], v[136:139], a[164:167], v[72:75]
    v_exp_f32 v35, v35
    v_mfma_f32_16x16x32_bf16 v[76:79], v[136:139], a[180:183], v[76:79]
    v_cvt_pk_bf16_f32 v112, v32, v33
    v_cvt_pk_bf16_f32 v113, v34, v35
    v_mfma_f32_16x16x32_bf16 v[80:83], v[136:139], a[196:199], v[80:83]
    v_exp_f32 v52, v52
    v_exp_f32 v53, v53
    v_mfma_f32_16x16x32_bf16 v[84:87], v[136:139], a[212:215], v[84:87]
    v_exp_f32 v54, v54
    v_exp_f32 v55, v55
    v_mfma_f32_16x16x32_bf16 v[88:91], v[136:139], a[228:231], v[88:91]
    v_cvt_pk_bf16_f32 v114, v52, v53
    v_cvt_pk_bf16_f32 v115, v54, v55
    v_mfma_f32_16x16x32_bf16 v[92:95], v[152:155], a[164:167], v[92:95]
    v_exp_f32 v36, v36
    v_exp_f32 v37, v37
    v_mfma_f32_16x16x32_bf16 v[96:99], v[152:155], a[180:183], v[96:99]
    v_exp_f32 v38, v38
    v_exp_f32 v39, v39
    v_mfma_f32_16x16x32_bf16 v[100:103], v[152:155], a[196:199], v[100:103]
    v_cvt_pk_bf16_f32 v116, v36, v37
    v_cvt_pk_bf16_f32 v117, v38, v39
    v_mfma_f32_16x16x32_bf16 v[104:107], v[152:155], a[212:215], v[104:107]
    v_exp_f32 v56, v56
    v_exp_f32 v57, v57
    v_mfma_f32_16x16x32_bf16 v[108:111], v[152:155], a[228:231], v[108:111]
    v_exp_f32 v58, v58
    v_exp_f32 v59, v59
    v_mfma_f32_16x16x32_bf16 v[72:75], v[140:143], a[168:171], v[72:75]
    v_cvt_pk_bf16_f32 v118, v56, v57
    v_mfma_f32_16x16x32_bf16 v[76:79], v[140:143], a[184:187], v[76:79]
    v_cvt_pk_bf16_f32 v119, v58, v59
    v_exp_f32 v40, v40
    v_mfma_f32_16x16x32_bf16 v[80:83], v[140:143], a[200:203], v[80:83]
    v_exp_f32 v41, v41
    v_exp_f32 v42, v42
    v_mfma_f32_16x16x32_bf16 v[84:87], v[140:143], a[216:219], v[84:87]
    v_exp_f32 v43, v43
    v_cvt_pk_bf16_f32 v120, v40, v41
    v_mfma_f32_16x16x32_bf16 v[88:91], v[140:143], a[232:235], v[88:91]
    v_cvt_pk_bf16_f32 v121, v42, v43
    v_exp_f32 v60, v60
    v_mfma_f32_16x16x32_bf16 v[92:95], v[156:159], a[168:171], v[92:95]
    v_exp_f32 v61, v61
    v_exp_f32 v62, v62
    v_mfma_f32_16x16x32_bf16 v[96:99], v[156:159], a[184:187], v[96:99]
    v_exp_f32 v63, v63
    v_cvt_pk_bf16_f32 v122, v60, v61
    v_mfma_f32_16x16x32_bf16 v[100:103], v[156:159], a[200:203], v[100:103]
    v_cvt_pk_bf16_f32 v123, v62, v63
    v_exp_f32 v44, v44
    v_mfma_f32_16x16x32_bf16 v[104:107], v[156:159], a[216:219], v[104:107]
    v_exp_f32 v45, v45
    v_exp_f32 v46, v46
    v_mfma_f32_16x16x32_bf16 v[108:111], v[156:159], a[232:235], v[108:111]
    v_exp_f32 v47, v47
    v_cvt_pk_bf16_f32 v124, v44, v45
    v_mfma_f32_16x16x32_bf16 v[72:75], v[144:147], a[172:175], v[72:75]
    v_cvt_pk_bf16_f32 v125, v46, v47
    v_mfma_f32_16x16x32_bf16 v[76:79], v[144:147], a[188:191], v[76:79]
    v_exp_f32 v64, v64
    v_exp_f32 v65, v65
    v_mfma_f32_16x16x32_bf16 v[80:83], v[144:147], a[204:207], v[80:83]
    v_exp_f32 v66, v66
    v_exp_f32 v67, v67
    v_mfma_f32_16x16x32_bf16 v[84:87], v[144:147], a[220:223], v[84:87]
    v_cvt_pk_bf16_f32 v126, v64, v65
    v_cvt_pk_bf16_f32 v127, v66, v67
    v_mfma_f32_16x16x32_bf16 v[88:91], v[144:147], a[236:239], v[88:91]
    v_exp_f32 v48, v48
    v_exp_f32 v49, v49
    v_mfma_f32_16x16x32_bf16 v[92:95], v[160:163], a[172:175], v[92:95]
    v_exp_f32 v50, v50
    v_exp_f32 v51, v51
    v_mfma_f32_16x16x32_bf16 v[96:99], v[160:163], a[188:191], v[96:99]
    v_cvt_pk_bf16_f32 v128, v48, v49
    v_cvt_pk_bf16_f32 v129, v50, v51
    v_mfma_f32_16x16x32_bf16 v[100:103], v[160:163], a[204:207], v[100:103]
    v_exp_f32 v68, v68
    v_exp_f32 v69, v69
    v_mfma_f32_16x16x32_bf16 v[104:107], v[160:163], a[220:223], v[104:107]
    v_exp_f32 v70, v70
    v_exp_f32 v71, v71
    v_mfma_f32_16x16x32_bf16 v[108:111], v[160:163], a[236:239], v[108:111]
    v_cvt_pk_bf16_f32 v130, v68, v69
    v_cvt_pk_bf16_f32 v131, v70, v71
    s_waitcnt lgkmcnt(0)
    s_nop 1
    v_mfma_f32_16x16x32_bf16 a[0:3], v[164:167], v[112:115], a[0:3]
    v_mfma_f32_16x16x32_bf16 a[4:7], v[164:167], v[116:119], a[4:7]
    v_mfma_f32_16x16x32_bf16 a[8:11], v[164:167], v[120:123], a[8:11]
    v_mfma_f32_16x16x32_bf16 a[12:15], v[164:167], v[124:127], a[12:15]
    ds_read_b128 v[132:135], v8 offset:0
    v_mfma_f32_16x16x32_bf16 a[16:19], v[164:167], v[128:131], a[16:19]
    ds_read_b128 v[136:139], v9 offset:0
    ds_read_b128 v[140:143], v10 offset:0
    v_mfma_f32_16x16x32_bf16 a[20:23], v[168:171], v[112:115], a[20:23]
    ds_read_b128 v[144:147], v11 offset:0
    ds_read_b128 v[148:151], v8 offset:4096
    v_mfma_f32_16x16x32_bf16 a[24:27], v[168:171], v[116:119], a[24:27]
    ds_read_b128 v[152:155], v9 offset:4096
    ds_read_b128 v[156:159], v10 offset:4096
    v_mfma_f32_16x16x32_bf16 a[28:31], v[168:171], v[120:123], a[28:31]
    ds_read_b128 v[160:163], v11 offset:4096
    v_add_f32 v216, v216, v32
    v_mfma_f32_16x16x32_bf16 a[32:35], v[168:171], v[124:127], a[32:35]
    v_add_f32 v217, v217, v36
    v_add_f32 v218, v218, v40
    v_mfma_f32_16x16x32_bf16 a[36:39], v[168:171], v[128:131], a[36:39]
    v_add_f32 v219, v219, v44
    v_mfma_f32_16x16x32_bf16 a[40:43], v[172:175], v[112:115], a[40:43]
    v_add_f32 v220, v220, v48
    v_add_f32 v216, v216, v33
    v_mfma_f32_16x16x32_bf16 a[44:47], v[172:175], v[116:119], a[44:47]
    v_add_f32 v217, v217, v37
    v_add_f32 v218, v218, v41
    v_mfma_f32_16x16x32_bf16 a[48:51], v[172:175], v[120:123], a[48:51]
    v_add_f32 v219, v219, v45
    v_add_f32 v220, v220, v49
    v_mfma_f32_16x16x32_bf16 a[52:55], v[172:175], v[124:127], a[52:55]
    v_add_f32 v216, v216, v34
    v_add_f32 v217, v217, v38
    v_mfma_f32_16x16x32_bf16 a[56:59], v[172:175], v[128:131], a[56:59]
    v_add_f32 v218, v218, v42
    v_add_f32 v219, v219, v46
    v_mfma_f32_16x16x32_bf16 a[60:63], v[176:179], v[112:115], a[60:63]
    v_add_f32 v220, v220, v50
    v_mfma_f32_16x16x32_bf16 a[64:67], v[176:179], v[116:119], a[64:67]
    v_add_f32 v216, v216, v35
    v_add_f32 v217, v217, v39
    v_mfma_f32_16x16x32_bf16 a[68:71], v[176:179], v[120:123], a[68:71]
    v_add_f32 v218, v218, v43
    v_add_f32 v219, v219, v47
    v_mfma_f32_16x16x32_bf16 a[72:75], v[176:179], v[124:127], a[72:75]
    v_add_f32 v220, v220, v51
    v_add_f32 v216, v216, v52
    v_mfma_f32_16x16x32_bf16 a[76:79], v[176:179], v[128:131], a[76:79]
    v_add_f32 v217, v217, v56
    v_add_f32 v218, v218, v60
    v_mfma_f32_16x16x32_bf16 a[80:83], v[180:183], v[112:115], a[80:83]
    v_add_f32 v219, v219, v64
    v_add_f32 v220, v220, v68
    v_mfma_f32_16x16x32_bf16 a[84:87], v[180:183], v[116:119], a[84:87]
    v_add_f32 v216, v216, v53
    v_mfma_f32_16x16x32_bf16 a[88:91], v[180:183], v[120:123], a[88:91]
    v_add_f32 v217, v217, v57
    v_add_f32 v218, v218, v61
    v_mfma_f32_16x16x32_bf16 a[92:95], v[180:183], v[124:127], a[92:95]
    v_add_f32 v219, v219, v65
    v_add_f32 v220, v220, v69
    v_mfma_f32_16x16x32_bf16 a[96:99], v[180:183], v[128:131], a[96:99]
    v_add_f32 v216, v216, v54
    v_add_f32 v217, v217, v58
    v_mfma_f32_16x16x32_bf16 a[100:103], v[184:187], v[112:115], a[100:103]
    v_add_f32 v218, v218, v62
    v_add_f32 v219, v219, v66
    v_mfma_f32_16x16x32_bf16 a[104:107], v[184:187], v[116:119], a[104:107]
    v_add_f32 v220, v220, v70
    v_add_f32 v216, v216, v55
    v_mfma_f32_16x16x32_bf16 a[108:111], v[184:187], v[120:123], a[108:111]
    v_add_f32 v217, v217, v59
    v_mfma_f32_16x16x32_bf16 a[112:115], v[184:187], v[124:127], a[112:115]
    v_add_f32 v218, v218, v63
    v_add_f32 v219, v219, v67
    v_mfma_f32_16x16x32_bf16 a[116:119], v[184:187], v[128:131], a[116:119]
    v_add_f32 v220, v220, v71
    v_max3_f32 v226, v72, v73, v74
    v_mfma_f32_16x16x32_bf16 a[120:123], v[188:191], v[112:115], a[120:123]
    v_max3_f32 v226, v226, v75, v76
    v_max3_f32 v226, v226, v77, v78
    v_mfma_f32_16x16x32_bf16 a[124:127], v[188:191], v[116:119], a[124:127]
    v_max3_f32 v226, v226, v79, v80
    v_max3_f32 v226, v226, v81, v82
    v_mfma_f32_16x16x32_bf16 a[128:131], v[188:191], v[120:123], a[128:131]
    v_max3_f32 v226, v226, v83, v84
    v_max3_f32 v226, v226, v85, v86
    v_mfma_f32_16x16x32_bf16 a[132:135], v[188:191], v[124:127], a[132:135]
    v_max3_f32 v226, v226, v87, v88
    v_mfma_f32_16x16x32_bf16 a[136:139], v[188:191], v[128:131], a[136:139]
    v_max3_f32 v226, v226, v89, v90
    v_max3_f32 v226, v226, v91, v92
    v_mfma_f32_16x16x32_bf16 a[140:143], v[192:195], v[112:115], a[140:143]
    v_max3_f32 v226, v226, v93, v94
    v_max3_f32 v226, v226, v95, v96
    v_mfma_f32_16x16x32_bf16 a[144:147], v[192:195], v[116:119], a[144:147]
    v_max3_f32 v226, v226, v97, v98
    v_max3_f32 v226, v226, v99, v100
    v_mfma_f32_16x16x32_bf16 a[148:151], v[192:195], v[120:123], a[148:151]
    v_max3_f32 v226, v226, v101, v102
    v_max3_f32 v226, v226, v103, v104
    v_mfma_f32_16x16x32_bf16 a[152:155], v[192:195], v[124:127], a[152:155]
    v_max3_f32 v226, v226, v105, v106
    v_max3_f32 v226, v226, v107, v108
    v_mfma_f32_16x16x32_bf16 a[156:159], v[192:195], v[128:131], a[156:159]
    v_max3_f32 v226, v226, v109, v110
    v_max_f32 v226, v226, v111
    s_nop 0
    v_cmp_lt_f32 vcc, s50, v226
    s_nop 1
    s_cbranch_vccnz k1_kernel_L17
k1_kernel_L18:
    s_waitcnt vmcnt(16)
    s_barrier
    s_cmp_eq_u32 s40, 0
    s_cselect_b32 s44, 12, 10
    s_lshl_b32 s45, s44, 13
    s_add_u32 s45, s45, s42
    s_and_b32 s46, s44, 3
    s_lshl_b32 s46, s46, 14
    s_add_u32 s46, s46, s43
    s_add_u32 s47, s46, 0
    s_mov_b32 m0, s47
    s_add_u32 s48, s45, 0
    buffer_load_dwordx4 v4, s[32:35], s48 offen lds
    s_add_u32 s47, s46, 1024
    s_mov_b32 m0, s47
    s_add_u32 s48, s45, 1024
    buffer_load_dwordx4 v5, s[32:35], s48 offen lds
    s_add_u32 s47, s46, 2048
    s_mov_b32 m0, s47
    s_add_u32 s48, s45, 2048
    buffer_load_dwordx4 v6, s[32:35], s48 offen lds
    s_add_u32 s47, s46, 3072
    s_mov_b32 m0, s47
    s_add_u32 s48, s45, 3072
    buffer_load_dwordx4 v7, s[32:35], s48 offen lds
    s_add_u32 s47, s46, 4096
    s_mov_b32 m0, s47
    s_add_u32 s48, s45, 4096
    buffer_load_dwordx4 v4, s[32:35], s48 offen lds
    s_add_u32 s47, s46, 5120
    s_mov_b32 m0, s47
    s_add_u32 s48, s45, 5120
    buffer_load_dwordx4 v5, s[32:35], s48 offen lds
    s_add_u32 s47, s46, 6144
    s_mov_b32 m0, s47
    s_add_u32 s48, s45, 6144
    buffer_load_dwordx4 v6, s[32:35], s48 offen lds
    s_add_u32 s47, s46, 7168
    s_mov_b32 m0, s47
    s_add_u32 s48, s45, 7168
    buffer_load_dwordx4 v7, s[32:35], s48 offen lds
    s_waitcnt lgkmcnt(0)
    v_mfma_f32_16x16x32_bf16 v[32:35], v[132:135], a[160:163], v[196:199]
    ds_read_b64_tr_b16 v[164:165], v12 offset:49152
    v_mfma_f32_16x16x32_bf16 v[36:39], v[132:135], a[176:179], v[200:203]
    ds_read_b64_tr_b16 v[166:167], v12 offset:53248
    ds_read_b64_tr_b16 v[168:169], v13 offset:49152
    v_mfma_f32_16x16x32_bf16 v[40:43], v[132:135], a[192:195], v[204:207]
    ds_read_b64_tr_b16 v[170:171], v13 offset:53248
    ds_read_b64_tr_b16 v[172:173], v14 offset:49152
    v_mfma_f32_16x16x32_bf16 v[44:47], v[132:135], a[208:211], v[208:211]
    ds_read_b64_tr_b16 v[174:175], v14 offset:53248
    ds_read_b64_tr_b16 v[176:177], v15 offset:49152
    v_mfma_f32_16x16x32_bf16 v[48:51], v[132:135], a[224:227], v[212:215]
    ds_read_b64_tr_b16 v[178:179], v15 offset:53248
    ds_read_b64_tr_b16 v[180:181], v16 offset:49152
    v_mfma_f32_16x16x32_bf16 v[52:55], v[148:151], a[160:163], v[196:199]
    ds_read_b64_tr_b16 v[182:183], v16 offset:53248
    ds_read_b64_tr_b16 v[184:185], v17 offset:49152
    v_mfma_f32_16x16x32_bf16 v[56:59], v[148:151], a[176:179], v[200:203]
    ds_read_b64_tr_b16 v[186:187], v17 offset:53248
    ds_read_b64_tr_b16 v[188:189], v18 offset:49152
    v_mfma_f32_16x16x32_bf16 v[60:63], v[148:151], a[192:195], v[204:207]
    ds_read_b64_tr_b16 v[190:191], v18 offset:53248
    ds_read_b64_tr_b16 v[192:193], v19 offset:49152
    v_mfma_f32_16x16x32_bf16 v[64:67], v[148:151], a[208:211], v[208:211]
    ds_read_b64_tr_b16 v[194:195], v19 offset:53248
    v_exp_f32 v72, v72
    v_mfma_f32_16x16x32_bf16 v[68:71], v[148:151], a[224:227], v[212:215]
    v_exp_f32 v73, v73
    v_exp_f32 v74, v74
    v_mfma_f32_16x16x32_bf16 v[32:35], v[136:139], a[164:167], v[32:35]
    v_exp_f32 v75, v75
    v_mfma_f32_16x16x32_bf16 v[36:39], v[136:139], a[180:183], v[36:39]
    v_cvt_pk_bf16_f32 v112, v72, v73
    v_cvt_pk_bf16_f32 v113, v74, v75
    v_mfma_f32_16x16x32_bf16 v[40:43], v[136:139], a[196:199], v[40:43]
    v_exp_f32 v92, v92
    v_exp_f32 v93, v93
    v_mfma_f32_16x16x32_bf16 v[44:47], v[136:139], a[212:215], v[44:47]
    v_exp_f32 v94, v94
    v_exp_f32 v95, v95
    v_mfma_f32_16x16x32_bf16 v[48:51], v[136:139], a[228:231], v[48:51]
    v_cvt_pk_bf16_f32 v114, v92, v93
    v_cvt_pk_bf16_f32 v115, v94, v95
    v_mfma_f32_16x16x32_bf16 v[52:55], v[152:155], a[164:167], v[52:55]
    v_exp_f32 v76, v76
    v_exp_f32 v77, v77
    v_mfma_f32_16x16x32_bf16 v[56:59], v[152:155], a[180:183], v[56:59]
    v_exp_f32 v78, v78
    v_exp_f32 v79, v79
    v_mfma_f32_16x16x32_bf16 v[60:63], v[152:155], a[196:199], v[60:63]
    v_cvt_pk_bf16_f32 v116, v76, v77
    v_cvt_pk_bf16_f32 v117, v78, v79
    v_mfma_f32_16x16x32_bf16 v[64:67], v[152:155], a[212:215], v[64:67]
    v_exp_f32 v96, v96
    v_exp_f32 v97, v97
    v_mfma_f32_16x16x32_bf16 v[68:71], v[152:155], a[228:231], v[68:71]
    v_exp_f32 v98, v98
    v_exp_f32 v99, v99
    v_mfma_f32_16x16x32_bf16 v[32:35], v[140:143], a[168:171], v[32:35]
    v_cvt_pk_bf16_f32 v118, v96, v97
    v_mfma_f32_16x16x32_bf16 v[36:39], v[140:143], a[184:187], v[36:39]
    v_cvt_pk_bf16_f32 v119, v98, v99
    v_exp_f32 v80, v80
    v_mfma_f32_16x16x32_bf16 v[40:43], v[140:143], a[200:203], v[40:43]
    v_exp_f32 v81, v81
    v_exp_f32 v82, v82
    v_mfma_f32_16x16x32_bf16 v[44:47], v[140:143], a[216:219], v[44:47]
    v_exp_f32 v83, v83
    v_cvt_pk_bf16_f32 v120, v80, v81
    v_mfma_f32_16x16x32_bf16 v[48:51], v[140:143], a[232:235], v[48:51]
    v_cvt_pk_bf16_f32 v121, v82, v83
    v_exp_f32 v100, v100
    v_mfma_f32_16x16x32_bf16 v[52:55], v[156:159], a[168:171], v[52:55]
    v_exp_f32 v101, v101
    v_exp_f32 v102, v102
    v_mfma_f32_16x16x32_bf16 v[56:59], v[156:159], a[184:187], v[56:59]
    v_exp_f32 v103, v103
    v_cvt_pk_bf16_f32 v122, v100, v101
    v_mfma_f32_16x16x32_bf16 v[60:63], v[156:159], a[200:203], v[60:63]
    v_cvt_pk_bf16_f32 v123, v102, v103
    v_exp_f32 v84, v84
    v_mfma_f32_16x16x32_bf16 v[64:67], v[156:159], a[216:219], v[64:67]
    v_exp_f32 v85, v85
    v_exp_f32 v86, v86
    v_mfma_f32_16x16x32_bf16 v[68:71], v[156:159], a[232:235], v[68:71]
    v_exp_f32 v87, v87
    v_cvt_pk_bf16_f32 v124, v84, v85
    v_mfma_f32_16x16x32_bf16 v[32:35], v[144:147], a[172:175], v[32:35]
    v_cvt_pk_bf16_f32 v125, v86, v87
    v_mfma_f32_16x16x32_bf16 v[36:39], v[144:147], a[188:191], v[36:39]
    v_exp_f32 v104, v104
    v_exp_f32 v105, v105
    v_mfma_f32_16x16x32_bf16 v[40:43], v[144:147], a[204:207], v[40:43]
    v_exp_f32 v106, v106
    v_exp_f32 v107, v107
    v_mfma_f32_16x16x32_bf16 v[44:47], v[144:147], a[220:223], v[44:47]
    v_cvt_pk_bf16_f32 v126, v104, v105
    v_cvt_pk_bf16_f32 v127, v106, v107
    v_mfma_f32_16x16x32_bf16 v[48:51], v[144:147], a[236:239], v[48:51]
    v_exp_f32 v88, v88
    v_exp_f32 v89, v89
    v_mfma_f32_16x16x32_bf16 v[52:55], v[160:163], a[172:175], v[52:55]
    v_exp_f32 v90, v90
    v_exp_f32 v91, v91
    v_mfma_f32_16x16x32_bf16 v[56:59], v[160:163], a[188:191], v[56:59]
    v_cvt_pk_bf16_f32 v128, v88, v89
    v_cvt_pk_bf16_f32 v129, v90, v91
    v_mfma_f32_16x16x32_bf16 v[60:63], v[160:163], a[204:207], v[60:63]
    v_exp_f32 v108, v108
    v_exp_f32 v109, v109
    v_mfma_f32_16x16x32_bf16 v[64:67], v[160:163], a[220:223], v[64:67]
    v_exp_f32 v110, v110
    v_exp_f32 v111, v111
    v_mfma_f32_16x16x32_bf16 v[68:71], v[160:163], a[236:239], v[68:71]
    v_cvt_pk_bf16_f32 v130, v108, v109
    v_cvt_pk_bf16_f32 v131, v110, v111
    s_waitcnt lgkmcnt(0)
    s_nop 1
    v_mfma_f32_16x16x32_bf16 a[0:3], v[164:167], v[112:115], a[0:3]
    v_mfma_f32_16x16x32_bf16 a[4:7], v[164:167], v[116:119], a[4:7]
    v_mfma_f32_16x16x32_bf16 a[8:11], v[164:167], v[120:123], a[8:11]
    v_mfma_f32_16x16x32_bf16 a[12:15], v[164:167], v[124:127], a[12:15]
    ds_read_b128 v[132:135], v8 offset:16384
    v_mfma_f32_16x16x32_bf16 a[16:19], v[164:167], v[128:131], a[16:19]
    ds_read_b128 v[136:139], v9 offset:16384
    ds_read_b128 v[140:143], v10 offset:16384
    v_mfma_f32_16x16x32_bf16 a[20:23], v[168:171], v[112:115], a[20:23]
    ds_read_b128 v[144:147], v11 offset:16384
    ds_read_b128 v[148:151], v8 offset:20480
    v_mfma_f32_16x16x32_bf16 a[24:27], v[168:171], v[116:119], a[24:27]
    ds_read_b128 v[152:155], v9 offset:20480
    ds_read_b128 v[156:159], v10 offset:20480
    v_mfma_f32_16x16x32_bf16 a[28:31], v[168:171], v[120:123], a[28:31]
    ds_read_b128 v[160:163], v11 offset:20480
    v_add_f32 v216, v216, v72
    v_mfma_f32_16x16x32_bf16 a[32:35], v[168:171], v[124:127], a[32:35]
    v_add_f32 v217, v217, v76
    v_add_f32 v218, v218, v80
    v_mfma_f32_16x16x32_bf16 a[36:39], v[168:171], v[128:131], a[36:39]
    v_add_f32 v219, v219, v84
    v_mfma_f32_16x16x32_bf16 a[40:43], v[172:175], v[112:115], a[40:43]
    v_add_f32 v220, v220, v88
    v_add_f32 v216, v216, v73
    v_mfma_f32_16x16x32_bf16 a[44:47], v[172:175], v[116:119], a[44:47]
    v_add_f32 v217, v217, v77
    v_add_f32 v218, v218, v81
    v_mfma_f32_16x16x32_bf16 a[48:51], v[172:175], v[120:123], a[48:51]
    v_add_f32 v219, v219, v85
    v_add_f32 v220, v220, v89
    v_mfma_f32_16x16x32_bf16 a[52:55], v[172:175], v[124:127], a[52:55]
    v_add_f32 v216, v216, v74
    v_add_f32 v217, v217, v78
    v_mfma_f32_16x16x32_bf16 a[56:59], v[172:175], v[128:131], a[56:59]
    v_add_f32 v218, v218, v82
    v_add_f32 v219, v219, v86
    v_mfma_f32_16x16x32_bf16 a[60:63], v[176:179], v[112:115], a[60:63]
    v_add_f32 v220, v220, v90
    v_mfma_f32_16x16x32_bf16 a[64:67], v[176:179], v[116:119], a[64:67]
    v_add_f32 v216, v216, v75
    v_add_f32 v217, v217, v79
    v_mfma_f32_16x16x32_bf16 a[68:71], v[176:179], v[120:123], a[68:71]
    v_add_f32 v218, v218, v83
    v_add_f32 v219, v219, v87
    v_mfma_f32_16x16x32_bf16 a[72:75], v[176:179], v[124:127], a[72:75]
    v_add_f32 v220, v220, v91
    v_add_f32 v216, v216, v92
    v_mfma_f32_16x16x32_bf16 a[76:79], v[176:179], v[128:131], a[76:79]
    v_add_f32 v217, v217, v96
    v_add_f32 v218, v218, v100
    v_mfma_f32_16x16x32_bf16 a[80:83], v[180:183], v[112:115], a[80:83]
    v_add_f32 v219, v219, v104
    v_add_f32 v220, v220, v108
    v_mfma_f32_16x16x32_bf16 a[84:87], v[180:183], v[116:119], a[84:87]
    v_add_f32 v216, v216, v93
    v_mfma_f32_16x16x32_bf16 a[88:91], v[180:183], v[120:123], a[88:91]
    v_add_f32 v217, v217, v97
    v_add_f32 v218, v218, v101
    v_mfma_f32_16x16x32_bf16 a[92:95], v[180:183], v[124:127], a[92:95]
    v_add_f32 v219, v219, v105
    v_add_f32 v220, v220, v109
    v_mfma_f32_16x16x32_bf16 a[96:99], v[180:183], v[128:131], a[96:99]
    v_add_f32 v216, v216, v94
    v_add_f32 v217, v217, v98
    v_mfma_f32_16x16x32_bf16 a[100:103], v[184:187], v[112:115], a[100:103]
    v_add_f32 v218, v218, v102
    v_add_f32 v219, v219, v106
    v_mfma_f32_16x16x32_bf16 a[104:107], v[184:187], v[116:119], a[104:107]
    v_add_f32 v220, v220, v110
    v_add_f32 v216, v216, v95
    v_mfma_f32_16x16x32_bf16 a[108:111], v[184:187], v[120:123], a[108:111]
    v_add_f32 v217, v217, v99
    v_mfma_f32_16x16x32_bf16 a[112:115], v[184:187], v[124:127], a[112:115]
    v_add_f32 v218, v218, v103
    v_add_f32 v219, v219, v107
    v_mfma_f32_16x16x32_bf16 a[116:119], v[184:187], v[128:131], a[116:119]
    v_add_f32 v220, v220, v111
    v_max3_f32 v226, v32, v33, v34
    v_mfma_f32_16x16x32_bf16 a[120:123], v[188:191], v[112:115], a[120:123]
    v_max3_f32 v226, v226, v35, v36
    v_max3_f32 v226, v226, v37, v38
    v_mfma_f32_16x16x32_bf16 a[124:127], v[188:191], v[116:119], a[124:127]
    v_max3_f32 v226, v226, v39, v40
    v_max3_f32 v226, v226, v41, v42
    v_mfma_f32_16x16x32_bf16 a[128:131], v[188:191], v[120:123], a[128:131]
    v_max3_f32 v226, v226, v43, v44
    v_max3_f32 v226, v226, v45, v46
    v_mfma_f32_16x16x32_bf16 a[132:135], v[188:191], v[124:127], a[132:135]
    v_max3_f32 v226, v226, v47, v48
    v_mfma_f32_16x16x32_bf16 a[136:139], v[188:191], v[128:131], a[136:139]
    v_max3_f32 v226, v226, v49, v50
    v_max3_f32 v226, v226, v51, v52
    v_mfma_f32_16x16x32_bf16 a[140:143], v[192:195], v[112:115], a[140:143]
    v_max3_f32 v226, v226, v53, v54
    v_max3_f32 v226, v226, v55, v56
    v_mfma_f32_16x16x32_bf16 a[144:147], v[192:195], v[116:119], a[144:147]
    v_max3_f32 v226, v226, v57, v58
    v_max3_f32 v226, v226, v59, v60
    v_mfma_f32_16x16x32_bf16 a[148:151], v[192:195], v[120:123], a[148:151]
    v_max3_f32 v226, v226, v61, v62
    v_max3_f32 v226, v226, v63, v64
    v_mfma_f32_16x16x32_bf16 a[152:155], v[192:195], v[124:127], a[152:155]
    v_max3_f32 v226, v226, v65, v66
    v_max3_f32 v226, v226, v67, v68
    v_mfma_f32_16x16x32_bf16 a[156:159], v[192:195], v[128:131], a[156:159]
    v_max3_f32 v226, v226, v69, v70
    v_max_f32 v226, v226, v71
    s_nop 0
    v_cmp_lt_f32 vcc, s50, v226
    s_nop 1
    s_cbranch_vccnz k1_kernel_L19
k1_kernel_L20:
    s_waitcnt vmcnt(16)
    s_barrier
    s_cmp_eq_u32 s40, 0
    s_cselect_b32 s44, 13, 11
    s_lshl_b32 s45, s44, 13
    s_add_u32 s45, s45, s42
    s_and_b32 s46, s44, 3
    s_lshl_b32 s46, s46, 14
    s_add_u32 s46, s46, s43
    s_add_u32 s47, s46, 0
    s_mov_b32 m0, s47
    s_add_u32 s48, s45, 0
    buffer_load_dwordx4 v4, s[32:35], s48 offen lds
    s_add_u32 s47, s46, 1024
    s_mov_b32 m0, s47
    s_add_u32 s48, s45, 1024
    buffer_load_dwordx4 v5, s[32:35], s48 offen lds
    s_add_u32 s47, s46, 2048
    s_mov_b32 m0, s47
    s_add_u32 s48, s45, 2048
    buffer_load_dwordx4 v6, s[32:35], s48 offen lds
    s_add_u32 s47, s46, 3072
    s_mov_b32 m0, s47
    s_add_u32 s48, s45, 3072
    buffer_load_dwordx4 v7, s[32:35], s48 offen lds
    s_add_u32 s47, s46, 4096
    s_mov_b32 m0, s47
    s_add_u32 s48, s45, 4096
    buffer_load_dwordx4 v4, s[32:35], s48 offen lds
    s_add_u32 s47, s46, 5120
    s_mov_b32 m0, s47
    s_add_u32 s48, s45, 5120
    buffer_load_dwordx4 v5, s[32:35], s48 offen lds
    s_add_u32 s47, s46, 6144
    s_mov_b32 m0, s47
    s_add_u32 s48, s45, 6144
    buffer_load_dwordx4 v6, s[32:35], s48 offen lds
    s_add_u32 s47, s46, 7168
    s_mov_b32 m0, s47
    s_add_u32 s48, s45, 7168
    buffer_load_dwordx4 v7, s[32:35], s48 offen lds
    s_waitcnt lgkmcnt(0)
    v_mfma_f32_16x16x32_bf16 v[72:75], v[132:135], a[160:163], v[196:199]
    ds_read_b64_tr_b16 v[164:165], v12 offset:0
    v_mfma_f32_16x16x32_bf16 v[76:79], v[132:135], a[176:179], v[200:203]
    ds_read_b64_tr_b16 v[166:167], v12 offset:4096
    ds_read_b64_tr_b16 v[168:169], v13 offset:0
    v_mfma_f32_16x16x32_bf16 v[80:83], v[132:135], a[192:195], v[204:207]
    ds_read_b64_tr_b16 v[170:171], v13 offset:4096
    ds_read_b64_tr_b16 v[172:173], v14 offset:0
    v_mfma_f32_16x16x32_bf16 v[84:87], v[132:135], a[208:211], v[208:211]
    ds_read_b64_tr_b16 v[174:175], v14 offset:4096
    ds_read_b64_tr_b16 v[176:177], v15 offset:0
    v_mfma_f32_16x16x32_bf16 v[88:91], v[132:135], a[224:227], v[212:215]
    ds_read_b64_tr_b16 v[178:179], v15 offset:4096
    ds_read_b64_tr_b16 v[180:181], v16 offset:0
    v_mfma_f32_16x16x32_bf16 v[92:95], v[148:151], a[160:163], v[196:199]
    ds_read_b64_tr_b16 v[182:183], v16 offset:4096
    ds_read_b64_tr_b16 v[184:185], v17 offset:0
    v_mfma_f32_16x16x32_bf16 v[96:99], v[148:151], a[176:179], v[200:203]
    ds_read_b64_tr_b16 v[186:187], v17 offset:4096
    ds_read_b64_tr_b16 v[188:189], v18 offset:0
    v_mfma_f32_16x16x32_bf16 v[100:103], v[148:151], a[192:195], v[204:207]
    ds_read_b64_tr_b16 v[190:191], v18 offset:4096
    ds_read_b64_tr_b16 v[192:193], v19 offset:0
    v_mfma_f32_16x16x32_bf16 v[104:107], v[148:151], a[208:211], v[208:211]
    ds_read_b64_tr_b16 v[194:195], v19 offset:4096
    v_exp_f32 v32, v32
    v_mfma_f32_16x16x32_bf16 v[108:111], v[148:151], a[224:227], v[212:215]
    v_exp_f32 v33, v33
    v_exp_f32 v34, v34
    v_mfma_f32_16x16x32_bf16 v[72:75], v[136:139], a[164:167], v[72:75]
    v_exp_f32 v35, v35
    v_mfma_f32_16x16x32_bf16 v[76:79], v[136:139], a[180:183], v[76:79]
    v_cvt_pk_bf16_f32 v112, v32, v33
    v_cvt_pk_bf16_f32 v113, v34, v35
    v_mfma_f32_16x16x32_bf16 v[80:83], v[136:139], a[196:199], v[80:83]
    v_exp_f32 v52, v52
    v_exp_f32 v53, v53
    v_mfma_f32_16x16x32_bf16 v[84:87], v[136:139], a[212:215], v[84:87]
    v_exp_f32 v54, v54
    v_exp_f32 v55, v55
    v_mfma_f32_16x16x32_bf16 v[88:91], v[136:139], a[228:231], v[88:91]
    v_cvt_pk_bf16_f32 v114, v52, v53
    v_cvt_pk_bf16_f32 v115, v54, v55
    v_mfma_f32_16x16x32_bf16 v[92:95], v[152:155], a[164:167], v[92:95]
    v_exp_f32 v36, v36
    v_exp_f32 v37, v37
    v_mfma_f32_16x16x32_bf16 v[96:99], v[152:155], a[180:183], v[96:99]
    v_exp_f32 v38, v38
    v_exp_f32 v39, v39
    v_mfma_f32_16x16x32_bf16 v[100:103], v[152:155], a[196:199], v[100:103]
    v_cvt_pk_bf16_f32 v116, v36, v37
    v_cvt_pk_bf16_f32 v117, v38, v39
    v_mfma_f32_16x16x32_bf16 v[104:107], v[152:155], a[212:215], v[104:107]
    v_exp_f32 v56, v56
    v_exp_f32 v57, v57
    v_mfma_f32_16x16x32_bf16 v[108:111], v[152:155], a[228:231], v[108:111]
    v_exp_f32 v58, v58
    v_exp_f32 v59, v59
    v_mfma_f32_16x16x32_bf16 v[72:75], v[140:143], a[168:171], v[72:75]
    v_cvt_pk_bf16_f32 v118, v56, v57
    v_mfma_f32_16x16x32_bf16 v[76:79], v[140:143], a[184:187], v[76:79]
    v_cvt_pk_bf16_f32 v119, v58, v59
    v_exp_f32 v40, v40
    v_mfma_f32_16x16x32_bf16 v[80:83], v[140:143], a[200:203], v[80:83]
    v_exp_f32 v41, v41
    v_exp_f32 v42, v42
    v_mfma_f32_16x16x32_bf16 v[84:87], v[140:143], a[216:219], v[84:87]
    v_exp_f32 v43, v43
    v_cvt_pk_bf16_f32 v120, v40, v41
    v_mfma_f32_16x16x32_bf16 v[88:91], v[140:143], a[232:235], v[88:91]
    v_cvt_pk_bf16_f32 v121, v42, v43
    v_exp_f32 v60, v60
    v_mfma_f32_16x16x32_bf16 v[92:95], v[156:159], a[168:171], v[92:95]
    v_exp_f32 v61, v61
    v_exp_f32 v62, v62
    v_mfma_f32_16x16x32_bf16 v[96:99], v[156:159], a[184:187], v[96:99]
    v_exp_f32 v63, v63
    v_cvt_pk_bf16_f32 v122, v60, v61
    v_mfma_f32_16x16x32_bf16 v[100:103], v[156:159], a[200:203], v[100:103]
    v_cvt_pk_bf16_f32 v123, v62, v63
    v_exp_f32 v44, v44
    v_mfma_f32_16x16x32_bf16 v[104:107], v[156:159], a[216:219], v[104:107]
    v_exp_f32 v45, v45
    v_exp_f32 v46, v46
    v_mfma_f32_16x16x32_bf16 v[108:111], v[156:159], a[232:235], v[108:111]
    v_exp_f32 v47, v47
    v_cvt_pk_bf16_f32 v124, v44, v45
    v_mfma_f32_16x16x32_bf16 v[72:75], v[144:147], a[172:175], v[72:75]
    v_cvt_pk_bf16_f32 v125, v46, v47
    v_mfma_f32_16x16x32_bf16 v[76:79], v[144:147], a[188:191], v[76:79]
    v_exp_f32 v64, v64
    v_exp_f32 v65, v65
    v_mfma_f32_16x16x32_bf16 v[80:83], v[144:147], a[204:207], v[80:83]
    v_exp_f32 v66, v66
    v_exp_f32 v67, v67
    v_mfma_f32_16x16x32_bf16 v[84:87], v[144:147], a[220:223], v[84:87]
    v_cvt_pk_bf16_f32 v126, v64, v65
    v_cvt_pk_bf16_f32 v127, v66, v67
    v_mfma_f32_16x16x32_bf16 v[88:91], v[144:147], a[236:239], v[88:91]
    v_exp_f32 v48, v48
    v_exp_f32 v49, v49
    v_mfma_f32_16x16x32_bf16 v[92:95], v[160:163], a[172:175], v[92:95]
    v_exp_f32 v50, v50
    v_exp_f32 v51, v51
    v_mfma_f32_16x16x32_bf16 v[96:99], v[160:163], a[188:191], v[96:99]
    v_cvt_pk_bf16_f32 v128, v48, v49
    v_cvt_pk_bf16_f32 v129, v50, v51
    v_mfma_f32_16x16x32_bf16 v[100:103], v[160:163], a[204:207], v[100:103]
    v_exp_f32 v68, v68
    v_exp_f32 v69, v69
    v_mfma_f32_16x16x32_bf16 v[104:107], v[160:163], a[220:223], v[104:107]
    v_exp_f32 v70, v70
    v_exp_f32 v71, v71
    v_mfma_f32_16x16x32_bf16 v[108:111], v[160:163], a[236:239], v[108:111]
    v_cvt_pk_bf16_f32 v130, v68, v69
    v_cvt_pk_bf16_f32 v131, v70, v71
    s_waitcnt lgkmcnt(0)
    s_nop 1
    v_mfma_f32_16x16x32_bf16 a[0:3], v[164:167], v[112:115], a[0:3]
    v_mfma_f32_16x16x32_bf16 a[4:7], v[164:167], v[116:119], a[4:7]
    v_mfma_f32_16x16x32_bf16 a[8:11], v[164:167], v[120:123], a[8:11]
    v_mfma_f32_16x16x32_bf16 a[12:15], v[164:167], v[124:127], a[12:15]
    ds_read_b128 v[132:135], v8 offset:32768
    v_mfma_f32_16x16x32_bf16 a[16:19], v[164:167], v[128:131], a[16:19]
    ds_read_b128 v[136:139], v9 offset:32768
    ds_read_b128 v[140:143], v10 offset:32768
    v_mfma_f32_16x16x32_bf16 a[20:23], v[168:171], v[112:115], a[20:23]
    ds_read_b128 v[144:147], v11 offset:32768
    ds_read_b128 v[148:151], v8 offset:36864
    v_mfma_f32_16x16x32_bf16 a[24:27], v[168:171], v[116:119], a[24:27]
    ds_read_b128 v[152:155], v9 offset:36864
    ds_read_b128 v[156:159], v10 offset:36864
    v_mfma_f32_16x16x32_bf16 a[28:31], v[168:171], v[120:123], a[28:31]
    ds_read_b128 v[160:163], v11 offset:36864
    v_add_f32 v216, v216, v32
    v_mfma_f32_16x16x32_bf16 a[32:35], v[168:171], v[124:127], a[32:35]
    v_add_f32 v217, v217, v36
    v_add_f32 v218, v218, v40
    v_mfma_f32_16x16x32_bf16 a[36:39], v[168:171], v[128:131], a[36:39]
    v_add_f32 v219, v219, v44
    v_mfma_f32_16x16x32_bf16 a[40:43], v[172:175], v[112:115], a[40:43]
    v_add_f32 v220, v220, v48
    v_add_f32 v216, v216, v33
    v_mfma_f32_16x16x32_bf16 a[44:47], v[172:175], v[116:119], a[44:47]
    v_add_f32 v217, v217, v37
    v_add_f32 v218, v218, v41
    v_mfma_f32_16x16x32_bf16 a[48:51], v[172:175], v[120:123], a[48:51]
    v_add_f32 v219, v219, v45
    v_add_f32 v220, v220, v49
    v_mfma_f32_16x16x32_bf16 a[52:55], v[172:175], v[124:127], a[52:55]
    v_add_f32 v216, v216, v34
    v_add_f32 v217, v217, v38
    v_mfma_f32_16x16x32_bf16 a[56:59], v[172:175], v[128:131], a[56:59]
    v_add_f32 v218, v218, v42
    v_add_f32 v219, v219, v46
    v_mfma_f32_16x16x32_bf16 a[60:63], v[176:179], v[112:115], a[60:63]
    v_add_f32 v220, v220, v50
    v_mfma_f32_16x16x32_bf16 a[64:67], v[176:179], v[116:119], a[64:67]
    v_add_f32 v216, v216, v35
    v_add_f32 v217, v217, v39
    v_mfma_f32_16x16x32_bf16 a[68:71], v[176:179], v[120:123], a[68:71]
    v_add_f32 v218, v218, v43
    v_add_f32 v219, v219, v47
    v_mfma_f32_16x16x32_bf16 a[72:75], v[176:179], v[124:127], a[72:75]
    v_add_f32 v220, v220, v51
    v_add_f32 v216, v216, v52
    v_mfma_f32_16x16x32_bf16 a[76:79], v[176:179], v[128:131], a[76:79]
    v_add_f32 v217, v217, v56
    v_add_f32 v218, v218, v60
    v_mfma_f32_16x16x32_bf16 a[80:83], v[180:183], v[112:115], a[80:83]
    v_add_f32 v219, v219, v64
    v_add_f32 v220, v220, v68
    v_mfma_f32_16x16x32_bf16 a[84:87], v[180:183], v[116:119], a[84:87]
    v_add_f32 v216, v216, v53
    v_mfma_f32_16x16x32_bf16 a[88:91], v[180:183], v[120:123], a[88:91]
    v_add_f32 v217, v217, v57
    v_add_f32 v218, v218, v61
    v_mfma_f32_16x16x32_bf16 a[92:95], v[180:183], v[124:127], a[92:95]
    v_add_f32 v219, v219, v65
    v_add_f32 v220, v220, v69
    v_mfma_f32_16x16x32_bf16 a[96:99], v[180:183], v[128:131], a[96:99]
    v_add_f32 v216, v216, v54
    v_add_f32 v217, v217, v58
    v_mfma_f32_16x16x32_bf16 a[100:103], v[184:187], v[112:115], a[100:103]
    v_add_f32 v218, v218, v62
    v_add_f32 v219, v219, v66
    v_mfma_f32_16x16x32_bf16 a[104:107], v[184:187], v[116:119], a[104:107]
    v_add_f32 v220, v220, v70
    v_add_f32 v216, v216, v55
    v_mfma_f32_16x16x32_bf16 a[108:111], v[184:187], v[120:123], a[108:111]
    v_add_f32 v217, v217, v59
    v_mfma_f32_16x16x32_bf16 a[112:115], v[184:187], v[124:127], a[112:115]
    v_add_f32 v218, v218, v63
    v_add_f32 v219, v219, v67
    v_mfma_f32_16x16x32_bf16 a[116:119], v[184:187], v[128:131], a[116:119]
    v_add_f32 v220, v220, v71
    v_max3_f32 v226, v72, v73, v74
    v_mfma_f32_16x16x32_bf16 a[120:123], v[188:191], v[112:115], a[120:123]
    v_max3_f32 v226, v226, v75, v76
    v_max3_f32 v226, v226, v77, v78
    v_mfma_f32_16x16x32_bf16 a[124:127], v[188:191], v[116:119], a[124:127]
    v_max3_f32 v226, v226, v79, v80
    v_max3_f32 v226, v226, v81, v82
    v_mfma_f32_16x16x32_bf16 a[128:131], v[188:191], v[120:123], a[128:131]
    v_max3_f32 v226, v226, v83, v84
    v_max3_f32 v226, v226, v85, v86
    v_mfma_f32_16x16x32_bf16 a[132:135], v[188:191], v[124:127], a[132:135]
    v_max3_f32 v226, v226, v87, v88
    v_mfma_f32_16x16x32_bf16 a[136:139], v[188:191], v[128:131], a[136:139]
    v_max3_f32 v226, v226, v89, v90
    v_max3_f32 v226, v226, v91, v92
    v_mfma_f32_16x16x32_bf16 a[140:143], v[192:195], v[112:115], a[140:143]
    v_max3_f32 v226, v226, v93, v94
    v_max3_f32 v226, v226, v95, v96
    v_mfma_f32_16x16x32_bf16 a[144:147], v[192:195], v[116:119], a[144:147]
    v_max3_f32 v226, v226, v97, v98
    v_max3_f32 v226, v226, v99, v100
    v_mfma_f32_16x16x32_bf16 a[148:151], v[192:195], v[120:123], a[148:151]
    v_max3_f32 v226, v226, v101, v102
    v_max3_f32 v226, v226, v103, v104
    v_mfma_f32_16x16x32_bf16 a[152:155], v[192:195], v[124:127], a[152:155]
    v_max3_f32 v226, v226, v105, v106
    v_max3_f32 v226, v226, v107, v108
    v_mfma_f32_16x16x32_bf16 a[156:159], v[192:195], v[128:131], a[156:159]
    v_max3_f32 v226, v226, v109, v110
    v_max_f32 v226, v226, v111
    s_nop 0
    v_cmp_lt_f32 vcc, s50, v226
    s_nop 1
    s_cbranch_vccnz k1_kernel_L21
k1_kernel_L22:
    s_waitcnt vmcnt(16)
    s_barrier
    s_cmp_eq_u32 s40, 0
    s_cselect_b32 s44, 14, 12
    s_lshl_b32 s45, s44, 13
    s_add_u32 s45, s45, s42
    s_and_b32 s46, s44, 3
    s_lshl_b32 s46, s46, 14
    s_add_u32 s46, s46, s43
    s_add_u32 s47, s46, 0
    s_mov_b32 m0, s47
    s_add_u32 s48, s45, 0
    buffer_load_dwordx4 v4, s[32:35], s48 offen lds
    s_add_u32 s47, s46, 1024
    s_mov_b32 m0, s47
    s_add_u32 s48, s45, 1024
    buffer_load_dwordx4 v5, s[32:35], s48 offen lds
    s_add_u32 s47, s46, 2048
    s_mov_b32 m0, s47
    s_add_u32 s48, s45, 2048
    buffer_load_dwordx4 v6, s[32:35], s48 offen lds
    s_add_u32 s47, s46, 3072
    s_mov_b32 m0, s47
    s_add_u32 s48, s45, 3072
    buffer_load_dwordx4 v7, s[32:35], s48 offen lds
    s_add_u32 s47, s46, 4096
    s_mov_b32 m0, s47
    s_add_u32 s48, s45, 4096
    buffer_load_dwordx4 v4, s[32:35], s48 offen lds
    s_add_u32 s47, s46, 5120
    s_mov_b32 m0, s47
    s_add_u32 s48, s45, 5120
    buffer_load_dwordx4 v5, s[32:35], s48 offen lds
    s_add_u32 s47, s46, 6144
    s_mov_b32 m0, s47
    s_add_u32 s48, s45, 6144
    buffer_load_dwordx4 v6, s[32:35], s48 offen lds
    s_add_u32 s47, s46, 7168
    s_mov_b32 m0, s47
    s_add_u32 s48, s45, 7168
    buffer_load_dwordx4 v7, s[32:35], s48 offen lds
    s_waitcnt lgkmcnt(0)
    v_mfma_f32_16x16x32_bf16 v[32:35], v[132:135], a[160:163], v[196:199]
    ds_read_b64_tr_b16 v[164:165], v12 offset:16384
    v_mfma_f32_16x16x32_bf16 v[36:39], v[132:135], a[176:179], v[200:203]
    ds_read_b64_tr_b16 v[166:167], v12 offset:20480
    ds_read_b64_tr_b16 v[168:169], v13 offset:16384
    v_mfma_f32_16x16x32_bf16 v[40:43], v[132:135], a[192:195], v[204:207]
    ds_read_b64_tr_b16 v[170:171], v13 offset:20480
    ds_read_b64_tr_b16 v[172:173], v14 offset:16384
    v_mfma_f32_16x16x32_bf16 v[44:47], v[132:135], a[208:211], v[208:211]
    ds_read_b64_tr_b16 v[174:175], v14 offset:20480
    ds_read_b64_tr_b16 v[176:177], v15 offset:16384
    v_mfma_f32_16x16x32_bf16 v[48:51], v[132:135], a[224:227], v[212:215]
    ds_read_b64_tr_b16 v[178:179], v15 offset:20480
    ds_read_b64_tr_b16 v[180:181], v16 offset:16384
    v_mfma_f32_16x16x32_bf16 v[52:55], v[148:151], a[160:163], v[196:199]
    ds_read_b64_tr_b16 v[182:183], v16 offset:20480
    ds_read_b64_tr_b16 v[184:185], v17 offset:16384
    v_mfma_f32_16x16x32_bf16 v[56:59], v[148:151], a[176:179], v[200:203]
    ds_read_b64_tr_b16 v[186:187], v17 offset:20480
    ds_read_b64_tr_b16 v[188:189], v18 offset:16384
    v_mfma_f32_16x16x32_bf16 v[60:63], v[148:151], a[192:195], v[204:207]
    ds_read_b64_tr_b16 v[190:191], v18 offset:20480
    ds_read_b64_tr_b16 v[192:193], v19 offset:16384
    v_mfma_f32_16x16x32_bf16 v[64:67], v[148:151], a[208:211], v[208:211]
    ds_read_b64_tr_b16 v[194:195], v19 offset:20480
    v_exp_f32 v72, v72
    v_mfma_f32_16x16x32_bf16 v[68:71], v[148:151], a[224:227], v[212:215]
    v_exp_f32 v73, v73
    v_exp_f32 v74, v74
    v_mfma_f32_16x16x32_bf16 v[32:35], v[136:139], a[164:167], v[32:35]
    v_exp_f32 v75, v75
    v_mfma_f32_16x16x32_bf16 v[36:39], v[136:139], a[180:183], v[36:39]
    v_cvt_pk_bf16_f32 v112, v72, v73
    v_cvt_pk_bf16_f32 v113, v74, v75
    v_mfma_f32_16x16x32_bf16 v[40:43], v[136:139], a[196:199], v[40:43]
    v_exp_f32 v92, v92
    v_exp_f32 v93, v93
    v_mfma_f32_16x16x32_bf16 v[44:47], v[136:139], a[212:215], v[44:47]
    v_exp_f32 v94, v94
    v_exp_f32 v95, v95
    v_mfma_f32_16x16x32_bf16 v[48:51], v[136:139], a[228:231], v[48:51]
    v_cvt_pk_bf16_f32 v114, v92, v93
    v_cvt_pk_bf16_f32 v115, v94, v95
    v_mfma_f32_16x16x32_bf16 v[52:55], v[152:155], a[164:167], v[52:55]
    v_exp_f32 v76, v76
    v_exp_f32 v77, v77
    v_mfma_f32_16x16x32_bf16 v[56:59], v[152:155], a[180:183], v[56:59]
    v_exp_f32 v78, v78
    v_exp_f32 v79, v79
    v_mfma_f32_16x16x32_bf16 v[60:63], v[152:155], a[196:199], v[60:63]
    v_cvt_pk_bf16_f32 v116, v76, v77
    v_cvt_pk_bf16_f32 v117, v78, v79
    v_mfma_f32_16x16x32_bf16 v[64:67], v[152:155], a[212:215], v[64:67]
    v_exp_f32 v96, v96
    v_exp_f32 v97, v97
    v_mfma_f32_16x16x32_bf16 v[68:71], v[152:155], a[228:231], v[68:71]
    v_exp_f32 v98, v98
    v_exp_f32 v99, v99
    v_mfma_f32_16x16x32_bf16 v[32:35], v[140:143], a[168:171], v[32:35]
    v_cvt_pk_bf16_f32 v118, v96, v97
    v_mfma_f32_16x16x32_bf16 v[36:39], v[140:143], a[184:187], v[36:39]
    v_cvt_pk_bf16_f32 v119, v98, v99
    v_exp_f32 v80, v80
    v_mfma_f32_16x16x32_bf16 v[40:43], v[140:143], a[200:203], v[40:43]
    v_exp_f32 v81, v81
    v_exp_f32 v82, v82
    v_mfma_f32_16x16x32_bf16 v[44:47], v[140:143], a[216:219], v[44:47]
    v_exp_f32 v83, v83
    v_cvt_pk_bf16_f32 v120, v80, v81
    v_mfma_f32_16x16x32_bf16 v[48:51], v[140:143], a[232:235], v[48:51]
    v_cvt_pk_bf16_f32 v121, v82, v83
    v_exp_f32 v100, v100
    v_mfma_f32_16x16x32_bf16 v[52:55], v[156:159], a[168:171], v[52:55]
    v_exp_f32 v101, v101
    v_exp_f32 v102, v102
    v_mfma_f32_16x16x32_bf16 v[56:59], v[156:159], a[184:187], v[56:59]
    v_exp_f32 v103, v103
    v_cvt_pk_bf16_f32 v122, v100, v101
    v_mfma_f32_16x16x32_bf16 v[60:63], v[156:159], a[200:203], v[60:63]
    v_cvt_pk_bf16_f32 v123, v102, v103
    v_exp_f32 v84, v84
    v_mfma_f32_16x16x32_bf16 v[64:67], v[156:159], a[216:219], v[64:67]
    v_exp_f32 v85, v85
    v_exp_f32 v86, v86
    v_mfma_f32_16x16x32_bf16 v[68:71], v[156:159], a[232:235], v[68:71]
    v_exp_f32 v87, v87
    v_cvt_pk_bf16_f32 v124, v84, v85
    v_mfma_f32_16x16x32_bf16 v[32:35], v[144:147], a[172:175], v[32:35]
    v_cvt_pk_bf16_f32 v125, v86, v87
    v_mfma_f32_16x16x32_bf16 v[36:39], v[144:147], a[188:191], v[36:39]
    v_exp_f32 v104, v104
    v_exp_f32 v105, v105
    v_mfma_f32_16x16x32_bf16 v[40:43], v[144:147], a[204:207], v[40:43]
    v_exp_f32 v106, v106
    v_exp_f32 v107, v107
    v_mfma_f32_16x16x32_bf16 v[44:47], v[144:147], a[220:223], v[44:47]
    v_cvt_pk_bf16_f32 v126, v104, v105
    v_cvt_pk_bf16_f32 v127, v106, v107
    v_mfma_f32_16x16x32_bf16 v[48:51], v[144:147], a[236:239], v[48:51]
    v_exp_f32 v88, v88
    v_exp_f32 v89, v89
    v_mfma_f32_16x16x32_bf16 v[52:55], v[160:163], a[172:175], v[52:55]
    v_exp_f32 v90, v90
    v_exp_f32 v91, v91
    v_mfma_f32_16x16x32_bf16 v[56:59], v[160:163], a[188:191], v[56:59]
    v_cvt_pk_bf16_f32 v128, v88, v89
    v_cvt_pk_bf16_f32 v129, v90, v91
    v_mfma_f32_16x16x32_bf16 v[60:63], v[160:163], a[204:207], v[60:63]
    v_exp_f32 v108, v108
    v_exp_f32 v109, v109
    v_mfma_f32_16x16x32_bf16 v[64:67], v[160:163], a[220:223], v[64:67]
    v_exp_f32 v110, v110
    v_exp_f32 v111, v111
    v_mfma_f32_16x16x32_bf16 v[68:71], v[160:163], a[236:239], v[68:71]
    v_cvt_pk_bf16_f32 v130, v108, v109
    v_cvt_pk_bf16_f32 v131, v110, v111
    s_waitcnt lgkmcnt(0)
    s_nop 1
    v_mfma_f32_16x16x32_bf16 a[0:3], v[164:167], v[112:115], a[0:3]
    v_mfma_f32_16x16x32_bf16 a[4:7], v[164:167], v[116:119], a[4:7]
    v_mfma_f32_16x16x32_bf16 a[8:11], v[164:167], v[120:123], a[8:11]
    v_mfma_f32_16x16x32_bf16 a[12:15], v[164:167], v[124:127], a[12:15]
    ds_read_b128 v[132:135], v8 offset:49152
    v_mfma_f32_16x16x32_bf16 a[16:19], v[164:167], v[128:131], a[16:19]
    ds_read_b128 v[136:139], v9 offset:49152
    ds_read_b128 v[140:143], v10 offset:49152
    v_mfma_f32_16x16x32_bf16 a[20:23], v[168:171], v[112:115], a[20:23]
    ds_read_b128 v[144:147], v11 offset:49152
    ds_read_b128 v[148:151], v8 offset:53248
    v_mfma_f32_16x16x32_bf16 a[24:27], v[168:171], v[116:119], a[24:27]
    ds_read_b128 v[152:155], v9 offset:53248
    ds_read_b128 v[156:159], v10 offset:53248
    v_mfma_f32_16x16x32_bf16 a[28:31], v[168:171], v[120:123], a[28:31]
    ds_read_b128 v[160:163], v11 offset:53248
    v_add_f32 v216, v216, v72
    v_mfma_f32_16x16x32_bf16 a[32:35], v[168:171], v[124:127], a[32:35]
    v_add_f32 v217, v217, v76
    v_add_f32 v218, v218, v80
    v_mfma_f32_16x16x32_bf16 a[36:39], v[168:171], v[128:131], a[36:39]
    v_add_f32 v219, v219, v84
    v_mfma_f32_16x16x32_bf16 a[40:43], v[172:175], v[112:115], a[40:43]
    v_add_f32 v220, v220, v88
    v_add_f32 v216, v216, v73
    v_mfma_f32_16x16x32_bf16 a[44:47], v[172:175], v[116:119], a[44:47]
    v_add_f32 v217, v217, v77
    v_add_f32 v218, v218, v81
    v_mfma_f32_16x16x32_bf16 a[48:51], v[172:175], v[120:123], a[48:51]
    v_add_f32 v219, v219, v85
    v_add_f32 v220, v220, v89
    v_mfma_f32_16x16x32_bf16 a[52:55], v[172:175], v[124:127], a[52:55]
    v_add_f32 v216, v216, v74
    v_add_f32 v217, v217, v78
    v_mfma_f32_16x16x32_bf16 a[56:59], v[172:175], v[128:131], a[56:59]
    v_add_f32 v218, v218, v82
    v_add_f32 v219, v219, v86
    v_mfma_f32_16x16x32_bf16 a[60:63], v[176:179], v[112:115], a[60:63]
    v_add_f32 v220, v220, v90
    v_mfma_f32_16x16x32_bf16 a[64:67], v[176:179], v[116:119], a[64:67]
    v_add_f32 v216, v216, v75
    v_add_f32 v217, v217, v79
    v_mfma_f32_16x16x32_bf16 a[68:71], v[176:179], v[120:123], a[68:71]
    v_add_f32 v218, v218, v83
    v_add_f32 v219, v219, v87
    v_mfma_f32_16x16x32_bf16 a[72:75], v[176:179], v[124:127], a[72:75]
    v_add_f32 v220, v220, v91
    v_add_f32 v216, v216, v92
    v_mfma_f32_16x16x32_bf16 a[76:79], v[176:179], v[128:131], a[76:79]
    v_add_f32 v217, v217, v96
    v_add_f32 v218, v218, v100
    v_mfma_f32_16x16x32_bf16 a[80:83], v[180:183], v[112:115], a[80:83]
    v_add_f32 v219, v219, v104
    v_add_f32 v220, v220, v108
    v_mfma_f32_16x16x32_bf16 a[84:87], v[180:183], v[116:119], a[84:87]
    v_add_f32 v216, v216, v93
    v_mfma_f32_16x16x32_bf16 a[88:91], v[180:183], v[120:123], a[88:91]
    v_add_f32 v217, v217, v97
    v_add_f32 v218, v218, v101
    v_mfma_f32_16x16x32_bf16 a[92:95], v[180:183], v[124:127], a[92:95]
    v_add_f32 v219, v219, v105
    v_add_f32 v220, v220, v109
    v_mfma_f32_16x16x32_bf16 a[96:99], v[180:183], v[128:131], a[96:99]
    v_add_f32 v216, v216, v94
    v_add_f32 v217, v217, v98
    v_mfma_f32_16x16x32_bf16 a[100:103], v[184:187], v[112:115], a[100:103]
    v_add_f32 v218, v218, v102
    v_add_f32 v219, v219, v106
    v_mfma_f32_16x16x32_bf16 a[104:107], v[184:187], v[116:119], a[104:107]
    v_add_f32 v220, v220, v110
    v_add_f32 v216, v216, v95
    v_mfma_f32_16x16x32_bf16 a[108:111], v[184:187], v[120:123], a[108:111]
    v_add_f32 v217, v217, v99
    v_mfma_f32_16x16x32_bf16 a[112:115], v[184:187], v[124:127], a[112:115]
    v_add_f32 v218, v218, v103
    v_add_f32 v219, v219, v107
    v_mfma_f32_16x16x32_bf16 a[116:119], v[184:187], v[128:131], a[116:119]
    v_add_f32 v220, v220, v111
    v_max3_f32 v226, v32, v33, v34
    v_mfma_f32_16x16x32_bf16 a[120:123], v[188:191], v[112:115], a[120:123]
    v_max3_f32 v226, v226, v35, v36
    v_max3_f32 v226, v226, v37, v38
    v_mfma_f32_16x16x32_bf16 a[124:127], v[188:191], v[116:119], a[124:127]
    v_max3_f32 v226, v226, v39, v40
    v_max3_f32 v226, v226, v41, v42
    v_mfma_f32_16x16x32_bf16 a[128:131], v[188:191], v[120:123], a[128:131]
    v_max3_f32 v226, v226, v43, v44
    v_max3_f32 v226, v226, v45, v46
    v_mfma_f32_16x16x32_bf16 a[132:135], v[188:191], v[124:127], a[132:135]
    v_max3_f32 v226, v226, v47, v48
    v_mfma_f32_16x16x32_bf16 a[136:139], v[188:191], v[128:131], a[136:139]
    v_max3_f32 v226, v226, v49, v50
    v_max3_f32 v226, v226, v51, v52
    v_mfma_f32_16x16x32_bf16 a[140:143], v[192:195], v[112:115], a[140:143]
    v_max3_f32 v226, v226, v53, v54
    v_max3_f32 v226, v226, v55, v56
    v_mfma_f32_16x16x32_bf16 a[144:147], v[192:195], v[116:119], a[144:147]
    v_max3_f32 v226, v226, v57, v58
    v_max3_f32 v226, v226, v59, v60
    v_mfma_f32_16x16x32_bf16 a[148:151], v[192:195], v[120:123], a[148:151]
    v_max3_f32 v226, v226, v61, v62
    v_max3_f32 v226, v226, v63, v64
    v_mfma_f32_16x16x32_bf16 a[152:155], v[192:195], v[124:127], a[152:155]
    v_max3_f32 v226, v226, v65, v66
    v_max3_f32 v226, v226, v67, v68
    v_mfma_f32_16x16x32_bf16 a[156:159], v[192:195], v[128:131], a[156:159]
    v_max3_f32 v226, v226, v69, v70
    v_max_f32 v226, v226, v71
    s_nop 0
    v_cmp_lt_f32 vcc, s50, v226
    s_nop 1
    s_cbranch_vccnz k1_kernel_L23
k1_kernel_L24:
    s_waitcnt vmcnt(16)
    s_barrier
    s_cmp_eq_u32 s40, 0
    s_cselect_b32 s44, 15, 13
    s_lshl_b32 s45, s44, 13
    s_add_u32 s45, s45, s42
    s_and_b32 s46, s44, 3
    s_lshl_b32 s46, s46, 14
    s_add_u32 s46, s46, s43
    s_add_u32 s47, s46, 0
    s_mov_b32 m0, s47
    s_add_u32 s48, s45, 0
    buffer_load_dwordx4 v4, s[32:35], s48 offen lds
    s_add_u32 s47, s46, 1024
    s_mov_b32 m0, s47
    s_add_u32 s48, s45, 1024
    buffer_load_dwordx4 v5, s[32:35], s48 offen lds
    s_add_u32 s47, s46, 2048
    s_mov_b32 m0, s47
    s_add_u32 s48, s45, 2048
    buffer_load_dwordx4 v6, s[32:35], s48 offen lds
    s_add_u32 s47, s46, 3072
    s_mov_b32 m0, s47
    s_add_u32 s48, s45, 3072
    buffer_load_dwordx4 v7, s[32:35], s48 offen lds
    s_add_u32 s47, s46, 4096
    s_mov_b32 m0, s47
    s_add_u32 s48, s45, 4096
    buffer_load_dwordx4 v4, s[32:35], s48 offen lds
    s_add_u32 s47, s46, 5120
    s_mov_b32 m0, s47
    s_add_u32 s48, s45, 5120
    buffer_load_dwordx4 v5, s[32:35], s48 offen lds
    s_add_u32 s47, s46, 6144
    s_mov_b32 m0, s47
    s_add_u32 s48, s45, 6144
    buffer_load_dwordx4 v6, s[32:35], s48 offen lds
    s_add_u32 s47, s46, 7168
    s_mov_b32 m0, s47
    s_add_u32 s48, s45, 7168
    buffer_load_dwordx4 v7, s[32:35], s48 offen lds
    s_waitcnt lgkmcnt(0)
    v_mfma_f32_16x16x32_bf16 v[72:75], v[132:135], a[160:163], v[196:199]
    ds_read_b64_tr_b16 v[164:165], v12 offset:32768
    v_mfma_f32_16x16x32_bf16 v[76:79], v[132:135], a[176:179], v[200:203]
    ds_read_b64_tr_b16 v[166:167], v12 offset:36864
    ds_read_b64_tr_b16 v[168:169], v13 offset:32768
    v_mfma_f32_16x16x32_bf16 v[80:83], v[132:135], a[192:195], v[204:207]
    ds_read_b64_tr_b16 v[170:171], v13 offset:36864
    ds_read_b64_tr_b16 v[172:173], v14 offset:32768
    v_mfma_f32_16x16x32_bf16 v[84:87], v[132:135], a[208:211], v[208:211]
    ds_read_b64_tr_b16 v[174:175], v14 offset:36864
    ds_read_b64_tr_b16 v[176:177], v15 offset:32768
    v_mfma_f32_16x16x32_bf16 v[88:91], v[132:135], a[224:227], v[212:215]
    ds_read_b64_tr_b16 v[178:179], v15 offset:36864
    ds_read_b64_tr_b16 v[180:181], v16 offset:32768
    v_mfma_f32_16x16x32_bf16 v[92:95], v[148:151], a[160:163], v[196:199]
    ds_read_b64_tr_b16 v[182:183], v16 offset:36864
    ds_read_b64_tr_b16 v[184:185], v17 offset:32768
    v_mfma_f32_16x16x32_bf16 v[96:99], v[148:151], a[176:179], v[200:203]
    ds_read_b64_tr_b16 v[186:187], v17 offset:36864
    ds_read_b64_tr_b16 v[188:189], v18 offset:32768
    v_mfma_f32_16x16x32_bf16 v[100:103], v[148:151], a[192:195], v[204:207]
    ds_read_b64_tr_b16 v[190:191], v18 offset:36864
    ds_read_b64_tr_b16 v[192:193], v19 offset:32768
    v_mfma_f32_16x16x32_bf16 v[104:107], v[148:151], a[208:211], v[208:211]
    ds_read_b64_tr_b16 v[194:195], v19 offset:36864
    v_exp_f32 v32, v32
    v_mfma_f32_16x16x32_bf16 v[108:111], v[148:151], a[224:227], v[212:215]
    v_exp_f32 v33, v33
    v_exp_f32 v34, v34
    v_mfma_f32_16x16x32_bf16 v[72:75], v[136:139], a[164:167], v[72:75]
    v_exp_f32 v35, v35
    v_mfma_f32_16x16x32_bf16 v[76:79], v[136:139], a[180:183], v[76:79]
    v_cvt_pk_bf16_f32 v112, v32, v33
    v_cvt_pk_bf16_f32 v113, v34, v35
    v_mfma_f32_16x16x32_bf16 v[80:83], v[136:139], a[196:199], v[80:83]
    v_exp_f32 v52, v52
    v_exp_f32 v53, v53
    v_mfma_f32_16x16x32_bf16 v[84:87], v[136:139], a[212:215], v[84:87]
    v_exp_f32 v54, v54
    v_exp_f32 v55, v55
    v_mfma_f32_16x16x32_bf16 v[88:91], v[136:139], a[228:231], v[88:91]
    v_cvt_pk_bf16_f32 v114, v52, v53
    v_cvt_pk_bf16_f32 v115, v54, v55
    v_mfma_f32_16x16x32_bf16 v[92:95], v[152:155], a[164:167], v[92:95]
    v_exp_f32 v36, v36
    v_exp_f32 v37, v37
    v_mfma_f32_16x16x32_bf16 v[96:99], v[152:155], a[180:183], v[96:99]
    v_exp_f32 v38, v38
    v_exp_f32 v39, v39
    v_mfma_f32_16x16x32_bf16 v[100:103], v[152:155], a[196:199], v[100:103]
    v_cvt_pk_bf16_f32 v116, v36, v37
    v_cvt_pk_bf16_f32 v117, v38, v39
    v_mfma_f32_16x16x32_bf16 v[104:107], v[152:155], a[212:215], v[104:107]
    v_exp_f32 v56, v56
    v_exp_f32 v57, v57
    v_mfma_f32_16x16x32_bf16 v[108:111], v[152:155], a[228:231], v[108:111]
    v_exp_f32 v58, v58
    v_exp_f32 v59, v59
    v_mfma_f32_16x16x32_bf16 v[72:75], v[140:143], a[168:171], v[72:75]
    v_cvt_pk_bf16_f32 v118, v56, v57
    v_mfma_f32_16x16x32_bf16 v[76:79], v[140:143], a[184:187], v[76:79]
    v_cvt_pk_bf16_f32 v119, v58, v59
    v_exp_f32 v40, v40
    v_mfma_f32_16x16x32_bf16 v[80:83], v[140:143], a[200:203], v[80:83]
    v_exp_f32 v41, v41
    v_exp_f32 v42, v42
    v_mfma_f32_16x16x32_bf16 v[84:87], v[140:143], a[216:219], v[84:87]
    v_exp_f32 v43, v43
    v_cvt_pk_bf16_f32 v120, v40, v41
    v_mfma_f32_16x16x32_bf16 v[88:91], v[140:143], a[232:235], v[88:91]
    v_cvt_pk_bf16_f32 v121, v42, v43
    v_exp_f32 v60, v60
    v_mfma_f32_16x16x32_bf16 v[92:95], v[156:159], a[168:171], v[92:95]
    v_exp_f32 v61, v61
    v_exp_f32 v62, v62
    v_mfma_f32_16x16x32_bf16 v[96:99], v[156:159], a[184:187], v[96:99]
    v_exp_f32 v63, v63
    v_cvt_pk_bf16_f32 v122, v60, v61
    v_mfma_f32_16x16x32_bf16 v[100:103], v[156:159], a[200:203], v[100:103]
    v_cvt_pk_bf16_f32 v123, v62, v63
    v_exp_f32 v44, v44
    v_mfma_f32_16x16x32_bf16 v[104:107], v[156:159], a[216:219], v[104:107]
    v_exp_f32 v45, v45
    v_exp_f32 v46, v46
    v_mfma_f32_16x16x32_bf16 v[108:111], v[156:159], a[232:235], v[108:111]
    v_exp_f32 v47, v47
    v_cvt_pk_bf16_f32 v124, v44, v45
    v_mfma_f32_16x16x32_bf16 v[72:75], v[144:147], a[172:175], v[72:75]
    v_cvt_pk_bf16_f32 v125, v46, v47
    v_mfma_f32_16x16x32_bf16 v[76:79], v[144:147], a[188:191], v[76:79]
    v_exp_f32 v64, v64
    v_exp_f32 v65, v65
    v_mfma_f32_16x16x32_bf16 v[80:83], v[144:147], a[204:207], v[80:83]
    v_exp_f32 v66, v66
    v_exp_f32 v67, v67
    v_mfma_f32_16x16x32_bf16 v[84:87], v[144:147], a[220:223], v[84:87]
    v_cvt_pk_bf16_f32 v126, v64, v65
    v_cvt_pk_bf16_f32 v127, v66, v67
    v_mfma_f32_16x16x32_bf16 v[88:91], v[144:147], a[236:239], v[88:91]
    v_exp_f32 v48, v48
    v_exp_f32 v49, v49
    v_mfma_f32_16x16x32_bf16 v[92:95], v[160:163], a[172:175], v[92:95]
    v_exp_f32 v50, v50
    v_exp_f32 v51, v51
    v_mfma_f32_16x16x32_bf16 v[96:99], v[160:163], a[188:191], v[96:99]
    v_cvt_pk_bf16_f32 v128, v48, v49
    v_cvt_pk_bf16_f32 v129, v50, v51
    v_mfma_f32_16x16x32_bf16 v[100:103], v[160:163], a[204:207], v[100:103]
    v_exp_f32 v68, v68
    v_exp_f32 v69, v69
    v_mfma_f32_16x16x32_bf16 v[104:107], v[160:163], a[220:223], v[104:107]
    v_exp_f32 v70, v70
    v_exp_f32 v71, v71
    v_mfma_f32_16x16x32_bf16 v[108:111], v[160:163], a[236:239], v[108:111]
    v_cvt_pk_bf16_f32 v130, v68, v69
    v_cvt_pk_bf16_f32 v131, v70, v71
    s_waitcnt lgkmcnt(0)
    s_nop 1
    v_mfma_f32_16x16x32_bf16 a[0:3], v[164:167], v[112:115], a[0:3]
    v_mfma_f32_16x16x32_bf16 a[4:7], v[164:167], v[116:119], a[4:7]
    v_mfma_f32_16x16x32_bf16 a[8:11], v[164:167], v[120:123], a[8:11]
    v_mfma_f32_16x16x32_bf16 a[12:15], v[164:167], v[124:127], a[12:15]
    ds_read_b128 v[132:135], v8 offset:0
    v_mfma_f32_16x16x32_bf16 a[16:19], v[164:167], v[128:131], a[16:19]
    ds_read_b128 v[136:139], v9 offset:0
    ds_read_b128 v[140:143], v10 offset:0
    v_mfma_f32_16x16x32_bf16 a[20:23], v[168:171], v[112:115], a[20:23]
    ds_read_b128 v[144:147], v11 offset:0
    ds_read_b128 v[148:151], v8 offset:4096
    v_mfma_f32_16x16x32_bf16 a[24:27], v[168:171], v[116:119], a[24:27]
    ds_read_b128 v[152:155], v9 offset:4096
    ds_read_b128 v[156:159], v10 offset:4096
    v_mfma_f32_16x16x32_bf16 a[28:31], v[168:171], v[120:123], a[28:31]
    ds_read_b128 v[160:163], v11 offset:4096
    v_add_f32 v216, v216, v32
    v_mfma_f32_16x16x32_bf16 a[32:35], v[168:171], v[124:127], a[32:35]
    v_add_f32 v217, v217, v36
    v_add_f32 v218, v218, v40
    v_mfma_f32_16x16x32_bf16 a[36:39], v[168:171], v[128:131], a[36:39]
    v_add_f32 v219, v219, v44
    v_mfma_f32_16x16x32_bf16 a[40:43], v[172:175], v[112:115], a[40:43]
    v_add_f32 v220, v220, v48
    v_add_f32 v216, v216, v33
    v_mfma_f32_16x16x32_bf16 a[44:47], v[172:175], v[116:119], a[44:47]
    v_add_f32 v217, v217, v37
    v_add_f32 v218, v218, v41
    v_mfma_f32_16x16x32_bf16 a[48:51], v[172:175], v[120:123], a[48:51]
    v_add_f32 v219, v219, v45
    v_add_f32 v220, v220, v49
    v_mfma_f32_16x16x32_bf16 a[52:55], v[172:175], v[124:127], a[52:55]
    v_add_f32 v216, v216, v34
    v_add_f32 v217, v217, v38
    v_mfma_f32_16x16x32_bf16 a[56:59], v[172:175], v[128:131], a[56:59]
    v_add_f32 v218, v218, v42
    v_add_f32 v219, v219, v46
    v_mfma_f32_16x16x32_bf16 a[60:63], v[176:179], v[112:115], a[60:63]
    v_add_f32 v220, v220, v50
    v_mfma_f32_16x16x32_bf16 a[64:67], v[176:179], v[116:119], a[64:67]
    v_add_f32 v216, v216, v35
    v_add_f32 v217, v217, v39
    v_mfma_f32_16x16x32_bf16 a[68:71], v[176:179], v[120:123], a[68:71]
    v_add_f32 v218, v218, v43
    v_add_f32 v219, v219, v47
    v_mfma_f32_16x16x32_bf16 a[72:75], v[176:179], v[124:127], a[72:75]
    v_add_f32 v220, v220, v51
    v_add_f32 v216, v216, v52
    v_mfma_f32_16x16x32_bf16 a[76:79], v[176:179], v[128:131], a[76:79]
    v_add_f32 v217, v217, v56
    v_add_f32 v218, v218, v60
    v_mfma_f32_16x16x32_bf16 a[80:83], v[180:183], v[112:115], a[80:83]
    v_add_f32 v219, v219, v64
    v_add_f32 v220, v220, v68
    v_mfma_f32_16x16x32_bf16 a[84:87], v[180:183], v[116:119], a[84:87]
    v_add_f32 v216, v216, v53
    v_mfma_f32_16x16x32_bf16 a[88:91], v[180:183], v[120:123], a[88:91]
    v_add_f32 v217, v217, v57
    v_add_f32 v218, v218, v61
    v_mfma_f32_16x16x32_bf16 a[92:95], v[180:183], v[124:127], a[92:95]
    v_add_f32 v219, v219, v65
    v_add_f32 v220, v220, v69
    v_mfma_f32_16x16x32_bf16 a[96:99], v[180:183], v[128:131], a[96:99]
    v_add_f32 v216, v216, v54
    v_add_f32 v217, v217, v58
    v_mfma_f32_16x16x32_bf16 a[100:103], v[184:187], v[112:115], a[100:103]
    v_add_f32 v218, v218, v62
    v_add_f32 v219, v219, v66
    v_mfma_f32_16x16x32_bf16 a[104:107], v[184:187], v[116:119], a[104:107]
    v_add_f32 v220, v220, v70
    v_add_f32 v216, v216, v55
    v_mfma_f32_16x16x32_bf16 a[108:111], v[184:187], v[120:123], a[108:111]
    v_add_f32 v217, v217, v59
    v_mfma_f32_16x16x32_bf16 a[112:115], v[184:187], v[124:127], a[112:115]
    v_add_f32 v218, v218, v63
    v_add_f32 v219, v219, v67
    v_mfma_f32_16x16x32_bf16 a[116:119], v[184:187], v[128:131], a[116:119]
    v_add_f32 v220, v220, v71
    v_max3_f32 v226, v72, v73, v74
    v_mfma_f32_16x16x32_bf16 a[120:123], v[188:191], v[112:115], a[120:123]
    v_max3_f32 v226, v226, v75, v76
    v_max3_f32 v226, v226, v77, v78
    v_mfma_f32_16x16x32_bf16 a[124:127], v[188:191], v[116:119], a[124:127]
    v_max3_f32 v226, v226, v79, v80
    v_max3_f32 v226, v226, v81, v82
    v_mfma_f32_16x16x32_bf16 a[128:131], v[188:191], v[120:123], a[128:131]
    v_max3_f32 v226, v226, v83, v84
    v_max3_f32 v226, v226, v85, v86
    v_mfma_f32_16x16x32_bf16 a[132:135], v[188:191], v[124:127], a[132:135]
    v_max3_f32 v226, v226, v87, v88
    v_mfma_f32_16x16x32_bf16 a[136:139], v[188:191], v[128:131], a[136:139]
    v_max3_f32 v226, v226, v89, v90
    v_max3_f32 v226, v226, v91, v92
    v_mfma_f32_16x16x32_bf16 a[140:143], v[192:195], v[112:115], a[140:143]
    v_max3_f32 v226, v226, v93, v94
    v_max3_f32 v226, v226, v95, v96
    v_mfma_f32_16x16x32_bf16 a[144:147], v[192:195], v[116:119], a[144:147]
    v_max3_f32 v226, v226, v97, v98
    v_max3_f32 v226, v226, v99, v100
    v_mfma_f32_16x16x32_bf16 a[148:151], v[192:195], v[120:123], a[148:151]
    v_max3_f32 v226, v226, v101, v102
    v_max3_f32 v226, v226, v103, v104
    v_mfma_f32_16x16x32_bf16 a[152:155], v[192:195], v[124:127], a[152:155]
    v_max3_f32 v226, v226, v105, v106
    v_max3_f32 v226, v226, v107, v108
    v_mfma_f32_16x16x32_bf16 a[156:159], v[192:195], v[128:131], a[156:159]
    v_max3_f32 v226, v226, v109, v110
    v_max_f32 v226, v226, v111
    s_nop 0
    v_cmp_lt_f32 vcc, s50, v226
    s_nop 1
    s_cbranch_vccnz k1_kernel_L25
k1_kernel_L26:
    s_waitcnt vmcnt(16)
    s_barrier
    s_cmp_eq_u32 s40, 0
    s_cbranch_scc1 k1_kernel_L27
    s_cmp_eq_u32 s40, 0
    s_cselect_b32 s44, 0, 14
    s_lshl_b32 s45, s44, 13
    s_add_u32 s45, s45, s42
    s_and_b32 s46, s44, 3
    s_lshl_b32 s46, s46, 14
    s_add_u32 s46, s46, s43
    s_add_u32 s47, s46, 0
    s_mov_b32 m0, s47
    s_add_u32 s48, s45, 0
    buffer_load_dwordx4 v4, s[32:35], s48 offen lds
    s_add_u32 s47, s46, 1024
    s_mov_b32 m0, s47
    s_add_u32 s48, s45, 1024
    buffer_load_dwordx4 v5, s[32:35], s48 offen lds
    s_add_u32 s47, s46, 2048
    s_mov_b32 m0, s47
    s_add_u32 s48, s45, 2048
    buffer_load_dwordx4 v6, s[32:35], s48 offen lds
    s_add_u32 s47, s46, 3072
    s_mov_b32 m0, s47
    s_add_u32 s48, s45, 3072
    buffer_load_dwordx4 v7, s[32:35], s48 offen lds
    s_add_u32 s47, s46, 4096
    s_mov_b32 m0, s47
    s_add_u32 s48, s45, 4096
    buffer_load_dwordx4 v4, s[32:35], s48 offen lds
    s_add_u32 s47, s46, 5120
    s_mov_b32 m0, s47
    s_add_u32 s48, s45, 5120
    buffer_load_dwordx4 v5, s[32:35], s48 offen lds
    s_add_u32 s47, s46, 6144
    s_mov_b32 m0, s47
    s_add_u32 s48, s45, 6144
    buffer_load_dwordx4 v6, s[32:35], s48 offen lds
    s_add_u32 s47, s46, 7168
    s_mov_b32 m0, s47
    s_add_u32 s48, s45, 7168
    buffer_load_dwordx4 v7, s[32:35], s48 offen lds
k1_kernel_L27:
    s_waitcnt lgkmcnt(0)
    v_mfma_f32_16x16x32_bf16 v[32:35], v[132:135], a[160:163], v[196:199]
    ds_read_b64_tr_b16 v[164:165], v12 offset:49152
    v_mfma_f32_16x16x32_bf16 v[36:39], v[132:135], a[176:179], v[200:203]
    ds_read_b64_tr_b16 v[166:167], v12 offset:53248
    ds_read_b64_tr_b16 v[168:169], v13 offset:49152
    v_mfma_f32_16x16x32_bf16 v[40:43], v[132:135], a[192:195], v[204:207]
    ds_read_b64_tr_b16 v[170:171], v13 offset:53248
    ds_read_b64_tr_b16 v[172:173], v14 offset:49152
    v_mfma_f32_16x16x32_bf16 v[44:47], v[132:135], a[208:211], v[208:211]
    ds_read_b64_tr_b16 v[174:175], v14 offset:53248
    ds_read_b64_tr_b16 v[176:177], v15 offset:49152
    v_mfma_f32_16x16x32_bf16 v[48:51], v[132:135], a[224:227], v[212:215]
    ds_read_b64_tr_b16 v[178:179], v15 offset:53248
    ds_read_b64_tr_b16 v[180:181], v16 offset:49152
    v_mfma_f32_16x16x32_bf16 v[52:55], v[148:151], a[160:163], v[196:199]
    ds_read_b64_tr_b16 v[182:183], v16 offset:53248
    ds_read_b64_tr_b16 v[184:185], v17 offset:49152
    v_mfma_f32_16x16x32_bf16 v[56:59], v[148:151], a[176:179], v[200:203]
    ds_read_b64_tr_b16 v[186:187], v17 offset:53248
    ds_read_b64_tr_b16 v[188:189], v18 offset:49152
    v_mfma_f32_16x16x32_bf16 v[60:63], v[148:151], a[192:195], v[204:207]
    ds_read_b64_tr_b16 v[190:191], v18 offset:53248
    ds_read_b64_tr_b16 v[192:193], v19 offset:49152
    v_mfma_f32_16x16x32_bf16 v[64:67], v[148:151], a[208:211], v[208:211]
    ds_read_b64_tr_b16 v[194:195], v19 offset:53248
    v_exp_f32 v72, v72
    v_mfma_f32_16x16x32_bf16 v[68:71], v[148:151], a[224:227], v[212:215]
    v_exp_f32 v73, v73
    v_exp_f32 v74, v74
    v_mfma_f32_16x16x32_bf16 v[32:35], v[136:139], a[164:167], v[32:35]
    v_exp_f32 v75, v75
    v_mfma_f32_16x16x32_bf16 v[36:39], v[136:139], a[180:183], v[36:39]
    v_cvt_pk_bf16_f32 v112, v72, v73
    v_cvt_pk_bf16_f32 v113, v74, v75
    v_mfma_f32_16x16x32_bf16 v[40:43], v[136:139], a[196:199], v[40:43]
    v_exp_f32 v92, v92
    v_exp_f32 v93, v93
    v_mfma_f32_16x16x32_bf16 v[44:47], v[136:139], a[212:215], v[44:47]
    v_exp_f32 v94, v94
    v_exp_f32 v95, v95
    v_mfma_f32_16x16x32_bf16 v[48:51], v[136:139], a[228:231], v[48:51]
    v_cvt_pk_bf16_f32 v114, v92, v93
    v_cvt_pk_bf16_f32 v115, v94, v95
    v_mfma_f32_16x16x32_bf16 v[52:55], v[152:155], a[164:167], v[52:55]
    v_exp_f32 v76, v76
    v_exp_f32 v77, v77
    v_mfma_f32_16x16x32_bf16 v[56:59], v[152:155], a[180:183], v[56:59]
    v_exp_f32 v78, v78
    v_exp_f32 v79, v79
    v_mfma_f32_16x16x32_bf16 v[60:63], v[152:155], a[196:199], v[60:63]
    v_cvt_pk_bf16_f32 v116, v76, v77
    v_cvt_pk_bf16_f32 v117, v78, v79
    v_mfma_f32_16x16x32_bf16 v[64:67], v[152:155], a[212:215], v[64:67]
    v_exp_f32 v96, v96
    v_exp_f32 v97, v97
    v_mfma_f32_16x16x32_bf16 v[68:71], v[152:155], a[228:231], v[68:71]
    v_exp_f32 v98, v98
    v_exp_f32 v99, v99
    v_mfma_f32_16x16x32_bf16 v[32:35], v[140:143], a[168:171], v[32:35]
    v_cvt_pk_bf16_f32 v118, v96, v97
    v_mfma_f32_16x16x32_bf16 v[36:39], v[140:143], a[184:187], v[36:39]
    v_cvt_pk_bf16_f32 v119, v98, v99
    v_exp_f32 v80, v80
    v_mfma_f32_16x16x32_bf16 v[40:43], v[140:143], a[200:203], v[40:43]
    v_exp_f32 v81, v81
    v_exp_f32 v82, v82
    v_mfma_f32_16x16x32_bf16 v[44:47], v[140:143], a[216:219], v[44:47]
    v_exp_f32 v83, v83
    v_cvt_pk_bf16_f32 v120, v80, v81
    v_mfma_f32_16x16x32_bf16 v[48:51], v[140:143], a[232:235], v[48:51]
    v_cvt_pk_bf16_f32 v121, v82, v83
    v_exp_f32 v100, v100
    v_mfma_f32_16x16x32_bf16 v[52:55], v[156:159], a[168:171], v[52:55]
    v_exp_f32 v101, v101
    v_exp_f32 v102, v102
    v_mfma_f32_16x16x32_bf16 v[56:59], v[156:159], a[184:187], v[56:59]
    v_exp_f32 v103, v103
    v_cvt_pk_bf16_f32 v122, v100, v101
    v_mfma_f32_16x16x32_bf16 v[60:63], v[156:159], a[200:203], v[60:63]
    v_cvt_pk_bf16_f32 v123, v102, v103
    v_exp_f32 v84, v84
    v_mfma_f32_16x16x32_bf16 v[64:67], v[156:159], a[216:219], v[64:67]
    v_exp_f32 v85, v85
    v_exp_f32 v86, v86
    v_mfma_f32_16x16x32_bf16 v[68:71], v[156:159], a[232:235], v[68:71]
    v_exp_f32 v87, v87
    v_cvt_pk_bf16_f32 v124, v84, v85
    v_mfma_f32_16x16x32_bf16 v[32:35], v[144:147], a[172:175], v[32:35]
    v_cvt_pk_bf16_f32 v125, v86, v87
    v_mfma_f32_16x16x32_bf16 v[36:39], v[144:147], a[188:191], v[36:39]
    v_exp_f32 v104, v104
    v_exp_f32 v105, v105
    v_mfma_f32_16x16x32_bf16 v[40:43], v[144:147], a[204:207], v[40:43]
    v_exp_f32 v106, v106
    v_exp_f32 v107, v107
    v_mfma_f32_16x16x32_bf16 v[44:47], v[144:147], a[220:223], v[44:47]
    v_cvt_pk_bf16_f32 v126, v104, v105
    v_cvt_pk_bf16_f32 v127, v106, v107
    v_mfma_f32_16x16x32_bf16 v[48:51], v[144:147], a[236:239], v[48:51]
    v_exp_f32 v88, v88
    v_exp_f32 v89, v89
    v_mfma_f32_16x16x32_bf16 v[52:55], v[160:163], a[172:175], v[52:55]
    v_exp_f32 v90, v90
    v_exp_f32 v91, v91
    v_mfma_f32_16x16x32_bf16 v[56:59], v[160:163], a[188:191], v[56:59]
    v_cvt_pk_bf16_f32 v128, v88, v89
    v_cvt_pk_bf16_f32 v129, v90, v91
    v_mfma_f32_16x16x32_bf16 v[60:63], v[160:163], a[204:207], v[60:63]
    v_exp_f32 v108, v108
    v_exp_f32 v109, v109
    v_mfma_f32_16x16x32_bf16 v[64:67], v[160:163], a[220:223], v[64:67]
    v_exp_f32 v110, v110
    v_exp_f32 v111, v111
    v_mfma_f32_16x16x32_bf16 v[68:71], v[160:163], a[236:239], v[68:71]
    v_cvt_pk_bf16_f32 v130, v108, v109
    v_cvt_pk_bf16_f32 v131, v110, v111
    s_waitcnt lgkmcnt(0)
    s_nop 1
    v_mfma_f32_16x16x32_bf16 a[0:3], v[164:167], v[112:115], a[0:3]
    v_mfma_f32_16x16x32_bf16 a[4:7], v[164:167], v[116:119], a[4:7]
    v_mfma_f32_16x16x32_bf16 a[8:11], v[164:167], v[120:123], a[8:11]
    v_mfma_f32_16x16x32_bf16 a[12:15], v[164:167], v[124:127], a[12:15]
    ds_read_b128 v[132:135], v8 offset:16384
    v_mfma_f32_16x16x32_bf16 a[16:19], v[164:167], v[128:131], a[16:19]
    ds_read_b128 v[136:139], v9 offset:16384
    ds_read_b128 v[140:143], v10 offset:16384
    v_mfma_f32_16x16x32_bf16 a[20:23], v[168:171], v[112:115], a[20:23]
    ds_read_b128 v[144:147], v11 offset:16384
    ds_read_b128 v[148:151], v8 offset:20480
    v_mfma_f32_16x16x32_bf16 a[24:27], v[168:171], v[116:119], a[24:27]
    ds_read_b128 v[152:155], v9 offset:20480
    ds_read_b128 v[156:159], v10 offset:20480
    v_mfma_f32_16x16x32_bf16 a[28:31], v[168:171], v[120:123], a[28:31]
    ds_read_b128 v[160:163], v11 offset:20480
    v_add_f32 v216, v216, v72
    v_mfma_f32_16x16x32_bf16 a[32:35], v[168:171], v[124:127], a[32:35]
    v_add_f32 v217, v217, v76
    v_add_f32 v218, v218, v80
    v_mfma_f32_16x16x32_bf16 a[36:39], v[168:171], v[128:131], a[36:39]
    v_add_f32 v219, v219, v84
    v_mfma_f32_16x16x32_bf16 a[40:43], v[172:175], v[112:115], a[40:43]
    v_add_f32 v220, v220, v88
    v_add_f32 v216, v216, v73
    v_mfma_f32_16x16x32_bf16 a[44:47], v[172:175], v[116:119], a[44:47]
    v_add_f32 v217, v217, v77
    v_add_f32 v218, v218, v81
    v_mfma_f32_16x16x32_bf16 a[48:51], v[172:175], v[120:123], a[48:51]
    v_add_f32 v219, v219, v85
    v_add_f32 v220, v220, v89
    v_mfma_f32_16x16x32_bf16 a[52:55], v[172:175], v[124:127], a[52:55]
    v_add_f32 v216, v216, v74
    v_add_f32 v217, v217, v78
    v_mfma_f32_16x16x32_bf16 a[56:59], v[172:175], v[128:131], a[56:59]
    v_add_f32 v218, v218, v82
    v_add_f32 v219, v219, v86
    v_mfma_f32_16x16x32_bf16 a[60:63], v[176:179], v[112:115], a[60:63]
    v_add_f32 v220, v220, v90
    v_mfma_f32_16x16x32_bf16 a[64:67], v[176:179], v[116:119], a[64:67]
    v_add_f32 v216, v216, v75
    v_add_f32 v217, v217, v79
    v_mfma_f32_16x16x32_bf16 a[68:71], v[176:179], v[120:123], a[68:71]
    v_add_f32 v218, v218, v83
    v_add_f32 v219, v219, v87
    v_mfma_f32_16x16x32_bf16 a[72:75], v[176:179], v[124:127], a[72:75]
    v_add_f32 v220, v220, v91
    v_add_f32 v216, v216, v92
    v_mfma_f32_16x16x32_bf16 a[76:79], v[176:179], v[128:131], a[76:79]
    v_add_f32 v217, v217, v96
    v_add_f32 v218, v218, v100
    v_mfma_f32_16x16x32_bf16 a[80:83], v[180:183], v[112:115], a[80:83]
    v_add_f32 v219, v219, v104
    v_add_f32 v220, v220, v108
    v_mfma_f32_16x16x32_bf16 a[84:87], v[180:183], v[116:119], a[84:87]
    v_add_f32 v216, v216, v93
    v_mfma_f32_16x16x32_bf16 a[88:91], v[180:183], v[120:123], a[88:91]
    v_add_f32 v217, v217, v97
    v_add_f32 v218, v218, v101
    v_mfma_f32_16x16x32_bf16 a[92:95], v[180:183], v[124:127], a[92:95]
    v_add_f32 v219, v219, v105
    v_add_f32 v220, v220, v109
    v_mfma_f32_16x16x32_bf16 a[96:99], v[180:183], v[128:131], a[96:99]
    v_add_f32 v216, v216, v94
    v_add_f32 v217, v217, v98
    v_mfma_f32_16x16x32_bf16 a[100:103], v[184:187], v[112:115], a[100:103]
    v_add_f32 v218, v218, v102
    v_add_f32 v219, v219, v106
    v_mfma_f32_16x16x32_bf16 a[104:107], v[184:187], v[116:119], a[104:107]
    v_add_f32 v220, v220, v110
    v_add_f32 v216, v216, v95
    v_mfma_f32_16x16x32_bf16 a[108:111], v[184:187], v[120:123], a[108:111]
    v_add_f32 v217, v217, v99
    v_mfma_f32_16x16x32_bf16 a[112:115], v[184:187], v[124:127], a[112:115]
    v_add_f32 v218, v218, v103
    v_add_f32 v219, v219, v107
    v_mfma_f32_16x16x32_bf16 a[116:119], v[184:187], v[128:131], a[116:119]
    v_add_f32 v220, v220, v111
    v_max3_f32 v226, v32, v33, v34
    v_mfma_f32_16x16x32_bf16 a[120:123], v[188:191], v[112:115], a[120:123]
    v_max3_f32 v226, v226, v35, v36
    v_max3_f32 v226, v226, v37, v38
    v_mfma_f32_16x16x32_bf16 a[124:127], v[188:191], v[116:119], a[124:127]
    v_max3_f32 v226, v226, v39, v40
    v_max3_f32 v226, v226, v41, v42
    v_mfma_f32_16x16x32_bf16 a[128:131], v[188:191], v[120:123], a[128:131]
    v_max3_f32 v226, v226, v43, v44
    v_max3_f32 v226, v226, v45, v46
    v_mfma_f32_16x16x32_bf16 a[132:135], v[188:191], v[124:127], a[132:135]
    v_max3_f32 v226, v226, v47, v48
    v_mfma_f32_16x16x32_bf16 a[136:139], v[188:191], v[128:131], a[136:139]
    v_max3_f32 v226, v226, v49, v50
    v_max3_f32 v226, v226, v51, v52
    v_mfma_f32_16x16x32_bf16 a[140:143], v[192:195], v[112:115], a[140:143]
    v_max3_f32 v226, v226, v53, v54
    v_max3_f32 v226, v226, v55, v56
    v_mfma_f32_16x16x32_bf16 a[144:147], v[192:195], v[116:119], a[144:147]
    v_max3_f32 v226, v226, v57, v58
    v_max3_f32 v226, v226, v59, v60
    v_mfma_f32_16x16x32_bf16 a[148:151], v[192:195], v[120:123], a[148:151]
    v_max3_f32 v226, v226, v61, v62
    v_max3_f32 v226, v226, v63, v64
    v_mfma_f32_16x16x32_bf16 a[152:155], v[192:195], v[124:127], a[152:155]
    v_max3_f32 v226, v226, v65, v66
    v_max3_f32 v226, v226, v67, v68
    v_mfma_f32_16x16x32_bf16 a[156:159], v[192:195], v[128:131], a[156:159]
    v_max3_f32 v226, v226, v69, v70
    v_max_f32 v226, v226, v71
    s_nop 0
    v_cmp_lt_f32 vcc, s50, v226
    s_nop 1
    s_cbranch_vccnz k1_kernel_L28
k1_kernel_L29:
    s_waitcnt vmcnt(8)
    s_barrier
    s_cmp_eq_u32 s40, 0
    s_cbranch_scc1 k1_kernel_L30
    s_cmp_eq_u32 s40, 0
    s_cselect_b32 s44, 0, 15
    s_lshl_b32 s45, s44, 13
    s_add_u32 s45, s45, s42
    s_and_b32 s46, s44, 3
    s_lshl_b32 s46, s46, 14
    s_add_u32 s46, s46, s43
    s_add_u32 s47, s46, 0
    s_mov_b32 m0, s47
    s_add_u32 s48, s45, 0
    buffer_load_dwordx4 v4, s[32:35], s48 offen lds
    s_add_u32 s47, s46, 1024
    s_mov_b32 m0, s47
    s_add_u32 s48, s45, 1024
    buffer_load_dwordx4 v5, s[32:35], s48 offen lds
    s_add_u32 s47, s46, 2048
    s_mov_b32 m0, s47
    s_add_u32 s48, s45, 2048
    buffer_load_dwordx4 v6, s[32:35], s48 offen lds
    s_add_u32 s47, s46, 3072
    s_mov_b32 m0, s47
    s_add_u32 s48, s45, 3072
    buffer_load_dwordx4 v7, s[32:35], s48 offen lds
    s_add_u32 s47, s46, 4096
    s_mov_b32 m0, s47
    s_add_u32 s48, s45, 4096
    buffer_load_dwordx4 v4, s[32:35], s48 offen lds
    s_add_u32 s47, s46, 5120
    s_mov_b32 m0, s47
    s_add_u32 s48, s45, 5120
    buffer_load_dwordx4 v5, s[32:35], s48 offen lds
    s_add_u32 s47, s46, 6144
    s_mov_b32 m0, s47
    s_add_u32 s48, s45, 6144
    buffer_load_dwordx4 v6, s[32:35], s48 offen lds
    s_add_u32 s47, s46, 7168
    s_mov_b32 m0, s47
    s_add_u32 s48, s45, 7168
    buffer_load_dwordx4 v7, s[32:35], s48 offen lds
k1_kernel_L30:
    s_waitcnt lgkmcnt(0)
    v_mfma_f32_16x16x32_bf16 v[72:75], v[132:135], a[160:163], v[196:199]
    ds_read_b64_tr_b16 v[164:165], v12 offset:0
    v_mfma_f32_16x16x32_bf16 v[76:79], v[132:135], a[176:179], v[200:203]
    ds_read_b64_tr_b16 v[166:167], v12 offset:4096
    ds_read_b64_tr_b16 v[168:169], v13 offset:0
    v_mfma_f32_16x16x32_bf16 v[80:83], v[132:135], a[192:195], v[204:207]
    ds_read_b64_tr_b16 v[170:171], v13 offset:4096
    ds_read_b64_tr_b16 v[172:173], v14 offset:0
    v_mfma_f32_16x16x32_bf16 v[84:87], v[132:135], a[208:211], v[208:211]
    ds_read_b64_tr_b16 v[174:175], v14 offset:4096
    ds_read_b64_tr_b16 v[176:177], v15 offset:0
    v_mfma_f32_16x16x32_bf16 v[88:91], v[132:135], a[224:227], v[212:215]
    ds_read_b64_tr_b16 v[178:179], v15 offset:4096
    ds_read_b64_tr_b16 v[180:181], v16 offset:0
    v_mfma_f32_16x16x32_bf16 v[92:95], v[148:151], a[160:163], v[196:199]
    ds_read_b64_tr_b16 v[182:183], v16 offset:4096
    ds_read_b64_tr_b16 v[184:185], v17 offset:0
    v_mfma_f32_16x16x32_bf16 v[96:99], v[148:151], a[176:179], v[200:203]
    ds_read_b64_tr_b16 v[186:187], v17 offset:4096
    ds_read_b64_tr_b16 v[188:189], v18 offset:0
    v_mfma_f32_16x16x32_bf16 v[100:103], v[148:151], a[192:195], v[204:207]
    ds_read_b64_tr_b16 v[190:191], v18 offset:4096
    ds_read_b64_tr_b16 v[192:193], v19 offset:0
    v_mfma_f32_16x16x32_bf16 v[104:107], v[148:151], a[208:211], v[208:211]
    ds_read_b64_tr_b16 v[194:195], v19 offset:4096
    v_exp_f32 v32, v32
    v_mfma_f32_16x16x32_bf16 v[108:111], v[148:151], a[224:227], v[212:215]
    v_exp_f32 v33, v33
    v_exp_f32 v34, v34
    v_mfma_f32_16x16x32_bf16 v[72:75], v[136:139], a[164:167], v[72:75]
    v_exp_f32 v35, v35
    v_mfma_f32_16x16x32_bf16 v[76:79], v[136:139], a[180:183], v[76:79]
    v_cvt_pk_bf16_f32 v112, v32, v33
    v_cvt_pk_bf16_f32 v113, v34, v35
    v_mfma_f32_16x16x32_bf16 v[80:83], v[136:139], a[196:199], v[80:83]
    v_exp_f32 v52, v52
    v_exp_f32 v53, v53
    v_mfma_f32_16x16x32_bf16 v[84:87], v[136:139], a[212:215], v[84:87]
    v_exp_f32 v54, v54
    v_exp_f32 v55, v55
    v_mfma_f32_16x16x32_bf16 v[88:91], v[136:139], a[228:231], v[88:91]
    v_cvt_pk_bf16_f32 v114, v52, v53
    v_cvt_pk_bf16_f32 v115, v54, v55
    v_mfma_f32_16x16x32_bf16 v[92:95], v[152:155], a[164:167], v[92:95]
    v_exp_f32 v36, v36
    v_exp_f32 v37, v37
    v_mfma_f32_16x16x32_bf16 v[96:99], v[152:155], a[180:183], v[96:99]
    v_exp_f32 v38, v38
    v_exp_f32 v39, v39
    v_mfma_f32_16x16x32_bf16 v[100:103], v[152:155], a[196:199], v[100:103]
    v_cvt_pk_bf16_f32 v116, v36, v37
    v_cvt_pk_bf16_f32 v117, v38, v39
    v_mfma_f32_16x16x32_bf16 v[104:107], v[152:155], a[212:215], v[104:107]
    v_exp_f32 v56, v56
    v_exp_f32 v57, v57
    v_mfma_f32_16x16x32_bf16 v[108:111], v[152:155], a[228:231], v[108:111]
    v_exp_f32 v58, v58
    v_exp_f32 v59, v59
    v_mfma_f32_16x16x32_bf16 v[72:75], v[140:143], a[168:171], v[72:75]
    v_cvt_pk_bf16_f32 v118, v56, v57
    v_mfma_f32_16x16x32_bf16 v[76:79], v[140:143], a[184:187], v[76:79]
    v_cvt_pk_bf16_f32 v119, v58, v59
    v_exp_f32 v40, v40
    v_mfma_f32_16x16x32_bf16 v[80:83], v[140:143], a[200:203], v[80:83]
    v_exp_f32 v41, v41
    v_exp_f32 v42, v42
    v_mfma_f32_16x16x32_bf16 v[84:87], v[140:143], a[216:219], v[84:87]
    v_exp_f32 v43, v43
    v_cvt_pk_bf16_f32 v120, v40, v41
    v_mfma_f32_16x16x32_bf16 v[88:91], v[140:143], a[232:235], v[88:91]
    v_cvt_pk_bf16_f32 v121, v42, v43
    v_exp_f32 v60, v60
    v_mfma_f32_16x16x32_bf16 v[92:95], v[156:159], a[168:171], v[92:95]
    v_exp_f32 v61, v61
    v_exp_f32 v62, v62
    v_mfma_f32_16x16x32_bf16 v[96:99], v[156:159], a[184:187], v[96:99]
    v_exp_f32 v63, v63
    v_cvt_pk_bf16_f32 v122, v60, v61
    v_mfma_f32_16x16x32_bf16 v[100:103], v[156:159], a[200:203], v[100:103]
    v_cvt_pk_bf16_f32 v123, v62, v63
    v_exp_f32 v44, v44
    v_mfma_f32_16x16x32_bf16 v[104:107], v[156:159], a[216:219], v[104:107]
    v_exp_f32 v45, v45
    v_exp_f32 v46, v46
    v_mfma_f32_16x16x32_bf16 v[108:111], v[156:159], a[232:235], v[108:111]
    v_exp_f32 v47, v47
    v_cvt_pk_bf16_f32 v124, v44, v45
    v_mfma_f32_16x16x32_bf16 v[72:75], v[144:147], a[172:175], v[72:75]
    v_cvt_pk_bf16_f32 v125, v46, v47
    v_mfma_f32_16x16x32_bf16 v[76:79], v[144:147], a[188:191], v[76:79]
    v_exp_f32 v64, v64
    v_exp_f32 v65, v65
    v_mfma_f32_16x16x32_bf16 v[80:83], v[144:147], a[204:207], v[80:83]
    v_exp_f32 v66, v66
    v_exp_f32 v67, v67
    v_mfma_f32_16x16x32_bf16 v[84:87], v[144:147], a[220:223], v[84:87]
    v_cvt_pk_bf16_f32 v126, v64, v65
    v_cvt_pk_bf16_f32 v127, v66, v67
    v_mfma_f32_16x16x32_bf16 v[88:91], v[144:147], a[236:239], v[88:91]
    v_exp_f32 v48, v48
    v_exp_f32 v49, v49
    v_mfma_f32_16x16x32_bf16 v[92:95], v[160:163], a[172:175], v[92:95]
    v_exp_f32 v50, v50
    v_exp_f32 v51, v51
    v_mfma_f32_16x16x32_bf16 v[96:99], v[160:163], a[188:191], v[96:99]
    v_cvt_pk_bf16_f32 v128, v48, v49
    v_cvt_pk_bf16_f32 v129, v50, v51
    v_mfma_f32_16x16x32_bf16 v[100:103], v[160:163], a[204:207], v[100:103]
    v_exp_f32 v68, v68
    v_exp_f32 v69, v69
    v_mfma_f32_16x16x32_bf16 v[104:107], v[160:163], a[220:223], v[104:107]
    v_exp_f32 v70, v70
    v_exp_f32 v71, v71
    v_mfma_f32_16x16x32_bf16 v[108:111], v[160:163], a[236:239], v[108:111]
    v_cvt_pk_bf16_f32 v130, v68, v69
    v_cvt_pk_bf16_f32 v131, v70, v71
    s_waitcnt lgkmcnt(0)
    s_nop 1
    v_mfma_f32_16x16x32_bf16 a[0:3], v[164:167], v[112:115], a[0:3]
    v_mfma_f32_16x16x32_bf16 a[4:7], v[164:167], v[116:119], a[4:7]
    v_mfma_f32_16x16x32_bf16 a[8:11], v[164:167], v[120:123], a[8:11]
    v_mfma_f32_16x16x32_bf16 a[12:15], v[164:167], v[124:127], a[12:15]
    ds_read_b128 v[132:135], v8 offset:32768
    v_mfma_f32_16x16x32_bf16 a[16:19], v[164:167], v[128:131], a[16:19]
    ds_read_b128 v[136:139], v9 offset:32768
    ds_read_b128 v[140:143], v10 offset:32768
    v_mfma_f32_16x16x32_bf16 a[20:23], v[168:171], v[112:115], a[20:23]
    ds_read_b128 v[144:147], v11 offset:32768
    ds_read_b128 v[148:151], v8 offset:36864
    v_mfma_f32_16x16x32_bf16 a[24:27], v[168:171], v[116:119], a[24:27]
    ds_read_b128 v[152:155], v9 offset:36864
    ds_read_b128 v[156:159], v10 offset:36864
    v_mfma_f32_16x16x32_bf16 a[28:31], v[168:171], v[120:123], a[28:31]
    ds_read_b128 v[160:163], v11 offset:36864
    v_add_f32 v216, v216, v32
    v_mfma_f32_16x16x32_bf16 a[32:35], v[168:171], v[124:127], a[32:35]
    v_add_f32 v217, v217, v36
    v_add_f32 v218, v218, v40
    v_mfma_f32_16x16x32_bf16 a[36:39], v[168:171], v[128:131], a[36:39]
    v_add_f32 v219, v219, v44
    v_mfma_f32_16x16x32_bf16 a[40:43], v[172:175], v[112:115], a[40:43]
    v_add_f32 v220, v220, v48
    v_add_f32 v216, v216, v33
    v_mfma_f32_16x16x32_bf16 a[44:47], v[172:175], v[116:119], a[44:47]
    v_add_f32 v217, v217, v37
    v_add_f32 v218, v218, v41
    v_mfma_f32_16x16x32_bf16 a[48:51], v[172:175], v[120:123], a[48:51]
    v_add_f32 v219, v219, v45
    v_add_f32 v220, v220, v49
    v_mfma_f32_16x16x32_bf16 a[52:55], v[172:175], v[124:127], a[52:55]
    v_add_f32 v216, v216, v34
    v_add_f32 v217, v217, v38
    v_mfma_f32_16x16x32_bf16 a[56:59], v[172:175], v[128:131], a[56:59]
    v_add_f32 v218, v218, v42
    v_add_f32 v219, v219, v46
    v_mfma_f32_16x16x32_bf16 a[60:63], v[176:179], v[112:115], a[60:63]
    v_add_f32 v220, v220, v50
    v_mfma_f32_16x16x32_bf16 a[64:67], v[176:179], v[116:119], a[64:67]
    v_add_f32 v216, v216, v35
    v_add_f32 v217, v217, v39
    v_mfma_f32_16x16x32_bf16 a[68:71], v[176:179], v[120:123], a[68:71]
    v_add_f32 v218, v218, v43
    v_add_f32 v219, v219, v47
    v_mfma_f32_16x16x32_bf16 a[72:75], v[176:179], v[124:127], a[72:75]
    v_add_f32 v220, v220, v51
    v_add_f32 v216, v216, v52
    v_mfma_f32_16x16x32_bf16 a[76:79], v[176:179], v[128:131], a[76:79]
    v_add_f32 v217, v217, v56
    v_add_f32 v218, v218, v60
    v_mfma_f32_16x16x32_bf16 a[80:83], v[180:183], v[112:115], a[80:83]
    v_add_f32 v219, v219, v64
    v_add_f32 v220, v220, v68
    v_mfma_f32_16x16x32_bf16 a[84:87], v[180:183], v[116:119], a[84:87]
    v_add_f32 v216, v216, v53
    v_mfma_f32_16x16x32_bf16 a[88:91], v[180:183], v[120:123], a[88:91]
    v_add_f32 v217, v217, v57
    v_add_f32 v218, v218, v61
    v_mfma_f32_16x16x32_bf16 a[92:95], v[180:183], v[124:127], a[92:95]
    v_add_f32 v219, v219, v65
    v_add_f32 v220, v220, v69
    v_mfma_f32_16x16x32_bf16 a[96:99], v[180:183], v[128:131], a[96:99]
    v_add_f32 v216, v216, v54
    v_add_f32 v217, v217, v58
    v_mfma_f32_16x16x32_bf16 a[100:103], v[184:187], v[112:115], a[100:103]
    v_add_f32 v218, v218, v62
    v_add_f32 v219, v219, v66
    v_mfma_f32_16x16x32_bf16 a[104:107], v[184:187], v[116:119], a[104:107]
    v_add_f32 v220, v220, v70
    v_add_f32 v216, v216, v55
    v_mfma_f32_16x16x32_bf16 a[108:111], v[184:187], v[120:123], a[108:111]
    v_add_f32 v217, v217, v59
    v_mfma_f32_16x16x32_bf16 a[112:115], v[184:187], v[124:127], a[112:115]
    v_add_f32 v218, v218, v63
    v_add_f32 v219, v219, v67
    v_mfma_f32_16x16x32_bf16 a[116:119], v[184:187], v[128:131], a[116:119]
    v_add_f32 v220, v220, v71
    v_max3_f32 v226, v72, v73, v74
    v_mfma_f32_16x16x32_bf16 a[120:123], v[188:191], v[112:115], a[120:123]
    v_max3_f32 v226, v226, v75, v76
    v_max3_f32 v226, v226, v77, v78
    v_mfma_f32_16x16x32_bf16 a[124:127], v[188:191], v[116:119], a[124:127]
    v_max3_f32 v226, v226, v79, v80
    v_max3_f32 v226, v226, v81, v82
    v_mfma_f32_16x16x32_bf16 a[128:131], v[188:191], v[120:123], a[128:131]
    v_max3_f32 v226, v226, v83, v84
    v_max3_f32 v226, v226, v85, v86
    v_mfma_f32_16x16x32_bf16 a[132:135], v[188:191], v[124:127], a[132:135]
    v_max3_f32 v226, v226, v87, v88
    v_mfma_f32_16x16x32_bf16 a[136:139], v[188:191], v[128:131], a[136:139]
    v_max3_f32 v226, v226, v89, v90
    v_max3_f32 v226, v226, v91, v92
    v_mfma_f32_16x16x32_bf16 a[140:143], v[192:195], v[112:115], a[140:143]
    v_max3_f32 v226, v226, v93, v94
    v_max3_f32 v226, v226, v95, v96
    v_mfma_f32_16x16x32_bf16 a[144:147], v[192:195], v[116:119], a[144:147]
    v_max3_f32 v226, v226, v97, v98
    v_max3_f32 v226, v226, v99, v100
    v_mfma_f32_16x16x32_bf16 a[148:151], v[192:195], v[120:123], a[148:151]
    v_max3_f32 v226, v226, v101, v102
    v_max3_f32 v226, v226, v103, v104
    v_mfma_f32_16x16x32_bf16 a[152:155], v[192:195], v[124:127], a[152:155]
    v_max3_f32 v226, v226, v105, v106
    v_max3_f32 v226, v226, v107, v108
    v_mfma_f32_16x16x32_bf16 a[156:159], v[192:195], v[128:131], a[156:159]
    v_max3_f32 v226, v226, v109, v110
    v_max_f32 v226, v226, v111
    s_nop 0
    v_cmp_lt_f32 vcc, s50, v226
    s_nop 1
    s_cbranch_vccnz k1_kernel_L31
k1_kernel_L32:
    s_waitcnt vmcnt(0)
    s_barrier
    s_waitcnt lgkmcnt(0)
    v_mfma_f32_16x16x32_bf16 v[32:35], v[132:135], a[160:163], v[196:199]
    ds_read_b64_tr_b16 v[164:165], v12 offset:16384
    v_mfma_f32_16x16x32_bf16 v[36:39], v[132:135], a[176:179], v[200:203]
    ds_read_b64_tr_b16 v[166:167], v12 offset:20480
    ds_read_b64_tr_b16 v[168:169], v13 offset:16384
    v_mfma_f32_16x16x32_bf16 v[40:43], v[132:135], a[192:195], v[204:207]
    ds_read_b64_tr_b16 v[170:171], v13 offset:20480
    ds_read_b64_tr_b16 v[172:173], v14 offset:16384
    v_mfma_f32_16x16x32_bf16 v[44:47], v[132:135], a[208:211], v[208:211]
    ds_read_b64_tr_b16 v[174:175], v14 offset:20480
    ds_read_b64_tr_b16 v[176:177], v15 offset:16384
    v_mfma_f32_16x16x32_bf16 v[48:51], v[132:135], a[224:227], v[212:215]
    ds_read_b64_tr_b16 v[178:179], v15 offset:20480
    ds_read_b64_tr_b16 v[180:181], v16 offset:16384
    v_mfma_f32_16x16x32_bf16 v[52:55], v[148:151], a[160:163], v[196:199]
    ds_read_b64_tr_b16 v[182:183], v16 offset:20480
    ds_read_b64_tr_b16 v[184:185], v17 offset:16384
    v_mfma_f32_16x16x32_bf16 v[56:59], v[148:151], a[176:179], v[200:203]
    ds_read_b64_tr_b16 v[186:187], v17 offset:20480
    ds_read_b64_tr_b16 v[188:189], v18 offset:16384
    v_mfma_f32_16x16x32_bf16 v[60:63], v[148:151], a[192:195], v[204:207]
    ds_read_b64_tr_b16 v[190:191], v18 offset:20480
    ds_read_b64_tr_b16 v[192:193], v19 offset:16384
    v_mfma_f32_16x16x32_bf16 v[64:67], v[148:151], a[208:211], v[208:211]
    ds_read_b64_tr_b16 v[194:195], v19 offset:20480
    v_exp_f32 v72, v72
    v_mfma_f32_16x16x32_bf16 v[68:71], v[148:151], a[224:227], v[212:215]
    v_exp_f32 v73, v73
    v_exp_f32 v74, v74
    v_mfma_f32_16x16x32_bf16 v[32:35], v[136:139], a[164:167], v[32:35]
    v_exp_f32 v75, v75
    v_mfma_f32_16x16x32_bf16 v[36:39], v[136:139], a[180:183], v[36:39]
    v_cvt_pk_bf16_f32 v112, v72, v73
    v_cvt_pk_bf16_f32 v113, v74, v75
    v_mfma_f32_16x16x32_bf16 v[40:43], v[136:139], a[196:199], v[40:43]
    v_exp_f32 v92, v92
    v_exp_f32 v93, v93
    v_mfma_f32_16x16x32_bf16 v[44:47], v[136:139], a[212:215], v[44:47]
    v_exp_f32 v94, v94
    v_exp_f32 v95, v95
    v_mfma_f32_16x16x32_bf16 v[48:51], v[136:139], a[228:231], v[48:51]
    v_cvt_pk_bf16_f32 v114, v92, v93
    v_cvt_pk_bf16_f32 v115, v94, v95
    v_mfma_f32_16x16x32_bf16 v[52:55], v[152:155], a[164:167], v[52:55]
    v_exp_f32 v76, v76
    v_exp_f32 v77, v77
    v_mfma_f32_16x16x32_bf16 v[56:59], v[152:155], a[180:183], v[56:59]
    v_exp_f32 v78, v78
    v_exp_f32 v79, v79
    v_mfma_f32_16x16x32_bf16 v[60:63], v[152:155], a[196:199], v[60:63]
    v_cvt_pk_bf16_f32 v116, v76, v77
    v_cvt_pk_bf16_f32 v117, v78, v79
    v_mfma_f32_16x16x32_bf16 v[64:67], v[152:155], a[212:215], v[64:67]
    v_exp_f32 v96, v96
    v_exp_f32 v97, v97
    v_mfma_f32_16x16x32_bf16 v[68:71], v[152:155], a[228:231], v[68:71]
    v_exp_f32 v98, v98
    v_exp_f32 v99, v99
    v_mfma_f32_16x16x32_bf16 v[32:35], v[140:143], a[168:171], v[32:35]
    v_cvt_pk_bf16_f32 v118, v96, v97
    v_mfma_f32_16x16x32_bf16 v[36:39], v[140:143], a[184:187], v[36:39]
    v_cvt_pk_bf16_f32 v119, v98, v99
    v_exp_f32 v80, v80
    v_mfma_f32_16x16x32_bf16 v[40:43], v[140:143], a[200:203], v[40:43]
    v_exp_f32 v81, v81
    v_exp_f32 v82, v82
    v_mfma_f32_16x16x32_bf16 v[44:47], v[140:143], a[216:219], v[44:47]
    v_exp_f32 v83, v83
    v_cvt_pk_bf16_f32 v120, v80, v81
    v_mfma_f32_16x16x32_bf16 v[48:51], v[140:143], a[232:235], v[48:51]
    v_cvt_pk_bf16_f32 v121, v82, v83
    v_exp_f32 v100, v100
    v_mfma_f32_16x16x32_bf16 v[52:55], v[156:159], a[168:171], v[52:55]
    v_exp_f32 v101, v101
    v_exp_f32 v102, v102
    v_mfma_f32_16x16x32_bf16 v[56:59], v[156:159], a[184:187], v[56:59]
    v_exp_f32 v103, v103
    v_cvt_pk_bf16_f32 v122, v100, v101
    v_mfma_f32_16x16x32_bf16 v[60:63], v[156:159], a[200:203], v[60:63]
    v_cvt_pk_bf16_f32 v123, v102, v103
    v_exp_f32 v84, v84
    v_mfma_f32_16x16x32_bf16 v[64:67], v[156:159], a[216:219], v[64:67]
    v_exp_f32 v85, v85
    v_exp_f32 v86, v86
    v_mfma_f32_16x16x32_bf16 v[68:71], v[156:159], a[232:235], v[68:71]
    v_exp_f32 v87, v87
    v_cvt_pk_bf16_f32 v124, v84, v85
    v_mfma_f32_16x16x32_bf16 v[32:35], v[144:147], a[172:175], v[32:35]
    v_cvt_pk_bf16_f32 v125, v86, v87
    v_mfma_f32_16x16x32_bf16 v[36:39], v[144:147], a[188:191], v[36:39]
    v_exp_f32 v104, v104
    v_exp_f32 v105, v105
    v_mfma_f32_16x16x32_bf16 v[40:43], v[144:147], a[204:207], v[40:43]
    v_exp_f32 v106, v106
    v_exp_f32 v107, v107
    v_mfma_f32_16x16x32_bf16 v[44:47], v[144:147], a[220:223], v[44:47]
    v_cvt_pk_bf16_f32 v126, v104, v105
    v_cvt_pk_bf16_f32 v127, v106, v107
    v_mfma_f32_16x16x32_bf16 v[48:51], v[144:147], a[236:239], v[48:51]
    v_exp_f32 v88, v88
    v_exp_f32 v89, v89
    v_mfma_f32_16x16x32_bf16 v[52:55], v[160:163], a[172:175], v[52:55]
    v_exp_f32 v90, v90
    v_exp_f32 v91, v91
    v_mfma_f32_16x16x32_bf16 v[56:59], v[160:163], a[188:191], v[56:59]
    v_cvt_pk_bf16_f32 v128, v88, v89
    v_cvt_pk_bf16_f32 v129, v90, v91
    v_mfma_f32_16x16x32_bf16 v[60:63], v[160:163], a[204:207], v[60:63]
    v_exp_f32 v108, v108
    v_exp_f32 v109, v109
    v_mfma_f32_16x16x32_bf16 v[64:67], v[160:163], a[220:223], v[64:67]
    v_exp_f32 v110, v110
    v_exp_f32 v111, v111
    v_mfma_f32_16x16x32_bf16 v[68:71], v[160:163], a[236:239], v[68:71]
    v_cvt_pk_bf16_f32 v130, v108, v109
    v_cvt_pk_bf16_f32 v131, v110, v111
    s_waitcnt lgkmcnt(0)
    s_nop 1
    v_mfma_f32_16x16x32_bf16 a[0:3], v[164:167], v[112:115], a[0:3]
    v_mfma_f32_16x16x32_bf16 a[4:7], v[164:167], v[116:119], a[4:7]
    v_mfma_f32_16x16x32_bf16 a[8:11], v[164:167], v[120:123], a[8:11]
    v_mfma_f32_16x16x32_bf16 a[12:15], v[164:167], v[124:127], a[12:15]
    ds_read_b128 v[132:135], v8 offset:49152
    v_mfma_f32_16x16x32_bf16 a[16:19], v[164:167], v[128:131], a[16:19]
    ds_read_b128 v[136:139], v9 offset:49152
    ds_read_b128 v[140:143], v10 offset:49152
    v_mfma_f32_16x16x32_bf16 a[20:23], v[168:171], v[112:115], a[20:23]
    ds_read_b128 v[144:147], v11 offset:49152
    ds_read_b128 v[148:151], v8 offset:53248
    v_mfma_f32_16x16x32_bf16 a[24:27], v[168:171], v[116:119], a[24:27]
    ds_read_b128 v[152:155], v9 offset:53248
    ds_read_b128 v[156:159], v10 offset:53248
    v_mfma_f32_16x16x32_bf16 a[28:31], v[168:171], v[120:123], a[28:31]
    ds_read_b128 v[160:163], v11 offset:53248
    v_add_f32 v216, v216, v72
    v_mfma_f32_16x16x32_bf16 a[32:35], v[168:171], v[124:127], a[32:35]
    v_add_f32 v217, v217, v76
    v_add_f32 v218, v218, v80
    v_mfma_f32_16x16x32_bf16 a[36:39], v[168:171], v[128:131], a[36:39]
    v_add_f32 v219, v219, v84
    v_mfma_f32_16x16x32_bf16 a[40:43], v[172:175], v[112:115], a[40:43]
    v_add_f32 v220, v220, v88
    v_add_f32 v216, v216, v73
    v_mfma_f32_16x16x32_bf16 a[44:47], v[172:175], v[116:119], a[44:47]
    v_add_f32 v217, v217, v77
    v_add_f32 v218, v218, v81
    v_mfma_f32_16x16x32_bf16 a[48:51], v[172:175], v[120:123], a[48:51]
    v_add_f32 v219, v219, v85
    v_add_f32 v220, v220, v89
    v_mfma_f32_16x16x32_bf16 a[52:55], v[172:175], v[124:127], a[52:55]
    v_add_f32 v216, v216, v74
    v_add_f32 v217, v217, v78
    v_mfma_f32_16x16x32_bf16 a[56:59], v[172:175], v[128:131], a[56:59]
    v_add_f32 v218, v218, v82
    v_add_f32 v219, v219, v86
    v_mfma_f32_16x16x32_bf16 a[60:63], v[176:179], v[112:115], a[60:63]
    v_add_f32 v220, v220, v90
    v_mfma_f32_16x16x32_bf16 a[64:67], v[176:179], v[116:119], a[64:67]
    v_add_f32 v216, v216, v75
    v_add_f32 v217, v217, v79
    v_mfma_f32_16x16x32_bf16 a[68:71], v[176:179], v[120:123], a[68:71]
    v_add_f32 v218, v218, v83
    v_add_f32 v219, v219, v87
    v_mfma_f32_16x16x32_bf16 a[72:75], v[176:179], v[124:127], a[72:75]
    v_add_f32 v220, v220, v91
    v_add_f32 v216, v216, v92
    v_mfma_f32_16x16x32_bf16 a[76:79], v[176:179], v[128:131], a[76:79]
    v_add_f32 v217, v217, v96
    v_add_f32 v218, v218, v100
    v_mfma_f32_16x16x32_bf16 a[80:83], v[180:183], v[112:115], a[80:83]
    v_add_f32 v219, v219, v104
    v_add_f32 v220, v220, v108
    v_mfma_f32_16x16x32_bf16 a[84:87], v[180:183], v[116:119], a[84:87]
    v_add_f32 v216, v216, v93
    v_mfma_f32_16x16x32_bf16 a[88:91], v[180:183], v[120:123], a[88:91]
    v_add_f32 v217, v217, v97
    v_add_f32 v218, v218, v101
    v_mfma_f32_16x16x32_bf16 a[92:95], v[180:183], v[124:127], a[92:95]
    v_add_f32 v219, v219, v105
    v_add_f32 v220, v220, v109
    v_mfma_f32_16x16x32_bf16 a[96:99], v[180:183], v[128:131], a[96:99]
    v_add_f32 v216, v216, v94
    v_add_f32 v217, v217, v98
    v_mfma_f32_16x16x32_bf16 a[100:103], v[184:187], v[112:115], a[100:103]
    v_add_f32 v218, v218, v102
    v_add_f32 v219, v219, v106
    v_mfma_f32_16x16x32_bf16 a[104:107], v[184:187], v[116:119], a[104:107]
    v_add_f32 v220, v220, v110
    v_add_f32 v216, v216, v95
    v_mfma_f32_16x16x32_bf16 a[108:111], v[184:187], v[120:123], a[108:111]
    v_add_f32 v217, v217, v99
    v_mfma_f32_16x16x32_bf16 a[112:115], v[184:187], v[124:127], a[112:115]
    v_add_f32 v218, v218, v103
    v_add_f32 v219, v219, v107
    v_mfma_f32_16x16x32_bf16 a[116:119], v[184:187], v[128:131], a[116:119]
    v_add_f32 v220, v220, v111
    v_max3_f32 v226, v32, v33, v34
    v_mfma_f32_16x16x32_bf16 a[120:123], v[188:191], v[112:115], a[120:123]
    v_max3_f32 v226, v226, v35, v36
    v_max3_f32 v226, v226, v37, v38
    v_mfma_f32_16x16x32_bf16 a[124:127], v[188:191], v[116:119], a[124:127]
    v_max3_f32 v226, v226, v39, v40
    v_max3_f32 v226, v226, v41, v42
    v_mfma_f32_16x16x32_bf16 a[128:131], v[188:191], v[120:123], a[128:131]
    v_max3_f32 v226, v226, v43, v44
    v_max3_f32 v226, v226, v45, v46
    v_mfma_f32_16x16x32_bf16 a[132:135], v[188:191], v[124:127], a[132:135]
    v_max3_f32 v226, v226, v47, v48
    v_mfma_f32_16x16x32_bf16 a[136:139], v[188:191], v[128:131], a[136:139]
    v_max3_f32 v226, v226, v49, v50
    v_max3_f32 v226, v226, v51, v52
    v_mfma_f32_16x16x32_bf16 a[140:143], v[192:195], v[112:115], a[140:143]
    v_max3_f32 v226, v226, v53, v54
    v_max3_f32 v226, v226, v55, v56
    v_mfma_f32_16x16x32_bf16 a[144:147], v[192:195], v[116:119], a[144:147]
    v_max3_f32 v226, v226, v57, v58
    v_max3_f32 v226, v226, v59, v60
    v_mfma_f32_16x16x32_bf16 a[148:151], v[192:195], v[120:123], a[148:151]
    v_max3_f32 v226, v226, v61, v62
    v_max3_f32 v226, v226, v63, v64
    v_mfma_f32_16x16x32_bf16 a[152:155], v[192:195], v[124:127], a[152:155]
    v_max3_f32 v226, v226, v65, v66
    v_max3_f32 v226, v226, v67, v68
    v_mfma_f32_16x16x32_bf16 a[156:159], v[192:195], v[128:131], a[156:159]
    v_max3_f32 v226, v226, v69, v70
    v_max_f32 v226, v226, v71
    s_nop 0
    v_cmp_lt_f32 vcc, s50, v226
    s_nop 1
    s_cbranch_vccnz k1_kernel_L33
k1_kernel_L34:
    s_waitcnt vmcnt(8)
    s_barrier
    s_waitcnt lgkmcnt(0)
    v_mfma_f32_16x16x32_bf16 v[72:75], v[132:135], a[160:163], v[196:199]
    ds_read_b64_tr_b16 v[164:165], v12 offset:32768
    v_mfma_f32_16x16x32_bf16 v[76:79], v[132:135], a[176:179], v[200:203]
    ds_read_b64_tr_b16 v[166:167], v12 offset:36864
    ds_read_b64_tr_b16 v[168:169], v13 offset:32768
    v_mfma_f32_16x16x32_bf16 v[80:83], v[132:135], a[192:195], v[204:207]
    ds_read_b64_tr_b16 v[170:171], v13 offset:36864
    ds_read_b64_tr_b16 v[172:173], v14 offset:32768
    v_mfma_f32_16x16x32_bf16 v[84:87], v[132:135], a[208:211], v[208:211]
    ds_read_b64_tr_b16 v[174:175], v14 offset:36864
    ds_read_b64_tr_b16 v[176:177], v15 offset:32768
    v_mfma_f32_16x16x32_bf16 v[88:91], v[132:135], a[224:227], v[212:215]
    ds_read_b64_tr_b16 v[178:179], v15 offset:36864
    ds_read_b64_tr_b16 v[180:181], v16 offset:32768
    v_mfma_f32_16x16x32_bf16 v[92:95], v[148:151], a[160:163], v[196:199]
    ds_read_b64_tr_b16 v[182:183], v16 offset:36864
    ds_read_b64_tr_b16 v[184:185], v17 offset:32768
    v_mfma_f32_16x16x32_bf16 v[96:99], v[148:151], a[176:179], v[200:203]
    ds_read_b64_tr_b16 v[186:187], v17 offset:36864
    ds_read_b64_tr_b16 v[188:189], v18 offset:32768
    v_mfma_f32_16x16x32_bf16 v[100:103], v[148:151], a[192:195], v[204:207]
    ds_read_b64_tr_b16 v[190:191], v18 offset:36864
    ds_read_b64_tr_b16 v[192:193], v19 offset:32768
    v_mfma_f32_16x16x32_bf16 v[104:107], v[148:151], a[208:211], v[208:211]
    ds_read_b64_tr_b16 v[194:195], v19 offset:36864
    v_exp_f32 v32, v32
    v_mfma_f32_16x16x32_bf16 v[108:111], v[148:151], a[224:227], v[212:215]
    v_exp_f32 v33, v33
    v_exp_f32 v34, v34
    v_mfma_f32_16x16x32_bf16 v[72:75], v[136:139], a[164:167], v[72:75]
    v_exp_f32 v35, v35
    v_mfma_f32_16x16x32_bf16 v[76:79], v[136:139], a[180:183], v[76:79]
    v_cvt_pk_bf16_f32 v112, v32, v33
    v_cvt_pk_bf16_f32 v113, v34, v35
    v_mfma_f32_16x16x32_bf16 v[80:83], v[136:139], a[196:199], v[80:83]
    v_exp_f32 v52, v52
    v_exp_f32 v53, v53
    v_mfma_f32_16x16x32_bf16 v[84:87], v[136:139], a[212:215], v[84:87]
    v_exp_f32 v54, v54
    v_exp_f32 v55, v55
    v_mfma_f32_16x16x32_bf16 v[88:91], v[136:139], a[228:231], v[88:91]
    v_cvt_pk_bf16_f32 v114, v52, v53
    v_cvt_pk_bf16_f32 v115, v54, v55
    v_mfma_f32_16x16x32_bf16 v[92:95], v[152:155], a[164:167], v[92:95]
    v_exp_f32 v36, v36
    v_exp_f32 v37, v37
    v_mfma_f32_16x16x32_bf16 v[96:99], v[152:155], a[180:183], v[96:99]
    v_exp_f32 v38, v38
    v_exp_f32 v39, v39
    v_mfma_f32_16x16x32_bf16 v[100:103], v[152:155], a[196:199], v[100:103]
    v_cvt_pk_bf16_f32 v116, v36, v37
    v_cvt_pk_bf16_f32 v117, v38, v39
    v_mfma_f32_16x16x32_bf16 v[104:107], v[152:155], a[212:215], v[104:107]
    v_exp_f32 v56, v56
    v_exp_f32 v57, v57
    v_mfma_f32_16x16x32_bf16 v[108:111], v[152:155], a[228:231], v[108:111]
    v_exp_f32 v58, v58
    v_exp_f32 v59, v59
    v_mfma_f32_16x16x32_bf16 v[72:75], v[140:143], a[168:171], v[72:75]
    v_cvt_pk_bf16_f32 v118, v56, v57
    v_mfma_f32_16x16x32_bf16 v[76:79], v[140:143], a[184:187], v[76:79]
    v_cvt_pk_bf16_f32 v119, v58, v59
    v_exp_f32 v40, v40
    v_mfma_f32_16x16x32_bf16 v[80:83], v[140:143], a[200:203], v[80:83]
    v_exp_f32 v41, v41
    v_exp_f32 v42, v42
    v_mfma_f32_16x16x32_bf16 v[84:87], v[140:143], a[216:219], v[84:87]
    v_exp_f32 v43, v43
    v_cvt_pk_bf16_f32 v120, v40, v41
    v_mfma_f32_16x16x32_bf16 v[88:91], v[140:143], a[232:235], v[88:91]
    v_cvt_pk_bf16_f32 v121, v42, v43
    v_exp_f32 v60, v60
    v_mfma_f32_16x16x32_bf16 v[92:95], v[156:159], a[168:171], v[92:95]
    v_exp_f32 v61, v61
    v_exp_f32 v62, v62
    v_mfma_f32_16x16x32_bf16 v[96:99], v[156:159], a[184:187], v[96:99]
    v_exp_f32 v63, v63
    v_cvt_pk_bf16_f32 v122, v60, v61
    v_mfma_f32_16x16x32_bf16 v[100:103], v[156:159], a[200:203], v[100:103]
    v_cvt_pk_bf16_f32 v123, v62, v63
    v_exp_f32 v44, v44
    v_mfma_f32_16x16x32_bf16 v[104:107], v[156:159], a[216:219], v[104:107]
    v_exp_f32 v45, v45
    v_exp_f32 v46, v46
    v_mfma_f32_16x16x32_bf16 v[108:111], v[156:159], a[232:235], v[108:111]
    v_exp_f32 v47, v47
    v_cvt_pk_bf16_f32 v124, v44, v45
    v_mfma_f32_16x16x32_bf16 v[72:75], v[144:147], a[172:175], v[72:75]
    v_cvt_pk_bf16_f32 v125, v46, v47
    v_mfma_f32_16x16x32_bf16 v[76:79], v[144:147], a[188:191], v[76:79]
    v_exp_f32 v64, v64
    v_exp_f32 v65, v65
    v_mfma_f32_16x16x32_bf16 v[80:83], v[144:147], a[204:207], v[80:83]
    v_exp_f32 v66, v66
    v_exp_f32 v67, v67
    v_mfma_f32_16x16x32_bf16 v[84:87], v[144:147], a[220:223], v[84:87]
    v_cvt_pk_bf16_f32 v126, v64, v65
    v_cvt_pk_bf16_f32 v127, v66, v67
    v_mfma_f32_16x16x32_bf16 v[88:91], v[144:147], a[236:239], v[88:91]
    v_exp_f32 v48, v48
    v_exp_f32 v49, v49
    v_mfma_f32_16x16x32_bf16 v[92:95], v[160:163], a[172:175], v[92:95]
    v_exp_f32 v50, v50
    v_exp_f32 v51, v51
    v_mfma_f32_16x16x32_bf16 v[96:99], v[160:163], a[188:191], v[96:99]
    v_cvt_pk_bf16_f32 v128, v48, v49
    v_cvt_pk_bf16_f32 v129, v50, v51
    v_mfma_f32_16x16x32_bf16 v[100:103], v[160:163], a[204:207], v[100:103]
    v_exp_f32 v68, v68
    v_exp_f32 v69, v69
    v_mfma_f32_16x16x32_bf16 v[104:107], v[160:163], a[220:223], v[104:107]
    v_exp_f32 v70, v70
    v_exp_f32 v71, v71
    v_mfma_f32_16x16x32_bf16 v[108:111], v[160:163], a[236:239], v[108:111]
    v_cvt_pk_bf16_f32 v130, v68, v69
    v_cvt_pk_bf16_f32 v131, v70, v71
    s_waitcnt lgkmcnt(0)
    s_nop 1
    v_mfma_f32_16x16x32_bf16 a[0:3], v[164:167], v[112:115], a[0:3]
    v_mfma_f32_16x16x32_bf16 a[4:7], v[164:167], v[116:119], a[4:7]
    v_mfma_f32_16x16x32_bf16 a[8:11], v[164:167], v[120:123], a[8:11]
    v_mfma_f32_16x16x32_bf16 a[12:15], v[164:167], v[124:127], a[12:15]
    v_add_f32 v216, v216, v32
    v_mfma_f32_16x16x32_bf16 a[16:19], v[164:167], v[128:131], a[16:19]
    v_add_f32 v217, v217, v36
    v_add_f32 v218, v218, v40
    v_mfma_f32_16x16x32_bf16 a[20:23], v[168:171], v[112:115], a[20:23]
    v_add_f32 v219, v219, v44
    v_mfma_f32_16x16x32_bf16 a[24:27], v[168:171], v[116:119], a[24:27]
    v_add_f32 v220, v220, v48
    v_add_f32 v216, v216, v33
    v_mfma_f32_16x16x32_bf16 a[28:31], v[168:171], v[120:123], a[28:31]
    v_add_f32 v217, v217, v37
    v_add_f32 v218, v218, v41
    v_mfma_f32_16x16x32_bf16 a[32:35], v[168:171], v[124:127], a[32:35]
    v_add_f32 v219, v219, v45
    v_mfma_f32_16x16x32_bf16 a[36:39], v[168:171], v[128:131], a[36:39]
    v_add_f32 v220, v220, v49
    v_add_f32 v216, v216, v34
    v_mfma_f32_16x16x32_bf16 a[40:43], v[172:175], v[112:115], a[40:43]
    v_add_f32 v217, v217, v38
    v_mfma_f32_16x16x32_bf16 a[44:47], v[172:175], v[116:119], a[44:47]
    v_add_f32 v218, v218, v42
    v_add_f32 v219, v219, v46
    v_mfma_f32_16x16x32_bf16 a[48:51], v[172:175], v[120:123], a[48:51]
    v_add_f32 v220, v220, v50
    v_add_f32 v216, v216, v35
    v_mfma_f32_16x16x32_bf16 a[52:55], v[172:175], v[124:127], a[52:55]
    v_add_f32 v217, v217, v39
    v_mfma_f32_16x16x32_bf16 a[56:59], v[172:175], v[128:131], a[56:59]
    v_add_f32 v218, v218, v43
    v_add_f32 v219, v219, v47
    v_mfma_f32_16x16x32_bf16 a[60:63], v[176:179], v[112:115], a[60:63]
    v_add_f32 v220, v220, v51
    v_add_f32 v216, v216, v52
    v_mfma_f32_16x16x32_bf16 a[64:67], v[176:179], v[116:119], a[64:67]
    v_add_f32 v217, v217, v56
    v_mfma_f32_16x16x32_bf16 a[68:71], v[176:179], v[120:123], a[68:71]
    v_add_f32 v218, v218, v60
    v_add_f32 v219, v219, v64
    v_mfma_f32_16x16x32_bf16 a[72:75], v[176:179], v[124:127], a[72:75]
    v_add_f32 v220, v220, v68
    v_mfma_f32_16x16x32_bf16 a[76:79], v[176:179], v[128:131], a[76:79]
    v_add_f32 v216, v216, v53
    v_add_f32 v217, v217, v57
    v_mfma_f32_16x16x32_bf16 a[80:83], v[180:183], v[112:115], a[80:83]
    v_add_f32 v218, v218, v61
    v_add_f32 v219, v219, v65
    v_mfma_f32_16x16x32_bf16 a[84:87], v[180:183], v[116:119], a[84:87]
    v_add_f32 v220, v220, v69
    v_mfma_f32_16x16x32_bf16 a[88:91], v[180:183], v[120:123], a[88:91]
    v_add_f32 v216, v216, v54
    v_add_f32 v217, v217, v58
    v_mfma_f32_16x16x32_bf16 a[92:95], v[180:183], v[124:127], a[92:95]
    v_add_f32 v218, v218, v62
    v_add_f32 v219, v219, v66
    v_mfma_f32_16x16x32_bf16 a[96:99], v[180:183], v[128:131], a[96:99]
    v_add_f32 v220, v220, v70
    v_mfma_f32_16x16x32_bf16 a[100:103], v[184:187], v[112:115], a[100:103]
    v_add_f32 v216, v216, v55
    v_add_f32 v217, v217, v59
    v_mfma_f32_16x16x32_bf16 a[104:107], v[184:187], v[116:119], a[104:107]
    v_add_f32 v218, v218, v63
    v_mfma_f32_16x16x32_bf16 a[108:111], v[184:187], v[120:123], a[108:111]
    v_add_f32 v219, v219, v67
    v_add_f32 v220, v220, v71
    v_mfma_f32_16x16x32_bf16 a[112:115], v[184:187], v[124:127], a[112:115]
    v_max3_f32 v226, v72, v73, v74
    v_max3_f32 v226, v226, v75, v76
    v_mfma_f32_16x16x32_bf16 a[116:119], v[184:187], v[128:131], a[116:119]
    v_max3_f32 v226, v226, v77, v78
    v_mfma_f32_16x16x32_bf16 a[120:123], v[188:191], v[112:115], a[120:123]
    v_max3_f32 v226, v226, v79, v80
    v_max3_f32 v226, v226, v81, v82
    v_mfma_f32_16x16x32_bf16 a[124:127], v[188:191], v[116:119], a[124:127]
    v_max3_f32 v226, v226, v83, v84
    v_max3_f32 v226, v226, v85, v86
    v_mfma_f32_16x16x32_bf16 a[128:131], v[188:191], v[120:123], a[128:131]
    v_max3_f32 v226, v226, v87, v88
    v_mfma_f32_16x16x32_bf16 a[132:135], v[188:191], v[124:127], a[132:135]
    v_max3_f32 v226, v226, v89, v90
    v_max3_f32 v226, v226, v91, v92
    v_mfma_f32_16x16x32_bf16 a[136:139], v[188:191], v[128:131], a[136:139]
    v_max3_f32 v226, v226, v93, v94
    v_mfma_f32_16x16x32_bf16 a[140:143], v[192:195], v[112:115], a[140:143]
    v_max3_f32 v226, v226, v95, v96
    v_max3_f32 v226, v226, v97, v98
    v_mfma_f32_16x16x32_bf16 a[144:147], v[192:195], v[116:119], a[144:147]
    v_max3_f32 v226, v226, v99, v100
    v_max3_f32 v226, v226, v101, v102
    v_mfma_f32_16x16x32_bf16 a[148:151], v[192:195], v[120:123], a[148:151]
    v_max3_f32 v226, v226, v103, v104
    v_mfma_f32_16x16x32_bf16 a[152:155], v[192:195], v[124:127], a[152:155]
    v_max3_f32 v226, v226, v105, v106
    v_max3_f32 v226, v226, v107, v108
    v_mfma_f32_16x16x32_bf16 a[156:159], v[192:195], v[128:131], a[156:159]
    v_max3_f32 v226, v226, v109, v110
    v_max_f32 v226, v226, v111
    s_nop 0
    v_cmp_lt_f32 vcc, s50, v226
    s_nop 1
    s_cbranch_vccnz k1_kernel_L35
k1_kernel_L36:
    s_waitcnt vmcnt(0)
    s_barrier
    s_waitcnt lgkmcnt(0)
    ds_read_b64_tr_b16 v[164:165], v12 offset:49152
    ds_read_b64_tr_b16 v[166:167], v12 offset:53248
    ds_read_b64_tr_b16 v[168:169], v13 offset:49152
    ds_read_b64_tr_b16 v[170:171], v13 offset:53248
    ds_read_b64_tr_b16 v[172:173], v14 offset:49152
    ds_read_b64_tr_b16 v[174:175], v14 offset:53248
    ds_read_b64_tr_b16 v[176:177], v15 offset:49152
    ds_read_b64_tr_b16 v[178:179], v15 offset:53248
    ds_read_b64_tr_b16 v[180:181], v16 offset:49152
    ds_read_b64_tr_b16 v[182:183], v16 offset:53248
    ds_read_b64_tr_b16 v[184:185], v17 offset:49152
    ds_read_b64_tr_b16 v[186:187], v17 offset:53248
    ds_read_b64_tr_b16 v[188:189], v18 offset:49152
    ds_read_b64_tr_b16 v[190:191], v18 offset:53248
    ds_read_b64_tr_b16 v[192:193], v19 offset:49152
    ds_read_b64_tr_b16 v[194:195], v19 offset:53248
    v_exp_f32 v72, v72
    v_exp_f32 v73, v73
    v_exp_f32 v74, v74
    v_exp_f32 v75, v75
    v_cvt_pk_bf16_f32 v112, v72, v73
    v_cvt_pk_bf16_f32 v113, v74, v75
    v_exp_f32 v92, v92
    v_exp_f32 v93, v93
    v_exp_f32 v94, v94
    v_exp_f32 v95, v95
    v_cvt_pk_bf16_f32 v114, v92, v93
    v_cvt_pk_bf16_f32 v115, v94, v95
    v_exp_f32 v76, v76
    v_exp_f32 v77, v77
    v_exp_f32 v78, v78
    v_exp_f32 v79, v79
    v_cvt_pk_bf16_f32 v116, v76, v77
    v_cvt_pk_bf16_f32 v117, v78, v79
    v_exp_f32 v96, v96
    v_exp_f32 v97, v97
    v_exp_f32 v98, v98
    v_exp_f32 v99, v99
    v_cvt_pk_bf16_f32 v118, v96, v97
    v_cvt_pk_bf16_f32 v119, v98, v99
    v_exp_f32 v80, v80
    v_exp_f32 v81, v81
    v_exp_f32 v82, v82
    v_exp_f32 v83, v83
    v_cvt_pk_bf16_f32 v120, v80, v81
    v_cvt_pk_bf16_f32 v121, v82, v83
    v_exp_f32 v100, v100
    v_exp_f32 v101, v101
    v_exp_f32 v102, v102
    v_exp_f32 v103, v103
    v_cvt_pk_bf16_f32 v122, v100, v101
    v_cvt_pk_bf16_f32 v123, v102, v103
    v_exp_f32 v84, v84
    v_exp_f32 v85, v85
    v_exp_f32 v86, v86
    v_exp_f32 v87, v87
    v_cvt_pk_bf16_f32 v124, v84, v85
    v_cvt_pk_bf16_f32 v125, v86, v87
    v_exp_f32 v104, v104
    v_exp_f32 v105, v105
    v_exp_f32 v106, v106
    v_exp_f32 v107, v107
    v_cvt_pk_bf16_f32 v126, v104, v105
    v_cvt_pk_bf16_f32 v127, v106, v107
    v_exp_f32 v88, v88
    v_exp_f32 v89, v89
    v_exp_f32 v90, v90
    v_exp_f32 v91, v91
    v_cvt_pk_bf16_f32 v128, v88, v89
    v_cvt_pk_bf16_f32 v129, v90, v91
    v_exp_f32 v108, v108
    v_exp_f32 v109, v109
    v_exp_f32 v110, v110
    v_exp_f32 v111, v111
    v_cvt_pk_bf16_f32 v130, v108, v109
    v_cvt_pk_bf16_f32 v131, v110, v111
    s_waitcnt lgkmcnt(0)
    s_nop 1
    v_mfma_f32_16x16x32_bf16 a[0:3], v[164:167], v[112:115], a[0:3]
    v_mfma_f32_16x16x32_bf16 a[4:7], v[164:167], v[116:119], a[4:7]
    v_mfma_f32_16x16x32_bf16 a[8:11], v[164:167], v[120:123], a[8:11]
    v_mfma_f32_16x16x32_bf16 a[12:15], v[164:167], v[124:127], a[12:15]
    v_add_f32 v216, v216, v72
    v_mfma_f32_16x16x32_bf16 a[16:19], v[164:167], v[128:131], a[16:19]
    v_add_f32 v217, v217, v76
    v_mfma_f32_16x16x32_bf16 a[20:23], v[168:171], v[112:115], a[20:23]
    v_add_f32 v218, v218, v80
    v_mfma_f32_16x16x32_bf16 a[24:27], v[168:171], v[116:119], a[24:27]
    v_add_f32 v219, v219, v84
    v_mfma_f32_16x16x32_bf16 a[28:31], v[168:171], v[120:123], a[28:31]
    v_add_f32 v220, v220, v88
    v_mfma_f32_16x16x32_bf16 a[32:35], v[168:171], v[124:127], a[32:35]
    v_add_f32 v216, v216, v73
    v_mfma_f32_16x16x32_bf16 a[36:39], v[168:171], v[128:131], a[36:39]
    v_add_f32 v217, v217, v77
    v_mfma_f32_16x16x32_bf16 a[40:43], v[172:175], v[112:115], a[40:43]
    v_add_f32 v218, v218, v81
    v_mfma_f32_16x16x32_bf16 a[44:47], v[172:175], v[116:119], a[44:47]
    v_add_f32 v219, v219, v85
    v_mfma_f32_16x16x32_bf16 a[48:51], v[172:175], v[120:123], a[48:51]
    v_add_f32 v220, v220, v89
    v_mfma_f32_16x16x32_bf16 a[52:55], v[172:175], v[124:127], a[52:55]
    v_add_f32 v216, v216, v74
    v_mfma_f32_16x16x32_bf16 a[56:59], v[172:175], v[128:131], a[56:59]
    v_add_f32 v217, v217, v78
    v_mfma_f32_16x16x32_bf16 a[60:63], v[176:179], v[112:115], a[60:63]
    v_add_f32 v218, v218, v82
    v_add_f32 v219, v219, v86
    v_mfma_f32_16x16x32_bf16 a[64:67], v[176:179], v[116:119], a[64:67]
    v_add_f32 v220, v220, v90
    v_mfma_f32_16x16x32_bf16 a[68:71], v[176:179], v[120:123], a[68:71]
    v_add_f32 v216, v216, v75
    v_mfma_f32_16x16x32_bf16 a[72:75], v[176:179], v[124:127], a[72:75]
    v_add_f32 v217, v217, v79
    v_mfma_f32_16x16x32_bf16 a[76:79], v[176:179], v[128:131], a[76:79]
    v_add_f32 v218, v218, v83
    v_mfma_f32_16x16x32_bf16 a[80:83], v[180:183], v[112:115], a[80:83]
    v_add_f32 v219, v219, v87
    v_mfma_f32_16x16x32_bf16 a[84:87], v[180:183], v[116:119], a[84:87]
    v_add_f32 v220, v220, v91
    v_mfma_f32_16x16x32_bf16 a[88:91], v[180:183], v[120:123], a[88:91]
    v_add_f32 v216, v216, v92
    v_mfma_f32_16x16x32_bf16 a[92:95], v[180:183], v[124:127], a[92:95]
    v_add_f32 v217, v217, v96
    v_mfma_f32_16x16x32_bf16 a[96:99], v[180:183], v[128:131], a[96:99]
    v_add_f32 v218, v218, v100
    v_mfma_f32_16x16x32_bf16 a[100:103], v[184:187], v[112:115], a[100:103]
    v_add_f32 v219, v219, v104
    v_mfma_f32_16x16x32_bf16 a[104:107], v[184:187], v[116:119], a[104:107]
    v_add_f32 v220, v220, v108
    v_mfma_f32_16x16x32_bf16 a[108:111], v[184:187], v[120:123], a[108:111]
    v_add_f32 v216, v216, v93
    v_add_f32 v217, v217, v97
    v_mfma_f32_16x16x32_bf16 a[112:115], v[184:187], v[124:127], a[112:115]
    v_add_f32 v218, v218, v101
    v_mfma_f32_16x16x32_bf16 a[116:119], v[184:187], v[128:131], a[116:119]
    v_add_f32 v219, v219, v105
    v_mfma_f32_16x16x32_bf16 a[120:123], v[188:191], v[112:115], a[120:123]
    v_add_f32 v220, v220, v109
    v_mfma_f32_16x16x32_bf16 a[124:127], v[188:191], v[116:119], a[124:127]
    v_add_f32 v216, v216, v94
    v_mfma_f32_16x16x32_bf16 a[128:131], v[188:191], v[120:123], a[128:131]
    v_add_f32 v217, v217, v98
    v_mfma_f32_16x16x32_bf16 a[132:135], v[188:191], v[124:127], a[132:135]
    v_add_f32 v218, v218, v102
    v_mfma_f32_16x16x32_bf16 a[136:139], v[188:191], v[128:131], a[136:139]
    v_add_f32 v219, v219, v106
    v_mfma_f32_16x16x32_bf16 a[140:143], v[192:195], v[112:115], a[140:143]
    v_add_f32 v220, v220, v110
    v_mfma_f32_16x16x32_bf16 a[144:147], v[192:195], v[116:119], a[144:147]
    v_add_f32 v216, v216, v95
    v_mfma_f32_16x16x32_bf16 a[148:151], v[192:195], v[120:123], a[148:151]
    v_add_f32 v217, v217, v99
    v_mfma_f32_16x16x32_bf16 a[152:155], v[192:195], v[124:127], a[152:155]
    v_add_f32 v218, v218, v103
    v_mfma_f32_16x16x32_bf16 a[156:159], v[192:195], v[128:131], a[156:159]
    v_add_f32 v219, v219, v107
    v_add_f32 v220, v220, v111
    s_nop 7
    v_mov_b32 v228, v216
    s_nop 1
    v_permlane32_swap_b32 v216, v228
    s_nop 1
    v_add_f32 v216, v216, v228
    v_mov_b32 v228, v216
    s_nop 1
    v_permlane16_swap_b32 v216, v228
    s_nop 1
    v_add_f32 v216, v216, v228
    v_mov_b32 v228, v217
    s_nop 1
    v_permlane32_swap_b32 v217, v228
    s_nop 1
    v_add_f32 v217, v217, v228
    v_mov_b32 v228, v217
    s_nop 1
    v_permlane16_swap_b32 v217, v228
    s_nop 1
    v_add_f32 v217, v217, v228
    v_mov_b32 v228, v218
    s_nop 1
    v_permlane32_swap_b32 v218, v228
    s_nop 1
    v_add_f32 v218, v218, v228
    v_mov_b32 v228, v218
    s_nop 1
    v_permlane16_swap_b32 v218, v228
    s_nop 1
    v_add_f32 v218, v218, v228
    v_mov_b32 v228, v219
    s_nop 1
    v_permlane32_swap_b32 v219, v228
    s_nop 1
    v_add_f32 v219, v219, v228
    v_mov_b32 v228, v219
    s_nop 1
    v_permlane16_swap_b32 v219, v228
    s_nop 1
    v_add_f32 v219, v219, v228
    v_mov_b32 v228, v220
    s_nop 1
    v_permlane32_swap_b32 v220, v228
    s_nop 1
    v_add_f32 v220, v220, v228
    v_mov_b32 v228, v220
    s_nop 1
    v_permlane16_swap_b32 v220, v228
    s_nop 1
    v_add_f32 v220, v220, v228
    s_waitcnt vmcnt(0) lgkmcnt(0)
    s_barrier
    s_mul_i32 s47, s40, 45056
    v_lshlrev_b32 v20, 4, v1
    v_add_u32 v20, s47, v20
    v_lshlrev_b32 v21, 2, v1
    v_add_u32 v21, s47, v21

    s_cmp_eq_u32 s41, 0
    s_cbranch_scc1 k1_kernel_L37
    v_accvgpr_read_b32 v32, a0
    v_accvgpr_read_b32 v33, a1
    v_accvgpr_read_b32 v34, a2
    v_accvgpr_read_b32 v35, a3
    s_nop 0
    ds_write_b128 v20, v[32:35] offset:0
    v_accvgpr_read_b32 v36, a4
    v_accvgpr_read_b32 v37, a5
    v_accvgpr_read_b32 v38, a6
    v_accvgpr_read_b32 v39, a7
    s_nop 0
    ds_write_b128 v20, v[36:39] offset:1024
    v_accvgpr_read_b32 v40, a8
    v_accvgpr_read_b32 v41, a9
    v_accvgpr_read_b32 v42, a10
    v_accvgpr_read_b32 v43, a11
    s_nop 0
    ds_write_b128 v20, v[40:43] offset:2048
    v_accvgpr_read_b32 v44, a12
    v_accvgpr_read_b32 v45, a13
    v_accvgpr_read_b32 v46, a14
    v_accvgpr_read_b32 v47, a15
    s_nop 0
    ds_write_b128 v20, v[44:47] offset:3072
    v_accvgpr_read_b32 v48, a16
    v_accvgpr_read_b32 v49, a17
    v_accvgpr_read_b32 v50, a18
    v_accvgpr_read_b32 v51, a19
    s_nop 0
    ds_write_b128 v20, v[48:51] offset:4096
    v_accvgpr_read_b32 v52, a20
    v_accvgpr_read_b32 v53, a21
    v_accvgpr_read_b32 v54, a22
    v_accvgpr_read_b32 v55, a23
    s_nop 0
    ds_write_b128 v20, v[52:55] offset:5120
    v_accvgpr_read_b32 v56, a24
    v_accvgpr_read_b32 v57, a25
    v_accvgpr_read_b32 v58, a26
    v_accvgpr_read_b32 v59, a27
    s_nop 0
    ds_write_b128 v20, v[56:59] offset:6144
    v_accvgpr_read_b32 v60, a28
    v_accvgpr_read_b32 v61, a29
    v_accvgpr_read_b32 v62, a30
    v_accvgpr_read_b32 v63, a31
    s_nop 0
    ds_write_b128 v20, v[60:63] offset:7168
    v_accvgpr_read_b32 v32, a32
    v_accvgpr_read_b32 v33, a33
    v_accvgpr_read_b32 v34, a34
    v_accvgpr_read_b32 v35, a35
    s_nop 0
    ds_write_b128 v20, v[32:35] offset:8192
    v_accvgpr_read_b32 v36, a36
    v_accvgpr_read_b32 v37, a37
    v_accvgpr_read_b32 v38, a38
    v_accvgpr_read_b32 v39, a39
    s_nop 0
    ds_write_b128 v20, v[36:39] offset:9216
    v_accvgpr_read_b32 v40, a40
    v_accvgpr_read_b32 v41, a41
    v_accvgpr_read_b32 v42, a42
    v_accvgpr_read_b32 v43, a43
    s_nop 0
    ds_write_b128 v20, v[40:43] offset:10240
    v_accvgpr_read_b32 v44, a44
    v_accvgpr_read_b32 v45, a45
    v_accvgpr_read_b32 v46, a46
    v_accvgpr_read_b32 v47, a47
    s_nop 0
    ds_write_b128 v20, v[44:47] offset:11264
    v_accvgpr_read_b32 v48, a48
    v_accvgpr_read_b32 v49, a49
    v_accvgpr_read_b32 v50, a50
    v_accvgpr_read_b32 v51, a51
    s_nop 0
    ds_write_b128 v20, v[48:51] offset:12288
    v_accvgpr_read_b32 v52, a52
    v_accvgpr_read_b32 v53, a53
    v_accvgpr_read_b32 v54, a54
    v_accvgpr_read_b32 v55, a55
    s_nop 0
    ds_write_b128 v20, v[52:55] offset:13312
    v_accvgpr_read_b32 v56, a56
    v_accvgpr_read_b32 v57, a57
    v_accvgpr_read_b32 v58, a58
    v_accvgpr_read_b32 v59, a59
    s_nop 0
    ds_write_b128 v20, v[56:59] offset:14336
    v_accvgpr_read_b32 v60, a60
    v_accvgpr_read_b32 v61, a61
    v_accvgpr_read_b32 v62, a62
    v_accvgpr_read_b32 v63, a63
    s_nop 0
    ds_write_b128 v20, v[60:63] offset:15360
    v_accvgpr_read_b32 v32, a64
    v_accvgpr_read_b32 v33, a65
    v_accvgpr_read_b32 v34, a66
    v_accvgpr_read_b32 v35, a67
    s_nop 0
    ds_write_b128 v20, v[32:35] offset:16384
    v_accvgpr_read_b32 v36, a68
    v_accvgpr_read_b32 v37, a69
    v_accvgpr_read_b32 v38, a70
    v_accvgpr_read_b32 v39, a71
    s_nop 0
    ds_write_b128 v20, v[36:39] offset:17408
    v_accvgpr_read_b32 v40, a72
    v_accvgpr_read_b32 v41, a73
    v_accvgpr_read_b32 v42, a74
    v_accvgpr_read_b32 v43, a75
    s_nop 0
    ds_write_b128 v20, v[40:43] offset:18432
    v_accvgpr_read_b32 v44, a76
    v_accvgpr_read_b32 v45, a77
    v_accvgpr_read_b32 v46, a78
    v_accvgpr_read_b32 v47, a79
    s_nop 0
    ds_write_b128 v20, v[44:47] offset:19456
    v_accvgpr_read_b32 v48, a80
    v_accvgpr_read_b32 v49, a81
    v_accvgpr_read_b32 v50, a82
    v_accvgpr_read_b32 v51, a83
    s_nop 0
    ds_write_b128 v20, v[48:51] offset:20480
    v_accvgpr_read_b32 v52, a84
    v_accvgpr_read_b32 v53, a85
    v_accvgpr_read_b32 v54, a86
    v_accvgpr_read_b32 v55, a87
    s_nop 0
    ds_write_b128 v20, v[52:55] offset:21504
    v_accvgpr_read_b32 v56, a88
    v_accvgpr_read_b32 v57, a89
    v_accvgpr_read_b32 v58, a90
    v_accvgpr_read_b32 v59, a91
    s_nop 0
    ds_write_b128 v20, v[56:59] offset:22528
    v_accvgpr_read_b32 v60, a92
    v_accvgpr_read_b32 v61, a93
    v_accvgpr_read_b32 v62, a94
    v_accvgpr_read_b32 v63, a95
    s_nop 0
    ds_write_b128 v20, v[60:63] offset:23552
    v_accvgpr_read_b32 v32, a96
    v_accvgpr_read_b32 v33, a97
    v_accvgpr_read_b32 v34, a98
    v_accvgpr_read_b32 v35, a99
    s_nop 0
    ds_write_b128 v20, v[32:35] offset:24576
    v_accvgpr_read_b32 v36, a100
    v_accvgpr_read_b32 v37, a101
    v_accvgpr_read_b32 v38, a102
    v_accvgpr_read_b32 v39, a103
    s_nop 0
    ds_write_b128 v20, v[36:39] offset:25600
    v_accvgpr_read_b32 v40, a104
    v_accvgpr_read_b32 v41, a105
    v_accvgpr_read_b32 v42, a106
    v_accvgpr_read_b32 v43, a107
    s_nop 0
    ds_write_b128 v20, v[40:43] offset:26624
    v_accvgpr_read_b32 v44, a108
    v_accvgpr_read_b32 v45, a109
    v_accvgpr_read_b32 v46, a110
    v_accvgpr_read_b32 v47, a111
    s_nop 0
    ds_write_b128 v20, v[44:47] offset:27648
    v_accvgpr_read_b32 v48, a112
    v_accvgpr_read_b32 v49, a113
    v_accvgpr_read_b32 v50, a114
    v_accvgpr_read_b32 v51, a115
    s_nop 0
    ds_write_b128 v20, v[48:51] offset:28672
    v_accvgpr_read_b32 v52, a116
    v_accvgpr_read_b32 v53, a117
    v_accvgpr_read_b32 v54, a118
    v_accvgpr_read_b32 v55, a119
    s_nop 0
    ds_write_b128 v20, v[52:55] offset:29696
    v_accvgpr_read_b32 v56, a120
    v_accvgpr_read_b32 v57, a121
    v_accvgpr_read_b32 v58, a122
    v_accvgpr_read_b32 v59, a123
    s_nop 0
    ds_write_b128 v20, v[56:59] offset:30720
    v_accvgpr_read_b32 v60, a124
    v_accvgpr_read_b32 v61, a125
    v_accvgpr_read_b32 v62, a126
    v_accvgpr_read_b32 v63, a127
    s_nop 0
    ds_write_b128 v20, v[60:63] offset:31744
    v_accvgpr_read_b32 v32, a128
    v_accvgpr_read_b32 v33, a129
    v_accvgpr_read_b32 v34, a130
    v_accvgpr_read_b32 v35, a131
    s_nop 0
    ds_write_b128 v20, v[32:35] offset:32768
    v_accvgpr_read_b32 v36, a132
    v_accvgpr_read_b32 v37, a133
    v_accvgpr_read_b32 v38, a134
    v_accvgpr_read_b32 v39, a135
    s_nop 0
    ds_write_b128 v20, v[36:39] offset:33792
    v_accvgpr_read_b32 v40, a136
    v_accvgpr_read_b32 v41, a137
    v_accvgpr_read_b32 v42, a138
    v_accvgpr_read_b32 v43, a139
    s_nop 0
    ds_write_b128 v20, v[40:43] offset:34816
    v_accvgpr_read_b32 v44, a140
    v_accvgpr_read_b32 v45, a141
    v_accvgpr_read_b32 v46, a142
    v_accvgpr_read_b32 v47, a143
    s_nop 0
    ds_write_b128 v20, v[44:47] offset:35840
    v_accvgpr_read_b32 v48, a144
    v_accvgpr_read_b32 v49, a145
    v_accvgpr_read_b32 v50, a146
    v_accvgpr_read_b32 v51, a147
    s_nop 0
    ds_write_b128 v20, v[48:51] offset:36864
    v_accvgpr_read_b32 v52, a148
    v_accvgpr_read_b32 v53, a149
    v_accvgpr_read_b32 v54, a150
    v_accvgpr_read_b32 v55, a151
    s_nop 0
    ds_write_b128 v20, v[52:55] offset:37888
    v_accvgpr_read_b32 v56, a152
    v_accvgpr_read_b32 v57, a153
    v_accvgpr_read_b32 v58, a154
    v_accvgpr_read_b32 v59, a155
    s_nop 0
    ds_write_b128 v20, v[56:59] offset:38912
    v_accvgpr_read_b32 v60, a156
    v_accvgpr_read_b32 v61, a157
    v_accvgpr_read_b32 v62, a158
    v_accvgpr_read_b32 v63, a159
    s_nop 0
    ds_write_b128 v20, v[60:63] offset:39936
    ds_write_b32 v21, v221 offset:40960
    ds_write_b32 v21, v216 offset:42240
    ds_write_b32 v21, v222 offset:41216
    ds_write_b32 v21, v217 offset:42496
    ds_write_b32 v21, v223 offset:41472
    ds_write_b32 v21, v218 offset:42752
    ds_write_b32 v21, v224 offset:41728
    ds_write_b32 v21, v219 offset:43008
    ds_write_b32 v21, v225 offset:41984
    ds_write_b32 v21, v220 offset:43264
    s_waitcnt lgkmcnt(0)
k1_kernel_L37:
    s_barrier
    s_cmp_eq_u32 s41, 1
    s_cbranch_scc1 k1_kernel_L38
    ds_read_b32 v32, v21 offset:40960
    ds_read_b32 v40, v21 offset:42240
    ds_read_b32 v33, v21 offset:41216
    ds_read_b32 v41, v21 offset:42496
    ds_read_b32 v34, v21 offset:41472
    ds_read_b32 v42, v21 offset:42752
    ds_read_b32 v35, v21 offset:41728
    ds_read_b32 v43, v21 offset:43008
    ds_read_b32 v36, v21 offset:41984
    ds_read_b32 v44, v21 offset:43264
    s_waitcnt lgkmcnt(0)
    v_max_f32 v48, v221, v32
    v_sub_f32 v49, v221, v48
    v_sub_f32 v50, v32, v48
    v_exp_f32 v49, v49
    v_exp_f32 v50, v50
    s_nop 0
    v_mul_f32 v51, v49, v216
    v_fma_f32 v51, v50, v40, v51
    v_rcp_f32 v51, v51
    s_nop 0
    v_mul_f32 v52, v49, v51
    v_mul_f32 v60, v50, v51
    v_max_f32 v48, v222, v33
    v_sub_f32 v49, v222, v48
    v_sub_f32 v50, v33, v48
    v_exp_f32 v49, v49
    v_exp_f32 v50, v50
    s_nop 0
    v_mul_f32 v51, v49, v217
    v_fma_f32 v51, v50, v41, v51
    v_rcp_f32 v51, v51
    s_nop 0
    v_mul_f32 v53, v49, v51
    v_mul_f32 v61, v50, v51
    v_max_f32 v48, v223, v34
    v_sub_f32 v49, v223, v48
    v_sub_f32 v50, v34, v48
    v_exp_f32 v49, v49
    v_exp_f32 v50, v50
    s_nop 0
    v_mul_f32 v51, v49, v218
    v_fma_f32 v51, v50, v42, v51
    v_rcp_f32 v51, v51
    s_nop 0
    v_mul_f32 v54, v49, v51
    v_mul_f32 v62, v50, v51
    v_max_f32 v48, v224, v35
    v_sub_f32 v49, v224, v48
    v_sub_f32 v50, v35, v48
    v_exp_f32 v49, v49
    v_exp_f32 v50, v50
    s_nop 0
    v_mul_f32 v51, v49, v219
    v_fma_f32 v51, v50, v43, v51
    v_rcp_f32 v51, v51
    s_nop 0
    v_mul_f32 v55, v49, v51
    v_mul_f32 v63, v50, v51
    v_max_f32 v48, v225, v36
    v_sub_f32 v49, v225, v48
    v_sub_f32 v50, v36, v48
    v_exp_f32 v49, v49
    v_exp_f32 v50, v50
    s_nop 0
    v_mul_f32 v51, v49, v220
    v_fma_f32 v51, v50, v44, v51
    v_rcp_f32 v51, v51
    s_nop 0
    v_mul_f32 v56, v49, v51
    v_mul_f32 v64, v50, v51
    v_mov_b32 v22, 528
    v_mul_lo_u32 v22, v3, v22
    v_lshlrev_b32 v23, 4, v2
    v_add_u32 v22, v22, v23
    s_lshl_b32 s47, s40, 8
    s_add_u32 s47, s47, 98304
    v_add_u32 v22, s47, v22

    ds_read_b128 v[72:75], v20 offset:0
    ds_read_b128 v[76:79], v20 offset:1024
    ds_read_b128 v[80:83], v20 offset:2048
    ds_read_b128 v[84:87], v20 offset:3072
    ds_read_b128 v[88:91], v20 offset:4096
    ds_read_b128 v[92:95], v20 offset:5120
    ds_read_b128 v[96:99], v20 offset:6144
    ds_read_b128 v[100:103], v20 offset:7168
    ds_read_b128 v[104:107], v20 offset:8192
    ds_read_b128 v[108:111], v20 offset:9216
    v_accvgpr_read_b32 v116, a0
    v_accvgpr_read_b32 v117, a1
    v_accvgpr_read_b32 v118, a2
    v_accvgpr_read_b32 v119, a3
    s_waitcnt lgkmcnt(9)
    v_mul_f32 v116, v116, v52
    v_mul_f32 v117, v117, v52
    v_mul_f32 v118, v118, v52
    v_mul_f32 v119, v119, v52
    v_fma_f32 v116, v72, v60, v116
    v_fma_f32 v117, v73, v60, v117
    v_fma_f32 v118, v74, v60, v118
    v_fma_f32 v119, v75, v60, v119
    v_cvt_pk_bf16_f32 v120, v116, v117
    v_cvt_pk_bf16_f32 v121, v118, v119
    ds_write_b64 v22, v[120:121] offset:0
    ds_read_b128 v[72:75], v20 offset:10240
    v_accvgpr_read_b32 v122, a4
    v_accvgpr_read_b32 v123, a5
    v_accvgpr_read_b32 v124, a6
    v_accvgpr_read_b32 v125, a7
    s_waitcnt lgkmcnt(9)
    v_mul_f32 v122, v122, v53
    v_mul_f32 v123, v123, v53
    v_mul_f32 v124, v124, v53
    v_mul_f32 v125, v125, v53
    v_fma_f32 v122, v76, v61, v122
    v_fma_f32 v123, v77, v61, v123
    v_fma_f32 v124, v78, v61, v124
    v_fma_f32 v125, v79, v61, v125
    v_cvt_pk_bf16_f32 v126, v122, v123
    v_cvt_pk_bf16_f32 v127, v124, v125
    ds_write_b64 v22, v[126:127] offset:8448
    ds_read_b128 v[76:79], v20 offset:11264
    v_accvgpr_read_b32 v128, a8
    v_accvgpr_read_b32 v129, a9
    v_accvgpr_read_b32 v130, a10
    v_accvgpr_read_b32 v131, a11
    s_waitcnt lgkmcnt(9)
    v_mul_f32 v128, v128, v54
    v_mul_f32 v129, v129, v54
    v_mul_f32 v130, v130, v54
    v_mul_f32 v131, v131, v54
    v_fma_f32 v128, v80, v62, v128
    v_fma_f32 v129, v81, v62, v129
    v_fma_f32 v130, v82, v62, v130
    v_fma_f32 v131, v83, v62, v131
    v_cvt_pk_bf16_f32 v132, v128, v129
    v_cvt_pk_bf16_f32 v133, v130, v131
    ds_write_b64 v22, v[132:133] offset:16896
    ds_read_b128 v[80:83], v20 offset:12288
    v_accvgpr_read_b32 v134, a12
    v_accvgpr_read_b32 v135, a13
    v_accvgpr_read_b32 v136, a14
    v_accvgpr_read_b32 v137, a15
    s_waitcnt lgkmcnt(9)
    v_mul_f32 v134, v134, v55
    v_mul_f32 v135, v135, v55
    v_mul_f32 v136, v136, v55
    v_mul_f32 v137, v137, v55
    v_fma_f32 v134, v84, v63, v134
    v_fma_f32 v135, v85, v63, v135
    v_fma_f32 v136, v86, v63, v136
    v_fma_f32 v137, v87, v63, v137
    v_cvt_pk_bf16_f32 v138, v134, v135
    v_cvt_pk_bf16_f32 v139, v136, v137
    ds_write_b64 v22, v[138:139] offset:25344
    ds_read_b128 v[84:87], v20 offset:13312
    v_accvgpr_read_b32 v116, a16
    v_accvgpr_read_b32 v117, a17
    v_accvgpr_read_b32 v118, a18
    v_accvgpr_read_b32 v119, a19
    s_waitcnt lgkmcnt(9)
    v_mul_f32 v116, v116, v56
    v_mul_f32 v117, v117, v56
    v_mul_f32 v118, v118, v56
    v_mul_f32 v119, v119, v56
    v_fma_f32 v116, v88, v64, v116
    v_fma_f32 v117, v89, v64, v117
    v_fma_f32 v118, v90, v64, v118
    v_fma_f32 v119, v91, v64, v119
    v_cvt_pk_bf16_f32 v120, v116, v117
    v_cvt_pk_bf16_f32 v121, v118, v119
    ds_write_b64 v22, v[120:121] offset:33792
    ds_read_b128 v[88:91], v20 offset:14336
    v_accvgpr_read_b32 v122, a20
    v_accvgpr_read_b32 v123, a21
    v_accvgpr_read_b32 v124, a22
    v_accvgpr_read_b32 v125, a23
    s_waitcnt lgkmcnt(9)
    v_mul_f32 v122, v122, v52
    v_mul_f32 v123, v123, v52
    v_mul_f32 v124, v124, v52
    v_mul_f32 v125, v125, v52
    v_fma_f32 v122, v92, v60, v122
    v_fma_f32 v123, v93, v60, v123
    v_fma_f32 v124, v94, v60, v124
    v_fma_f32 v125, v95, v60, v125
    v_cvt_pk_bf16_f32 v126, v122, v123
    v_cvt_pk_bf16_f32 v127, v124, v125
    ds_write_b64 v22, v[126:127] offset:8
    ds_read_b128 v[92:95], v20 offset:15360
    v_accvgpr_read_b32 v128, a24
    v_accvgpr_read_b32 v129, a25
    v_accvgpr_read_b32 v130, a26
    v_accvgpr_read_b32 v131, a27
    s_waitcnt lgkmcnt(9)
    v_mul_f32 v128, v128, v53
    v_mul_f32 v129, v129, v53
    v_mul_f32 v130, v130, v53
    v_mul_f32 v131, v131, v53
    v_fma_f32 v128, v96, v61, v128
    v_fma_f32 v129, v97, v61, v129
    v_fma_f32 v130, v98, v61, v130
    v_fma_f32 v131, v99, v61, v131
    v_cvt_pk_bf16_f32 v132, v128, v129
    v_cvt_pk_bf16_f32 v133, v130, v131
    ds_write_b64 v22, v[132:133] offset:8456
    ds_read_b128 v[96:99], v20 offset:16384
    v_accvgpr_read_b32 v134, a28
    v_accvgpr_read_b32 v135, a29
    v_accvgpr_read_b32 v136, a30
    v_accvgpr_read_b32 v137, a31
    s_waitcnt lgkmcnt(9)
    v_mul_f32 v134, v134, v54
    v_mul_f32 v135, v135, v54
    v_mul_f32 v136, v136, v54
    v_mul_f32 v137, v137, v54
    v_fma_f32 v134, v100, v62, v134
    v_fma_f32 v135, v101, v62, v135
    v_fma_f32 v136, v102, v62, v136
    v_fma_f32 v137, v103, v62, v137
    v_cvt_pk_bf16_f32 v138, v134, v135
    v_cvt_pk_bf16_f32 v139, v136, v137
    ds_write_b64 v22, v[138:139] offset:16904
    ds_read_b128 v[100:103], v20 offset:17408
    v_accvgpr_read_b32 v116, a32
    v_accvgpr_read_b32 v117, a33
    v_accvgpr_read_b32 v118, a34
    v_accvgpr_read_b32 v119, a35
    s_waitcnt lgkmcnt(9)
    v_mul_f32 v116, v116, v55
    v_mul_f32 v117, v117, v55
    v_mul_f32 v118, v118, v55
    v_mul_f32 v119, v119, v55
    v_fma_f32 v116, v104, v63, v116
    v_fma_f32 v117, v105, v63, v117
    v_fma_f32 v118, v106, v63, v118
    v_fma_f32 v119, v107, v63, v119
    v_cvt_pk_bf16_f32 v120, v116, v117
    v_cvt_pk_bf16_f32 v121, v118, v119
    ds_write_b64 v22, v[120:121] offset:25352
    ds_read_b128 v[104:107], v20 offset:18432
    v_accvgpr_read_b32 v122, a36
    v_accvgpr_read_b32 v123, a37
    v_accvgpr_read_b32 v124, a38
    v_accvgpr_read_b32 v125, a39
    s_waitcnt lgkmcnt(9)
    v_mul_f32 v122, v122, v56
    v_mul_f32 v123, v123, v56
    v_mul_f32 v124, v124, v56
    v_mul_f32 v125, v125, v56
    v_fma_f32 v122, v108, v64, v122
    v_fma_f32 v123, v109, v64, v123
    v_fma_f32 v124, v110, v64, v124
    v_fma_f32 v125, v111, v64, v125
    v_cvt_pk_bf16_f32 v126, v122, v123
    v_cvt_pk_bf16_f32 v127, v124, v125
    ds_write_b64 v22, v[126:127] offset:33800
    ds_read_b128 v[108:111], v20 offset:19456
    v_accvgpr_read_b32 v128, a40
    v_accvgpr_read_b32 v129, a41
    v_accvgpr_read_b32 v130, a42
    v_accvgpr_read_b32 v131, a43
    s_waitcnt lgkmcnt(9)
    v_mul_f32 v128, v128, v52
    v_mul_f32 v129, v129, v52
    v_mul_f32 v130, v130, v52
    v_mul_f32 v131, v131, v52
    v_fma_f32 v128, v72, v60, v128
    v_fma_f32 v129, v73, v60, v129
    v_fma_f32 v130, v74, v60, v130
    v_fma_f32 v131, v75, v60, v131
    v_cvt_pk_bf16_f32 v132, v128, v129
    v_cvt_pk_bf16_f32 v133, v130, v131
    ds_write_b64 v22, v[132:133] offset:64
    ds_read_b128 v[72:75], v20 offset:20480
    v_accvgpr_read_b32 v134, a44
    v_accvgpr_read_b32 v135, a45
    v_accvgpr_read_b32 v136, a46
    v_accvgpr_read_b32 v137, a47
    s_waitcnt lgkmcnt(9)
    v_mul_f32 v134, v134, v53
    v_mul_f32 v135, v135, v53
    v_mul_f32 v136, v136, v53
    v_mul_f32 v137, v137, v53
    v_fma_f32 v134, v76, v61, v134
    v_fma_f32 v135, v77, v61, v135
    v_fma_f32 v136, v78, v61, v136
    v_fma_f32 v137, v79, v61, v137
    v_cvt_pk_bf16_f32 v138, v134, v135
    v_cvt_pk_bf16_f32 v139, v136, v137
    ds_write_b64 v22, v[138:139] offset:8512
    ds_read_b128 v[76:79], v20 offset:21504
    v_accvgpr_read_b32 v116, a48
    v_accvgpr_read_b32 v117, a49
    v_accvgpr_read_b32 v118, a50
    v_accvgpr_read_b32 v119, a51
    s_waitcnt lgkmcnt(9)
    v_mul_f32 v116, v116, v54
    v_mul_f32 v117, v117, v54
    v_mul_f32 v118, v118, v54
    v_mul_f32 v119, v119, v54
    v_fma_f32 v116, v80, v62, v116
    v_fma_f32 v117, v81, v62, v117
    v_fma_f32 v118, v82, v62, v118
    v_fma_f32 v119, v83, v62, v119
    v_cvt_pk_bf16_f32 v120, v116, v117
    v_cvt_pk_bf16_f32 v121, v118, v119
    ds_write_b64 v22, v[120:121] offset:16960
    ds_read_b128 v[80:83], v20 offset:22528
    v_accvgpr_read_b32 v122, a52
    v_accvgpr_read_b32 v123, a53
    v_accvgpr_read_b32 v124, a54
    v_accvgpr_read_b32 v125, a55
    s_waitcnt lgkmcnt(9)
    v_mul_f32 v122, v122, v55
    v_mul_f32 v123, v123, v55
    v_mul_f32 v124, v124, v55
    v_mul_f32 v125, v125, v55
    v_fma_f32 v122, v84, v63, v122
    v_fma_f32 v123, v85, v63, v123
    v_fma_f32 v124, v86, v63, v124
    v_fma_f32 v125, v87, v63, v125
    v_cvt_pk_bf16_f32 v126, v122, v123
    v_cvt_pk_bf16_f32 v127, v124, v125
    ds_write_b64 v22, v[126:127] offset:25408
    ds_read_b128 v[84:87], v20 offset:23552
    v_accvgpr_read_b32 v128, a56
    v_accvgpr_read_b32 v129, a57
    v_accvgpr_read_b32 v130, a58
    v_accvgpr_read_b32 v131, a59
    s_waitcnt lgkmcnt(9)
    v_mul_f32 v128, v128, v56
    v_mul_f32 v129, v129, v56
    v_mul_f32 v130, v130, v56
    v_mul_f32 v131, v131, v56
    v_fma_f32 v128, v88, v64, v128
    v_fma_f32 v129, v89, v64, v129
    v_fma_f32 v130, v90, v64, v130
    v_fma_f32 v131, v91, v64, v131
    v_cvt_pk_bf16_f32 v132, v128, v129
    v_cvt_pk_bf16_f32 v133, v130, v131
    ds_write_b64 v22, v[132:133] offset:33856
    ds_read_b128 v[88:91], v20 offset:24576
    v_accvgpr_read_b32 v134, a60
    v_accvgpr_read_b32 v135, a61
    v_accvgpr_read_b32 v136, a62
    v_accvgpr_read_b32 v137, a63
    s_waitcnt lgkmcnt(9)
    v_mul_f32 v134, v134, v52
    v_mul_f32 v135, v135, v52
    v_mul_f32 v136, v136, v52
    v_mul_f32 v137, v137, v52
    v_fma_f32 v134, v92, v60, v134
    v_fma_f32 v135, v93, v60, v135
    v_fma_f32 v136, v94, v60, v136
    v_fma_f32 v137, v95, v60, v137
    v_cvt_pk_bf16_f32 v138, v134, v135
    v_cvt_pk_bf16_f32 v139, v136, v137
    ds_write_b64 v22, v[138:139] offset:72
    ds_read_b128 v[92:95], v20 offset:25600
    v_accvgpr_read_b32 v116, a64
    v_accvgpr_read_b32 v117, a65
    v_accvgpr_read_b32 v118, a66
    v_accvgpr_read_b32 v119, a67
    s_waitcnt lgkmcnt(9)
    v_mul_f32 v116, v116, v53
    v_mul_f32 v117, v117, v53
    v_mul_f32 v118, v118, v53
    v_mul_f32 v119, v119, v53
    v_fma_f32 v116, v96, v61, v116
    v_fma_f32 v117, v97, v61, v117
    v_fma_f32 v118, v98, v61, v118
    v_fma_f32 v119, v99, v61, v119
    v_cvt_pk_bf16_f32 v120, v116, v117
    v_cvt_pk_bf16_f32 v121, v118, v119
    ds_write_b64 v22, v[120:121] offset:8520
    ds_read_b128 v[96:99], v20 offset:26624
    v_accvgpr_read_b32 v122, a68
    v_accvgpr_read_b32 v123, a69
    v_accvgpr_read_b32 v124, a70
    v_accvgpr_read_b32 v125, a71
    s_waitcnt lgkmcnt(9)
    v_mul_f32 v122, v122, v54
    v_mul_f32 v123, v123, v54
    v_mul_f32 v124, v124, v54
    v_mul_f32 v125, v125, v54
    v_fma_f32 v122, v100, v62, v122
    v_fma_f32 v123, v101, v62, v123
    v_fma_f32 v124, v102, v62, v124
    v_fma_f32 v125, v103, v62, v125
    v_cvt_pk_bf16_f32 v126, v122, v123
    v_cvt_pk_bf16_f32 v127, v124, v125
    ds_write_b64 v22, v[126:127] offset:16968
    ds_read_b128 v[100:103], v20 offset:27648
    v_accvgpr_read_b32 v128, a72
    v_accvgpr_read_b32 v129, a73
    v_accvgpr_read_b32 v130, a74
    v_accvgpr_read_b32 v131, a75
    s_waitcnt lgkmcnt(9)
    v_mul_f32 v128, v128, v55
    v_mul_f32 v129, v129, v55
    v_mul_f32 v130, v130, v55
    v_mul_f32 v131, v131, v55
    v_fma_f32 v128, v104, v63, v128
    v_fma_f32 v129, v105, v63, v129
    v_fma_f32 v130, v106, v63, v130
    v_fma_f32 v131, v107, v63, v131
    v_cvt_pk_bf16_f32 v132, v128, v129
    v_cvt_pk_bf16_f32 v133, v130, v131
    ds_write_b64 v22, v[132:133] offset:25416
    ds_read_b128 v[104:107], v20 offset:28672
    v_accvgpr_read_b32 v134, a76
    v_accvgpr_read_b32 v135, a77
    v_accvgpr_read_b32 v136, a78
    v_accvgpr_read_b32 v137, a79
    s_waitcnt lgkmcnt(9)
    v_mul_f32 v134, v134, v56
    v_mul_f32 v135, v135, v56
    v_mul_f32 v136, v136, v56
    v_mul_f32 v137, v137, v56
    v_fma_f32 v134, v108, v64, v134
    v_fma_f32 v135, v109, v64, v135
    v_fma_f32 v136, v110, v64, v136
    v_fma_f32 v137, v111, v64, v137
    v_cvt_pk_bf16_f32 v138, v134, v135
    v_cvt_pk_bf16_f32 v139, v136, v137
    ds_write_b64 v22, v[138:139] offset:33864
    ds_read_b128 v[108:111], v20 offset:29696
    v_accvgpr_read_b32 v116, a80
    v_accvgpr_read_b32 v117, a81
    v_accvgpr_read_b32 v118, a82
    v_accvgpr_read_b32 v119, a83
    s_waitcnt lgkmcnt(9)
    v_mul_f32 v116, v116, v52
    v_mul_f32 v117, v117, v52
    v_mul_f32 v118, v118, v52
    v_mul_f32 v119, v119, v52
    v_fma_f32 v116, v72, v60, v116
    v_fma_f32 v117, v73, v60, v117
    v_fma_f32 v118, v74, v60, v118
    v_fma_f32 v119, v75, v60, v119
    v_cvt_pk_bf16_f32 v120, v116, v117
    v_cvt_pk_bf16_f32 v121, v118, v119
    ds_write_b64 v22, v[120:121] offset:128
    ds_read_b128 v[72:75], v20 offset:30720
    v_accvgpr_read_b32 v122, a84
    v_accvgpr_read_b32 v123, a85
    v_accvgpr_read_b32 v124, a86
    v_accvgpr_read_b32 v125, a87
    s_waitcnt lgkmcnt(9)
    v_mul_f32 v122, v122, v53
    v_mul_f32 v123, v123, v53
    v_mul_f32 v124, v124, v53
    v_mul_f32 v125, v125, v53
    v_fma_f32 v122, v76, v61, v122
    v_fma_f32 v123, v77, v61, v123
    v_fma_f32 v124, v78, v61, v124
    v_fma_f32 v125, v79, v61, v125
    v_cvt_pk_bf16_f32 v126, v122, v123
    v_cvt_pk_bf16_f32 v127, v124, v125
    ds_write_b64 v22, v[126:127] offset:8576
    ds_read_b128 v[76:79], v20 offset:31744
    v_accvgpr_read_b32 v128, a88
    v_accvgpr_read_b32 v129, a89
    v_accvgpr_read_b32 v130, a90
    v_accvgpr_read_b32 v131, a91
    s_waitcnt lgkmcnt(9)
    v_mul_f32 v128, v128, v54
    v_mul_f32 v129, v129, v54
    v_mul_f32 v130, v130, v54
    v_mul_f32 v131, v131, v54
    v_fma_f32 v128, v80, v62, v128
    v_fma_f32 v129, v81, v62, v129
    v_fma_f32 v130, v82, v62, v130
    v_fma_f32 v131, v83, v62, v131
    v_cvt_pk_bf16_f32 v132, v128, v129
    v_cvt_pk_bf16_f32 v133, v130, v131
    ds_write_b64 v22, v[132:133] offset:17024
    ds_read_b128 v[80:83], v20 offset:32768
    v_accvgpr_read_b32 v134, a92
    v_accvgpr_read_b32 v135, a93
    v_accvgpr_read_b32 v136, a94
    v_accvgpr_read_b32 v137, a95
    s_waitcnt lgkmcnt(9)
    v_mul_f32 v134, v134, v55
    v_mul_f32 v135, v135, v55
    v_mul_f32 v136, v136, v55
    v_mul_f32 v137, v137, v55
    v_fma_f32 v134, v84, v63, v134
    v_fma_f32 v135, v85, v63, v135
    v_fma_f32 v136, v86, v63, v136
    v_fma_f32 v137, v87, v63, v137
    v_cvt_pk_bf16_f32 v138, v134, v135
    v_cvt_pk_bf16_f32 v139, v136, v137
    ds_write_b64 v22, v[138:139] offset:25472
    ds_read_b128 v[84:87], v20 offset:33792
    v_accvgpr_read_b32 v116, a96
    v_accvgpr_read_b32 v117, a97
    v_accvgpr_read_b32 v118, a98
    v_accvgpr_read_b32 v119, a99
    s_waitcnt lgkmcnt(9)
    v_mul_f32 v116, v116, v56
    v_mul_f32 v117, v117, v56
    v_mul_f32 v118, v118, v56
    v_mul_f32 v119, v119, v56
    v_fma_f32 v116, v88, v64, v116
    v_fma_f32 v117, v89, v64, v117
    v_fma_f32 v118, v90, v64, v118
    v_fma_f32 v119, v91, v64, v119
    v_cvt_pk_bf16_f32 v120, v116, v117
    v_cvt_pk_bf16_f32 v121, v118, v119
    ds_write_b64 v22, v[120:121] offset:33920
    ds_read_b128 v[88:91], v20 offset:34816
    v_accvgpr_read_b32 v122, a100
    v_accvgpr_read_b32 v123, a101
    v_accvgpr_read_b32 v124, a102
    v_accvgpr_read_b32 v125, a103
    s_waitcnt lgkmcnt(9)
    v_mul_f32 v122, v122, v52
    v_mul_f32 v123, v123, v52
    v_mul_f32 v124, v124, v52
    v_mul_f32 v125, v125, v52
    v_fma_f32 v122, v92, v60, v122
    v_fma_f32 v123, v93, v60, v123
    v_fma_f32 v124, v94, v60, v124
    v_fma_f32 v125, v95, v60, v125
    v_cvt_pk_bf16_f32 v126, v122, v123
    v_cvt_pk_bf16_f32 v127, v124, v125
    ds_write_b64 v22, v[126:127] offset:136
    ds_read_b128 v[92:95], v20 offset:35840
    v_accvgpr_read_b32 v128, a104
    v_accvgpr_read_b32 v129, a105
    v_accvgpr_read_b32 v130, a106
    v_accvgpr_read_b32 v131, a107
    s_waitcnt lgkmcnt(9)
    v_mul_f32 v128, v128, v53
    v_mul_f32 v129, v129, v53
    v_mul_f32 v130, v130, v53
    v_mul_f32 v131, v131, v53
    v_fma_f32 v128, v96, v61, v128
    v_fma_f32 v129, v97, v61, v129
    v_fma_f32 v130, v98, v61, v130
    v_fma_f32 v131, v99, v61, v131
    v_cvt_pk_bf16_f32 v132, v128, v129
    v_cvt_pk_bf16_f32 v133, v130, v131
    ds_write_b64 v22, v[132:133] offset:8584
    ds_read_b128 v[96:99], v20 offset:36864
    v_accvgpr_read_b32 v134, a108
    v_accvgpr_read_b32 v135, a109
    v_accvgpr_read_b32 v136, a110
    v_accvgpr_read_b32 v137, a111
    s_waitcnt lgkmcnt(9)
    v_mul_f32 v134, v134, v54
    v_mul_f32 v135, v135, v54
    v_mul_f32 v136, v136, v54
    v_mul_f32 v137, v137, v54
    v_fma_f32 v134, v100, v62, v134
    v_fma_f32 v135, v101, v62, v135
    v_fma_f32 v136, v102, v62, v136
    v_fma_f32 v137, v103, v62, v137
    v_cvt_pk_bf16_f32 v138, v134, v135
    v_cvt_pk_bf16_f32 v139, v136, v137
    ds_write_b64 v22, v[138:139] offset:17032
    ds_read_b128 v[100:103], v20 offset:37888
    v_accvgpr_read_b32 v116, a112
    v_accvgpr_read_b32 v117, a113
    v_accvgpr_read_b32 v118, a114
    v_accvgpr_read_b32 v119, a115
    s_waitcnt lgkmcnt(9)
    v_mul_f32 v116, v116, v55
    v_mul_f32 v117, v117, v55
    v_mul_f32 v118, v118, v55
    v_mul_f32 v119, v119, v55
    v_fma_f32 v116, v104, v63, v116
    v_fma_f32 v117, v105, v63, v117
    v_fma_f32 v118, v106, v63, v118
    v_fma_f32 v119, v107, v63, v119
    v_cvt_pk_bf16_f32 v120, v116, v117
    v_cvt_pk_bf16_f32 v121, v118, v119
    ds_write_b64 v22, v[120:121] offset:25480
    ds_read_b128 v[104:107], v20 offset:38912
    v_accvgpr_read_b32 v122, a116
    v_accvgpr_read_b32 v123, a117
    v_accvgpr_read_b32 v124, a118
    v_accvgpr_read_b32 v125, a119
    s_waitcnt lgkmcnt(9)
    v_mul_f32 v122, v122, v56
    v_mul_f32 v123, v123, v56
    v_mul_f32 v124, v124, v56
    v_mul_f32 v125, v125, v56
    v_fma_f32 v122, v108, v64, v122
    v_fma_f32 v123, v109, v64, v123
    v_fma_f32 v124, v110, v64, v124
    v_fma_f32 v125, v111, v64, v125
    v_cvt_pk_bf16_f32 v126, v122, v123
    v_cvt_pk_bf16_f32 v127, v124, v125
    ds_write_b64 v22, v[126:127] offset:33928
    ds_read_b128 v[108:111], v20 offset:39936
    v_accvgpr_read_b32 v128, a120
    v_accvgpr_read_b32 v129, a121
    v_accvgpr_read_b32 v130, a122
    v_accvgpr_read_b32 v131, a123
    s_waitcnt lgkmcnt(9)
    v_mul_f32 v128, v128, v52
    v_mul_f32 v129, v129, v52
    v_mul_f32 v130, v130, v52
    v_mul_f32 v131, v131, v52
    v_fma_f32 v128, v72, v60, v128
    v_fma_f32 v129, v73, v60, v129
    v_fma_f32 v130, v74, v60, v130
    v_fma_f32 v131, v75, v60, v131
    v_cvt_pk_bf16_f32 v132, v128, v129
    v_cvt_pk_bf16_f32 v133, v130, v131
    ds_write_b64 v22, v[132:133] offset:192
    v_accvgpr_read_b32 v134, a124
    v_accvgpr_read_b32 v135, a125
    v_accvgpr_read_b32 v136, a126
    v_accvgpr_read_b32 v137, a127
    s_waitcnt lgkmcnt(8)
    v_mul_f32 v134, v134, v53
    v_mul_f32 v135, v135, v53
    v_mul_f32 v136, v136, v53
    v_mul_f32 v137, v137, v53
    v_fma_f32 v134, v76, v61, v134
    v_fma_f32 v135, v77, v61, v135
    v_fma_f32 v136, v78, v61, v136
    v_fma_f32 v137, v79, v61, v137
    v_cvt_pk_bf16_f32 v138, v134, v135
    v_cvt_pk_bf16_f32 v139, v136, v137
    ds_write_b64 v22, v[138:139] offset:8640
    v_accvgpr_read_b32 v116, a128
    v_accvgpr_read_b32 v117, a129
    v_accvgpr_read_b32 v118, a130
    v_accvgpr_read_b32 v119, a131
    s_waitcnt lgkmcnt(7)
    v_mul_f32 v116, v116, v54
    v_mul_f32 v117, v117, v54
    v_mul_f32 v118, v118, v54
    v_mul_f32 v119, v119, v54
    v_fma_f32 v116, v80, v62, v116
    v_fma_f32 v117, v81, v62, v117
    v_fma_f32 v118, v82, v62, v118
    v_fma_f32 v119, v83, v62, v119
    v_cvt_pk_bf16_f32 v120, v116, v117
    v_cvt_pk_bf16_f32 v121, v118, v119
    ds_write_b64 v22, v[120:121] offset:17088
    v_accvgpr_read_b32 v122, a132
    v_accvgpr_read_b32 v123, a133
    v_accvgpr_read_b32 v124, a134
    v_accvgpr_read_b32 v125, a135
    s_waitcnt lgkmcnt(6)
    v_mul_f32 v122, v122, v55
    v_mul_f32 v123, v123, v55
    v_mul_f32 v124, v124, v55
    v_mul_f32 v125, v125, v55
    v_fma_f32 v122, v84, v63, v122
    v_fma_f32 v123, v85, v63, v123
    v_fma_f32 v124, v86, v63, v124
    v_fma_f32 v125, v87, v63, v125
    v_cvt_pk_bf16_f32 v126, v122, v123
    v_cvt_pk_bf16_f32 v127, v124, v125
    ds_write_b64 v22, v[126:127] offset:25536
    v_accvgpr_read_b32 v128, a136
    v_accvgpr_read_b32 v129, a137
    v_accvgpr_read_b32 v130, a138
    v_accvgpr_read_b32 v131, a139
    s_waitcnt lgkmcnt(5)
    v_mul_f32 v128, v128, v56
    v_mul_f32 v129, v129, v56
    v_mul_f32 v130, v130, v56
    v_mul_f32 v131, v131, v56
    v_fma_f32 v128, v88, v64, v128
    v_fma_f32 v129, v89, v64, v129
    v_fma_f32 v130, v90, v64, v130
    v_fma_f32 v131, v91, v64, v131
    v_cvt_pk_bf16_f32 v132, v128, v129
    v_cvt_pk_bf16_f32 v133, v130, v131
    ds_write_b64 v22, v[132:133] offset:33984
    v_accvgpr_read_b32 v134, a140
    v_accvgpr_read_b32 v135, a141
    v_accvgpr_read_b32 v136, a142
    v_accvgpr_read_b32 v137, a143
    s_waitcnt lgkmcnt(4)
    v_mul_f32 v134, v134, v52
    v_mul_f32 v135, v135, v52
    v_mul_f32 v136, v136, v52
    v_mul_f32 v137, v137, v52
    v_fma_f32 v134, v92, v60, v134
    v_fma_f32 v135, v93, v60, v135
    v_fma_f32 v136, v94, v60, v136
    v_fma_f32 v137, v95, v60, v137
    v_cvt_pk_bf16_f32 v138, v134, v135
    v_cvt_pk_bf16_f32 v139, v136, v137
    ds_write_b64 v22, v[138:139] offset:200
    v_accvgpr_read_b32 v116, a144
    v_accvgpr_read_b32 v117, a145
    v_accvgpr_read_b32 v118, a146
    v_accvgpr_read_b32 v119, a147
    s_waitcnt lgkmcnt(3)
    v_mul_f32 v116, v116, v53
    v_mul_f32 v117, v117, v53
    v_mul_f32 v118, v118, v53
    v_mul_f32 v119, v119, v53
    v_fma_f32 v116, v96, v61, v116
    v_fma_f32 v117, v97, v61, v117
    v_fma_f32 v118, v98, v61, v118
    v_fma_f32 v119, v99, v61, v119
    v_cvt_pk_bf16_f32 v120, v116, v117
    v_cvt_pk_bf16_f32 v121, v118, v119
    ds_write_b64 v22, v[120:121] offset:8648
    v_accvgpr_read_b32 v122, a148
    v_accvgpr_read_b32 v123, a149
    v_accvgpr_read_b32 v124, a150
    v_accvgpr_read_b32 v125, a151
    s_waitcnt lgkmcnt(2)
    v_mul_f32 v122, v122, v54
    v_mul_f32 v123, v123, v54
    v_mul_f32 v124, v124, v54
    v_mul_f32 v125, v125, v54
    v_fma_f32 v122, v100, v62, v122
    v_fma_f32 v123, v101, v62, v123
    v_fma_f32 v124, v102, v62, v124
    v_fma_f32 v125, v103, v62, v125
    v_cvt_pk_bf16_f32 v126, v122, v123
    v_cvt_pk_bf16_f32 v127, v124, v125
    ds_write_b64 v22, v[126:127] offset:17096
    v_accvgpr_read_b32 v128, a152
    v_accvgpr_read_b32 v129, a153
    v_accvgpr_read_b32 v130, a154
    v_accvgpr_read_b32 v131, a155
    s_waitcnt lgkmcnt(1)
    v_mul_f32 v128, v128, v55
    v_mul_f32 v129, v129, v55
    v_mul_f32 v130, v130, v55
    v_mul_f32 v131, v131, v55
    v_fma_f32 v128, v104, v63, v128
    v_fma_f32 v129, v105, v63, v129
    v_fma_f32 v130, v106, v63, v130
    v_fma_f32 v131, v107, v63, v131
    v_cvt_pk_bf16_f32 v132, v128, v129
    v_cvt_pk_bf16_f32 v133, v130, v131
    ds_write_b64 v22, v[132:133] offset:25544
    v_accvgpr_read_b32 v134, a156
    v_accvgpr_read_b32 v135, a157
    v_accvgpr_read_b32 v136, a158
    v_accvgpr_read_b32 v137, a159
    s_waitcnt lgkmcnt(0)
    v_mul_f32 v134, v134, v56
    v_mul_f32 v135, v135, v56
    v_mul_f32 v136, v136, v56
    v_mul_f32 v137, v137, v56
    v_fma_f32 v134, v108, v64, v134
    v_fma_f32 v135, v109, v64, v135
    v_fma_f32 v136, v110, v64, v136
    v_fma_f32 v137, v111, v64, v137
    v_cvt_pk_bf16_f32 v138, v134, v135
    v_cvt_pk_bf16_f32 v139, v136, v137
    ds_write_b64 v22, v[138:139] offset:33992
    s_waitcnt lgkmcnt(0)
k1_kernel_L38:
    s_barrier
    v_lshlrev_b32 v20, 10, v2
    v_lshlrev_b32 v21, 1, v2
    v_xor_b32 v21, v3, v21
    v_lshlrev_b32 v4, 4, v21
    v_add_u32 v4, v4, v20
    v_xor_b32 v21, 8, v21
    v_lshlrev_b32 v5, 4, v21
    v_add_u32 v5, v5, v20
    s_lshl_b32 s47, s37, 2
    s_lshl_b32 s48, s38, 1
    s_add_u32 s47, s47, s48
    s_lshl_b32 s47, s47, 17
    s_lshl_b32 s48, s39, 8
    s_add_u32 s45, s47, s48
    s_mul_i32 s46, s39, 24576
    s_add_u32 s46, s46, 0

    v_lshrrev_b32 v20, 2, v3
    v_and_b32 v21, 3, v3
    v_lshlrev_b32 v22, 2, v2
    v_add_u32 v20, v20, v22
    v_and_b32 v22, 7, v20
    v_lshlrev_b32 v22, 5, v22
    v_lshlrev_b32 v20, 8, v20
    v_add_u32 v20, v20, v22
    v_lshlrev_b32 v21, 3, v21
    v_add_u32 v20, v20, v21
    v_add_u32 v12, s46, v20

    v_xor_b32 v13, 32, v12
    v_xor_b32 v14, 64, v12
    v_xor_b32 v15, 96, v12
    v_xor_b32 v16, 128, v12
    v_xor_b32 v17, 160, v12
    v_xor_b32 v18, 192, v12
    v_xor_b32 v19, 224, v12
    v_mov_b32 v22, 528
    v_mul_lo_u32 v22, v3, v22
    v_lshlrev_b32 v23, 4, v2
    v_add_u32 v22, v22, v23
    v_add_u32 v24, 98304, v22
    v_add_u32 v25, 106752, v22
    v_add_u32 v26, 115200, v22
    v_add_u32 v27, 123648, v22
    v_add_u32 v28, 132096, v22

    s_add_u32 s47, s46, 0
    s_mov_b32 m0, s47
    s_add_u32 s48, s45, 0
    buffer_load_dwordx4 v4, s[24:27], s48 offen lds
    s_add_u32 s47, s46, 1024
    s_mov_b32 m0, s47
    s_add_u32 s48, s45, 4096
    buffer_load_dwordx4 v5, s[24:27], s48 offen lds
    s_add_u32 s47, s46, 2048
    s_mov_b32 m0, s47
    s_add_u32 s48, s45, 8192
    buffer_load_dwordx4 v4, s[24:27], s48 offen lds
    s_add_u32 s47, s46, 3072
    s_mov_b32 m0, s47
    s_add_u32 s48, s45, 12288
    buffer_load_dwordx4 v5, s[24:27], s48 offen lds
    s_add_u32 s47, s46, 4096
    s_mov_b32 m0, s47
    s_add_u32 s48, s45, 16384
    buffer_load_dwordx4 v4, s[24:27], s48 offen lds
    s_add_u32 s47, s46, 5120
    s_mov_b32 m0, s47
    s_add_u32 s48, s45, 20480
    buffer_load_dwordx4 v5, s[24:27], s48 offen lds
    s_add_u32 s47, s46, 6144
    s_mov_b32 m0, s47
    s_add_u32 s48, s45, 24576
    buffer_load_dwordx4 v4, s[24:27], s48 offen lds
    s_add_u32 s47, s46, 7168
    s_mov_b32 m0, s47
    s_add_u32 s48, s45, 28672
    buffer_load_dwordx4 v5, s[24:27], s48 offen lds
    s_add_u32 s47, s46, 8192
    s_mov_b32 m0, s47
    s_add_u32 s48, s45, 32768
    buffer_load_dwordx4 v4, s[24:27], s48 offen lds
    s_add_u32 s47, s46, 9216
    s_mov_b32 m0, s47
    s_add_u32 s48, s45, 36864
    buffer_load_dwordx4 v5, s[24:27], s48 offen lds
    s_add_u32 s47, s46, 10240
    s_mov_b32 m0, s47
    s_add_u32 s48, s45, 40960
    buffer_load_dwordx4 v4, s[24:27], s48 offen lds
    s_add_u32 s47, s46, 11264
    s_mov_b32 m0, s47
    s_add_u32 s48, s45, 45056
    buffer_load_dwordx4 v5, s[24:27], s48 offen lds
    s_add_u32 s47, s46, 12288
    s_mov_b32 m0, s47
    s_add_u32 s48, s45, 49152
    buffer_load_dwordx4 v4, s[24:27], s48 offen lds
    s_add_u32 s47, s46, 13312
    s_mov_b32 m0, s47
    s_add_u32 s48, s45, 53248
    buffer_load_dwordx4 v5, s[24:27], s48 offen lds
    s_add_u32 s47, s46, 14336
    s_mov_b32 m0, s47
    s_add_u32 s48, s45, 57344
    buffer_load_dwordx4 v4, s[24:27], s48 offen lds
    s_add_u32 s47, s46, 15360
    s_mov_b32 m0, s47
    s_add_u32 s48, s45, 61440
    buffer_load_dwordx4 v5, s[24:27], s48 offen lds
    v_accvgpr_write_b32 a0, 0
    v_accvgpr_write_b32 a1, 0
    v_accvgpr_write_b32 a2, 0
    v_accvgpr_write_b32 a3, 0
    v_accvgpr_write_b32 a4, 0
    v_accvgpr_write_b32 a5, 0
    v_accvgpr_write_b32 a6, 0
    v_accvgpr_write_b32 a7, 0
    v_accvgpr_write_b32 a8, 0
    v_accvgpr_write_b32 a9, 0
    v_accvgpr_write_b32 a10, 0
    v_accvgpr_write_b32 a11, 0
    v_accvgpr_write_b32 a12, 0
    v_accvgpr_write_b32 a13, 0
    v_accvgpr_write_b32 a14, 0
    v_accvgpr_write_b32 a15, 0
    v_accvgpr_write_b32 a16, 0
    v_accvgpr_write_b32 a17, 0
    v_accvgpr_write_b32 a18, 0
    v_accvgpr_write_b32 a19, 0
    v_accvgpr_write_b32 a20, 0
    v_accvgpr_write_b32 a21, 0
    v_accvgpr_write_b32 a22, 0
    v_accvgpr_write_b32 a23, 0
    v_accvgpr_write_b32 a24, 0
    v_accvgpr_write_b32 a25, 0
    v_accvgpr_write_b32 a26, 0
    v_accvgpr_write_b32 a27, 0
    v_accvgpr_write_b32 a28, 0
    v_accvgpr_write_b32 a29, 0
    v_accvgpr_write_b32 a30, 0
    v_accvgpr_write_b32 a31, 0
    v_accvgpr_write_b32 a32, 0
    v_accvgpr_write_b32 a33, 0
    v_accvgpr_write_b32 a34, 0
    v_accvgpr_write_b32 a35, 0
    v_accvgpr_write_b32 a36, 0
    v_accvgpr_write_b32 a37, 0
    v_accvgpr_write_b32 a38, 0
    v_accvgpr_write_b32 a39, 0
    v_accvgpr_write_b32 a40, 0
    v_accvgpr_write_b32 a41, 0
    v_accvgpr_write_b32 a42, 0
    v_accvgpr_write_b32 a43, 0
    v_accvgpr_write_b32 a44, 0
    v_accvgpr_write_b32 a45, 0
    v_accvgpr_write_b32 a46, 0
    v_accvgpr_write_b32 a47, 0
    v_accvgpr_write_b32 a48, 0
    v_accvgpr_write_b32 a49, 0
    v_accvgpr_write_b32 a50, 0
    v_accvgpr_write_b32 a51, 0
    v_accvgpr_write_b32 a52, 0
    v_accvgpr_write_b32 a53, 0
    v_accvgpr_write_b32 a54, 0
    v_accvgpr_write_b32 a55, 0
    v_accvgpr_write_b32 a56, 0
    v_accvgpr_write_b32 a57, 0
    v_accvgpr_write_b32 a58, 0
    v_accvgpr_write_b32 a59, 0
    v_accvgpr_write_b32 a60, 0
    v_accvgpr_write_b32 a61, 0
    v_accvgpr_write_b32 a62, 0
    v_accvgpr_write_b32 a63, 0
    v_accvgpr_write_b32 a64, 0
    v_accvgpr_write_b32 a65, 0
    v_accvgpr_write_b32 a66, 0
    v_accvgpr_write_b32 a67, 0
    v_accvgpr_write_b32 a68, 0
    v_accvgpr_write_b32 a69, 0
    v_accvgpr_write_b32 a70, 0
    v_accvgpr_write_b32 a71, 0
    v_accvgpr_write_b32 a72, 0
    v_accvgpr_write_b32 a73, 0
    v_accvgpr_write_b32 a74, 0
    v_accvgpr_write_b32 a75, 0
    v_accvgpr_write_b32 a76, 0
    v_accvgpr_write_b32 a77, 0
    v_accvgpr_write_b32 a78, 0
    v_accvgpr_write_b32 a79, 0
    v_accvgpr_write_b32 a80, 0
    v_accvgpr_write_b32 a81, 0
    v_accvgpr_write_b32 a82, 0
    v_accvgpr_write_b32 a83, 0
    v_accvgpr_write_b32 a84, 0
    v_accvgpr_write_b32 a85, 0
    v_accvgpr_write_b32 a86, 0
    v_accvgpr_write_b32 a87, 0
    v_accvgpr_write_b32 a88, 0
    v_accvgpr_write_b32 a89, 0
    v_accvgpr_write_b32 a90, 0
    v_accvgpr_write_b32 a91, 0
    v_accvgpr_write_b32 a92, 0
    v_accvgpr_write_b32 a93, 0
    v_accvgpr_write_b32 a94, 0
    v_accvgpr_write_b32 a95, 0
    v_accvgpr_write_b32 a96, 0
    v_accvgpr_write_b32 a97, 0
    v_accvgpr_write_b32 a98, 0
    v_accvgpr_write_b32 a99, 0
    v_accvgpr_write_b32 a100, 0
    v_accvgpr_write_b32 a101, 0
    v_accvgpr_write_b32 a102, 0
    v_accvgpr_write_b32 a103, 0
    v_accvgpr_write_b32 a104, 0
    v_accvgpr_write_b32 a105, 0
    v_accvgpr_write_b32 a106, 0
    v_accvgpr_write_b32 a107, 0
    v_accvgpr_write_b32 a108, 0
    v_accvgpr_write_b32 a109, 0
    v_accvgpr_write_b32 a110, 0
    v_accvgpr_write_b32 a111, 0
    v_accvgpr_write_b32 a112, 0
    v_accvgpr_write_b32 a113, 0
    v_accvgpr_write_b32 a114, 0
    v_accvgpr_write_b32 a115, 0
    v_accvgpr_write_b32 a116, 0
    v_accvgpr_write_b32 a117, 0
    v_accvgpr_write_b32 a118, 0
    v_accvgpr_write_b32 a119, 0
    v_accvgpr_write_b32 a120, 0
    v_accvgpr_write_b32 a121, 0
    v_accvgpr_write_b32 a122, 0
    v_accvgpr_write_b32 a123, 0
    v_accvgpr_write_b32 a124, 0
    v_accvgpr_write_b32 a125, 0
    v_accvgpr_write_b32 a126, 0
    v_accvgpr_write_b32 a127, 0
    v_accvgpr_write_b32 a128, 0
    v_accvgpr_write_b32 a129, 0
    v_accvgpr_write_b32 a130, 0
    v_accvgpr_write_b32 a131, 0
    v_accvgpr_write_b32 a132, 0
    v_accvgpr_write_b32 a133, 0
    v_accvgpr_write_b32 a134, 0
    v_accvgpr_write_b32 a135, 0
    v_accvgpr_write_b32 a136, 0
    v_accvgpr_write_b32 a137, 0
    v_accvgpr_write_b32 a138, 0
    v_accvgpr_write_b32 a139, 0
    v_accvgpr_write_b32 a140, 0
    v_accvgpr_write_b32 a141, 0
    v_accvgpr_write_b32 a142, 0
    v_accvgpr_write_b32 a143, 0
    v_accvgpr_write_b32 a144, 0
    v_accvgpr_write_b32 a145, 0
    v_accvgpr_write_b32 a146, 0
    v_accvgpr_write_b32 a147, 0
    v_accvgpr_write_b32 a148, 0
    v_accvgpr_write_b32 a149, 0
    v_accvgpr_write_b32 a150, 0
    v_accvgpr_write_b32 a151, 0
    v_accvgpr_write_b32 a152, 0
    v_accvgpr_write_b32 a153, 0
    v_accvgpr_write_b32 a154, 0
    v_accvgpr_write_b32 a155, 0
    v_accvgpr_write_b32 a156, 0
    v_accvgpr_write_b32 a157, 0
    v_accvgpr_write_b32 a158, 0
    v_accvgpr_write_b32 a159, 0
    s_waitcnt vmcnt(8)
    ds_read_b64_tr_b16 v[32:33], v12 offset:0
    ds_read_b64_tr_b16 v[34:35], v12 offset:4096
    ds_read_b64_tr_b16 v[36:37], v13 offset:0
    ds_read_b64_tr_b16 v[38:39], v13 offset:4096
    ds_read_b64_tr_b16 v[40:41], v14 offset:0
    ds_read_b64_tr_b16 v[42:43], v14 offset:4096
    ds_read_b64_tr_b16 v[44:45], v15 offset:0
    ds_read_b64_tr_b16 v[46:47], v15 offset:4096
    ds_read_b64_tr_b16 v[48:49], v16 offset:0
    ds_read_b64_tr_b16 v[50:51], v16 offset:4096
    ds_read_b64_tr_b16 v[52:53], v17 offset:0
    ds_read_b64_tr_b16 v[54:55], v17 offset:4096
    ds_read_b64_tr_b16 v[56:57], v18 offset:0
    ds_read_b64_tr_b16 v[58:59], v18 offset:4096
    ds_read_b64_tr_b16 v[60:61], v19 offset:0
    ds_read_b64_tr_b16 v[62:63], v19 offset:4096
    ds_read_b128 v[96:99], v24 offset:0
    ds_read_b128 v[100:103], v25 offset:0
    ds_read_b128 v[104:107], v26 offset:0
    ds_read_b128 v[108:111], v27 offset:0
    ds_read_b128 v[112:115], v28 offset:0
    s_waitcnt vmcnt(0)
    ds_read_b64_tr_b16 v[64:65], v12 offset:8192
    ds_read_b64_tr_b16 v[66:67], v12 offset:12288
    ds_read_b64_tr_b16 v[68:69], v13 offset:8192
    ds_read_b64_tr_b16 v[70:71], v13 offset:12288
    ds_read_b64_tr_b16 v[72:73], v14 offset:8192
    ds_read_b64_tr_b16 v[74:75], v14 offset:12288
    ds_read_b64_tr_b16 v[76:77], v15 offset:8192
    ds_read_b64_tr_b16 v[78:79], v15 offset:12288
    ds_read_b64_tr_b16 v[80:81], v16 offset:8192
    ds_read_b64_tr_b16 v[82:83], v16 offset:12288
    ds_read_b64_tr_b16 v[84:85], v17 offset:8192
    ds_read_b64_tr_b16 v[86:87], v17 offset:12288
    ds_read_b64_tr_b16 v[88:89], v18 offset:8192
    ds_read_b64_tr_b16 v[90:91], v18 offset:12288
    ds_read_b64_tr_b16 v[92:93], v19 offset:8192
    ds_read_b64_tr_b16 v[94:95], v19 offset:12288
    ds_read_b128 v[116:119], v24 offset:64
    ds_read_b128 v[120:123], v25 offset:64
    ds_read_b128 v[124:127], v26 offset:64
    ds_read_b128 v[128:131], v27 offset:64
    ds_read_b128 v[132:135], v28 offset:64
    s_waitcnt lgkmcnt(15)
    s_add_u32 s47, s46, 16384
    s_mov_b32 m0, s47
    s_add_u32 s48, s45, 65536
    buffer_load_dwordx4 v4, s[24:27], s48 offen lds
    s_add_u32 s47, s46, 17408
    s_mov_b32 m0, s47
    s_add_u32 s48, s45, 69632
    buffer_load_dwordx4 v5, s[24:27], s48 offen lds
    s_add_u32 s47, s46, 18432
    s_mov_b32 m0, s47
    s_add_u32 s48, s45, 73728
    buffer_load_dwordx4 v4, s[24:27], s48 offen lds
    s_add_u32 s47, s46, 19456
    s_mov_b32 m0, s47
    s_add_u32 s48, s45, 77824
    buffer_load_dwordx4 v5, s[24:27], s48 offen lds
    s_add_u32 s47, s46, 20480
    s_mov_b32 m0, s47
    s_add_u32 s48, s45, 81920
    buffer_load_dwordx4 v4, s[24:27], s48 offen lds
    s_add_u32 s47, s46, 21504
    s_mov_b32 m0, s47
    s_add_u32 s48, s45, 86016
    buffer_load_dwordx4 v5, s[24:27], s48 offen lds
    s_add_u32 s47, s46, 22528
    s_mov_b32 m0, s47
    s_add_u32 s48, s45, 90112
    buffer_load_dwordx4 v4, s[24:27], s48 offen lds
    s_add_u32 s47, s46, 23552
    s_mov_b32 m0, s47
    s_add_u32 s48, s45, 94208
    buffer_load_dwordx4 v5, s[24:27], s48 offen lds
    v_mfma_f32_16x16x32_bf16 a[0:3], v[32:35], v[96:99], a[0:3]
    v_mfma_f32_16x16x32_bf16 a[4:7], v[32:35], v[100:103], a[4:7]
    v_mfma_f32_16x16x32_bf16 a[8:11], v[32:35], v[104:107], a[8:11]
    v_mfma_f32_16x16x32_bf16 a[12:15], v[32:35], v[108:111], a[12:15]
    v_mfma_f32_16x16x32_bf16 a[16:19], v[32:35], v[112:115], a[16:19]
    v_mfma_f32_16x16x32_bf16 a[20:23], v[36:39], v[96:99], a[20:23]
    v_mfma_f32_16x16x32_bf16 a[24:27], v[36:39], v[100:103], a[24:27]
    v_mfma_f32_16x16x32_bf16 a[28:31], v[36:39], v[104:107], a[28:31]
    v_mfma_f32_16x16x32_bf16 a[32:35], v[36:39], v[108:111], a[32:35]
    v_mfma_f32_16x16x32_bf16 a[36:39], v[36:39], v[112:115], a[36:39]
    v_mfma_f32_16x16x32_bf16 a[40:43], v[40:43], v[96:99], a[40:43]
    v_mfma_f32_16x16x32_bf16 a[44:47], v[40:43], v[100:103], a[44:47]
    v_mfma_f32_16x16x32_bf16 a[48:51], v[40:43], v[104:107], a[48:51]
    v_mfma_f32_16x16x32_bf16 a[52:55], v[40:43], v[108:111], a[52:55]
    v_mfma_f32_16x16x32_bf16 a[56:59], v[40:43], v[112:115], a[56:59]
    v_mfma_f32_16x16x32_bf16 a[60:63], v[44:47], v[96:99], a[60:63]
    v_mfma_f32_16x16x32_bf16 a[64:67], v[44:47], v[100:103], a[64:67]
    v_mfma_f32_16x16x32_bf16 a[68:71], v[44:47], v[104:107], a[68:71]
    v_mfma_f32_16x16x32_bf16 a[72:75], v[44:47], v[108:111], a[72:75]
    v_mfma_f32_16x16x32_bf16 a[76:79], v[44:47], v[112:115], a[76:79]
    v_mfma_f32_16x16x32_bf16 a[80:83], v[48:51], v[96:99], a[80:83]
    v_mfma_f32_16x16x32_bf16 a[84:87], v[48:51], v[100:103], a[84:87]
    v_mfma_f32_16x16x32_bf16 a[88:91], v[48:51], v[104:107], a[88:91]
    v_mfma_f32_16x16x32_bf16 a[92:95], v[48:51], v[108:111], a[92:95]
    v_mfma_f32_16x16x32_bf16 a[96:99], v[48:51], v[112:115], a[96:99]
    v_mfma_f32_16x16x32_bf16 a[100:103], v[52:55], v[96:99], a[100:103]
    v_mfma_f32_16x16x32_bf16 a[104:107], v[52:55], v[100:103], a[104:107]
    v_mfma_f32_16x16x32_bf16 a[108:111], v[52:55], v[104:107], a[108:111]
    v_mfma_f32_16x16x32_bf16 a[112:115], v[52:55], v[108:111], a[112:115]
    v_mfma_f32_16x16x32_bf16 a[116:119], v[52:55], v[112:115], a[116:119]
    v_mfma_f32_16x16x32_bf16 a[120:123], v[56:59], v[96:99], a[120:123]
    v_mfma_f32_16x16x32_bf16 a[124:127], v[56:59], v[100:103], a[124:127]
    v_mfma_f32_16x16x32_bf16 a[128:131], v[56:59], v[104:107], a[128:131]
    v_mfma_f32_16x16x32_bf16 a[132:135], v[56:59], v[108:111], a[132:135]
    v_mfma_f32_16x16x32_bf16 a[136:139], v[56:59], v[112:115], a[136:139]
    v_mfma_f32_16x16x32_bf16 a[140:143], v[60:63], v[96:99], a[140:143]
    v_mfma_f32_16x16x32_bf16 a[144:147], v[60:63], v[100:103], a[144:147]
    v_mfma_f32_16x16x32_bf16 a[148:151], v[60:63], v[104:107], a[148:151]
    v_mfma_f32_16x16x32_bf16 a[152:155], v[60:63], v[108:111], a[152:155]
    v_mfma_f32_16x16x32_bf16 a[156:159], v[60:63], v[112:115], a[156:159]
    s_waitcnt vmcnt(0)
    ds_read_b64_tr_b16 v[32:33], v12 offset:16384
    ds_read_b64_tr_b16 v[34:35], v12 offset:20480
    ds_read_b64_tr_b16 v[36:37], v13 offset:16384
    ds_read_b64_tr_b16 v[38:39], v13 offset:20480
    ds_read_b64_tr_b16 v[40:41], v14 offset:16384
    ds_read_b64_tr_b16 v[42:43], v14 offset:20480
    ds_read_b64_tr_b16 v[44:45], v15 offset:16384
    ds_read_b64_tr_b16 v[46:47], v15 offset:20480
    ds_read_b64_tr_b16 v[48:49], v16 offset:16384
    ds_read_b64_tr_b16 v[50:51], v16 offset:20480
    ds_read_b64_tr_b16 v[52:53], v17 offset:16384
    ds_read_b64_tr_b16 v[54:55], v17 offset:20480
    ds_read_b64_tr_b16 v[56:57], v18 offset:16384
    ds_read_b64_tr_b16 v[58:59], v18 offset:20480
    ds_read_b64_tr_b16 v[60:61], v19 offset:16384
    ds_read_b64_tr_b16 v[62:63], v19 offset:20480
    ds_read_b128 v[96:99], v24 offset:128
    ds_read_b128 v[100:103], v25 offset:128
    ds_read_b128 v[104:107], v26 offset:128
    ds_read_b128 v[108:111], v27 offset:128
    ds_read_b128 v[112:115], v28 offset:128
    s_waitcnt lgkmcnt(15)
    s_add_u32 s47, s46, 0
    s_mov_b32 m0, s47
    s_add_u32 s48, s45, 98304
    buffer_load_dwordx4 v4, s[24:27], s48 offen lds
    s_add_u32 s47, s46, 1024
    s_mov_b32 m0, s47
    s_add_u32 s48, s45, 102400
    buffer_load_dwordx4 v5, s[24:27], s48 offen lds
    s_add_u32 s47, s46, 2048
    s_mov_b32 m0, s47
    s_add_u32 s48, s45, 106496
    buffer_load_dwordx4 v4, s[24:27], s48 offen lds
    s_add_u32 s47, s46, 3072
    s_mov_b32 m0, s47
    s_add_u32 s48, s45, 110592
    buffer_load_dwordx4 v5, s[24:27], s48 offen lds
    s_add_u32 s47, s46, 4096
    s_mov_b32 m0, s47
    s_add_u32 s48, s45, 114688
    buffer_load_dwordx4 v4, s[24:27], s48 offen lds
    s_add_u32 s47, s46, 5120
    s_mov_b32 m0, s47
    s_add_u32 s48, s45, 118784
    buffer_load_dwordx4 v5, s[24:27], s48 offen lds
    s_add_u32 s47, s46, 6144
    s_mov_b32 m0, s47
    s_add_u32 s48, s45, 122880
    buffer_load_dwordx4 v4, s[24:27], s48 offen lds
    s_add_u32 s47, s46, 7168
    s_mov_b32 m0, s47
    s_add_u32 s48, s45, 126976
    buffer_load_dwordx4 v5, s[24:27], s48 offen lds
    v_mfma_f32_16x16x32_bf16 a[0:3], v[64:67], v[116:119], a[0:3]
    v_mfma_f32_16x16x32_bf16 a[4:7], v[64:67], v[120:123], a[4:7]
    v_mfma_f32_16x16x32_bf16 a[8:11], v[64:67], v[124:127], a[8:11]
    v_mfma_f32_16x16x32_bf16 a[12:15], v[64:67], v[128:131], a[12:15]
    v_mfma_f32_16x16x32_bf16 a[16:19], v[64:67], v[132:135], a[16:19]
    v_mfma_f32_16x16x32_bf16 a[20:23], v[68:71], v[116:119], a[20:23]
    v_mfma_f32_16x16x32_bf16 a[24:27], v[68:71], v[120:123], a[24:27]
    v_mfma_f32_16x16x32_bf16 a[28:31], v[68:71], v[124:127], a[28:31]
    v_mfma_f32_16x16x32_bf16 a[32:35], v[68:71], v[128:131], a[32:35]
    v_mfma_f32_16x16x32_bf16 a[36:39], v[68:71], v[132:135], a[36:39]
    v_mfma_f32_16x16x32_bf16 a[40:43], v[72:75], v[116:119], a[40:43]
    v_mfma_f32_16x16x32_bf16 a[44:47], v[72:75], v[120:123], a[44:47]
    v_mfma_f32_16x16x32_bf16 a[48:51], v[72:75], v[124:127], a[48:51]
    v_mfma_f32_16x16x32_bf16 a[52:55], v[72:75], v[128:131], a[52:55]
    v_mfma_f32_16x16x32_bf16 a[56:59], v[72:75], v[132:135], a[56:59]
    v_mfma_f32_16x16x32_bf16 a[60:63], v[76:79], v[116:119], a[60:63]
    v_mfma_f32_16x16x32_bf16 a[64:67], v[76:79], v[120:123], a[64:67]
    v_mfma_f32_16x16x32_bf16 a[68:71], v[76:79], v[124:127], a[68:71]
    v_mfma_f32_16x16x32_bf16 a[72:75], v[76:79], v[128:131], a[72:75]
    v_mfma_f32_16x16x32_bf16 a[76:79], v[76:79], v[132:135], a[76:79]
    v_mfma_f32_16x16x32_bf16 a[80:83], v[80:83], v[116:119], a[80:83]
    v_mfma_f32_16x16x32_bf16 a[84:87], v[80:83], v[120:123], a[84:87]
    v_mfma_f32_16x16x32_bf16 a[88:91], v[80:83], v[124:127], a[88:91]
    v_mfma_f32_16x16x32_bf16 a[92:95], v[80:83], v[128:131], a[92:95]
    v_mfma_f32_16x16x32_bf16 a[96:99], v[80:83], v[132:135], a[96:99]
    v_mfma_f32_16x16x32_bf16 a[100:103], v[84:87], v[116:119], a[100:103]
    v_mfma_f32_16x16x32_bf16 a[104:107], v[84:87], v[120:123], a[104:107]
    v_mfma_f32_16x16x32_bf16 a[108:111], v[84:87], v[124:127], a[108:111]
    v_mfma_f32_16x16x32_bf16 a[112:115], v[84:87], v[128:131], a[112:115]
    v_mfma_f32_16x16x32_bf16 a[116:119], v[84:87], v[132:135], a[116:119]
    v_mfma_f32_16x16x32_bf16 a[120:123], v[88:91], v[116:119], a[120:123]
    v_mfma_f32_16x16x32_bf16 a[124:127], v[88:91], v[120:123], a[124:127]
    v_mfma_f32_16x16x32_bf16 a[128:131], v[88:91], v[124:127], a[128:131]
    v_mfma_f32_16x16x32_bf16 a[132:135], v[88:91], v[128:131], a[132:135]
    v_mfma_f32_16x16x32_bf16 a[136:139], v[88:91], v[132:135], a[136:139]
    v_mfma_f32_16x16x32_bf16 a[140:143], v[92:95], v[116:119], a[140:143]
    v_mfma_f32_16x16x32_bf16 a[144:147], v[92:95], v[120:123], a[144:147]
    v_mfma_f32_16x16x32_bf16 a[148:151], v[92:95], v[124:127], a[148:151]
    v_mfma_f32_16x16x32_bf16 a[152:155], v[92:95], v[128:131], a[152:155]
    v_mfma_f32_16x16x32_bf16 a[156:159], v[92:95], v[132:135], a[156:159]
    s_waitcnt vmcnt(0)
    ds_read_b64_tr_b16 v[64:65], v12 offset:0
    ds_read_b64_tr_b16 v[66:67], v12 offset:4096
    ds_read_b64_tr_b16 v[68:69], v13 offset:0
    ds_read_b64_tr_b16 v[70:71], v13 offset:4096
    ds_read_b64_tr_b16 v[72:73], v14 offset:0
    ds_read_b64_tr_b16 v[74:75], v14 offset:4096
    ds_read_b64_tr_b16 v[76:77], v15 offset:0
    ds_read_b64_tr_b16 v[78:79], v15 offset:4096
    ds_read_b64_tr_b16 v[80:81], v16 offset:0
    ds_read_b64_tr_b16 v[82:83], v16 offset:4096
    ds_read_b64_tr_b16 v[84:85], v17 offset:0
    ds_read_b64_tr_b16 v[86:87], v17 offset:4096
    ds_read_b64_tr_b16 v[88:89], v18 offset:0
    ds_read_b64_tr_b16 v[90:91], v18 offset:4096
    ds_read_b64_tr_b16 v[92:93], v19 offset:0
    ds_read_b64_tr_b16 v[94:95], v19 offset:4096
    ds_read_b128 v[116:119], v24 offset:192
    ds_read_b128 v[120:123], v25 offset:192
    ds_read_b128 v[124:127], v26 offset:192
    ds_read_b128 v[128:131], v27 offset:192
    ds_read_b128 v[132:135], v28 offset:192
    s_waitcnt lgkmcnt(15)
    s_add_u32 s47, s46, 8192
    s_mov_b32 m0, s47
    s_add_u32 s48, s45, 131072
    buffer_load_dwordx4 v4, s[24:27], s48 offen lds
    s_add_u32 s47, s46, 9216
    s_mov_b32 m0, s47
    s_add_u32 s48, s45, 135168
    buffer_load_dwordx4 v5, s[24:27], s48 offen lds
    s_add_u32 s47, s46, 10240
    s_mov_b32 m0, s47
    s_add_u32 s48, s45, 139264
    buffer_load_dwordx4 v4, s[24:27], s48 offen lds
    s_add_u32 s47, s46, 11264
    s_mov_b32 m0, s47
    s_add_u32 s48, s45, 143360
    buffer_load_dwordx4 v5, s[24:27], s48 offen lds
    s_add_u32 s47, s46, 12288
    s_mov_b32 m0, s47
    s_add_u32 s48, s45, 147456
    buffer_load_dwordx4 v4, s[24:27], s48 offen lds
    s_add_u32 s47, s46, 13312
    s_mov_b32 m0, s47
    s_add_u32 s48, s45, 151552
    buffer_load_dwordx4 v5, s[24:27], s48 offen lds
    s_add_u32 s47, s46, 14336
    s_mov_b32 m0, s47
    s_add_u32 s48, s45, 155648
    buffer_load_dwordx4 v4, s[24:27], s48 offen lds
    s_add_u32 s47, s46, 15360
    s_mov_b32 m0, s47
    s_add_u32 s48, s45, 159744
    buffer_load_dwordx4 v5, s[24:27], s48 offen lds
    v_mfma_f32_16x16x32_bf16 a[0:3], v[32:35], v[96:99], a[0:3]
    v_mfma_f32_16x16x32_bf16 a[4:7], v[32:35], v[100:103], a[4:7]
    v_mfma_f32_16x16x32_bf16 a[8:11], v[32:35], v[104:107], a[8:11]
    v_mfma_f32_16x16x32_bf16 a[12:15], v[32:35], v[108:111], a[12:15]
    v_mfma_f32_16x16x32_bf16 a[16:19], v[32:35], v[112:115], a[16:19]
    v_mfma_f32_16x16x32_bf16 a[20:23], v[36:39], v[96:99], a[20:23]
    v_mfma_f32_16x16x32_bf16 a[24:27], v[36:39], v[100:103], a[24:27]
    v_mfma_f32_16x16x32_bf16 a[28:31], v[36:39], v[104:107], a[28:31]
    v_mfma_f32_16x16x32_bf16 a[32:35], v[36:39], v[108:111], a[32:35]
    v_mfma_f32_16x16x32_bf16 a[36:39], v[36:39], v[112:115], a[36:39]
    v_mfma_f32_16x16x32_bf16 a[40:43], v[40:43], v[96:99], a[40:43]
    v_mfma_f32_16x16x32_bf16 a[44:47], v[40:43], v[100:103], a[44:47]
    v_mfma_f32_16x16x32_bf16 a[48:51], v[40:43], v[104:107], a[48:51]
    v_mfma_f32_16x16x32_bf16 a[52:55], v[40:43], v[108:111], a[52:55]
    v_mfma_f32_16x16x32_bf16 a[56:59], v[40:43], v[112:115], a[56:59]
    v_mfma_f32_16x16x32_bf16 a[60:63], v[44:47], v[96:99], a[60:63]
    v_mfma_f32_16x16x32_bf16 a[64:67], v[44:47], v[100:103], a[64:67]
    v_mfma_f32_16x16x32_bf16 a[68:71], v[44:47], v[104:107], a[68:71]
    v_mfma_f32_16x16x32_bf16 a[72:75], v[44:47], v[108:111], a[72:75]
    v_mfma_f32_16x16x32_bf16 a[76:79], v[44:47], v[112:115], a[76:79]
    v_mfma_f32_16x16x32_bf16 a[80:83], v[48:51], v[96:99], a[80:83]
    v_mfma_f32_16x16x32_bf16 a[84:87], v[48:51], v[100:103], a[84:87]
    v_mfma_f32_16x16x32_bf16 a[88:91], v[48:51], v[104:107], a[88:91]
    v_mfma_f32_16x16x32_bf16 a[92:95], v[48:51], v[108:111], a[92:95]
    v_mfma_f32_16x16x32_bf16 a[96:99], v[48:51], v[112:115], a[96:99]
    v_mfma_f32_16x16x32_bf16 a[100:103], v[52:55], v[96:99], a[100:103]
    v_mfma_f32_16x16x32_bf16 a[104:107], v[52:55], v[100:103], a[104:107]
    v_mfma_f32_16x16x32_bf16 a[108:111], v[52:55], v[104:107], a[108:111]
    v_mfma_f32_16x16x32_bf16 a[112:115], v[52:55], v[108:111], a[112:115]
    v_mfma_f32_16x16x32_bf16 a[116:119], v[52:55], v[112:115], a[116:119]
    v_mfma_f32_16x16x32_bf16 a[120:123], v[56:59], v[96:99], a[120:123]
    v_mfma_f32_16x16x32_bf16 a[124:127], v[56:59], v[100:103], a[124:127]
    v_mfma_f32_16x16x32_bf16 a[128:131], v[56:59], v[104:107], a[128:131]
    v_mfma_f32_16x16x32_bf16 a[132:135], v[56:59], v[108:111], a[132:135]
    v_mfma_f32_16x16x32_bf16 a[136:139], v[56:59], v[112:115], a[136:139]
    v_mfma_f32_16x16x32_bf16 a[140:143], v[60:63], v[96:99], a[140:143]
    v_mfma_f32_16x16x32_bf16 a[144:147], v[60:63], v[100:103], a[144:147]
    v_mfma_f32_16x16x32_bf16 a[148:151], v[60:63], v[104:107], a[148:151]
    v_mfma_f32_16x16x32_bf16 a[152:155], v[60:63], v[108:111], a[152:155]
    v_mfma_f32_16x16x32_bf16 a[156:159], v[60:63], v[112:115], a[156:159]
    s_waitcnt vmcnt(0)
    ds_read_b64_tr_b16 v[32:33], v12 offset:8192
    ds_read_b64_tr_b16 v[34:35], v12 offset:12288
    ds_read_b64_tr_b16 v[36:37], v13 offset:8192
    ds_read_b64_tr_b16 v[38:39], v13 offset:12288
    ds_read_b64_tr_b16 v[40:41], v14 offset:8192
    ds_read_b64_tr_b16 v[42:43], v14 offset:12288
    ds_read_b64_tr_b16 v[44:45], v15 offset:8192
    ds_read_b64_tr_b16 v[46:47], v15 offset:12288
    ds_read_b64_tr_b16 v[48:49], v16 offset:8192
    ds_read_b64_tr_b16 v[50:51], v16 offset:12288
    ds_read_b64_tr_b16 v[52:53], v17 offset:8192
    ds_read_b64_tr_b16 v[54:55], v17 offset:12288
    ds_read_b64_tr_b16 v[56:57], v18 offset:8192
    ds_read_b64_tr_b16 v[58:59], v18 offset:12288
    ds_read_b64_tr_b16 v[60:61], v19 offset:8192
    ds_read_b64_tr_b16 v[62:63], v19 offset:12288
    ds_read_b128 v[96:99], v24 offset:256
    ds_read_b128 v[100:103], v25 offset:256
    ds_read_b128 v[104:107], v26 offset:256
    ds_read_b128 v[108:111], v27 offset:256
    ds_read_b128 v[112:115], v28 offset:256
    s_waitcnt lgkmcnt(15)
    s_add_u32 s47, s46, 16384
    s_mov_b32 m0, s47
    s_add_u32 s48, s45, 163840
    buffer_load_dwordx4 v4, s[24:27], s48 offen lds
    s_add_u32 s47, s46, 17408
    s_mov_b32 m0, s47
    s_add_u32 s48, s45, 167936
    buffer_load_dwordx4 v5, s[24:27], s48 offen lds
    s_add_u32 s47, s46, 18432
    s_mov_b32 m0, s47
    s_add_u32 s48, s45, 172032
    buffer_load_dwordx4 v4, s[24:27], s48 offen lds
    s_add_u32 s47, s46, 19456
    s_mov_b32 m0, s47
    s_add_u32 s48, s45, 176128
    buffer_load_dwordx4 v5, s[24:27], s48 offen lds
    s_add_u32 s47, s46, 20480
    s_mov_b32 m0, s47
    s_add_u32 s48, s45, 180224
    buffer_load_dwordx4 v4, s[24:27], s48 offen lds
    s_add_u32 s47, s46, 21504
    s_mov_b32 m0, s47
    s_add_u32 s48, s45, 184320
    buffer_load_dwordx4 v5, s[24:27], s48 offen lds
    s_add_u32 s47, s46, 22528
    s_mov_b32 m0, s47
    s_add_u32 s48, s45, 188416
    buffer_load_dwordx4 v4, s[24:27], s48 offen lds
    s_add_u32 s47, s46, 23552
    s_mov_b32 m0, s47
    s_add_u32 s48, s45, 192512
    buffer_load_dwordx4 v5, s[24:27], s48 offen lds
    v_mfma_f32_16x16x32_bf16 a[0:3], v[64:67], v[116:119], a[0:3]
    v_mfma_f32_16x16x32_bf16 a[4:7], v[64:67], v[120:123], a[4:7]
    v_mfma_f32_16x16x32_bf16 a[8:11], v[64:67], v[124:127], a[8:11]
    v_mfma_f32_16x16x32_bf16 a[12:15], v[64:67], v[128:131], a[12:15]
    v_mfma_f32_16x16x32_bf16 a[16:19], v[64:67], v[132:135], a[16:19]
    v_mfma_f32_16x16x32_bf16 a[20:23], v[68:71], v[116:119], a[20:23]
    v_mfma_f32_16x16x32_bf16 a[24:27], v[68:71], v[120:123], a[24:27]
    v_mfma_f32_16x16x32_bf16 a[28:31], v[68:71], v[124:127], a[28:31]
    v_mfma_f32_16x16x32_bf16 a[32:35], v[68:71], v[128:131], a[32:35]
    v_mfma_f32_16x16x32_bf16 a[36:39], v[68:71], v[132:135], a[36:39]
    v_mfma_f32_16x16x32_bf16 a[40:43], v[72:75], v[116:119], a[40:43]
    v_mfma_f32_16x16x32_bf16 a[44:47], v[72:75], v[120:123], a[44:47]
    v_mfma_f32_16x16x32_bf16 a[48:51], v[72:75], v[124:127], a[48:51]
    v_mfma_f32_16x16x32_bf16 a[52:55], v[72:75], v[128:131], a[52:55]
    v_mfma_f32_16x16x32_bf16 a[56:59], v[72:75], v[132:135], a[56:59]
    v_mfma_f32_16x16x32_bf16 a[60:63], v[76:79], v[116:119], a[60:63]
    v_mfma_f32_16x16x32_bf16 a[64:67], v[76:79], v[120:123], a[64:67]
    v_mfma_f32_16x16x32_bf16 a[68:71], v[76:79], v[124:127], a[68:71]
    v_mfma_f32_16x16x32_bf16 a[72:75], v[76:79], v[128:131], a[72:75]
    v_mfma_f32_16x16x32_bf16 a[76:79], v[76:79], v[132:135], a[76:79]
    v_mfma_f32_16x16x32_bf16 a[80:83], v[80:83], v[116:119], a[80:83]
    v_mfma_f32_16x16x32_bf16 a[84:87], v[80:83], v[120:123], a[84:87]
    v_mfma_f32_16x16x32_bf16 a[88:91], v[80:83], v[124:127], a[88:91]
    v_mfma_f32_16x16x32_bf16 a[92:95], v[80:83], v[128:131], a[92:95]
    v_mfma_f32_16x16x32_bf16 a[96:99], v[80:83], v[132:135], a[96:99]
    v_mfma_f32_16x16x32_bf16 a[100:103], v[84:87], v[116:119], a[100:103]
    v_mfma_f32_16x16x32_bf16 a[104:107], v[84:87], v[120:123], a[104:107]
    v_mfma_f32_16x16x32_bf16 a[108:111], v[84:87], v[124:127], a[108:111]
    v_mfma_f32_16x16x32_bf16 a[112:115], v[84:87], v[128:131], a[112:115]
    v_mfma_f32_16x16x32_bf16 a[116:119], v[84:87], v[132:135], a[116:119]
    v_mfma_f32_16x16x32_bf16 a[120:123], v[88:91], v[116:119], a[120:123]
    v_mfma_f32_16x16x32_bf16 a[124:127], v[88:91], v[120:123], a[124:127]
    v_mfma_f32_16x16x32_bf16 a[128:131], v[88:91], v[124:127], a[128:131]
    v_mfma_f32_16x16x32_bf16 a[132:135], v[88:91], v[128:131], a[132:135]
    v_mfma_f32_16x16x32_bf16 a[136:139], v[88:91], v[132:135], a[136:139]
    v_mfma_f32_16x16x32_bf16 a[140:143], v[92:95], v[116:119], a[140:143]
    v_mfma_f32_16x16x32_bf16 a[144:147], v[92:95], v[120:123], a[144:147]
    v_mfma_f32_16x16x32_bf16 a[148:151], v[92:95], v[124:127], a[148:151]
    v_mfma_f32_16x16x32_bf16 a[152:155], v[92:95], v[128:131], a[152:155]
    v_mfma_f32_16x16x32_bf16 a[156:159], v[92:95], v[132:135], a[156:159]
    s_waitcnt vmcnt(0)
    ds_read_b64_tr_b16 v[64:65], v12 offset:16384
    ds_read_b64_tr_b16 v[66:67], v12 offset:20480
    ds_read_b64_tr_b16 v[68:69], v13 offset:16384
    ds_read_b64_tr_b16 v[70:71], v13 offset:20480
    ds_read_b64_tr_b16 v[72:73], v14 offset:16384
    ds_read_b64_tr_b16 v[74:75], v14 offset:20480
    ds_read_b64_tr_b16 v[76:77], v15 offset:16384
    ds_read_b64_tr_b16 v[78:79], v15 offset:20480
    ds_read_b64_tr_b16 v[80:81], v16 offset:16384
    ds_read_b64_tr_b16 v[82:83], v16 offset:20480
    ds_read_b64_tr_b16 v[84:85], v17 offset:16384
    ds_read_b64_tr_b16 v[86:87], v17 offset:20480
    ds_read_b64_tr_b16 v[88:89], v18 offset:16384
    ds_read_b64_tr_b16 v[90:91], v18 offset:20480
    ds_read_b64_tr_b16 v[92:93], v19 offset:16384
    ds_read_b64_tr_b16 v[94:95], v19 offset:20480
    ds_read_b128 v[116:119], v24 offset:320
    ds_read_b128 v[120:123], v25 offset:320
    ds_read_b128 v[124:127], v26 offset:320
    ds_read_b128 v[128:131], v27 offset:320
    ds_read_b128 v[132:135], v28 offset:320
    s_waitcnt lgkmcnt(15)
    s_add_u32 s47, s46, 0
    s_mov_b32 m0, s47
    s_add_u32 s48, s45, 196608
    buffer_load_dwordx4 v4, s[24:27], s48 offen lds
    s_add_u32 s47, s46, 1024
    s_mov_b32 m0, s47
    s_add_u32 s48, s45, 200704
    buffer_load_dwordx4 v5, s[24:27], s48 offen lds
    s_add_u32 s47, s46, 2048
    s_mov_b32 m0, s47
    s_add_u32 s48, s45, 204800
    buffer_load_dwordx4 v4, s[24:27], s48 offen lds
    s_add_u32 s47, s46, 3072
    s_mov_b32 m0, s47
    s_add_u32 s48, s45, 208896
    buffer_load_dwordx4 v5, s[24:27], s48 offen lds
    s_add_u32 s47, s46, 4096
    s_mov_b32 m0, s47
    s_add_u32 s48, s45, 212992
    buffer_load_dwordx4 v4, s[24:27], s48 offen lds
    s_add_u32 s47, s46, 5120
    s_mov_b32 m0, s47
    s_add_u32 s48, s45, 217088
    buffer_load_dwordx4 v5, s[24:27], s48 offen lds
    s_add_u32 s47, s46, 6144
    s_mov_b32 m0, s47
    s_add_u32 s48, s45, 221184
    buffer_load_dwordx4 v4, s[24:27], s48 offen lds
    s_add_u32 s47, s46, 7168
    s_mov_b32 m0, s47
    s_add_u32 s48, s45, 225280
    buffer_load_dwordx4 v5, s[24:27], s48 offen lds
    v_mfma_f32_16x16x32_bf16 a[0:3], v[32:35], v[96:99], a[0:3]
    v_mfma_f32_16x16x32_bf16 a[4:7], v[32:35], v[100:103], a[4:7]
    v_mfma_f32_16x16x32_bf16 a[8:11], v[32:35], v[104:107], a[8:11]
    v_mfma_f32_16x16x32_bf16 a[12:15], v[32:35], v[108:111], a[12:15]
    v_mfma_f32_16x16x32_bf16 a[16:19], v[32:35], v[112:115], a[16:19]
    v_mfma_f32_16x16x32_bf16 a[20:23], v[36:39], v[96:99], a[20:23]
    v_mfma_f32_16x16x32_bf16 a[24:27], v[36:39], v[100:103], a[24:27]
    v_mfma_f32_16x16x32_bf16 a[28:31], v[36:39], v[104:107], a[28:31]
    v_mfma_f32_16x16x32_bf16 a[32:35], v[36:39], v[108:111], a[32:35]
    v_mfma_f32_16x16x32_bf16 a[36:39], v[36:39], v[112:115], a[36:39]
    v_mfma_f32_16x16x32_bf16 a[40:43], v[40:43], v[96:99], a[40:43]
    v_mfma_f32_16x16x32_bf16 a[44:47], v[40:43], v[100:103], a[44:47]
    v_mfma_f32_16x16x32_bf16 a[48:51], v[40:43], v[104:107], a[48:51]
    v_mfma_f32_16x16x32_bf16 a[52:55], v[40:43], v[108:111], a[52:55]
    v_mfma_f32_16x16x32_bf16 a[56:59], v[40:43], v[112:115], a[56:59]
    v_mfma_f32_16x16x32_bf16 a[60:63], v[44:47], v[96:99], a[60:63]
    v_mfma_f32_16x16x32_bf16 a[64:67], v[44:47], v[100:103], a[64:67]
    v_mfma_f32_16x16x32_bf16 a[68:71], v[44:47], v[104:107], a[68:71]
    v_mfma_f32_16x16x32_bf16 a[72:75], v[44:47], v[108:111], a[72:75]
    v_mfma_f32_16x16x32_bf16 a[76:79], v[44:47], v[112:115], a[76:79]
    v_mfma_f32_16x16x32_bf16 a[80:83], v[48:51], v[96:99], a[80:83]
    v_mfma_f32_16x16x32_bf16 a[84:87], v[48:51], v[100:103], a[84:87]
    v_mfma_f32_16x16x32_bf16 a[88:91], v[48:51], v[104:107], a[88:91]
    v_mfma_f32_16x16x32_bf16 a[92:95], v[48:51], v[108:111], a[92:95]
    v_mfma_f32_16x16x32_bf16 a[96:99], v[48:51], v[112:115], a[96:99]
    v_mfma_f32_16x16x32_bf16 a[100:103], v[52:55], v[96:99], a[100:103]
    v_mfma_f32_16x16x32_bf16 a[104:107], v[52:55], v[100:103], a[104:107]
    v_mfma_f32_16x16x32_bf16 a[108:111], v[52:55], v[104:107], a[108:111]
    v_mfma_f32_16x16x32_bf16 a[112:115], v[52:55], v[108:111], a[112:115]
    v_mfma_f32_16x16x32_bf16 a[116:119], v[52:55], v[112:115], a[116:119]
    v_mfma_f32_16x16x32_bf16 a[120:123], v[56:59], v[96:99], a[120:123]
    v_mfma_f32_16x16x32_bf16 a[124:127], v[56:59], v[100:103], a[124:127]
    v_mfma_f32_16x16x32_bf16 a[128:131], v[56:59], v[104:107], a[128:131]
    v_mfma_f32_16x16x32_bf16 a[132:135], v[56:59], v[108:111], a[132:135]
    v_mfma_f32_16x16x32_bf16 a[136:139], v[56:59], v[112:115], a[136:139]
    v_mfma_f32_16x16x32_bf16 a[140:143], v[60:63], v[96:99], a[140:143]
    v_mfma_f32_16x16x32_bf16 a[144:147], v[60:63], v[100:103], a[144:147]
    v_mfma_f32_16x16x32_bf16 a[148:151], v[60:63], v[104:107], a[148:151]
    v_mfma_f32_16x16x32_bf16 a[152:155], v[60:63], v[108:111], a[152:155]
    v_mfma_f32_16x16x32_bf16 a[156:159], v[60:63], v[112:115], a[156:159]
    s_waitcnt vmcnt(0)
    ds_read_b64_tr_b16 v[32:33], v12 offset:0
    ds_read_b64_tr_b16 v[34:35], v12 offset:4096
    ds_read_b64_tr_b16 v[36:37], v13 offset:0
    ds_read_b64_tr_b16 v[38:39], v13 offset:4096
    ds_read_b64_tr_b16 v[40:41], v14 offset:0
    ds_read_b64_tr_b16 v[42:43], v14 offset:4096
    ds_read_b64_tr_b16 v[44:45], v15 offset:0
    ds_read_b64_tr_b16 v[46:47], v15 offset:4096
    ds_read_b64_tr_b16 v[48:49], v16 offset:0
    ds_read_b64_tr_b16 v[50:51], v16 offset:4096
    ds_read_b64_tr_b16 v[52:53], v17 offset:0
    ds_read_b64_tr_b16 v[54:55], v17 offset:4096
    ds_read_b64_tr_b16 v[56:57], v18 offset:0
    ds_read_b64_tr_b16 v[58:59], v18 offset:4096
    ds_read_b64_tr_b16 v[60:61], v19 offset:0
    ds_read_b64_tr_b16 v[62:63], v19 offset:4096
    ds_read_b128 v[96:99], v24 offset:384
    ds_read_b128 v[100:103], v25 offset:384
    ds_read_b128 v[104:107], v26 offset:384
    ds_read_b128 v[108:111], v27 offset:384
    ds_read_b128 v[112:115], v28 offset:384
    s_waitcnt lgkmcnt(15)
    s_add_u32 s47, s46, 8192
    s_mov_b32 m0, s47
    s_add_u32 s48, s45, 229376
    buffer_load_dwordx4 v4, s[24:27], s48 offen lds
    s_add_u32 s47, s46, 9216
    s_mov_b32 m0, s47
    s_add_u32 s48, s45, 233472
    buffer_load_dwordx4 v5, s[24:27], s48 offen lds
    s_add_u32 s47, s46, 10240
    s_mov_b32 m0, s47
    s_add_u32 s48, s45, 237568
    buffer_load_dwordx4 v4, s[24:27], s48 offen lds
    s_add_u32 s47, s46, 11264
    s_mov_b32 m0, s47
    s_add_u32 s48, s45, 241664
    buffer_load_dwordx4 v5, s[24:27], s48 offen lds
    s_add_u32 s47, s46, 12288
    s_mov_b32 m0, s47
    s_add_u32 s48, s45, 245760
    buffer_load_dwordx4 v4, s[24:27], s48 offen lds
    s_add_u32 s47, s46, 13312
    s_mov_b32 m0, s47
    s_add_u32 s48, s45, 249856
    buffer_load_dwordx4 v5, s[24:27], s48 offen lds
    s_add_u32 s47, s46, 14336
    s_mov_b32 m0, s47
    s_add_u32 s48, s45, 253952
    buffer_load_dwordx4 v4, s[24:27], s48 offen lds
    s_add_u32 s47, s46, 15360
    s_mov_b32 m0, s47
    s_add_u32 s48, s45, 258048
    buffer_load_dwordx4 v5, s[24:27], s48 offen lds
    v_mfma_f32_16x16x32_bf16 a[0:3], v[64:67], v[116:119], a[0:3]
    v_mfma_f32_16x16x32_bf16 a[4:7], v[64:67], v[120:123], a[4:7]
    v_mfma_f32_16x16x32_bf16 a[8:11], v[64:67], v[124:127], a[8:11]
    v_mfma_f32_16x16x32_bf16 a[12:15], v[64:67], v[128:131], a[12:15]
    v_mfma_f32_16x16x32_bf16 a[16:19], v[64:67], v[132:135], a[16:19]
    v_mfma_f32_16x16x32_bf16 a[20:23], v[68:71], v[116:119], a[20:23]
    v_mfma_f32_16x16x32_bf16 a[24:27], v[68:71], v[120:123], a[24:27]
    v_mfma_f32_16x16x32_bf16 a[28:31], v[68:71], v[124:127], a[28:31]
    v_mfma_f32_16x16x32_bf16 a[32:35], v[68:71], v[128:131], a[32:35]
    v_mfma_f32_16x16x32_bf16 a[36:39], v[68:71], v[132:135], a[36:39]
    v_mfma_f32_16x16x32_bf16 a[40:43], v[72:75], v[116:119], a[40:43]
    v_mfma_f32_16x16x32_bf16 a[44:47], v[72:75], v[120:123], a[44:47]
    v_mfma_f32_16x16x32_bf16 a[48:51], v[72:75], v[124:127], a[48:51]
    v_mfma_f32_16x16x32_bf16 a[52:55], v[72:75], v[128:131], a[52:55]
    v_mfma_f32_16x16x32_bf16 a[56:59], v[72:75], v[132:135], a[56:59]
    v_mfma_f32_16x16x32_bf16 a[60:63], v[76:79], v[116:119], a[60:63]
    v_mfma_f32_16x16x32_bf16 a[64:67], v[76:79], v[120:123], a[64:67]
    v_mfma_f32_16x16x32_bf16 a[68:71], v[76:79], v[124:127], a[68:71]
    v_mfma_f32_16x16x32_bf16 a[72:75], v[76:79], v[128:131], a[72:75]
    v_mfma_f32_16x16x32_bf16 a[76:79], v[76:79], v[132:135], a[76:79]
    v_mfma_f32_16x16x32_bf16 a[80:83], v[80:83], v[116:119], a[80:83]
    v_mfma_f32_16x16x32_bf16 a[84:87], v[80:83], v[120:123], a[84:87]
    v_mfma_f32_16x16x32_bf16 a[88:91], v[80:83], v[124:127], a[88:91]
    v_mfma_f32_16x16x32_bf16 a[92:95], v[80:83], v[128:131], a[92:95]
    v_mfma_f32_16x16x32_bf16 a[96:99], v[80:83], v[132:135], a[96:99]
    v_mfma_f32_16x16x32_bf16 a[100:103], v[84:87], v[116:119], a[100:103]
    v_mfma_f32_16x16x32_bf16 a[104:107], v[84:87], v[120:123], a[104:107]
    v_mfma_f32_16x16x32_bf16 a[108:111], v[84:87], v[124:127], a[108:111]
    v_mfma_f32_16x16x32_bf16 a[112:115], v[84:87], v[128:131], a[112:115]
    v_mfma_f32_16x16x32_bf16 a[116:119], v[84:87], v[132:135], a[116:119]
    v_mfma_f32_16x16x32_bf16 a[120:123], v[88:91], v[116:119], a[120:123]
    v_mfma_f32_16x16x32_bf16 a[124:127], v[88:91], v[120:123], a[124:127]
    v_mfma_f32_16x16x32_bf16 a[128:131], v[88:91], v[124:127], a[128:131]
    v_mfma_f32_16x16x32_bf16 a[132:135], v[88:91], v[128:131], a[132:135]
    v_mfma_f32_16x16x32_bf16 a[136:139], v[88:91], v[132:135], a[136:139]
    v_mfma_f32_16x16x32_bf16 a[140:143], v[92:95], v[116:119], a[140:143]
    v_mfma_f32_16x16x32_bf16 a[144:147], v[92:95], v[120:123], a[144:147]
    v_mfma_f32_16x16x32_bf16 a[148:151], v[92:95], v[124:127], a[148:151]
    v_mfma_f32_16x16x32_bf16 a[152:155], v[92:95], v[128:131], a[152:155]
    v_mfma_f32_16x16x32_bf16 a[156:159], v[92:95], v[132:135], a[156:159]
    s_waitcnt vmcnt(0)
    ds_read_b64_tr_b16 v[64:65], v12 offset:8192
    ds_read_b64_tr_b16 v[66:67], v12 offset:12288
    ds_read_b64_tr_b16 v[68:69], v13 offset:8192
    ds_read_b64_tr_b16 v[70:71], v13 offset:12288
    ds_read_b64_tr_b16 v[72:73], v14 offset:8192
    ds_read_b64_tr_b16 v[74:75], v14 offset:12288
    ds_read_b64_tr_b16 v[76:77], v15 offset:8192
    ds_read_b64_tr_b16 v[78:79], v15 offset:12288
    ds_read_b64_tr_b16 v[80:81], v16 offset:8192
    ds_read_b64_tr_b16 v[82:83], v16 offset:12288
    ds_read_b64_tr_b16 v[84:85], v17 offset:8192
    ds_read_b64_tr_b16 v[86:87], v17 offset:12288
    ds_read_b64_tr_b16 v[88:89], v18 offset:8192
    ds_read_b64_tr_b16 v[90:91], v18 offset:12288
    ds_read_b64_tr_b16 v[92:93], v19 offset:8192
    ds_read_b64_tr_b16 v[94:95], v19 offset:12288
    ds_read_b128 v[116:119], v24 offset:448
    ds_read_b128 v[120:123], v25 offset:448
    ds_read_b128 v[124:127], v26 offset:448
    ds_read_b128 v[128:131], v27 offset:448
    ds_read_b128 v[132:135], v28 offset:448
    s_waitcnt lgkmcnt(15)
    v_mfma_f32_16x16x32_bf16 a[0:3], v[32:35], v[96:99], a[0:3]
    v_mfma_f32_16x16x32_bf16 a[4:7], v[32:35], v[100:103], a[4:7]
    v_mfma_f32_16x16x32_bf16 a[8:11], v[32:35], v[104:107], a[8:11]
    v_mfma_f32_16x16x32_bf16 a[12:15], v[32:35], v[108:111], a[12:15]
    v_mfma_f32_16x16x32_bf16 a[16:19], v[32:35], v[112:115], a[16:19]
    v_mfma_f32_16x16x32_bf16 a[20:23], v[36:39], v[96:99], a[20:23]
    v_mfma_f32_16x16x32_bf16 a[24:27], v[36:39], v[100:103], a[24:27]
    v_mfma_f32_16x16x32_bf16 a[28:31], v[36:39], v[104:107], a[28:31]
    v_mfma_f32_16x16x32_bf16 a[32:35], v[36:39], v[108:111], a[32:35]
    v_mfma_f32_16x16x32_bf16 a[36:39], v[36:39], v[112:115], a[36:39]
    v_mfma_f32_16x16x32_bf16 a[40:43], v[40:43], v[96:99], a[40:43]
    v_mfma_f32_16x16x32_bf16 a[44:47], v[40:43], v[100:103], a[44:47]
    v_mfma_f32_16x16x32_bf16 a[48:51], v[40:43], v[104:107], a[48:51]
    v_mfma_f32_16x16x32_bf16 a[52:55], v[40:43], v[108:111], a[52:55]
    v_mfma_f32_16x16x32_bf16 a[56:59], v[40:43], v[112:115], a[56:59]
    v_mfma_f32_16x16x32_bf16 a[60:63], v[44:47], v[96:99], a[60:63]
    v_mfma_f32_16x16x32_bf16 a[64:67], v[44:47], v[100:103], a[64:67]
    v_mfma_f32_16x16x32_bf16 a[68:71], v[44:47], v[104:107], a[68:71]
    v_mfma_f32_16x16x32_bf16 a[72:75], v[44:47], v[108:111], a[72:75]
    v_mfma_f32_16x16x32_bf16 a[76:79], v[44:47], v[112:115], a[76:79]
    v_mfma_f32_16x16x32_bf16 a[80:83], v[48:51], v[96:99], a[80:83]
    v_mfma_f32_16x16x32_bf16 a[84:87], v[48:51], v[100:103], a[84:87]
    v_mfma_f32_16x16x32_bf16 a[88:91], v[48:51], v[104:107], a[88:91]
    v_mfma_f32_16x16x32_bf16 a[92:95], v[48:51], v[108:111], a[92:95]
    v_mfma_f32_16x16x32_bf16 a[96:99], v[48:51], v[112:115], a[96:99]
    v_mfma_f32_16x16x32_bf16 a[100:103], v[52:55], v[96:99], a[100:103]
    v_mfma_f32_16x16x32_bf16 a[104:107], v[52:55], v[100:103], a[104:107]
    v_mfma_f32_16x16x32_bf16 a[108:111], v[52:55], v[104:107], a[108:111]
    v_mfma_f32_16x16x32_bf16 a[112:115], v[52:55], v[108:111], a[112:115]
    v_mfma_f32_16x16x32_bf16 a[116:119], v[52:55], v[112:115], a[116:119]
    v_mfma_f32_16x16x32_bf16 a[120:123], v[56:59], v[96:99], a[120:123]
    v_mfma_f32_16x16x32_bf16 a[124:127], v[56:59], v[100:103], a[124:127]
    v_mfma_f32_16x16x32_bf16 a[128:131], v[56:59], v[104:107], a[128:131]
    v_mfma_f32_16x16x32_bf16 a[132:135], v[56:59], v[108:111], a[132:135]
    v_mfma_f32_16x16x32_bf16 a[136:139], v[56:59], v[112:115], a[136:139]
    v_mfma_f32_16x16x32_bf16 a[140:143], v[60:63], v[96:99], a[140:143]
    v_mfma_f32_16x16x32_bf16 a[144:147], v[60:63], v[100:103], a[144:147]
    v_mfma_f32_16x16x32_bf16 a[148:151], v[60:63], v[104:107], a[148:151]
    v_mfma_f32_16x16x32_bf16 a[152:155], v[60:63], v[108:111], a[152:155]
    v_mfma_f32_16x16x32_bf16 a[156:159], v[60:63], v[112:115], a[156:159]
    s_waitcnt lgkmcnt(0)
    v_mfma_f32_16x16x32_bf16 a[0:3], v[64:67], v[116:119], a[0:3]
    v_mfma_f32_16x16x32_bf16 a[4:7], v[64:67], v[120:123], a[4:7]
    v_mfma_f32_16x16x32_bf16 a[8:11], v[64:67], v[124:127], a[8:11]
    v_mfma_f32_16x16x32_bf16 a[12:15], v[64:67], v[128:131], a[12:15]
    v_mfma_f32_16x16x32_bf16 a[16:19], v[64:67], v[132:135], a[16:19]
    v_mfma_f32_16x16x32_bf16 a[20:23], v[68:71], v[116:119], a[20:23]
    v_mfma_f32_16x16x32_bf16 a[24:27], v[68:71], v[120:123], a[24:27]
    v_mfma_f32_16x16x32_bf16 a[28:31], v[68:71], v[124:127], a[28:31]
    v_mfma_f32_16x16x32_bf16 a[32:35], v[68:71], v[128:131], a[32:35]
    v_mfma_f32_16x16x32_bf16 a[36:39], v[68:71], v[132:135], a[36:39]
    v_mfma_f32_16x16x32_bf16 a[40:43], v[72:75], v[116:119], a[40:43]
    v_mfma_f32_16x16x32_bf16 a[44:47], v[72:75], v[120:123], a[44:47]
    v_mfma_f32_16x16x32_bf16 a[48:51], v[72:75], v[124:127], a[48:51]
    v_mfma_f32_16x16x32_bf16 a[52:55], v[72:75], v[128:131], a[52:55]
    v_mfma_f32_16x16x32_bf16 a[56:59], v[72:75], v[132:135], a[56:59]
    v_mfma_f32_16x16x32_bf16 a[60:63], v[76:79], v[116:119], a[60:63]
    v_mfma_f32_16x16x32_bf16 a[64:67], v[76:79], v[120:123], a[64:67]
    v_mfma_f32_16x16x32_bf16 a[68:71], v[76:79], v[124:127], a[68:71]
    v_mfma_f32_16x16x32_bf16 a[72:75], v[76:79], v[128:131], a[72:75]
    v_mfma_f32_16x16x32_bf16 a[76:79], v[76:79], v[132:135], a[76:79]
    v_mfma_f32_16x16x32_bf16 a[80:83], v[80:83], v[116:119], a[80:83]
    v_mfma_f32_16x16x32_bf16 a[84:87], v[80:83], v[120:123], a[84:87]
    v_mfma_f32_16x16x32_bf16 a[88:91], v[80:83], v[124:127], a[88:91]
    v_mfma_f32_16x16x32_bf16 a[92:95], v[80:83], v[128:131], a[92:95]
    v_mfma_f32_16x16x32_bf16 a[96:99], v[80:83], v[132:135], a[96:99]
    v_mfma_f32_16x16x32_bf16 a[100:103], v[84:87], v[116:119], a[100:103]
    v_mfma_f32_16x16x32_bf16 a[104:107], v[84:87], v[120:123], a[104:107]
    v_mfma_f32_16x16x32_bf16 a[108:111], v[84:87], v[124:127], a[108:111]
    v_mfma_f32_16x16x32_bf16 a[112:115], v[84:87], v[128:131], a[112:115]
    v_mfma_f32_16x16x32_bf16 a[116:119], v[84:87], v[132:135], a[116:119]
    v_mfma_f32_16x16x32_bf16 a[120:123], v[88:91], v[116:119], a[120:123]
    v_mfma_f32_16x16x32_bf16 a[124:127], v[88:91], v[120:123], a[124:127]
    v_mfma_f32_16x16x32_bf16 a[128:131], v[88:91], v[124:127], a[128:131]
    v_mfma_f32_16x16x32_bf16 a[132:135], v[88:91], v[128:131], a[132:135]
    v_mfma_f32_16x16x32_bf16 a[136:139], v[88:91], v[132:135], a[136:139]
    v_mfma_f32_16x16x32_bf16 a[140:143], v[92:95], v[116:119], a[140:143]
    v_mfma_f32_16x16x32_bf16 a[144:147], v[92:95], v[120:123], a[144:147]
    v_mfma_f32_16x16x32_bf16 a[148:151], v[92:95], v[124:127], a[148:151]
    v_mfma_f32_16x16x32_bf16 a[152:155], v[92:95], v[128:131], a[152:155]
    v_mfma_f32_16x16x32_bf16 a[156:159], v[92:95], v[132:135], a[156:159]
    s_nop 7
    s_nop 7
    s_lshl_b32 s47, s37, 1
    s_add_u32 s47, s47, s38
    s_lshl_b32 s47, s47, 4
    s_add_u32 s47, s47, s36
    s_mul_i32 s47, s47, 163840
    s_lshl_b32 s48, s39, 9
    s_add_u32 s47, s47, s48
    s_add_u32 s47, s47, 10485760
    v_lshlrev_b32 v20, 11, v3
    v_lshlrev_b32 v21, 4, v2
    v_add_u32 v20, v20, v21

    s_add_u32 s52, s47, 0
    s_add_u32 s53, s47, 32768
    s_add_u32 s54, s47, 65536
    s_add_u32 s55, s47, 98304
    s_add_u32 s56, s47, 131072
    buffer_store_dwordx4 a[0:3], v20, s[28:31], s52 offen offset:0
    buffer_store_dwordx4 a[4:7], v20, s[28:31], s53 offen offset:0
    buffer_store_dwordx4 a[8:11], v20, s[28:31], s54 offen offset:0
    buffer_store_dwordx4 a[12:15], v20, s[28:31], s55 offen offset:0
    buffer_store_dwordx4 a[16:19], v20, s[28:31], s56 offen offset:0
    buffer_store_dwordx4 a[20:23], v20, s[28:31], s52 offen offset:64
    buffer_store_dwordx4 a[24:27], v20, s[28:31], s53 offen offset:64
    buffer_store_dwordx4 a[28:31], v20, s[28:31], s54 offen offset:64
    buffer_store_dwordx4 a[32:35], v20, s[28:31], s55 offen offset:64
    buffer_store_dwordx4 a[36:39], v20, s[28:31], s56 offen offset:64
    buffer_store_dwordx4 a[40:43], v20, s[28:31], s52 offen offset:128
    buffer_store_dwordx4 a[44:47], v20, s[28:31], s53 offen offset:128
    buffer_store_dwordx4 a[48:51], v20, s[28:31], s54 offen offset:128
    buffer_store_dwordx4 a[52:55], v20, s[28:31], s55 offen offset:128
    buffer_store_dwordx4 a[56:59], v20, s[28:31], s56 offen offset:128
    buffer_store_dwordx4 a[60:63], v20, s[28:31], s52 offen offset:192
    buffer_store_dwordx4 a[64:67], v20, s[28:31], s53 offen offset:192
    buffer_store_dwordx4 a[68:71], v20, s[28:31], s54 offen offset:192
    buffer_store_dwordx4 a[72:75], v20, s[28:31], s55 offen offset:192
    buffer_store_dwordx4 a[76:79], v20, s[28:31], s56 offen offset:192
    buffer_store_dwordx4 a[80:83], v20, s[28:31], s52 offen offset:256
    buffer_store_dwordx4 a[84:87], v20, s[28:31], s53 offen offset:256
    buffer_store_dwordx4 a[88:91], v20, s[28:31], s54 offen offset:256
    buffer_store_dwordx4 a[92:95], v20, s[28:31], s55 offen offset:256
    buffer_store_dwordx4 a[96:99], v20, s[28:31], s56 offen offset:256
    buffer_store_dwordx4 a[100:103], v20, s[28:31], s52 offen offset:320
    buffer_store_dwordx4 a[104:107], v20, s[28:31], s53 offen offset:320
    buffer_store_dwordx4 a[108:111], v20, s[28:31], s54 offen offset:320
    buffer_store_dwordx4 a[112:115], v20, s[28:31], s55 offen offset:320
    buffer_store_dwordx4 a[116:119], v20, s[28:31], s56 offen offset:320
    buffer_store_dwordx4 a[120:123], v20, s[28:31], s52 offen offset:384
    buffer_store_dwordx4 a[124:127], v20, s[28:31], s53 offen offset:384
    buffer_store_dwordx4 a[128:131], v20, s[28:31], s54 offen offset:384
    buffer_store_dwordx4 a[132:135], v20, s[28:31], s55 offen offset:384
    buffer_store_dwordx4 a[136:139], v20, s[28:31], s56 offen offset:384
    buffer_store_dwordx4 a[140:143], v20, s[28:31], s52 offen offset:448
    buffer_store_dwordx4 a[144:147], v20, s[28:31], s53 offen offset:448
    buffer_store_dwordx4 a[148:151], v20, s[28:31], s54 offen offset:448
    buffer_store_dwordx4 a[152:155], v20, s[28:31], s55 offen offset:448
    buffer_store_dwordx4 a[156:159], v20, s[28:31], s56 offen offset:448
    s_branch k1_kernel_done
k1_kernel_L3:
    s_nop 7
    v_max3_f32 v228, v32, v33, v34
    v_max3_f32 v228, v228, v35, v52
    v_max3_f32 v228, v228, v53, v54
    v_max_f32 v228, v228, v55
    v_mov_b32 v229, v228
    s_nop 1
    v_permlane32_swap_b32 v228, v229
    s_nop 1
    v_max_f32 v228, v228, v229
    v_mov_b32 v229, v228
    s_nop 1
    v_permlane16_swap_b32 v228, v229
    s_nop 1
    v_max_f32 v228, v228, v229
    v_max_f32 v228, s51, v228
    v_sub_f32 v229, 0, v228
    v_exp_f32 v229, v229
    v_add_f32 v221, v221, v228
    v_sub_f32 v196, v196, v228
    v_sub_f32 v32, v32, v228
    v_sub_f32 v52, v52, v228
    v_sub_f32 v197, v197, v228
    v_sub_f32 v33, v33, v228
    v_sub_f32 v53, v53, v228
    v_sub_f32 v198, v198, v228
    v_sub_f32 v34, v34, v228
    v_sub_f32 v54, v54, v228
    v_sub_f32 v199, v199, v228
    v_sub_f32 v35, v35, v228
    v_sub_f32 v55, v55, v228
    v_mul_f32 v216, v216, v229
    v_accvgpr_read_b32 v230, a0
    v_accvgpr_read_b32 v231, a1
    v_accvgpr_read_b32 v232, a2
    v_accvgpr_read_b32 v233, a3
    v_mul_f32 v230, v230, v229
    v_mul_f32 v231, v231, v229
    v_mul_f32 v232, v232, v229
    v_mul_f32 v233, v233, v229
    v_accvgpr_write_b32 a0, v230
    v_accvgpr_write_b32 a1, v231
    v_accvgpr_write_b32 a2, v232
    v_accvgpr_write_b32 a3, v233
    v_accvgpr_read_b32 v230, a20
    v_accvgpr_read_b32 v231, a21
    v_accvgpr_read_b32 v232, a22
    v_accvgpr_read_b32 v233, a23
    v_mul_f32 v230, v230, v229
    v_mul_f32 v231, v231, v229
    v_mul_f32 v232, v232, v229
    v_mul_f32 v233, v233, v229
    v_accvgpr_write_b32 a20, v230
    v_accvgpr_write_b32 a21, v231
    v_accvgpr_write_b32 a22, v232
    v_accvgpr_write_b32 a23, v233
    v_accvgpr_read_b32 v230, a40
    v_accvgpr_read_b32 v231, a41
    v_accvgpr_read_b32 v232, a42
    v_accvgpr_read_b32 v233, a43
    v_mul_f32 v230, v230, v229
    v_mul_f32 v231, v231, v229
    v_mul_f32 v232, v232, v229
    v_mul_f32 v233, v233, v229
    v_accvgpr_write_b32 a40, v230
    v_accvgpr_write_b32 a41, v231
    v_accvgpr_write_b32 a42, v232
    v_accvgpr_write_b32 a43, v233
    v_accvgpr_read_b32 v230, a60
    v_accvgpr_read_b32 v231, a61
    v_accvgpr_read_b32 v232, a62
    v_accvgpr_read_b32 v233, a63
    v_mul_f32 v230, v230, v229
    v_mul_f32 v231, v231, v229
    v_mul_f32 v232, v232, v229
    v_mul_f32 v233, v233, v229
    v_accvgpr_write_b32 a60, v230
    v_accvgpr_write_b32 a61, v231
    v_accvgpr_write_b32 a62, v232
    v_accvgpr_write_b32 a63, v233
    v_accvgpr_read_b32 v230, a80
    v_accvgpr_read_b32 v231, a81
    v_accvgpr_read_b32 v232, a82
    v_accvgpr_read_b32 v233, a83
    v_mul_f32 v230, v230, v229
    v_mul_f32 v231, v231, v229
    v_mul_f32 v232, v232, v229
    v_mul_f32 v233, v233, v229
    v_accvgpr_write_b32 a80, v230
    v_accvgpr_write_b32 a81, v231
    v_accvgpr_write_b32 a82, v232
    v_accvgpr_write_b32 a83, v233
    v_accvgpr_read_b32 v230, a100
    v_accvgpr_read_b32 v231, a101
    v_accvgpr_read_b32 v232, a102
    v_accvgpr_read_b32 v233, a103
    v_mul_f32 v230, v230, v229
    v_mul_f32 v231, v231, v229
    v_mul_f32 v232, v232, v229
    v_mul_f32 v233, v233, v229
    v_accvgpr_write_b32 a100, v230
    v_accvgpr_write_b32 a101, v231
    v_accvgpr_write_b32 a102, v232
    v_accvgpr_write_b32 a103, v233
    v_accvgpr_read_b32 v230, a120
    v_accvgpr_read_b32 v231, a121
    v_accvgpr_read_b32 v232, a122
    v_accvgpr_read_b32 v233, a123
    v_mul_f32 v230, v230, v229
    v_mul_f32 v231, v231, v229
    v_mul_f32 v232, v232, v229
    v_mul_f32 v233, v233, v229
    v_accvgpr_write_b32 a120, v230
    v_accvgpr_write_b32 a121, v231
    v_accvgpr_write_b32 a122, v232
    v_accvgpr_write_b32 a123, v233
    v_accvgpr_read_b32 v230, a140
    v_accvgpr_read_b32 v231, a141
    v_accvgpr_read_b32 v232, a142
    v_accvgpr_read_b32 v233, a143
    v_mul_f32 v230, v230, v229
    v_mul_f32 v231, v231, v229
    v_mul_f32 v232, v232, v229
    v_mul_f32 v233, v233, v229
    v_accvgpr_write_b32 a140, v230
    v_accvgpr_write_b32 a141, v231
    v_accvgpr_write_b32 a142, v232
    v_accvgpr_write_b32 a143, v233
    v_max3_f32 v228, v36, v37, v38
    v_max3_f32 v228, v228, v39, v56
    v_max3_f32 v228, v228, v57, v58
    v_max_f32 v228, v228, v59
    v_mov_b32 v229, v228
    s_nop 1
    v_permlane32_swap_b32 v228, v229
    s_nop 1
    v_max_f32 v228, v228, v229
    v_mov_b32 v229, v228
    s_nop 1
    v_permlane16_swap_b32 v228, v229
    s_nop 1
    v_max_f32 v228, v228, v229
    v_max_f32 v228, s51, v228
    v_sub_f32 v229, 0, v228
    v_exp_f32 v229, v229
    v_add_f32 v222, v222, v228
    v_sub_f32 v200, v200, v228
    v_sub_f32 v36, v36, v228
    v_sub_f32 v56, v56, v228
    v_sub_f32 v201, v201, v228
    v_sub_f32 v37, v37, v228
    v_sub_f32 v57, v57, v228
    v_sub_f32 v202, v202, v228
    v_sub_f32 v38, v38, v228
    v_sub_f32 v58, v58, v228
    v_sub_f32 v203, v203, v228
    v_sub_f32 v39, v39, v228
    v_sub_f32 v59, v59, v228
    v_mul_f32 v217, v217, v229
    v_accvgpr_read_b32 v230, a4
    v_accvgpr_read_b32 v231, a5
    v_accvgpr_read_b32 v232, a6
    v_accvgpr_read_b32 v233, a7
    v_mul_f32 v230, v230, v229
    v_mul_f32 v231, v231, v229
    v_mul_f32 v232, v232, v229
    v_mul_f32 v233, v233, v229
    v_accvgpr_write_b32 a4, v230
    v_accvgpr_write_b32 a5, v231
    v_accvgpr_write_b32 a6, v232
    v_accvgpr_write_b32 a7, v233
    v_accvgpr_read_b32 v230, a24
    v_accvgpr_read_b32 v231, a25
    v_accvgpr_read_b32 v232, a26
    v_accvgpr_read_b32 v233, a27
    v_mul_f32 v230, v230, v229
    v_mul_f32 v231, v231, v229
    v_mul_f32 v232, v232, v229
    v_mul_f32 v233, v233, v229
    v_accvgpr_write_b32 a24, v230
    v_accvgpr_write_b32 a25, v231
    v_accvgpr_write_b32 a26, v232
    v_accvgpr_write_b32 a27, v233
    v_accvgpr_read_b32 v230, a44
    v_accvgpr_read_b32 v231, a45
    v_accvgpr_read_b32 v232, a46
    v_accvgpr_read_b32 v233, a47
    v_mul_f32 v230, v230, v229
    v_mul_f32 v231, v231, v229
    v_mul_f32 v232, v232, v229
    v_mul_f32 v233, v233, v229
    v_accvgpr_write_b32 a44, v230
    v_accvgpr_write_b32 a45, v231
    v_accvgpr_write_b32 a46, v232
    v_accvgpr_write_b32 a47, v233
    v_accvgpr_read_b32 v230, a64
    v_accvgpr_read_b32 v231, a65
    v_accvgpr_read_b32 v232, a66
    v_accvgpr_read_b32 v233, a67
    v_mul_f32 v230, v230, v229
    v_mul_f32 v231, v231, v229
    v_mul_f32 v232, v232, v229
    v_mul_f32 v233, v233, v229
    v_accvgpr_write_b32 a64, v230
    v_accvgpr_write_b32 a65, v231
    v_accvgpr_write_b32 a66, v232
    v_accvgpr_write_b32 a67, v233
    v_accvgpr_read_b32 v230, a84
    v_accvgpr_read_b32 v231, a85
    v_accvgpr_read_b32 v232, a86
    v_accvgpr_read_b32 v233, a87
    v_mul_f32 v230, v230, v229
    v_mul_f32 v231, v231, v229
    v_mul_f32 v232, v232, v229
    v_mul_f32 v233, v233, v229
    v_accvgpr_write_b32 a84, v230
    v_accvgpr_write_b32 a85, v231
    v_accvgpr_write_b32 a86, v232
    v_accvgpr_write_b32 a87, v233
    v_accvgpr_read_b32 v230, a104
    v_accvgpr_read_b32 v231, a105
    v_accvgpr_read_b32 v232, a106
    v_accvgpr_read_b32 v233, a107
    v_mul_f32 v230, v230, v229
    v_mul_f32 v231, v231, v229
    v_mul_f32 v232, v232, v229
    v_mul_f32 v233, v233, v229
    v_accvgpr_write_b32 a104, v230
    v_accvgpr_write_b32 a105, v231
    v_accvgpr_write_b32 a106, v232
    v_accvgpr_write_b32 a107, v233
    v_accvgpr_read_b32 v230, a124
    v_accvgpr_read_b32 v231, a125
    v_accvgpr_read_b32 v232, a126
    v_accvgpr_read_b32 v233, a127
    v_mul_f32 v230, v230, v229
    v_mul_f32 v231, v231, v229
    v_mul_f32 v232, v232, v229
    v_mul_f32 v233, v233, v229
    v_accvgpr_write_b32 a124, v230
    v_accvgpr_write_b32 a125, v231
    v_accvgpr_write_b32 a126, v232
    v_accvgpr_write_b32 a127, v233
    v_accvgpr_read_b32 v230, a144
    v_accvgpr_read_b32 v231, a145
    v_accvgpr_read_b32 v232, a146
    v_accvgpr_read_b32 v233, a147
    v_mul_f32 v230, v230, v229
    v_mul_f32 v231, v231, v229
    v_mul_f32 v232, v232, v229
    v_mul_f32 v233, v233, v229
    v_accvgpr_write_b32 a144, v230
    v_accvgpr_write_b32 a145, v231
    v_accvgpr_write_b32 a146, v232
    v_accvgpr_write_b32 a147, v233
    v_max3_f32 v228, v40, v41, v42
    v_max3_f32 v228, v228, v43, v60
    v_max3_f32 v228, v228, v61, v62
    v_max_f32 v228, v228, v63
    v_mov_b32 v229, v228
    s_nop 1
    v_permlane32_swap_b32 v228, v229
    s_nop 1
    v_max_f32 v228, v228, v229
    v_mov_b32 v229, v228
    s_nop 1
    v_permlane16_swap_b32 v228, v229
    s_nop 1
    v_max_f32 v228, v228, v229
    v_max_f32 v228, s51, v228
    v_sub_f32 v229, 0, v228
    v_exp_f32 v229, v229
    v_add_f32 v223, v223, v228
    v_sub_f32 v204, v204, v228
    v_sub_f32 v40, v40, v228
    v_sub_f32 v60, v60, v228
    v_sub_f32 v205, v205, v228
    v_sub_f32 v41, v41, v228
    v_sub_f32 v61, v61, v228
    v_sub_f32 v206, v206, v228
    v_sub_f32 v42, v42, v228
    v_sub_f32 v62, v62, v228
    v_sub_f32 v207, v207, v228
    v_sub_f32 v43, v43, v228
    v_sub_f32 v63, v63, v228
    v_mul_f32 v218, v218, v229
    v_accvgpr_read_b32 v230, a8
    v_accvgpr_read_b32 v231, a9
    v_accvgpr_read_b32 v232, a10
    v_accvgpr_read_b32 v233, a11
    v_mul_f32 v230, v230, v229
    v_mul_f32 v231, v231, v229
    v_mul_f32 v232, v232, v229
    v_mul_f32 v233, v233, v229
    v_accvgpr_write_b32 a8, v230
    v_accvgpr_write_b32 a9, v231
    v_accvgpr_write_b32 a10, v232
    v_accvgpr_write_b32 a11, v233
    v_accvgpr_read_b32 v230, a28
    v_accvgpr_read_b32 v231, a29
    v_accvgpr_read_b32 v232, a30
    v_accvgpr_read_b32 v233, a31
    v_mul_f32 v230, v230, v229
    v_mul_f32 v231, v231, v229
    v_mul_f32 v232, v232, v229
    v_mul_f32 v233, v233, v229
    v_accvgpr_write_b32 a28, v230
    v_accvgpr_write_b32 a29, v231
    v_accvgpr_write_b32 a30, v232
    v_accvgpr_write_b32 a31, v233
    v_accvgpr_read_b32 v230, a48
    v_accvgpr_read_b32 v231, a49
    v_accvgpr_read_b32 v232, a50
    v_accvgpr_read_b32 v233, a51
    v_mul_f32 v230, v230, v229
    v_mul_f32 v231, v231, v229
    v_mul_f32 v232, v232, v229
    v_mul_f32 v233, v233, v229
    v_accvgpr_write_b32 a48, v230
    v_accvgpr_write_b32 a49, v231
    v_accvgpr_write_b32 a50, v232
    v_accvgpr_write_b32 a51, v233
    v_accvgpr_read_b32 v230, a68
    v_accvgpr_read_b32 v231, a69
    v_accvgpr_read_b32 v232, a70
    v_accvgpr_read_b32 v233, a71
    v_mul_f32 v230, v230, v229
    v_mul_f32 v231, v231, v229
    v_mul_f32 v232, v232, v229
    v_mul_f32 v233, v233, v229
    v_accvgpr_write_b32 a68, v230
    v_accvgpr_write_b32 a69, v231
    v_accvgpr_write_b32 a70, v232
    v_accvgpr_write_b32 a71, v233
    v_accvgpr_read_b32 v230, a88
    v_accvgpr_read_b32 v231, a89
    v_accvgpr_read_b32 v232, a90
    v_accvgpr_read_b32 v233, a91
    v_mul_f32 v230, v230, v229
    v_mul_f32 v231, v231, v229
    v_mul_f32 v232, v232, v229
    v_mul_f32 v233, v233, v229
    v_accvgpr_write_b32 a88, v230
    v_accvgpr_write_b32 a89, v231
    v_accvgpr_write_b32 a90, v232
    v_accvgpr_write_b32 a91, v233
    v_accvgpr_read_b32 v230, a108
    v_accvgpr_read_b32 v231, a109
    v_accvgpr_read_b32 v232, a110
    v_accvgpr_read_b32 v233, a111
    v_mul_f32 v230, v230, v229
    v_mul_f32 v231, v231, v229
    v_mul_f32 v232, v232, v229
    v_mul_f32 v233, v233, v229
    v_accvgpr_write_b32 a108, v230
    v_accvgpr_write_b32 a109, v231
    v_accvgpr_write_b32 a110, v232
    v_accvgpr_write_b32 a111, v233
    v_accvgpr_read_b32 v230, a128
    v_accvgpr_read_b32 v231, a129
    v_accvgpr_read_b32 v232, a130
    v_accvgpr_read_b32 v233, a131
    v_mul_f32 v230, v230, v229
    v_mul_f32 v231, v231, v229
    v_mul_f32 v232, v232, v229
    v_mul_f32 v233, v233, v229
    v_accvgpr_write_b32 a128, v230
    v_accvgpr_write_b32 a129, v231
    v_accvgpr_write_b32 a130, v232
    v_accvgpr_write_b32 a131, v233
    v_accvgpr_read_b32 v230, a148
    v_accvgpr_read_b32 v231, a149
    v_accvgpr_read_b32 v232, a150
    v_accvgpr_read_b32 v233, a151
    v_mul_f32 v230, v230, v229
    v_mul_f32 v231, v231, v229
    v_mul_f32 v232, v232, v229
    v_mul_f32 v233, v233, v229
    v_accvgpr_write_b32 a148, v230
    v_accvgpr_write_b32 a149, v231
    v_accvgpr_write_b32 a150, v232
    v_accvgpr_write_b32 a151, v233
    v_max3_f32 v228, v44, v45, v46
    v_max3_f32 v228, v228, v47, v64
    v_max3_f32 v228, v228, v65, v66
    v_max_f32 v228, v228, v67
    v_mov_b32 v229, v228
    s_nop 1
    v_permlane32_swap_b32 v228, v229
    s_nop 1
    v_max_f32 v228, v228, v229
    v_mov_b32 v229, v228
    s_nop 1
    v_permlane16_swap_b32 v228, v229
    s_nop 1
    v_max_f32 v228, v228, v229
    v_max_f32 v228, s51, v228
    v_sub_f32 v229, 0, v228
    v_exp_f32 v229, v229
    v_add_f32 v224, v224, v228
    v_sub_f32 v208, v208, v228
    v_sub_f32 v44, v44, v228
    v_sub_f32 v64, v64, v228
    v_sub_f32 v209, v209, v228
    v_sub_f32 v45, v45, v228
    v_sub_f32 v65, v65, v228
    v_sub_f32 v210, v210, v228
    v_sub_f32 v46, v46, v228
    v_sub_f32 v66, v66, v228
    v_sub_f32 v211, v211, v228
    v_sub_f32 v47, v47, v228
    v_sub_f32 v67, v67, v228
    v_mul_f32 v219, v219, v229
    v_accvgpr_read_b32 v230, a12
    v_accvgpr_read_b32 v231, a13
    v_accvgpr_read_b32 v232, a14
    v_accvgpr_read_b32 v233, a15
    v_mul_f32 v230, v230, v229
    v_mul_f32 v231, v231, v229
    v_mul_f32 v232, v232, v229
    v_mul_f32 v233, v233, v229
    v_accvgpr_write_b32 a12, v230
    v_accvgpr_write_b32 a13, v231
    v_accvgpr_write_b32 a14, v232
    v_accvgpr_write_b32 a15, v233
    v_accvgpr_read_b32 v230, a32
    v_accvgpr_read_b32 v231, a33
    v_accvgpr_read_b32 v232, a34
    v_accvgpr_read_b32 v233, a35
    v_mul_f32 v230, v230, v229
    v_mul_f32 v231, v231, v229
    v_mul_f32 v232, v232, v229
    v_mul_f32 v233, v233, v229
    v_accvgpr_write_b32 a32, v230
    v_accvgpr_write_b32 a33, v231
    v_accvgpr_write_b32 a34, v232
    v_accvgpr_write_b32 a35, v233
    v_accvgpr_read_b32 v230, a52
    v_accvgpr_read_b32 v231, a53
    v_accvgpr_read_b32 v232, a54
    v_accvgpr_read_b32 v233, a55
    v_mul_f32 v230, v230, v229
    v_mul_f32 v231, v231, v229
    v_mul_f32 v232, v232, v229
    v_mul_f32 v233, v233, v229
    v_accvgpr_write_b32 a52, v230
    v_accvgpr_write_b32 a53, v231
    v_accvgpr_write_b32 a54, v232
    v_accvgpr_write_b32 a55, v233
    v_accvgpr_read_b32 v230, a72
    v_accvgpr_read_b32 v231, a73
    v_accvgpr_read_b32 v232, a74
    v_accvgpr_read_b32 v233, a75
    v_mul_f32 v230, v230, v229
    v_mul_f32 v231, v231, v229
    v_mul_f32 v232, v232, v229
    v_mul_f32 v233, v233, v229
    v_accvgpr_write_b32 a72, v230
    v_accvgpr_write_b32 a73, v231
    v_accvgpr_write_b32 a74, v232
    v_accvgpr_write_b32 a75, v233
    v_accvgpr_read_b32 v230, a92
    v_accvgpr_read_b32 v231, a93
    v_accvgpr_read_b32 v232, a94
    v_accvgpr_read_b32 v233, a95
    v_mul_f32 v230, v230, v229
    v_mul_f32 v231, v231, v229
    v_mul_f32 v232, v232, v229
    v_mul_f32 v233, v233, v229
    v_accvgpr_write_b32 a92, v230
    v_accvgpr_write_b32 a93, v231
    v_accvgpr_write_b32 a94, v232
    v_accvgpr_write_b32 a95, v233
    v_accvgpr_read_b32 v230, a112
    v_accvgpr_read_b32 v231, a113
    v_accvgpr_read_b32 v232, a114
    v_accvgpr_read_b32 v233, a115
    v_mul_f32 v230, v230, v229
    v_mul_f32 v231, v231, v229
    v_mul_f32 v232, v232, v229
    v_mul_f32 v233, v233, v229
    v_accvgpr_write_b32 a112, v230
    v_accvgpr_write_b32 a113, v231
    v_accvgpr_write_b32 a114, v232
    v_accvgpr_write_b32 a115, v233
    v_accvgpr_read_b32 v230, a132
    v_accvgpr_read_b32 v231, a133
    v_accvgpr_read_b32 v232, a134
    v_accvgpr_read_b32 v233, a135
    v_mul_f32 v230, v230, v229
    v_mul_f32 v231, v231, v229
    v_mul_f32 v232, v232, v229
    v_mul_f32 v233, v233, v229
    v_accvgpr_write_b32 a132, v230
    v_accvgpr_write_b32 a133, v231
    v_accvgpr_write_b32 a134, v232
    v_accvgpr_write_b32 a135, v233
    v_accvgpr_read_b32 v230, a152
    v_accvgpr_read_b32 v231, a153
    v_accvgpr_read_b32 v232, a154
    v_accvgpr_read_b32 v233, a155
    v_mul_f32 v230, v230, v229
    v_mul_f32 v231, v231, v229
    v_mul_f32 v232, v232, v229
    v_mul_f32 v233, v233, v229
    v_accvgpr_write_b32 a152, v230
    v_accvgpr_write_b32 a153, v231
    v_accvgpr_write_b32 a154, v232
    v_accvgpr_write_b32 a155, v233
    v_max3_f32 v228, v48, v49, v50
    v_max3_f32 v228, v228, v51, v68
    v_max3_f32 v228, v228, v69, v70
    v_max_f32 v228, v228, v71
    v_mov_b32 v229, v228
    s_nop 1
    v_permlane32_swap_b32 v228, v229
    s_nop 1
    v_max_f32 v228, v228, v229
    v_mov_b32 v229, v228
    s_nop 1
    v_permlane16_swap_b32 v228, v229
    s_nop 1
    v_max_f32 v228, v228, v229
    v_max_f32 v228, s51, v228
    v_sub_f32 v229, 0, v228
    v_exp_f32 v229, v229
    v_add_f32 v225, v225, v228
    v_sub_f32 v212, v212, v228
    v_sub_f32 v48, v48, v228
    v_sub_f32 v68, v68, v228
    v_sub_f32 v213, v213, v228
    v_sub_f32 v49, v49, v228
    v_sub_f32 v69, v69, v228
    v_sub_f32 v214, v214, v228
    v_sub_f32 v50, v50, v228
    v_sub_f32 v70, v70, v228
    v_sub_f32 v215, v215, v228
    v_sub_f32 v51, v51, v228
    v_sub_f32 v71, v71, v228
    v_mul_f32 v220, v220, v229
    v_accvgpr_read_b32 v230, a16
    v_accvgpr_read_b32 v231, a17
    v_accvgpr_read_b32 v232, a18
    v_accvgpr_read_b32 v233, a19
    v_mul_f32 v230, v230, v229
    v_mul_f32 v231, v231, v229
    v_mul_f32 v232, v232, v229
    v_mul_f32 v233, v233, v229
    v_accvgpr_write_b32 a16, v230
    v_accvgpr_write_b32 a17, v231
    v_accvgpr_write_b32 a18, v232
    v_accvgpr_write_b32 a19, v233
    v_accvgpr_read_b32 v230, a36
    v_accvgpr_read_b32 v231, a37
    v_accvgpr_read_b32 v232, a38
    v_accvgpr_read_b32 v233, a39
    v_mul_f32 v230, v230, v229
    v_mul_f32 v231, v231, v229
    v_mul_f32 v232, v232, v229
    v_mul_f32 v233, v233, v229
    v_accvgpr_write_b32 a36, v230
    v_accvgpr_write_b32 a37, v231
    v_accvgpr_write_b32 a38, v232
    v_accvgpr_write_b32 a39, v233
    v_accvgpr_read_b32 v230, a56
    v_accvgpr_read_b32 v231, a57
    v_accvgpr_read_b32 v232, a58
    v_accvgpr_read_b32 v233, a59
    v_mul_f32 v230, v230, v229
    v_mul_f32 v231, v231, v229
    v_mul_f32 v232, v232, v229
    v_mul_f32 v233, v233, v229
    v_accvgpr_write_b32 a56, v230
    v_accvgpr_write_b32 a57, v231
    v_accvgpr_write_b32 a58, v232
    v_accvgpr_write_b32 a59, v233
    v_accvgpr_read_b32 v230, a76
    v_accvgpr_read_b32 v231, a77
    v_accvgpr_read_b32 v232, a78
    v_accvgpr_read_b32 v233, a79
    v_mul_f32 v230, v230, v229
    v_mul_f32 v231, v231, v229
    v_mul_f32 v232, v232, v229
    v_mul_f32 v233, v233, v229
    v_accvgpr_write_b32 a76, v230
    v_accvgpr_write_b32 a77, v231
    v_accvgpr_write_b32 a78, v232
    v_accvgpr_write_b32 a79, v233
    v_accvgpr_read_b32 v230, a96
    v_accvgpr_read_b32 v231, a97
    v_accvgpr_read_b32 v232, a98
    v_accvgpr_read_b32 v233, a99
    v_mul_f32 v230, v230, v229
    v_mul_f32 v231, v231, v229
    v_mul_f32 v232, v232, v229
    v_mul_f32 v233, v233, v229
    v_accvgpr_write_b32 a96, v230
    v_accvgpr_write_b32 a97, v231
    v_accvgpr_write_b32 a98, v232
    v_accvgpr_write_b32 a99, v233
    v_accvgpr_read_b32 v230, a116
    v_accvgpr_read_b32 v231, a117
    v_accvgpr_read_b32 v232, a118
    v_accvgpr_read_b32 v233, a119
    v_mul_f32 v230, v230, v229
    v_mul_f32 v231, v231, v229
    v_mul_f32 v232, v232, v229
    v_mul_f32 v233, v233, v229
    v_accvgpr_write_b32 a116, v230
    v_accvgpr_write_b32 a117, v231
    v_accvgpr_write_b32 a118, v232
    v_accvgpr_write_b32 a119, v233
    v_accvgpr_read_b32 v230, a136
    v_accvgpr_read_b32 v231, a137
    v_accvgpr_read_b32 v232, a138
    v_accvgpr_read_b32 v233, a139
    v_mul_f32 v230, v230, v229
    v_mul_f32 v231, v231, v229
    v_mul_f32 v232, v232, v229
    v_mul_f32 v233, v233, v229
    v_accvgpr_write_b32 a136, v230
    v_accvgpr_write_b32 a137, v231
    v_accvgpr_write_b32 a138, v232
    v_accvgpr_write_b32 a139, v233
    v_accvgpr_read_b32 v230, a156
    v_accvgpr_read_b32 v231, a157
    v_accvgpr_read_b32 v232, a158
    v_accvgpr_read_b32 v233, a159
    v_mul_f32 v230, v230, v229
    v_mul_f32 v231, v231, v229
    v_mul_f32 v232, v232, v229
    v_mul_f32 v233, v233, v229
    v_accvgpr_write_b32 a156, v230
    v_accvgpr_write_b32 a157, v231
    v_accvgpr_write_b32 a158, v232
    v_accvgpr_write_b32 a159, v233
    s_mov_b32 s50, 0x41000000
    s_mov_b32 s51, 0
    s_nop 1
    s_branch k1_kernel_L4
k1_kernel_L5:
    s_nop 7
    v_max3_f32 v228, v72, v73, v74
    v_max3_f32 v228, v228, v75, v92
    v_max3_f32 v228, v228, v93, v94
    v_max_f32 v228, v228, v95
    v_mov_b32 v229, v228
    s_nop 1
    v_permlane32_swap_b32 v228, v229
    s_nop 1
    v_max_f32 v228, v228, v229
    v_mov_b32 v229, v228
    s_nop 1
    v_permlane16_swap_b32 v228, v229
    s_nop 1
    v_max_f32 v228, v228, v229
    v_max_f32 v228, s51, v228
    v_sub_f32 v229, 0, v228
    v_exp_f32 v229, v229
    v_add_f32 v221, v221, v228
    v_sub_f32 v196, v196, v228
    v_sub_f32 v72, v72, v228
    v_sub_f32 v92, v92, v228
    v_sub_f32 v197, v197, v228
    v_sub_f32 v73, v73, v228
    v_sub_f32 v93, v93, v228
    v_sub_f32 v198, v198, v228
    v_sub_f32 v74, v74, v228
    v_sub_f32 v94, v94, v228
    v_sub_f32 v199, v199, v228
    v_sub_f32 v75, v75, v228
    v_sub_f32 v95, v95, v228
    v_mul_f32 v216, v216, v229
    v_accvgpr_read_b32 v230, a0
    v_accvgpr_read_b32 v231, a1
    v_accvgpr_read_b32 v232, a2
    v_accvgpr_read_b32 v233, a3
    v_mul_f32 v230, v230, v229
    v_mul_f32 v231, v231, v229
    v_mul_f32 v232, v232, v229
    v_mul_f32 v233, v233, v229
    v_accvgpr_write_b32 a0, v230
    v_accvgpr_write_b32 a1, v231
    v_accvgpr_write_b32 a2, v232
    v_accvgpr_write_b32 a3, v233
    v_accvgpr_read_b32 v230, a20
    v_accvgpr_read_b32 v231, a21
    v_accvgpr_read_b32 v232, a22
    v_accvgpr_read_b32 v233, a23
    v_mul_f32 v230, v230, v229
    v_mul_f32 v231, v231, v229
    v_mul_f32 v232, v232, v229
    v_mul_f32 v233, v233, v229
    v_accvgpr_write_b32 a20, v230
    v_accvgpr_write_b32 a21, v231
    v_accvgpr_write_b32 a22, v232
    v_accvgpr_write_b32 a23, v233
    v_accvgpr_read_b32 v230, a40
    v_accvgpr_read_b32 v231, a41
    v_accvgpr_read_b32 v232, a42
    v_accvgpr_read_b32 v233, a43
    v_mul_f32 v230, v230, v229
    v_mul_f32 v231, v231, v229
    v_mul_f32 v232, v232, v229
    v_mul_f32 v233, v233, v229
    v_accvgpr_write_b32 a40, v230
    v_accvgpr_write_b32 a41, v231
    v_accvgpr_write_b32 a42, v232
    v_accvgpr_write_b32 a43, v233
    v_accvgpr_read_b32 v230, a60
    v_accvgpr_read_b32 v231, a61
    v_accvgpr_read_b32 v232, a62
    v_accvgpr_read_b32 v233, a63
    v_mul_f32 v230, v230, v229
    v_mul_f32 v231, v231, v229
    v_mul_f32 v232, v232, v229
    v_mul_f32 v233, v233, v229
    v_accvgpr_write_b32 a60, v230
    v_accvgpr_write_b32 a61, v231
    v_accvgpr_write_b32 a62, v232
    v_accvgpr_write_b32 a63, v233
    v_accvgpr_read_b32 v230, a80
    v_accvgpr_read_b32 v231, a81
    v_accvgpr_read_b32 v232, a82
    v_accvgpr_read_b32 v233, a83
    v_mul_f32 v230, v230, v229
    v_mul_f32 v231, v231, v229
    v_mul_f32 v232, v232, v229
    v_mul_f32 v233, v233, v229
    v_accvgpr_write_b32 a80, v230
    v_accvgpr_write_b32 a81, v231
    v_accvgpr_write_b32 a82, v232
    v_accvgpr_write_b32 a83, v233
    v_accvgpr_read_b32 v230, a100
    v_accvgpr_read_b32 v231, a101
    v_accvgpr_read_b32 v232, a102
    v_accvgpr_read_b32 v233, a103
    v_mul_f32 v230, v230, v229
    v_mul_f32 v231, v231, v229
    v_mul_f32 v232, v232, v229
    v_mul_f32 v233, v233, v229
    v_accvgpr_write_b32 a100, v230
    v_accvgpr_write_b32 a101, v231
    v_accvgpr_write_b32 a102, v232
    v_accvgpr_write_b32 a103, v233
    v_accvgpr_read_b32 v230, a120
    v_accvgpr_read_b32 v231, a121
    v_accvgpr_read_b32 v232, a122
    v_accvgpr_read_b32 v233, a123
    v_mul_f32 v230, v230, v229
    v_mul_f32 v231, v231, v229
    v_mul_f32 v232, v232, v229
    v_mul_f32 v233, v233, v229
    v_accvgpr_write_b32 a120, v230
    v_accvgpr_write_b32 a121, v231
    v_accvgpr_write_b32 a122, v232
    v_accvgpr_write_b32 a123, v233
    v_accvgpr_read_b32 v230, a140
    v_accvgpr_read_b32 v231, a141
    v_accvgpr_read_b32 v232, a142
    v_accvgpr_read_b32 v233, a143
    v_mul_f32 v230, v230, v229
    v_mul_f32 v231, v231, v229
    v_mul_f32 v232, v232, v229
    v_mul_f32 v233, v233, v229
    v_accvgpr_write_b32 a140, v230
    v_accvgpr_write_b32 a141, v231
    v_accvgpr_write_b32 a142, v232
    v_accvgpr_write_b32 a143, v233
    v_max3_f32 v228, v76, v77, v78
    v_max3_f32 v228, v228, v79, v96
    v_max3_f32 v228, v228, v97, v98
    v_max_f32 v228, v228, v99
    v_mov_b32 v229, v228
    s_nop 1
    v_permlane32_swap_b32 v228, v229
    s_nop 1
    v_max_f32 v228, v228, v229
    v_mov_b32 v229, v228
    s_nop 1
    v_permlane16_swap_b32 v228, v229
    s_nop 1
    v_max_f32 v228, v228, v229
    v_max_f32 v228, s51, v228
    v_sub_f32 v229, 0, v228
    v_exp_f32 v229, v229
    v_add_f32 v222, v222, v228
    v_sub_f32 v200, v200, v228
    v_sub_f32 v76, v76, v228
    v_sub_f32 v96, v96, v228
    v_sub_f32 v201, v201, v228
    v_sub_f32 v77, v77, v228
    v_sub_f32 v97, v97, v228
    v_sub_f32 v202, v202, v228
    v_sub_f32 v78, v78, v228
    v_sub_f32 v98, v98, v228
    v_sub_f32 v203, v203, v228
    v_sub_f32 v79, v79, v228
    v_sub_f32 v99, v99, v228
    v_mul_f32 v217, v217, v229
    v_accvgpr_read_b32 v230, a4
    v_accvgpr_read_b32 v231, a5
    v_accvgpr_read_b32 v232, a6
    v_accvgpr_read_b32 v233, a7
    v_mul_f32 v230, v230, v229
    v_mul_f32 v231, v231, v229
    v_mul_f32 v232, v232, v229
    v_mul_f32 v233, v233, v229
    v_accvgpr_write_b32 a4, v230
    v_accvgpr_write_b32 a5, v231
    v_accvgpr_write_b32 a6, v232
    v_accvgpr_write_b32 a7, v233
    v_accvgpr_read_b32 v230, a24
    v_accvgpr_read_b32 v231, a25
    v_accvgpr_read_b32 v232, a26
    v_accvgpr_read_b32 v233, a27
    v_mul_f32 v230, v230, v229
    v_mul_f32 v231, v231, v229
    v_mul_f32 v232, v232, v229
    v_mul_f32 v233, v233, v229
    v_accvgpr_write_b32 a24, v230
    v_accvgpr_write_b32 a25, v231
    v_accvgpr_write_b32 a26, v232
    v_accvgpr_write_b32 a27, v233
    v_accvgpr_read_b32 v230, a44
    v_accvgpr_read_b32 v231, a45
    v_accvgpr_read_b32 v232, a46
    v_accvgpr_read_b32 v233, a47
    v_mul_f32 v230, v230, v229
    v_mul_f32 v231, v231, v229
    v_mul_f32 v232, v232, v229
    v_mul_f32 v233, v233, v229
    v_accvgpr_write_b32 a44, v230
    v_accvgpr_write_b32 a45, v231
    v_accvgpr_write_b32 a46, v232
    v_accvgpr_write_b32 a47, v233
    v_accvgpr_read_b32 v230, a64
    v_accvgpr_read_b32 v231, a65
    v_accvgpr_read_b32 v232, a66
    v_accvgpr_read_b32 v233, a67
    v_mul_f32 v230, v230, v229
    v_mul_f32 v231, v231, v229
    v_mul_f32 v232, v232, v229
    v_mul_f32 v233, v233, v229
    v_accvgpr_write_b32 a64, v230
    v_accvgpr_write_b32 a65, v231
    v_accvgpr_write_b32 a66, v232
    v_accvgpr_write_b32 a67, v233
    v_accvgpr_read_b32 v230, a84
    v_accvgpr_read_b32 v231, a85
    v_accvgpr_read_b32 v232, a86
    v_accvgpr_read_b32 v233, a87
    v_mul_f32 v230, v230, v229
    v_mul_f32 v231, v231, v229
    v_mul_f32 v232, v232, v229
    v_mul_f32 v233, v233, v229
    v_accvgpr_write_b32 a84, v230
    v_accvgpr_write_b32 a85, v231
    v_accvgpr_write_b32 a86, v232
    v_accvgpr_write_b32 a87, v233
    v_accvgpr_read_b32 v230, a104
    v_accvgpr_read_b32 v231, a105
    v_accvgpr_read_b32 v232, a106
    v_accvgpr_read_b32 v233, a107
    v_mul_f32 v230, v230, v229
    v_mul_f32 v231, v231, v229
    v_mul_f32 v232, v232, v229
    v_mul_f32 v233, v233, v229
    v_accvgpr_write_b32 a104, v230
    v_accvgpr_write_b32 a105, v231
    v_accvgpr_write_b32 a106, v232
    v_accvgpr_write_b32 a107, v233
    v_accvgpr_read_b32 v230, a124
    v_accvgpr_read_b32 v231, a125
    v_accvgpr_read_b32 v232, a126
    v_accvgpr_read_b32 v233, a127
    v_mul_f32 v230, v230, v229
    v_mul_f32 v231, v231, v229
    v_mul_f32 v232, v232, v229
    v_mul_f32 v233, v233, v229
    v_accvgpr_write_b32 a124, v230
    v_accvgpr_write_b32 a125, v231
    v_accvgpr_write_b32 a126, v232
    v_accvgpr_write_b32 a127, v233
    v_accvgpr_read_b32 v230, a144
    v_accvgpr_read_b32 v231, a145
    v_accvgpr_read_b32 v232, a146
    v_accvgpr_read_b32 v233, a147
    v_mul_f32 v230, v230, v229
    v_mul_f32 v231, v231, v229
    v_mul_f32 v232, v232, v229
    v_mul_f32 v233, v233, v229
    v_accvgpr_write_b32 a144, v230
    v_accvgpr_write_b32 a145, v231
    v_accvgpr_write_b32 a146, v232
    v_accvgpr_write_b32 a147, v233
    v_max3_f32 v228, v80, v81, v82
    v_max3_f32 v228, v228, v83, v100
    v_max3_f32 v228, v228, v101, v102
    v_max_f32 v228, v228, v103
    v_mov_b32 v229, v228
    s_nop 1
    v_permlane32_swap_b32 v228, v229
    s_nop 1
    v_max_f32 v228, v228, v229
    v_mov_b32 v229, v228
    s_nop 1
    v_permlane16_swap_b32 v228, v229
    s_nop 1
    v_max_f32 v228, v228, v229
    v_max_f32 v228, s51, v228
    v_sub_f32 v229, 0, v228
    v_exp_f32 v229, v229
    v_add_f32 v223, v223, v228
    v_sub_f32 v204, v204, v228
    v_sub_f32 v80, v80, v228
    v_sub_f32 v100, v100, v228
    v_sub_f32 v205, v205, v228
    v_sub_f32 v81, v81, v228
    v_sub_f32 v101, v101, v228
    v_sub_f32 v206, v206, v228
    v_sub_f32 v82, v82, v228
    v_sub_f32 v102, v102, v228
    v_sub_f32 v207, v207, v228
    v_sub_f32 v83, v83, v228
    v_sub_f32 v103, v103, v228
    v_mul_f32 v218, v218, v229
    v_accvgpr_read_b32 v230, a8
    v_accvgpr_read_b32 v231, a9
    v_accvgpr_read_b32 v232, a10
    v_accvgpr_read_b32 v233, a11
    v_mul_f32 v230, v230, v229
    v_mul_f32 v231, v231, v229
    v_mul_f32 v232, v232, v229
    v_mul_f32 v233, v233, v229
    v_accvgpr_write_b32 a8, v230
    v_accvgpr_write_b32 a9, v231
    v_accvgpr_write_b32 a10, v232
    v_accvgpr_write_b32 a11, v233
    v_accvgpr_read_b32 v230, a28
    v_accvgpr_read_b32 v231, a29
    v_accvgpr_read_b32 v232, a30
    v_accvgpr_read_b32 v233, a31
    v_mul_f32 v230, v230, v229
    v_mul_f32 v231, v231, v229
    v_mul_f32 v232, v232, v229
    v_mul_f32 v233, v233, v229
    v_accvgpr_write_b32 a28, v230
    v_accvgpr_write_b32 a29, v231
    v_accvgpr_write_b32 a30, v232
    v_accvgpr_write_b32 a31, v233
    v_accvgpr_read_b32 v230, a48
    v_accvgpr_read_b32 v231, a49
    v_accvgpr_read_b32 v232, a50
    v_accvgpr_read_b32 v233, a51
    v_mul_f32 v230, v230, v229
    v_mul_f32 v231, v231, v229
    v_mul_f32 v232, v232, v229
    v_mul_f32 v233, v233, v229
    v_accvgpr_write_b32 a48, v230
    v_accvgpr_write_b32 a49, v231
    v_accvgpr_write_b32 a50, v232
    v_accvgpr_write_b32 a51, v233
    v_accvgpr_read_b32 v230, a68
    v_accvgpr_read_b32 v231, a69
    v_accvgpr_read_b32 v232, a70
    v_accvgpr_read_b32 v233, a71
    v_mul_f32 v230, v230, v229
    v_mul_f32 v231, v231, v229
    v_mul_f32 v232, v232, v229
    v_mul_f32 v233, v233, v229
    v_accvgpr_write_b32 a68, v230
    v_accvgpr_write_b32 a69, v231
    v_accvgpr_write_b32 a70, v232
    v_accvgpr_write_b32 a71, v233
    v_accvgpr_read_b32 v230, a88
    v_accvgpr_read_b32 v231, a89
    v_accvgpr_read_b32 v232, a90
    v_accvgpr_read_b32 v233, a91
    v_mul_f32 v230, v230, v229
    v_mul_f32 v231, v231, v229
    v_mul_f32 v232, v232, v229
    v_mul_f32 v233, v233, v229
    v_accvgpr_write_b32 a88, v230
    v_accvgpr_write_b32 a89, v231
    v_accvgpr_write_b32 a90, v232
    v_accvgpr_write_b32 a91, v233
    v_accvgpr_read_b32 v230, a108
    v_accvgpr_read_b32 v231, a109
    v_accvgpr_read_b32 v232, a110
    v_accvgpr_read_b32 v233, a111
    v_mul_f32 v230, v230, v229
    v_mul_f32 v231, v231, v229
    v_mul_f32 v232, v232, v229
    v_mul_f32 v233, v233, v229
    v_accvgpr_write_b32 a108, v230
    v_accvgpr_write_b32 a109, v231
    v_accvgpr_write_b32 a110, v232
    v_accvgpr_write_b32 a111, v233
    v_accvgpr_read_b32 v230, a128
    v_accvgpr_read_b32 v231, a129
    v_accvgpr_read_b32 v232, a130
    v_accvgpr_read_b32 v233, a131
    v_mul_f32 v230, v230, v229
    v_mul_f32 v231, v231, v229
    v_mul_f32 v232, v232, v229
    v_mul_f32 v233, v233, v229
    v_accvgpr_write_b32 a128, v230
    v_accvgpr_write_b32 a129, v231
    v_accvgpr_write_b32 a130, v232
    v_accvgpr_write_b32 a131, v233
    v_accvgpr_read_b32 v230, a148
    v_accvgpr_read_b32 v231, a149
    v_accvgpr_read_b32 v232, a150
    v_accvgpr_read_b32 v233, a151
    v_mul_f32 v230, v230, v229
    v_mul_f32 v231, v231, v229
    v_mul_f32 v232, v232, v229
    v_mul_f32 v233, v233, v229
    v_accvgpr_write_b32 a148, v230
    v_accvgpr_write_b32 a149, v231
    v_accvgpr_write_b32 a150, v232
    v_accvgpr_write_b32 a151, v233
    v_max3_f32 v228, v84, v85, v86
    v_max3_f32 v228, v228, v87, v104
    v_max3_f32 v228, v228, v105, v106
    v_max_f32 v228, v228, v107
    v_mov_b32 v229, v228
    s_nop 1
    v_permlane32_swap_b32 v228, v229
    s_nop 1
    v_max_f32 v228, v228, v229
    v_mov_b32 v229, v228
    s_nop 1
    v_permlane16_swap_b32 v228, v229
    s_nop 1
    v_max_f32 v228, v228, v229
    v_max_f32 v228, s51, v228
    v_sub_f32 v229, 0, v228
    v_exp_f32 v229, v229
    v_add_f32 v224, v224, v228
    v_sub_f32 v208, v208, v228
    v_sub_f32 v84, v84, v228
    v_sub_f32 v104, v104, v228
    v_sub_f32 v209, v209, v228
    v_sub_f32 v85, v85, v228
    v_sub_f32 v105, v105, v228
    v_sub_f32 v210, v210, v228
    v_sub_f32 v86, v86, v228
    v_sub_f32 v106, v106, v228
    v_sub_f32 v211, v211, v228
    v_sub_f32 v87, v87, v228
    v_sub_f32 v107, v107, v228
    v_mul_f32 v219, v219, v229
    v_accvgpr_read_b32 v230, a12
    v_accvgpr_read_b32 v231, a13
    v_accvgpr_read_b32 v232, a14
    v_accvgpr_read_b32 v233, a15
    v_mul_f32 v230, v230, v229
    v_mul_f32 v231, v231, v229
    v_mul_f32 v232, v232, v229
    v_mul_f32 v233, v233, v229
    v_accvgpr_write_b32 a12, v230
    v_accvgpr_write_b32 a13, v231
    v_accvgpr_write_b32 a14, v232
    v_accvgpr_write_b32 a15, v233
    v_accvgpr_read_b32 v230, a32
    v_accvgpr_read_b32 v231, a33
    v_accvgpr_read_b32 v232, a34
    v_accvgpr_read_b32 v233, a35
    v_mul_f32 v230, v230, v229
    v_mul_f32 v231, v231, v229
    v_mul_f32 v232, v232, v229
    v_mul_f32 v233, v233, v229
    v_accvgpr_write_b32 a32, v230
    v_accvgpr_write_b32 a33, v231
    v_accvgpr_write_b32 a34, v232
    v_accvgpr_write_b32 a35, v233
    v_accvgpr_read_b32 v230, a52
    v_accvgpr_read_b32 v231, a53
    v_accvgpr_read_b32 v232, a54
    v_accvgpr_read_b32 v233, a55
    v_mul_f32 v230, v230, v229
    v_mul_f32 v231, v231, v229
    v_mul_f32 v232, v232, v229
    v_mul_f32 v233, v233, v229
    v_accvgpr_write_b32 a52, v230
    v_accvgpr_write_b32 a53, v231
    v_accvgpr_write_b32 a54, v232
    v_accvgpr_write_b32 a55, v233
    v_accvgpr_read_b32 v230, a72
    v_accvgpr_read_b32 v231, a73
    v_accvgpr_read_b32 v232, a74
    v_accvgpr_read_b32 v233, a75
    v_mul_f32 v230, v230, v229
    v_mul_f32 v231, v231, v229
    v_mul_f32 v232, v232, v229
    v_mul_f32 v233, v233, v229
    v_accvgpr_write_b32 a72, v230
    v_accvgpr_write_b32 a73, v231
    v_accvgpr_write_b32 a74, v232
    v_accvgpr_write_b32 a75, v233
    v_accvgpr_read_b32 v230, a92
    v_accvgpr_read_b32 v231, a93
    v_accvgpr_read_b32 v232, a94
    v_accvgpr_read_b32 v233, a95
    v_mul_f32 v230, v230, v229
    v_mul_f32 v231, v231, v229
    v_mul_f32 v232, v232, v229
    v_mul_f32 v233, v233, v229
    v_accvgpr_write_b32 a92, v230
    v_accvgpr_write_b32 a93, v231
    v_accvgpr_write_b32 a94, v232
    v_accvgpr_write_b32 a95, v233
    v_accvgpr_read_b32 v230, a112
    v_accvgpr_read_b32 v231, a113
    v_accvgpr_read_b32 v232, a114
    v_accvgpr_read_b32 v233, a115
    v_mul_f32 v230, v230, v229
    v_mul_f32 v231, v231, v229
    v_mul_f32 v232, v232, v229
    v_mul_f32 v233, v233, v229
    v_accvgpr_write_b32 a112, v230
    v_accvgpr_write_b32 a113, v231
    v_accvgpr_write_b32 a114, v232
    v_accvgpr_write_b32 a115, v233
    v_accvgpr_read_b32 v230, a132
    v_accvgpr_read_b32 v231, a133
    v_accvgpr_read_b32 v232, a134
    v_accvgpr_read_b32 v233, a135
    v_mul_f32 v230, v230, v229
    v_mul_f32 v231, v231, v229
    v_mul_f32 v232, v232, v229
    v_mul_f32 v233, v233, v229
    v_accvgpr_write_b32 a132, v230
    v_accvgpr_write_b32 a133, v231
    v_accvgpr_write_b32 a134, v232
    v_accvgpr_write_b32 a135, v233
    v_accvgpr_read_b32 v230, a152
    v_accvgpr_read_b32 v231, a153
    v_accvgpr_read_b32 v232, a154
    v_accvgpr_read_b32 v233, a155
    v_mul_f32 v230, v230, v229
    v_mul_f32 v231, v231, v229
    v_mul_f32 v232, v232, v229
    v_mul_f32 v233, v233, v229
    v_accvgpr_write_b32 a152, v230
    v_accvgpr_write_b32 a153, v231
    v_accvgpr_write_b32 a154, v232
    v_accvgpr_write_b32 a155, v233
    v_max3_f32 v228, v88, v89, v90
    v_max3_f32 v228, v228, v91, v108
    v_max3_f32 v228, v228, v109, v110
    v_max_f32 v228, v228, v111
    v_mov_b32 v229, v228
    s_nop 1
    v_permlane32_swap_b32 v228, v229
    s_nop 1
    v_max_f32 v228, v228, v229
    v_mov_b32 v229, v228
    s_nop 1
    v_permlane16_swap_b32 v228, v229
    s_nop 1
    v_max_f32 v228, v228, v229
    v_max_f32 v228, s51, v228
    v_sub_f32 v229, 0, v228
    v_exp_f32 v229, v229
    v_add_f32 v225, v225, v228
    v_sub_f32 v212, v212, v228
    v_sub_f32 v88, v88, v228
    v_sub_f32 v108, v108, v228
    v_sub_f32 v213, v213, v228
    v_sub_f32 v89, v89, v228
    v_sub_f32 v109, v109, v228
    v_sub_f32 v214, v214, v228
    v_sub_f32 v90, v90, v228
    v_sub_f32 v110, v110, v228
    v_sub_f32 v215, v215, v228
    v_sub_f32 v91, v91, v228
    v_sub_f32 v111, v111, v228
    v_mul_f32 v220, v220, v229
    v_accvgpr_read_b32 v230, a16
    v_accvgpr_read_b32 v231, a17
    v_accvgpr_read_b32 v232, a18
    v_accvgpr_read_b32 v233, a19
    v_mul_f32 v230, v230, v229
    v_mul_f32 v231, v231, v229
    v_mul_f32 v232, v232, v229
    v_mul_f32 v233, v233, v229
    v_accvgpr_write_b32 a16, v230
    v_accvgpr_write_b32 a17, v231
    v_accvgpr_write_b32 a18, v232
    v_accvgpr_write_b32 a19, v233
    v_accvgpr_read_b32 v230, a36
    v_accvgpr_read_b32 v231, a37
    v_accvgpr_read_b32 v232, a38
    v_accvgpr_read_b32 v233, a39
    v_mul_f32 v230, v230, v229
    v_mul_f32 v231, v231, v229
    v_mul_f32 v232, v232, v229
    v_mul_f32 v233, v233, v229
    v_accvgpr_write_b32 a36, v230
    v_accvgpr_write_b32 a37, v231
    v_accvgpr_write_b32 a38, v232
    v_accvgpr_write_b32 a39, v233
    v_accvgpr_read_b32 v230, a56
    v_accvgpr_read_b32 v231, a57
    v_accvgpr_read_b32 v232, a58
    v_accvgpr_read_b32 v233, a59
    v_mul_f32 v230, v230, v229
    v_mul_f32 v231, v231, v229
    v_mul_f32 v232, v232, v229
    v_mul_f32 v233, v233, v229
    v_accvgpr_write_b32 a56, v230
    v_accvgpr_write_b32 a57, v231
    v_accvgpr_write_b32 a58, v232
    v_accvgpr_write_b32 a59, v233
    v_accvgpr_read_b32 v230, a76
    v_accvgpr_read_b32 v231, a77
    v_accvgpr_read_b32 v232, a78
    v_accvgpr_read_b32 v233, a79
    v_mul_f32 v230, v230, v229
    v_mul_f32 v231, v231, v229
    v_mul_f32 v232, v232, v229
    v_mul_f32 v233, v233, v229
    v_accvgpr_write_b32 a76, v230
    v_accvgpr_write_b32 a77, v231
    v_accvgpr_write_b32 a78, v232
    v_accvgpr_write_b32 a79, v233
    v_accvgpr_read_b32 v230, a96
    v_accvgpr_read_b32 v231, a97
    v_accvgpr_read_b32 v232, a98
    v_accvgpr_read_b32 v233, a99
    v_mul_f32 v230, v230, v229
    v_mul_f32 v231, v231, v229
    v_mul_f32 v232, v232, v229
    v_mul_f32 v233, v233, v229
    v_accvgpr_write_b32 a96, v230
    v_accvgpr_write_b32 a97, v231
    v_accvgpr_write_b32 a98, v232
    v_accvgpr_write_b32 a99, v233
    v_accvgpr_read_b32 v230, a116
    v_accvgpr_read_b32 v231, a117
    v_accvgpr_read_b32 v232, a118
    v_accvgpr_read_b32 v233, a119
    v_mul_f32 v230, v230, v229
    v_mul_f32 v231, v231, v229
    v_mul_f32 v232, v232, v229
    v_mul_f32 v233, v233, v229
    v_accvgpr_write_b32 a116, v230
    v_accvgpr_write_b32 a117, v231
    v_accvgpr_write_b32 a118, v232
    v_accvgpr_write_b32 a119, v233
    v_accvgpr_read_b32 v230, a136
    v_accvgpr_read_b32 v231, a137
    v_accvgpr_read_b32 v232, a138
    v_accvgpr_read_b32 v233, a139
    v_mul_f32 v230, v230, v229
    v_mul_f32 v231, v231, v229
    v_mul_f32 v232, v232, v229
    v_mul_f32 v233, v233, v229
    v_accvgpr_write_b32 a136, v230
    v_accvgpr_write_b32 a137, v231
    v_accvgpr_write_b32 a138, v232
    v_accvgpr_write_b32 a139, v233
    v_accvgpr_read_b32 v230, a156
    v_accvgpr_read_b32 v231, a157
    v_accvgpr_read_b32 v232, a158
    v_accvgpr_read_b32 v233, a159
    v_mul_f32 v230, v230, v229
    v_mul_f32 v231, v231, v229
    v_mul_f32 v232, v232, v229
    v_mul_f32 v233, v233, v229
    v_accvgpr_write_b32 a156, v230
    v_accvgpr_write_b32 a157, v231
    v_accvgpr_write_b32 a158, v232
    v_accvgpr_write_b32 a159, v233
    s_mov_b32 s50, 0x41000000
    s_mov_b32 s51, 0
    s_nop 1
    s_branch k1_kernel_L6
k1_kernel_L7:
    s_nop 7
    v_max3_f32 v228, v32, v33, v34
    v_max3_f32 v228, v228, v35, v52
    v_max3_f32 v228, v228, v53, v54
    v_max_f32 v228, v228, v55
    v_mov_b32 v229, v228
    s_nop 1
    v_permlane32_swap_b32 v228, v229
    s_nop 1
    v_max_f32 v228, v228, v229
    v_mov_b32 v229, v228
    s_nop 1
    v_permlane16_swap_b32 v228, v229
    s_nop 1
    v_max_f32 v228, v228, v229
    v_max_f32 v228, s51, v228
    v_sub_f32 v229, 0, v228
    v_exp_f32 v229, v229
    v_add_f32 v221, v221, v228
    v_sub_f32 v196, v196, v228
    v_sub_f32 v32, v32, v228
    v_sub_f32 v52, v52, v228
    v_sub_f32 v197, v197, v228
    v_sub_f32 v33, v33, v228
    v_sub_f32 v53, v53, v228
    v_sub_f32 v198, v198, v228
    v_sub_f32 v34, v34, v228
    v_sub_f32 v54, v54, v228
    v_sub_f32 v199, v199, v228
    v_sub_f32 v35, v35, v228
    v_sub_f32 v55, v55, v228
    v_mul_f32 v216, v216, v229
    v_accvgpr_read_b32 v230, a0
    v_accvgpr_read_b32 v231, a1
    v_accvgpr_read_b32 v232, a2
    v_accvgpr_read_b32 v233, a3
    v_mul_f32 v230, v230, v229
    v_mul_f32 v231, v231, v229
    v_mul_f32 v232, v232, v229
    v_mul_f32 v233, v233, v229
    v_accvgpr_write_b32 a0, v230
    v_accvgpr_write_b32 a1, v231
    v_accvgpr_write_b32 a2, v232
    v_accvgpr_write_b32 a3, v233
    v_accvgpr_read_b32 v230, a20
    v_accvgpr_read_b32 v231, a21
    v_accvgpr_read_b32 v232, a22
    v_accvgpr_read_b32 v233, a23
    v_mul_f32 v230, v230, v229
    v_mul_f32 v231, v231, v229
    v_mul_f32 v232, v232, v229
    v_mul_f32 v233, v233, v229
    v_accvgpr_write_b32 a20, v230
    v_accvgpr_write_b32 a21, v231
    v_accvgpr_write_b32 a22, v232
    v_accvgpr_write_b32 a23, v233
    v_accvgpr_read_b32 v230, a40
    v_accvgpr_read_b32 v231, a41
    v_accvgpr_read_b32 v232, a42
    v_accvgpr_read_b32 v233, a43
    v_mul_f32 v230, v230, v229
    v_mul_f32 v231, v231, v229
    v_mul_f32 v232, v232, v229
    v_mul_f32 v233, v233, v229
    v_accvgpr_write_b32 a40, v230
    v_accvgpr_write_b32 a41, v231
    v_accvgpr_write_b32 a42, v232
    v_accvgpr_write_b32 a43, v233
    v_accvgpr_read_b32 v230, a60
    v_accvgpr_read_b32 v231, a61
    v_accvgpr_read_b32 v232, a62
    v_accvgpr_read_b32 v233, a63
    v_mul_f32 v230, v230, v229
    v_mul_f32 v231, v231, v229
    v_mul_f32 v232, v232, v229
    v_mul_f32 v233, v233, v229
    v_accvgpr_write_b32 a60, v230
    v_accvgpr_write_b32 a61, v231
    v_accvgpr_write_b32 a62, v232
    v_accvgpr_write_b32 a63, v233
    v_accvgpr_read_b32 v230, a80
    v_accvgpr_read_b32 v231, a81
    v_accvgpr_read_b32 v232, a82
    v_accvgpr_read_b32 v233, a83
    v_mul_f32 v230, v230, v229
    v_mul_f32 v231, v231, v229
    v_mul_f32 v232, v232, v229
    v_mul_f32 v233, v233, v229
    v_accvgpr_write_b32 a80, v230
    v_accvgpr_write_b32 a81, v231
    v_accvgpr_write_b32 a82, v232
    v_accvgpr_write_b32 a83, v233
    v_accvgpr_read_b32 v230, a100
    v_accvgpr_read_b32 v231, a101
    v_accvgpr_read_b32 v232, a102
    v_accvgpr_read_b32 v233, a103
    v_mul_f32 v230, v230, v229
    v_mul_f32 v231, v231, v229
    v_mul_f32 v232, v232, v229
    v_mul_f32 v233, v233, v229
    v_accvgpr_write_b32 a100, v230
    v_accvgpr_write_b32 a101, v231
    v_accvgpr_write_b32 a102, v232
    v_accvgpr_write_b32 a103, v233
    v_accvgpr_read_b32 v230, a120
    v_accvgpr_read_b32 v231, a121
    v_accvgpr_read_b32 v232, a122
    v_accvgpr_read_b32 v233, a123
    v_mul_f32 v230, v230, v229
    v_mul_f32 v231, v231, v229
    v_mul_f32 v232, v232, v229
    v_mul_f32 v233, v233, v229
    v_accvgpr_write_b32 a120, v230
    v_accvgpr_write_b32 a121, v231
    v_accvgpr_write_b32 a122, v232
    v_accvgpr_write_b32 a123, v233
    v_accvgpr_read_b32 v230, a140
    v_accvgpr_read_b32 v231, a141
    v_accvgpr_read_b32 v232, a142
    v_accvgpr_read_b32 v233, a143
    v_mul_f32 v230, v230, v229
    v_mul_f32 v231, v231, v229
    v_mul_f32 v232, v232, v229
    v_mul_f32 v233, v233, v229
    v_accvgpr_write_b32 a140, v230
    v_accvgpr_write_b32 a141, v231
    v_accvgpr_write_b32 a142, v232
    v_accvgpr_write_b32 a143, v233
    v_max3_f32 v228, v36, v37, v38
    v_max3_f32 v228, v228, v39, v56
    v_max3_f32 v228, v228, v57, v58
    v_max_f32 v228, v228, v59
    v_mov_b32 v229, v228
    s_nop 1
    v_permlane32_swap_b32 v228, v229
    s_nop 1
    v_max_f32 v228, v228, v229
    v_mov_b32 v229, v228
    s_nop 1
    v_permlane16_swap_b32 v228, v229
    s_nop 1
    v_max_f32 v228, v228, v229
    v_max_f32 v228, s51, v228
    v_sub_f32 v229, 0, v228
    v_exp_f32 v229, v229
    v_add_f32 v222, v222, v228
    v_sub_f32 v200, v200, v228
    v_sub_f32 v36, v36, v228
    v_sub_f32 v56, v56, v228
    v_sub_f32 v201, v201, v228
    v_sub_f32 v37, v37, v228
    v_sub_f32 v57, v57, v228
    v_sub_f32 v202, v202, v228
    v_sub_f32 v38, v38, v228
    v_sub_f32 v58, v58, v228
    v_sub_f32 v203, v203, v228
    v_sub_f32 v39, v39, v228
    v_sub_f32 v59, v59, v228
    v_mul_f32 v217, v217, v229
    v_accvgpr_read_b32 v230, a4
    v_accvgpr_read_b32 v231, a5
    v_accvgpr_read_b32 v232, a6
    v_accvgpr_read_b32 v233, a7
    v_mul_f32 v230, v230, v229
    v_mul_f32 v231, v231, v229
    v_mul_f32 v232, v232, v229
    v_mul_f32 v233, v233, v229
    v_accvgpr_write_b32 a4, v230
    v_accvgpr_write_b32 a5, v231
    v_accvgpr_write_b32 a6, v232
    v_accvgpr_write_b32 a7, v233
    v_accvgpr_read_b32 v230, a24
    v_accvgpr_read_b32 v231, a25
    v_accvgpr_read_b32 v232, a26
    v_accvgpr_read_b32 v233, a27
    v_mul_f32 v230, v230, v229
    v_mul_f32 v231, v231, v229
    v_mul_f32 v232, v232, v229
    v_mul_f32 v233, v233, v229
    v_accvgpr_write_b32 a24, v230
    v_accvgpr_write_b32 a25, v231
    v_accvgpr_write_b32 a26, v232
    v_accvgpr_write_b32 a27, v233
    v_accvgpr_read_b32 v230, a44
    v_accvgpr_read_b32 v231, a45
    v_accvgpr_read_b32 v232, a46
    v_accvgpr_read_b32 v233, a47
    v_mul_f32 v230, v230, v229
    v_mul_f32 v231, v231, v229
    v_mul_f32 v232, v232, v229
    v_mul_f32 v233, v233, v229
    v_accvgpr_write_b32 a44, v230
    v_accvgpr_write_b32 a45, v231
    v_accvgpr_write_b32 a46, v232
    v_accvgpr_write_b32 a47, v233
    v_accvgpr_read_b32 v230, a64
    v_accvgpr_read_b32 v231, a65
    v_accvgpr_read_b32 v232, a66
    v_accvgpr_read_b32 v233, a67
    v_mul_f32 v230, v230, v229
    v_mul_f32 v231, v231, v229
    v_mul_f32 v232, v232, v229
    v_mul_f32 v233, v233, v229
    v_accvgpr_write_b32 a64, v230
    v_accvgpr_write_b32 a65, v231
    v_accvgpr_write_b32 a66, v232
    v_accvgpr_write_b32 a67, v233
    v_accvgpr_read_b32 v230, a84
    v_accvgpr_read_b32 v231, a85
    v_accvgpr_read_b32 v232, a86
    v_accvgpr_read_b32 v233, a87
    v_mul_f32 v230, v230, v229
    v_mul_f32 v231, v231, v229
    v_mul_f32 v232, v232, v229
    v_mul_f32 v233, v233, v229
    v_accvgpr_write_b32 a84, v230
    v_accvgpr_write_b32 a85, v231
    v_accvgpr_write_b32 a86, v232
    v_accvgpr_write_b32 a87, v233
    v_accvgpr_read_b32 v230, a104
    v_accvgpr_read_b32 v231, a105
    v_accvgpr_read_b32 v232, a106
    v_accvgpr_read_b32 v233, a107
    v_mul_f32 v230, v230, v229
    v_mul_f32 v231, v231, v229
    v_mul_f32 v232, v232, v229
    v_mul_f32 v233, v233, v229
    v_accvgpr_write_b32 a104, v230
    v_accvgpr_write_b32 a105, v231
    v_accvgpr_write_b32 a106, v232
    v_accvgpr_write_b32 a107, v233
    v_accvgpr_read_b32 v230, a124
    v_accvgpr_read_b32 v231, a125
    v_accvgpr_read_b32 v232, a126
    v_accvgpr_read_b32 v233, a127
    v_mul_f32 v230, v230, v229
    v_mul_f32 v231, v231, v229
    v_mul_f32 v232, v232, v229
    v_mul_f32 v233, v233, v229
    v_accvgpr_write_b32 a124, v230
    v_accvgpr_write_b32 a125, v231
    v_accvgpr_write_b32 a126, v232
    v_accvgpr_write_b32 a127, v233
    v_accvgpr_read_b32 v230, a144
    v_accvgpr_read_b32 v231, a145
    v_accvgpr_read_b32 v232, a146
    v_accvgpr_read_b32 v233, a147
    v_mul_f32 v230, v230, v229
    v_mul_f32 v231, v231, v229
    v_mul_f32 v232, v232, v229
    v_mul_f32 v233, v233, v229
    v_accvgpr_write_b32 a144, v230
    v_accvgpr_write_b32 a145, v231
    v_accvgpr_write_b32 a146, v232
    v_accvgpr_write_b32 a147, v233
    v_max3_f32 v228, v40, v41, v42
    v_max3_f32 v228, v228, v43, v60
    v_max3_f32 v228, v228, v61, v62
    v_max_f32 v228, v228, v63
    v_mov_b32 v229, v228
    s_nop 1
    v_permlane32_swap_b32 v228, v229
    s_nop 1
    v_max_f32 v228, v228, v229
    v_mov_b32 v229, v228
    s_nop 1
    v_permlane16_swap_b32 v228, v229
    s_nop 1
    v_max_f32 v228, v228, v229
    v_max_f32 v228, s51, v228
    v_sub_f32 v229, 0, v228
    v_exp_f32 v229, v229
    v_add_f32 v223, v223, v228
    v_sub_f32 v204, v204, v228
    v_sub_f32 v40, v40, v228
    v_sub_f32 v60, v60, v228
    v_sub_f32 v205, v205, v228
    v_sub_f32 v41, v41, v228
    v_sub_f32 v61, v61, v228
    v_sub_f32 v206, v206, v228
    v_sub_f32 v42, v42, v228
    v_sub_f32 v62, v62, v228
    v_sub_f32 v207, v207, v228
    v_sub_f32 v43, v43, v228
    v_sub_f32 v63, v63, v228
    v_mul_f32 v218, v218, v229
    v_accvgpr_read_b32 v230, a8
    v_accvgpr_read_b32 v231, a9
    v_accvgpr_read_b32 v232, a10
    v_accvgpr_read_b32 v233, a11
    v_mul_f32 v230, v230, v229
    v_mul_f32 v231, v231, v229
    v_mul_f32 v232, v232, v229
    v_mul_f32 v233, v233, v229
    v_accvgpr_write_b32 a8, v230
    v_accvgpr_write_b32 a9, v231
    v_accvgpr_write_b32 a10, v232
    v_accvgpr_write_b32 a11, v233
    v_accvgpr_read_b32 v230, a28
    v_accvgpr_read_b32 v231, a29
    v_accvgpr_read_b32 v232, a30
    v_accvgpr_read_b32 v233, a31
    v_mul_f32 v230, v230, v229
    v_mul_f32 v231, v231, v229
    v_mul_f32 v232, v232, v229
    v_mul_f32 v233, v233, v229
    v_accvgpr_write_b32 a28, v230
    v_accvgpr_write_b32 a29, v231
    v_accvgpr_write_b32 a30, v232
    v_accvgpr_write_b32 a31, v233
    v_accvgpr_read_b32 v230, a48
    v_accvgpr_read_b32 v231, a49
    v_accvgpr_read_b32 v232, a50
    v_accvgpr_read_b32 v233, a51
    v_mul_f32 v230, v230, v229
    v_mul_f32 v231, v231, v229
    v_mul_f32 v232, v232, v229
    v_mul_f32 v233, v233, v229
    v_accvgpr_write_b32 a48, v230
    v_accvgpr_write_b32 a49, v231
    v_accvgpr_write_b32 a50, v232
    v_accvgpr_write_b32 a51, v233
    v_accvgpr_read_b32 v230, a68
    v_accvgpr_read_b32 v231, a69
    v_accvgpr_read_b32 v232, a70
    v_accvgpr_read_b32 v233, a71
    v_mul_f32 v230, v230, v229
    v_mul_f32 v231, v231, v229
    v_mul_f32 v232, v232, v229
    v_mul_f32 v233, v233, v229
    v_accvgpr_write_b32 a68, v230
    v_accvgpr_write_b32 a69, v231
    v_accvgpr_write_b32 a70, v232
    v_accvgpr_write_b32 a71, v233
    v_accvgpr_read_b32 v230, a88
    v_accvgpr_read_b32 v231, a89
    v_accvgpr_read_b32 v232, a90
    v_accvgpr_read_b32 v233, a91
    v_mul_f32 v230, v230, v229
    v_mul_f32 v231, v231, v229
    v_mul_f32 v232, v232, v229
    v_mul_f32 v233, v233, v229
    v_accvgpr_write_b32 a88, v230
    v_accvgpr_write_b32 a89, v231
    v_accvgpr_write_b32 a90, v232
    v_accvgpr_write_b32 a91, v233
    v_accvgpr_read_b32 v230, a108
    v_accvgpr_read_b32 v231, a109
    v_accvgpr_read_b32 v232, a110
    v_accvgpr_read_b32 v233, a111
    v_mul_f32 v230, v230, v229
    v_mul_f32 v231, v231, v229
    v_mul_f32 v232, v232, v229
    v_mul_f32 v233, v233, v229
    v_accvgpr_write_b32 a108, v230
    v_accvgpr_write_b32 a109, v231
    v_accvgpr_write_b32 a110, v232
    v_accvgpr_write_b32 a111, v233
    v_accvgpr_read_b32 v230, a128
    v_accvgpr_read_b32 v231, a129
    v_accvgpr_read_b32 v232, a130
    v_accvgpr_read_b32 v233, a131
    v_mul_f32 v230, v230, v229
    v_mul_f32 v231, v231, v229
    v_mul_f32 v232, v232, v229
    v_mul_f32 v233, v233, v229
    v_accvgpr_write_b32 a128, v230
    v_accvgpr_write_b32 a129, v231
    v_accvgpr_write_b32 a130, v232
    v_accvgpr_write_b32 a131, v233
    v_accvgpr_read_b32 v230, a148
    v_accvgpr_read_b32 v231, a149
    v_accvgpr_read_b32 v232, a150
    v_accvgpr_read_b32 v233, a151
    v_mul_f32 v230, v230, v229
    v_mul_f32 v231, v231, v229
    v_mul_f32 v232, v232, v229
    v_mul_f32 v233, v233, v229
    v_accvgpr_write_b32 a148, v230
    v_accvgpr_write_b32 a149, v231
    v_accvgpr_write_b32 a150, v232
    v_accvgpr_write_b32 a151, v233
    v_max3_f32 v228, v44, v45, v46
    v_max3_f32 v228, v228, v47, v64
    v_max3_f32 v228, v228, v65, v66
    v_max_f32 v228, v228, v67
    v_mov_b32 v229, v228
    s_nop 1
    v_permlane32_swap_b32 v228, v229
    s_nop 1
    v_max_f32 v228, v228, v229
    v_mov_b32 v229, v228
    s_nop 1
    v_permlane16_swap_b32 v228, v229
    s_nop 1
    v_max_f32 v228, v228, v229
    v_max_f32 v228, s51, v228
    v_sub_f32 v229, 0, v228
    v_exp_f32 v229, v229
    v_add_f32 v224, v224, v228
    v_sub_f32 v208, v208, v228
    v_sub_f32 v44, v44, v228
    v_sub_f32 v64, v64, v228
    v_sub_f32 v209, v209, v228
    v_sub_f32 v45, v45, v228
    v_sub_f32 v65, v65, v228
    v_sub_f32 v210, v210, v228
    v_sub_f32 v46, v46, v228
    v_sub_f32 v66, v66, v228
    v_sub_f32 v211, v211, v228
    v_sub_f32 v47, v47, v228
    v_sub_f32 v67, v67, v228
    v_mul_f32 v219, v219, v229
    v_accvgpr_read_b32 v230, a12
    v_accvgpr_read_b32 v231, a13
    v_accvgpr_read_b32 v232, a14
    v_accvgpr_read_b32 v233, a15
    v_mul_f32 v230, v230, v229
    v_mul_f32 v231, v231, v229
    v_mul_f32 v232, v232, v229
    v_mul_f32 v233, v233, v229
    v_accvgpr_write_b32 a12, v230
    v_accvgpr_write_b32 a13, v231
    v_accvgpr_write_b32 a14, v232
    v_accvgpr_write_b32 a15, v233
    v_accvgpr_read_b32 v230, a32
    v_accvgpr_read_b32 v231, a33
    v_accvgpr_read_b32 v232, a34
    v_accvgpr_read_b32 v233, a35
    v_mul_f32 v230, v230, v229
    v_mul_f32 v231, v231, v229
    v_mul_f32 v232, v232, v229
    v_mul_f32 v233, v233, v229
    v_accvgpr_write_b32 a32, v230
    v_accvgpr_write_b32 a33, v231
    v_accvgpr_write_b32 a34, v232
    v_accvgpr_write_b32 a35, v233
    v_accvgpr_read_b32 v230, a52
    v_accvgpr_read_b32 v231, a53
    v_accvgpr_read_b32 v232, a54
    v_accvgpr_read_b32 v233, a55
    v_mul_f32 v230, v230, v229
    v_mul_f32 v231, v231, v229
    v_mul_f32 v232, v232, v229
    v_mul_f32 v233, v233, v229
    v_accvgpr_write_b32 a52, v230
    v_accvgpr_write_b32 a53, v231
    v_accvgpr_write_b32 a54, v232
    v_accvgpr_write_b32 a55, v233
    v_accvgpr_read_b32 v230, a72
    v_accvgpr_read_b32 v231, a73
    v_accvgpr_read_b32 v232, a74
    v_accvgpr_read_b32 v233, a75
    v_mul_f32 v230, v230, v229
    v_mul_f32 v231, v231, v229
    v_mul_f32 v232, v232, v229
    v_mul_f32 v233, v233, v229
    v_accvgpr_write_b32 a72, v230
    v_accvgpr_write_b32 a73, v231
    v_accvgpr_write_b32 a74, v232
    v_accvgpr_write_b32 a75, v233
    v_accvgpr_read_b32 v230, a92
    v_accvgpr_read_b32 v231, a93
    v_accvgpr_read_b32 v232, a94
    v_accvgpr_read_b32 v233, a95
    v_mul_f32 v230, v230, v229
    v_mul_f32 v231, v231, v229
    v_mul_f32 v232, v232, v229
    v_mul_f32 v233, v233, v229
    v_accvgpr_write_b32 a92, v230
    v_accvgpr_write_b32 a93, v231
    v_accvgpr_write_b32 a94, v232
    v_accvgpr_write_b32 a95, v233
    v_accvgpr_read_b32 v230, a112
    v_accvgpr_read_b32 v231, a113
    v_accvgpr_read_b32 v232, a114
    v_accvgpr_read_b32 v233, a115
    v_mul_f32 v230, v230, v229
    v_mul_f32 v231, v231, v229
    v_mul_f32 v232, v232, v229
    v_mul_f32 v233, v233, v229
    v_accvgpr_write_b32 a112, v230
    v_accvgpr_write_b32 a113, v231
    v_accvgpr_write_b32 a114, v232
    v_accvgpr_write_b32 a115, v233
    v_accvgpr_read_b32 v230, a132
    v_accvgpr_read_b32 v231, a133
    v_accvgpr_read_b32 v232, a134
    v_accvgpr_read_b32 v233, a135
    v_mul_f32 v230, v230, v229
    v_mul_f32 v231, v231, v229
    v_mul_f32 v232, v232, v229
    v_mul_f32 v233, v233, v229
    v_accvgpr_write_b32 a132, v230
    v_accvgpr_write_b32 a133, v231
    v_accvgpr_write_b32 a134, v232
    v_accvgpr_write_b32 a135, v233
    v_accvgpr_read_b32 v230, a152
    v_accvgpr_read_b32 v231, a153
    v_accvgpr_read_b32 v232, a154
    v_accvgpr_read_b32 v233, a155
    v_mul_f32 v230, v230, v229
    v_mul_f32 v231, v231, v229
    v_mul_f32 v232, v232, v229
    v_mul_f32 v233, v233, v229
    v_accvgpr_write_b32 a152, v230
    v_accvgpr_write_b32 a153, v231
    v_accvgpr_write_b32 a154, v232
    v_accvgpr_write_b32 a155, v233
    v_max3_f32 v228, v48, v49, v50
    v_max3_f32 v228, v228, v51, v68
    v_max3_f32 v228, v228, v69, v70
    v_max_f32 v228, v228, v71
    v_mov_b32 v229, v228
    s_nop 1
    v_permlane32_swap_b32 v228, v229
    s_nop 1
    v_max_f32 v228, v228, v229
    v_mov_b32 v229, v228
    s_nop 1
    v_permlane16_swap_b32 v228, v229
    s_nop 1
    v_max_f32 v228, v228, v229
    v_max_f32 v228, s51, v228
    v_sub_f32 v229, 0, v228
    v_exp_f32 v229, v229
    v_add_f32 v225, v225, v228
    v_sub_f32 v212, v212, v228
    v_sub_f32 v48, v48, v228
    v_sub_f32 v68, v68, v228
    v_sub_f32 v213, v213, v228
    v_sub_f32 v49, v49, v228
    v_sub_f32 v69, v69, v228
    v_sub_f32 v214, v214, v228
    v_sub_f32 v50, v50, v228
    v_sub_f32 v70, v70, v228
    v_sub_f32 v215, v215, v228
    v_sub_f32 v51, v51, v228
    v_sub_f32 v71, v71, v228
    v_mul_f32 v220, v220, v229
    v_accvgpr_read_b32 v230, a16
    v_accvgpr_read_b32 v231, a17
    v_accvgpr_read_b32 v232, a18
    v_accvgpr_read_b32 v233, a19
    v_mul_f32 v230, v230, v229
    v_mul_f32 v231, v231, v229
    v_mul_f32 v232, v232, v229
    v_mul_f32 v233, v233, v229
    v_accvgpr_write_b32 a16, v230
    v_accvgpr_write_b32 a17, v231
    v_accvgpr_write_b32 a18, v232
    v_accvgpr_write_b32 a19, v233
    v_accvgpr_read_b32 v230, a36
    v_accvgpr_read_b32 v231, a37
    v_accvgpr_read_b32 v232, a38
    v_accvgpr_read_b32 v233, a39
    v_mul_f32 v230, v230, v229
    v_mul_f32 v231, v231, v229
    v_mul_f32 v232, v232, v229
    v_mul_f32 v233, v233, v229
    v_accvgpr_write_b32 a36, v230
    v_accvgpr_write_b32 a37, v231
    v_accvgpr_write_b32 a38, v232
    v_accvgpr_write_b32 a39, v233
    v_accvgpr_read_b32 v230, a56
    v_accvgpr_read_b32 v231, a57
    v_accvgpr_read_b32 v232, a58
    v_accvgpr_read_b32 v233, a59
    v_mul_f32 v230, v230, v229
    v_mul_f32 v231, v231, v229
    v_mul_f32 v232, v232, v229
    v_mul_f32 v233, v233, v229
    v_accvgpr_write_b32 a56, v230
    v_accvgpr_write_b32 a57, v231
    v_accvgpr_write_b32 a58, v232
    v_accvgpr_write_b32 a59, v233
    v_accvgpr_read_b32 v230, a76
    v_accvgpr_read_b32 v231, a77
    v_accvgpr_read_b32 v232, a78
    v_accvgpr_read_b32 v233, a79
    v_mul_f32 v230, v230, v229
    v_mul_f32 v231, v231, v229
    v_mul_f32 v232, v232, v229
    v_mul_f32 v233, v233, v229
    v_accvgpr_write_b32 a76, v230
    v_accvgpr_write_b32 a77, v231
    v_accvgpr_write_b32 a78, v232
    v_accvgpr_write_b32 a79, v233
    v_accvgpr_read_b32 v230, a96
    v_accvgpr_read_b32 v231, a97
    v_accvgpr_read_b32 v232, a98
    v_accvgpr_read_b32 v233, a99
    v_mul_f32 v230, v230, v229
    v_mul_f32 v231, v231, v229
    v_mul_f32 v232, v232, v229
    v_mul_f32 v233, v233, v229
    v_accvgpr_write_b32 a96, v230
    v_accvgpr_write_b32 a97, v231
    v_accvgpr_write_b32 a98, v232
    v_accvgpr_write_b32 a99, v233
    v_accvgpr_read_b32 v230, a116
    v_accvgpr_read_b32 v231, a117
    v_accvgpr_read_b32 v232, a118
    v_accvgpr_read_b32 v233, a119
    v_mul_f32 v230, v230, v229
    v_mul_f32 v231, v231, v229
    v_mul_f32 v232, v232, v229
    v_mul_f32 v233, v233, v229
    v_accvgpr_write_b32 a116, v230
    v_accvgpr_write_b32 a117, v231
    v_accvgpr_write_b32 a118, v232
    v_accvgpr_write_b32 a119, v233
    v_accvgpr_read_b32 v230, a136
    v_accvgpr_read_b32 v231, a137
    v_accvgpr_read_b32 v232, a138
    v_accvgpr_read_b32 v233, a139
    v_mul_f32 v230, v230, v229
    v_mul_f32 v231, v231, v229
    v_mul_f32 v232, v232, v229
    v_mul_f32 v233, v233, v229
    v_accvgpr_write_b32 a136, v230
    v_accvgpr_write_b32 a137, v231
    v_accvgpr_write_b32 a138, v232
    v_accvgpr_write_b32 a139, v233
    v_accvgpr_read_b32 v230, a156
    v_accvgpr_read_b32 v231, a157
    v_accvgpr_read_b32 v232, a158
    v_accvgpr_read_b32 v233, a159
    v_mul_f32 v230, v230, v229
    v_mul_f32 v231, v231, v229
    v_mul_f32 v232, v232, v229
    v_mul_f32 v233, v233, v229
    v_accvgpr_write_b32 a156, v230
    v_accvgpr_write_b32 a157, v231
    v_accvgpr_write_b32 a158, v232
    v_accvgpr_write_b32 a159, v233
    s_mov_b32 s50, 0x41000000
    s_mov_b32 s51, 0
    s_nop 1
    s_branch k1_kernel_L8
k1_kernel_L9:
    s_nop 7
    v_max3_f32 v228, v72, v73, v74
    v_max3_f32 v228, v228, v75, v92
    v_max3_f32 v228, v228, v93, v94
    v_max_f32 v228, v228, v95
    v_mov_b32 v229, v228
    s_nop 1
    v_permlane32_swap_b32 v228, v229
    s_nop 1
    v_max_f32 v228, v228, v229
    v_mov_b32 v229, v228
    s_nop 1
    v_permlane16_swap_b32 v228, v229
    s_nop 1
    v_max_f32 v228, v228, v229
    v_max_f32 v228, s51, v228
    v_sub_f32 v229, 0, v228
    v_exp_f32 v229, v229
    v_add_f32 v221, v221, v228
    v_sub_f32 v196, v196, v228
    v_sub_f32 v72, v72, v228
    v_sub_f32 v92, v92, v228
    v_sub_f32 v197, v197, v228
    v_sub_f32 v73, v73, v228
    v_sub_f32 v93, v93, v228
    v_sub_f32 v198, v198, v228
    v_sub_f32 v74, v74, v228
    v_sub_f32 v94, v94, v228
    v_sub_f32 v199, v199, v228
    v_sub_f32 v75, v75, v228
    v_sub_f32 v95, v95, v228
    v_mul_f32 v216, v216, v229
    v_accvgpr_read_b32 v230, a0
    v_accvgpr_read_b32 v231, a1
    v_accvgpr_read_b32 v232, a2
    v_accvgpr_read_b32 v233, a3
    v_mul_f32 v230, v230, v229
    v_mul_f32 v231, v231, v229
    v_mul_f32 v232, v232, v229
    v_mul_f32 v233, v233, v229
    v_accvgpr_write_b32 a0, v230
    v_accvgpr_write_b32 a1, v231
    v_accvgpr_write_b32 a2, v232
    v_accvgpr_write_b32 a3, v233
    v_accvgpr_read_b32 v230, a20
    v_accvgpr_read_b32 v231, a21
    v_accvgpr_read_b32 v232, a22
    v_accvgpr_read_b32 v233, a23
    v_mul_f32 v230, v230, v229
    v_mul_f32 v231, v231, v229
    v_mul_f32 v232, v232, v229
    v_mul_f32 v233, v233, v229
    v_accvgpr_write_b32 a20, v230
    v_accvgpr_write_b32 a21, v231
    v_accvgpr_write_b32 a22, v232
    v_accvgpr_write_b32 a23, v233
    v_accvgpr_read_b32 v230, a40
    v_accvgpr_read_b32 v231, a41
    v_accvgpr_read_b32 v232, a42
    v_accvgpr_read_b32 v233, a43
    v_mul_f32 v230, v230, v229
    v_mul_f32 v231, v231, v229
    v_mul_f32 v232, v232, v229
    v_mul_f32 v233, v233, v229
    v_accvgpr_write_b32 a40, v230
    v_accvgpr_write_b32 a41, v231
    v_accvgpr_write_b32 a42, v232
    v_accvgpr_write_b32 a43, v233
    v_accvgpr_read_b32 v230, a60
    v_accvgpr_read_b32 v231, a61
    v_accvgpr_read_b32 v232, a62
    v_accvgpr_read_b32 v233, a63
    v_mul_f32 v230, v230, v229
    v_mul_f32 v231, v231, v229
    v_mul_f32 v232, v232, v229
    v_mul_f32 v233, v233, v229
    v_accvgpr_write_b32 a60, v230
    v_accvgpr_write_b32 a61, v231
    v_accvgpr_write_b32 a62, v232
    v_accvgpr_write_b32 a63, v233
    v_accvgpr_read_b32 v230, a80
    v_accvgpr_read_b32 v231, a81
    v_accvgpr_read_b32 v232, a82
    v_accvgpr_read_b32 v233, a83
    v_mul_f32 v230, v230, v229
    v_mul_f32 v231, v231, v229
    v_mul_f32 v232, v232, v229
    v_mul_f32 v233, v233, v229
    v_accvgpr_write_b32 a80, v230
    v_accvgpr_write_b32 a81, v231
    v_accvgpr_write_b32 a82, v232
    v_accvgpr_write_b32 a83, v233
    v_accvgpr_read_b32 v230, a100
    v_accvgpr_read_b32 v231, a101
    v_accvgpr_read_b32 v232, a102
    v_accvgpr_read_b32 v233, a103
    v_mul_f32 v230, v230, v229
    v_mul_f32 v231, v231, v229
    v_mul_f32 v232, v232, v229
    v_mul_f32 v233, v233, v229
    v_accvgpr_write_b32 a100, v230
    v_accvgpr_write_b32 a101, v231
    v_accvgpr_write_b32 a102, v232
    v_accvgpr_write_b32 a103, v233
    v_accvgpr_read_b32 v230, a120
    v_accvgpr_read_b32 v231, a121
    v_accvgpr_read_b32 v232, a122
    v_accvgpr_read_b32 v233, a123
    v_mul_f32 v230, v230, v229
    v_mul_f32 v231, v231, v229
    v_mul_f32 v232, v232, v229
    v_mul_f32 v233, v233, v229
    v_accvgpr_write_b32 a120, v230
    v_accvgpr_write_b32 a121, v231
    v_accvgpr_write_b32 a122, v232
    v_accvgpr_write_b32 a123, v233
    v_accvgpr_read_b32 v230, a140
    v_accvgpr_read_b32 v231, a141
    v_accvgpr_read_b32 v232, a142
    v_accvgpr_read_b32 v233, a143
    v_mul_f32 v230, v230, v229
    v_mul_f32 v231, v231, v229
    v_mul_f32 v232, v232, v229
    v_mul_f32 v233, v233, v229
    v_accvgpr_write_b32 a140, v230
    v_accvgpr_write_b32 a141, v231
    v_accvgpr_write_b32 a142, v232
    v_accvgpr_write_b32 a143, v233
    v_max3_f32 v228, v76, v77, v78
    v_max3_f32 v228, v228, v79, v96
    v_max3_f32 v228, v228, v97, v98
    v_max_f32 v228, v228, v99
    v_mov_b32 v229, v228
    s_nop 1
    v_permlane32_swap_b32 v228, v229
    s_nop 1
    v_max_f32 v228, v228, v229
    v_mov_b32 v229, v228
    s_nop 1
    v_permlane16_swap_b32 v228, v229
    s_nop 1
    v_max_f32 v228, v228, v229
    v_max_f32 v228, s51, v228
    v_sub_f32 v229, 0, v228
    v_exp_f32 v229, v229
    v_add_f32 v222, v222, v228
    v_sub_f32 v200, v200, v228
    v_sub_f32 v76, v76, v228
    v_sub_f32 v96, v96, v228
    v_sub_f32 v201, v201, v228
    v_sub_f32 v77, v77, v228
    v_sub_f32 v97, v97, v228
    v_sub_f32 v202, v202, v228
    v_sub_f32 v78, v78, v228
    v_sub_f32 v98, v98, v228
    v_sub_f32 v203, v203, v228
    v_sub_f32 v79, v79, v228
    v_sub_f32 v99, v99, v228
    v_mul_f32 v217, v217, v229
    v_accvgpr_read_b32 v230, a4
    v_accvgpr_read_b32 v231, a5
    v_accvgpr_read_b32 v232, a6
    v_accvgpr_read_b32 v233, a7
    v_mul_f32 v230, v230, v229
    v_mul_f32 v231, v231, v229
    v_mul_f32 v232, v232, v229
    v_mul_f32 v233, v233, v229
    v_accvgpr_write_b32 a4, v230
    v_accvgpr_write_b32 a5, v231
    v_accvgpr_write_b32 a6, v232
    v_accvgpr_write_b32 a7, v233
    v_accvgpr_read_b32 v230, a24
    v_accvgpr_read_b32 v231, a25
    v_accvgpr_read_b32 v232, a26
    v_accvgpr_read_b32 v233, a27
    v_mul_f32 v230, v230, v229
    v_mul_f32 v231, v231, v229
    v_mul_f32 v232, v232, v229
    v_mul_f32 v233, v233, v229
    v_accvgpr_write_b32 a24, v230
    v_accvgpr_write_b32 a25, v231
    v_accvgpr_write_b32 a26, v232
    v_accvgpr_write_b32 a27, v233
    v_accvgpr_read_b32 v230, a44
    v_accvgpr_read_b32 v231, a45
    v_accvgpr_read_b32 v232, a46
    v_accvgpr_read_b32 v233, a47
    v_mul_f32 v230, v230, v229
    v_mul_f32 v231, v231, v229
    v_mul_f32 v232, v232, v229
    v_mul_f32 v233, v233, v229
    v_accvgpr_write_b32 a44, v230
    v_accvgpr_write_b32 a45, v231
    v_accvgpr_write_b32 a46, v232
    v_accvgpr_write_b32 a47, v233
    v_accvgpr_read_b32 v230, a64
    v_accvgpr_read_b32 v231, a65
    v_accvgpr_read_b32 v232, a66
    v_accvgpr_read_b32 v233, a67
    v_mul_f32 v230, v230, v229
    v_mul_f32 v231, v231, v229
    v_mul_f32 v232, v232, v229
    v_mul_f32 v233, v233, v229
    v_accvgpr_write_b32 a64, v230
    v_accvgpr_write_b32 a65, v231
    v_accvgpr_write_b32 a66, v232
    v_accvgpr_write_b32 a67, v233
    v_accvgpr_read_b32 v230, a84
    v_accvgpr_read_b32 v231, a85
    v_accvgpr_read_b32 v232, a86
    v_accvgpr_read_b32 v233, a87
    v_mul_f32 v230, v230, v229
    v_mul_f32 v231, v231, v229
    v_mul_f32 v232, v232, v229
    v_mul_f32 v233, v233, v229
    v_accvgpr_write_b32 a84, v230
    v_accvgpr_write_b32 a85, v231
    v_accvgpr_write_b32 a86, v232
    v_accvgpr_write_b32 a87, v233
    v_accvgpr_read_b32 v230, a104
    v_accvgpr_read_b32 v231, a105
    v_accvgpr_read_b32 v232, a106
    v_accvgpr_read_b32 v233, a107
    v_mul_f32 v230, v230, v229
    v_mul_f32 v231, v231, v229
    v_mul_f32 v232, v232, v229
    v_mul_f32 v233, v233, v229
    v_accvgpr_write_b32 a104, v230
    v_accvgpr_write_b32 a105, v231
    v_accvgpr_write_b32 a106, v232
    v_accvgpr_write_b32 a107, v233
    v_accvgpr_read_b32 v230, a124
    v_accvgpr_read_b32 v231, a125
    v_accvgpr_read_b32 v232, a126
    v_accvgpr_read_b32 v233, a127
    v_mul_f32 v230, v230, v229
    v_mul_f32 v231, v231, v229
    v_mul_f32 v232, v232, v229
    v_mul_f32 v233, v233, v229
    v_accvgpr_write_b32 a124, v230
    v_accvgpr_write_b32 a125, v231
    v_accvgpr_write_b32 a126, v232
    v_accvgpr_write_b32 a127, v233
    v_accvgpr_read_b32 v230, a144
    v_accvgpr_read_b32 v231, a145
    v_accvgpr_read_b32 v232, a146
    v_accvgpr_read_b32 v233, a147
    v_mul_f32 v230, v230, v229
    v_mul_f32 v231, v231, v229
    v_mul_f32 v232, v232, v229
    v_mul_f32 v233, v233, v229
    v_accvgpr_write_b32 a144, v230
    v_accvgpr_write_b32 a145, v231
    v_accvgpr_write_b32 a146, v232
    v_accvgpr_write_b32 a147, v233
    v_max3_f32 v228, v80, v81, v82
    v_max3_f32 v228, v228, v83, v100
    v_max3_f32 v228, v228, v101, v102
    v_max_f32 v228, v228, v103
    v_mov_b32 v229, v228
    s_nop 1
    v_permlane32_swap_b32 v228, v229
    s_nop 1
    v_max_f32 v228, v228, v229
    v_mov_b32 v229, v228
    s_nop 1
    v_permlane16_swap_b32 v228, v229
    s_nop 1
    v_max_f32 v228, v228, v229
    v_max_f32 v228, s51, v228
    v_sub_f32 v229, 0, v228
    v_exp_f32 v229, v229
    v_add_f32 v223, v223, v228
    v_sub_f32 v204, v204, v228
    v_sub_f32 v80, v80, v228
    v_sub_f32 v100, v100, v228
    v_sub_f32 v205, v205, v228
    v_sub_f32 v81, v81, v228
    v_sub_f32 v101, v101, v228
    v_sub_f32 v206, v206, v228
    v_sub_f32 v82, v82, v228
    v_sub_f32 v102, v102, v228
    v_sub_f32 v207, v207, v228
    v_sub_f32 v83, v83, v228
    v_sub_f32 v103, v103, v228
    v_mul_f32 v218, v218, v229
    v_accvgpr_read_b32 v230, a8
    v_accvgpr_read_b32 v231, a9
    v_accvgpr_read_b32 v232, a10
    v_accvgpr_read_b32 v233, a11
    v_mul_f32 v230, v230, v229
    v_mul_f32 v231, v231, v229
    v_mul_f32 v232, v232, v229
    v_mul_f32 v233, v233, v229
    v_accvgpr_write_b32 a8, v230
    v_accvgpr_write_b32 a9, v231
    v_accvgpr_write_b32 a10, v232
    v_accvgpr_write_b32 a11, v233
    v_accvgpr_read_b32 v230, a28
    v_accvgpr_read_b32 v231, a29
    v_accvgpr_read_b32 v232, a30
    v_accvgpr_read_b32 v233, a31
    v_mul_f32 v230, v230, v229
    v_mul_f32 v231, v231, v229
    v_mul_f32 v232, v232, v229
    v_mul_f32 v233, v233, v229
    v_accvgpr_write_b32 a28, v230
    v_accvgpr_write_b32 a29, v231
    v_accvgpr_write_b32 a30, v232
    v_accvgpr_write_b32 a31, v233
    v_accvgpr_read_b32 v230, a48
    v_accvgpr_read_b32 v231, a49
    v_accvgpr_read_b32 v232, a50
    v_accvgpr_read_b32 v233, a51
    v_mul_f32 v230, v230, v229
    v_mul_f32 v231, v231, v229
    v_mul_f32 v232, v232, v229
    v_mul_f32 v233, v233, v229
    v_accvgpr_write_b32 a48, v230
    v_accvgpr_write_b32 a49, v231
    v_accvgpr_write_b32 a50, v232
    v_accvgpr_write_b32 a51, v233
    v_accvgpr_read_b32 v230, a68
    v_accvgpr_read_b32 v231, a69
    v_accvgpr_read_b32 v232, a70
    v_accvgpr_read_b32 v233, a71
    v_mul_f32 v230, v230, v229
    v_mul_f32 v231, v231, v229
    v_mul_f32 v232, v232, v229
    v_mul_f32 v233, v233, v229
    v_accvgpr_write_b32 a68, v230
    v_accvgpr_write_b32 a69, v231
    v_accvgpr_write_b32 a70, v232
    v_accvgpr_write_b32 a71, v233
    v_accvgpr_read_b32 v230, a88
    v_accvgpr_read_b32 v231, a89
    v_accvgpr_read_b32 v232, a90
    v_accvgpr_read_b32 v233, a91
    v_mul_f32 v230, v230, v229
    v_mul_f32 v231, v231, v229
    v_mul_f32 v232, v232, v229
    v_mul_f32 v233, v233, v229
    v_accvgpr_write_b32 a88, v230
    v_accvgpr_write_b32 a89, v231
    v_accvgpr_write_b32 a90, v232
    v_accvgpr_write_b32 a91, v233
    v_accvgpr_read_b32 v230, a108
    v_accvgpr_read_b32 v231, a109
    v_accvgpr_read_b32 v232, a110
    v_accvgpr_read_b32 v233, a111
    v_mul_f32 v230, v230, v229
    v_mul_f32 v231, v231, v229
    v_mul_f32 v232, v232, v229
    v_mul_f32 v233, v233, v229
    v_accvgpr_write_b32 a108, v230
    v_accvgpr_write_b32 a109, v231
    v_accvgpr_write_b32 a110, v232
    v_accvgpr_write_b32 a111, v233
    v_accvgpr_read_b32 v230, a128
    v_accvgpr_read_b32 v231, a129
    v_accvgpr_read_b32 v232, a130
    v_accvgpr_read_b32 v233, a131
    v_mul_f32 v230, v230, v229
    v_mul_f32 v231, v231, v229
    v_mul_f32 v232, v232, v229
    v_mul_f32 v233, v233, v229
    v_accvgpr_write_b32 a128, v230
    v_accvgpr_write_b32 a129, v231
    v_accvgpr_write_b32 a130, v232
    v_accvgpr_write_b32 a131, v233
    v_accvgpr_read_b32 v230, a148
    v_accvgpr_read_b32 v231, a149
    v_accvgpr_read_b32 v232, a150
    v_accvgpr_read_b32 v233, a151
    v_mul_f32 v230, v230, v229
    v_mul_f32 v231, v231, v229
    v_mul_f32 v232, v232, v229
    v_mul_f32 v233, v233, v229
    v_accvgpr_write_b32 a148, v230
    v_accvgpr_write_b32 a149, v231
    v_accvgpr_write_b32 a150, v232
    v_accvgpr_write_b32 a151, v233
    v_max3_f32 v228, v84, v85, v86
    v_max3_f32 v228, v228, v87, v104
    v_max3_f32 v228, v228, v105, v106
    v_max_f32 v228, v228, v107
    v_mov_b32 v229, v228
    s_nop 1
    v_permlane32_swap_b32 v228, v229
    s_nop 1
    v_max_f32 v228, v228, v229
    v_mov_b32 v229, v228
    s_nop 1
    v_permlane16_swap_b32 v228, v229
    s_nop 1
    v_max_f32 v228, v228, v229
    v_max_f32 v228, s51, v228
    v_sub_f32 v229, 0, v228
    v_exp_f32 v229, v229
    v_add_f32 v224, v224, v228
    v_sub_f32 v208, v208, v228
    v_sub_f32 v84, v84, v228
    v_sub_f32 v104, v104, v228
    v_sub_f32 v209, v209, v228
    v_sub_f32 v85, v85, v228
    v_sub_f32 v105, v105, v228
    v_sub_f32 v210, v210, v228
    v_sub_f32 v86, v86, v228
    v_sub_f32 v106, v106, v228
    v_sub_f32 v211, v211, v228
    v_sub_f32 v87, v87, v228
    v_sub_f32 v107, v107, v228
    v_mul_f32 v219, v219, v229
    v_accvgpr_read_b32 v230, a12
    v_accvgpr_read_b32 v231, a13
    v_accvgpr_read_b32 v232, a14
    v_accvgpr_read_b32 v233, a15
    v_mul_f32 v230, v230, v229
    v_mul_f32 v231, v231, v229
    v_mul_f32 v232, v232, v229
    v_mul_f32 v233, v233, v229
    v_accvgpr_write_b32 a12, v230
    v_accvgpr_write_b32 a13, v231
    v_accvgpr_write_b32 a14, v232
    v_accvgpr_write_b32 a15, v233
    v_accvgpr_read_b32 v230, a32
    v_accvgpr_read_b32 v231, a33
    v_accvgpr_read_b32 v232, a34
    v_accvgpr_read_b32 v233, a35
    v_mul_f32 v230, v230, v229
    v_mul_f32 v231, v231, v229
    v_mul_f32 v232, v232, v229
    v_mul_f32 v233, v233, v229
    v_accvgpr_write_b32 a32, v230
    v_accvgpr_write_b32 a33, v231
    v_accvgpr_write_b32 a34, v232
    v_accvgpr_write_b32 a35, v233
    v_accvgpr_read_b32 v230, a52
    v_accvgpr_read_b32 v231, a53
    v_accvgpr_read_b32 v232, a54
    v_accvgpr_read_b32 v233, a55
    v_mul_f32 v230, v230, v229
    v_mul_f32 v231, v231, v229
    v_mul_f32 v232, v232, v229
    v_mul_f32 v233, v233, v229
    v_accvgpr_write_b32 a52, v230
    v_accvgpr_write_b32 a53, v231
    v_accvgpr_write_b32 a54, v232
    v_accvgpr_write_b32 a55, v233
    v_accvgpr_read_b32 v230, a72
    v_accvgpr_read_b32 v231, a73
    v_accvgpr_read_b32 v232, a74
    v_accvgpr_read_b32 v233, a75
    v_mul_f32 v230, v230, v229
    v_mul_f32 v231, v231, v229
    v_mul_f32 v232, v232, v229
    v_mul_f32 v233, v233, v229
    v_accvgpr_write_b32 a72, v230
    v_accvgpr_write_b32 a73, v231
    v_accvgpr_write_b32 a74, v232
    v_accvgpr_write_b32 a75, v233
    v_accvgpr_read_b32 v230, a92
    v_accvgpr_read_b32 v231, a93
    v_accvgpr_read_b32 v232, a94
    v_accvgpr_read_b32 v233, a95
    v_mul_f32 v230, v230, v229
    v_mul_f32 v231, v231, v229
    v_mul_f32 v232, v232, v229
    v_mul_f32 v233, v233, v229
    v_accvgpr_write_b32 a92, v230
    v_accvgpr_write_b32 a93, v231
    v_accvgpr_write_b32 a94, v232
    v_accvgpr_write_b32 a95, v233
    v_accvgpr_read_b32 v230, a112
    v_accvgpr_read_b32 v231, a113
    v_accvgpr_read_b32 v232, a114
    v_accvgpr_read_b32 v233, a115
    v_mul_f32 v230, v230, v229
    v_mul_f32 v231, v231, v229
    v_mul_f32 v232, v232, v229
    v_mul_f32 v233, v233, v229
    v_accvgpr_write_b32 a112, v230
    v_accvgpr_write_b32 a113, v231
    v_accvgpr_write_b32 a114, v232
    v_accvgpr_write_b32 a115, v233
    v_accvgpr_read_b32 v230, a132
    v_accvgpr_read_b32 v231, a133
    v_accvgpr_read_b32 v232, a134
    v_accvgpr_read_b32 v233, a135
    v_mul_f32 v230, v230, v229
    v_mul_f32 v231, v231, v229
    v_mul_f32 v232, v232, v229
    v_mul_f32 v233, v233, v229
    v_accvgpr_write_b32 a132, v230
    v_accvgpr_write_b32 a133, v231
    v_accvgpr_write_b32 a134, v232
    v_accvgpr_write_b32 a135, v233
    v_accvgpr_read_b32 v230, a152
    v_accvgpr_read_b32 v231, a153
    v_accvgpr_read_b32 v232, a154
    v_accvgpr_read_b32 v233, a155
    v_mul_f32 v230, v230, v229
    v_mul_f32 v231, v231, v229
    v_mul_f32 v232, v232, v229
    v_mul_f32 v233, v233, v229
    v_accvgpr_write_b32 a152, v230
    v_accvgpr_write_b32 a153, v231
    v_accvgpr_write_b32 a154, v232
    v_accvgpr_write_b32 a155, v233
    v_max3_f32 v228, v88, v89, v90
    v_max3_f32 v228, v228, v91, v108
    v_max3_f32 v228, v228, v109, v110
    v_max_f32 v228, v228, v111
    v_mov_b32 v229, v228
    s_nop 1
    v_permlane32_swap_b32 v228, v229
    s_nop 1
    v_max_f32 v228, v228, v229
    v_mov_b32 v229, v228
    s_nop 1
    v_permlane16_swap_b32 v228, v229
    s_nop 1
    v_max_f32 v228, v228, v229
    v_max_f32 v228, s51, v228
    v_sub_f32 v229, 0, v228
    v_exp_f32 v229, v229
    v_add_f32 v225, v225, v228
    v_sub_f32 v212, v212, v228
    v_sub_f32 v88, v88, v228
    v_sub_f32 v108, v108, v228
    v_sub_f32 v213, v213, v228
    v_sub_f32 v89, v89, v228
    v_sub_f32 v109, v109, v228
    v_sub_f32 v214, v214, v228
    v_sub_f32 v90, v90, v228
    v_sub_f32 v110, v110, v228
    v_sub_f32 v215, v215, v228
    v_sub_f32 v91, v91, v228
    v_sub_f32 v111, v111, v228
    v_mul_f32 v220, v220, v229
    v_accvgpr_read_b32 v230, a16
    v_accvgpr_read_b32 v231, a17
    v_accvgpr_read_b32 v232, a18
    v_accvgpr_read_b32 v233, a19
    v_mul_f32 v230, v230, v229
    v_mul_f32 v231, v231, v229
    v_mul_f32 v232, v232, v229
    v_mul_f32 v233, v233, v229
    v_accvgpr_write_b32 a16, v230
    v_accvgpr_write_b32 a17, v231
    v_accvgpr_write_b32 a18, v232
    v_accvgpr_write_b32 a19, v233
    v_accvgpr_read_b32 v230, a36
    v_accvgpr_read_b32 v231, a37
    v_accvgpr_read_b32 v232, a38
    v_accvgpr_read_b32 v233, a39
    v_mul_f32 v230, v230, v229
    v_mul_f32 v231, v231, v229
    v_mul_f32 v232, v232, v229
    v_mul_f32 v233, v233, v229
    v_accvgpr_write_b32 a36, v230
    v_accvgpr_write_b32 a37, v231
    v_accvgpr_write_b32 a38, v232
    v_accvgpr_write_b32 a39, v233
    v_accvgpr_read_b32 v230, a56
    v_accvgpr_read_b32 v231, a57
    v_accvgpr_read_b32 v232, a58
    v_accvgpr_read_b32 v233, a59
    v_mul_f32 v230, v230, v229
    v_mul_f32 v231, v231, v229
    v_mul_f32 v232, v232, v229
    v_mul_f32 v233, v233, v229
    v_accvgpr_write_b32 a56, v230
    v_accvgpr_write_b32 a57, v231
    v_accvgpr_write_b32 a58, v232
    v_accvgpr_write_b32 a59, v233
    v_accvgpr_read_b32 v230, a76
    v_accvgpr_read_b32 v231, a77
    v_accvgpr_read_b32 v232, a78
    v_accvgpr_read_b32 v233, a79
    v_mul_f32 v230, v230, v229
    v_mul_f32 v231, v231, v229
    v_mul_f32 v232, v232, v229
    v_mul_f32 v233, v233, v229
    v_accvgpr_write_b32 a76, v230
    v_accvgpr_write_b32 a77, v231
    v_accvgpr_write_b32 a78, v232
    v_accvgpr_write_b32 a79, v233
    v_accvgpr_read_b32 v230, a96
    v_accvgpr_read_b32 v231, a97
    v_accvgpr_read_b32 v232, a98
    v_accvgpr_read_b32 v233, a99
    v_mul_f32 v230, v230, v229
    v_mul_f32 v231, v231, v229
    v_mul_f32 v232, v232, v229
    v_mul_f32 v233, v233, v229
    v_accvgpr_write_b32 a96, v230
    v_accvgpr_write_b32 a97, v231
    v_accvgpr_write_b32 a98, v232
    v_accvgpr_write_b32 a99, v233
    v_accvgpr_read_b32 v230, a116
    v_accvgpr_read_b32 v231, a117
    v_accvgpr_read_b32 v232, a118
    v_accvgpr_read_b32 v233, a119
    v_mul_f32 v230, v230, v229
    v_mul_f32 v231, v231, v229
    v_mul_f32 v232, v232, v229
    v_mul_f32 v233, v233, v229
    v_accvgpr_write_b32 a116, v230
    v_accvgpr_write_b32 a117, v231
    v_accvgpr_write_b32 a118, v232
    v_accvgpr_write_b32 a119, v233
    v_accvgpr_read_b32 v230, a136
    v_accvgpr_read_b32 v231, a137
    v_accvgpr_read_b32 v232, a138
    v_accvgpr_read_b32 v233, a139
    v_mul_f32 v230, v230, v229
    v_mul_f32 v231, v231, v229
    v_mul_f32 v232, v232, v229
    v_mul_f32 v233, v233, v229
    v_accvgpr_write_b32 a136, v230
    v_accvgpr_write_b32 a137, v231
    v_accvgpr_write_b32 a138, v232
    v_accvgpr_write_b32 a139, v233
    v_accvgpr_read_b32 v230, a156
    v_accvgpr_read_b32 v231, a157
    v_accvgpr_read_b32 v232, a158
    v_accvgpr_read_b32 v233, a159
    v_mul_f32 v230, v230, v229
    v_mul_f32 v231, v231, v229
    v_mul_f32 v232, v232, v229
    v_mul_f32 v233, v233, v229
    v_accvgpr_write_b32 a156, v230
    v_accvgpr_write_b32 a157, v231
    v_accvgpr_write_b32 a158, v232
    v_accvgpr_write_b32 a159, v233
    s_mov_b32 s50, 0x41000000
    s_mov_b32 s51, 0
    s_nop 1
    s_branch k1_kernel_L10
k1_kernel_L11:
    s_nop 7
    v_max3_f32 v228, v32, v33, v34
    v_max3_f32 v228, v228, v35, v52
    v_max3_f32 v228, v228, v53, v54
    v_max_f32 v228, v228, v55
    v_mov_b32 v229, v228
    s_nop 1
    v_permlane32_swap_b32 v228, v229
    s_nop 1
    v_max_f32 v228, v228, v229
    v_mov_b32 v229, v228
    s_nop 1
    v_permlane16_swap_b32 v228, v229
    s_nop 1
    v_max_f32 v228, v228, v229
    v_max_f32 v228, s51, v228
    v_sub_f32 v229, 0, v228
    v_exp_f32 v229, v229
    v_add_f32 v221, v221, v228
    v_sub_f32 v196, v196, v228
    v_sub_f32 v32, v32, v228
    v_sub_f32 v52, v52, v228
    v_sub_f32 v197, v197, v228
    v_sub_f32 v33, v33, v228
    v_sub_f32 v53, v53, v228
    v_sub_f32 v198, v198, v228
    v_sub_f32 v34, v34, v228
    v_sub_f32 v54, v54, v228
    v_sub_f32 v199, v199, v228
    v_sub_f32 v35, v35, v228
    v_sub_f32 v55, v55, v228
    v_mul_f32 v216, v216, v229
    v_accvgpr_read_b32 v230, a0
    v_accvgpr_read_b32 v231, a1
    v_accvgpr_read_b32 v232, a2
    v_accvgpr_read_b32 v233, a3
    v_mul_f32 v230, v230, v229
    v_mul_f32 v231, v231, v229
    v_mul_f32 v232, v232, v229
    v_mul_f32 v233, v233, v229
    v_accvgpr_write_b32 a0, v230
    v_accvgpr_write_b32 a1, v231
    v_accvgpr_write_b32 a2, v232
    v_accvgpr_write_b32 a3, v233
    v_accvgpr_read_b32 v230, a20
    v_accvgpr_read_b32 v231, a21
    v_accvgpr_read_b32 v232, a22
    v_accvgpr_read_b32 v233, a23
    v_mul_f32 v230, v230, v229
    v_mul_f32 v231, v231, v229
    v_mul_f32 v232, v232, v229
    v_mul_f32 v233, v233, v229
    v_accvgpr_write_b32 a20, v230
    v_accvgpr_write_b32 a21, v231
    v_accvgpr_write_b32 a22, v232
    v_accvgpr_write_b32 a23, v233
    v_accvgpr_read_b32 v230, a40
    v_accvgpr_read_b32 v231, a41
    v_accvgpr_read_b32 v232, a42
    v_accvgpr_read_b32 v233, a43
    v_mul_f32 v230, v230, v229
    v_mul_f32 v231, v231, v229
    v_mul_f32 v232, v232, v229
    v_mul_f32 v233, v233, v229
    v_accvgpr_write_b32 a40, v230
    v_accvgpr_write_b32 a41, v231
    v_accvgpr_write_b32 a42, v232
    v_accvgpr_write_b32 a43, v233
    v_accvgpr_read_b32 v230, a60
    v_accvgpr_read_b32 v231, a61
    v_accvgpr_read_b32 v232, a62
    v_accvgpr_read_b32 v233, a63
    v_mul_f32 v230, v230, v229
    v_mul_f32 v231, v231, v229
    v_mul_f32 v232, v232, v229
    v_mul_f32 v233, v233, v229
    v_accvgpr_write_b32 a60, v230
    v_accvgpr_write_b32 a61, v231
    v_accvgpr_write_b32 a62, v232
    v_accvgpr_write_b32 a63, v233
    v_accvgpr_read_b32 v230, a80
    v_accvgpr_read_b32 v231, a81
    v_accvgpr_read_b32 v232, a82
    v_accvgpr_read_b32 v233, a83
    v_mul_f32 v230, v230, v229
    v_mul_f32 v231, v231, v229
    v_mul_f32 v232, v232, v229
    v_mul_f32 v233, v233, v229
    v_accvgpr_write_b32 a80, v230
    v_accvgpr_write_b32 a81, v231
    v_accvgpr_write_b32 a82, v232
    v_accvgpr_write_b32 a83, v233
    v_accvgpr_read_b32 v230, a100
    v_accvgpr_read_b32 v231, a101
    v_accvgpr_read_b32 v232, a102
    v_accvgpr_read_b32 v233, a103
    v_mul_f32 v230, v230, v229
    v_mul_f32 v231, v231, v229
    v_mul_f32 v232, v232, v229
    v_mul_f32 v233, v233, v229
    v_accvgpr_write_b32 a100, v230
    v_accvgpr_write_b32 a101, v231
    v_accvgpr_write_b32 a102, v232
    v_accvgpr_write_b32 a103, v233
    v_accvgpr_read_b32 v230, a120
    v_accvgpr_read_b32 v231, a121
    v_accvgpr_read_b32 v232, a122
    v_accvgpr_read_b32 v233, a123
    v_mul_f32 v230, v230, v229
    v_mul_f32 v231, v231, v229
    v_mul_f32 v232, v232, v229
    v_mul_f32 v233, v233, v229
    v_accvgpr_write_b32 a120, v230
    v_accvgpr_write_b32 a121, v231
    v_accvgpr_write_b32 a122, v232
    v_accvgpr_write_b32 a123, v233
    v_accvgpr_read_b32 v230, a140
    v_accvgpr_read_b32 v231, a141
    v_accvgpr_read_b32 v232, a142
    v_accvgpr_read_b32 v233, a143
    v_mul_f32 v230, v230, v229
    v_mul_f32 v231, v231, v229
    v_mul_f32 v232, v232, v229
    v_mul_f32 v233, v233, v229
    v_accvgpr_write_b32 a140, v230
    v_accvgpr_write_b32 a141, v231
    v_accvgpr_write_b32 a142, v232
    v_accvgpr_write_b32 a143, v233
    v_max3_f32 v228, v36, v37, v38
    v_max3_f32 v228, v228, v39, v56
    v_max3_f32 v228, v228, v57, v58
    v_max_f32 v228, v228, v59
    v_mov_b32 v229, v228
    s_nop 1
    v_permlane32_swap_b32 v228, v229
    s_nop 1
    v_max_f32 v228, v228, v229
    v_mov_b32 v229, v228
    s_nop 1
    v_permlane16_swap_b32 v228, v229
    s_nop 1
    v_max_f32 v228, v228, v229
    v_max_f32 v228, s51, v228
    v_sub_f32 v229, 0, v228
    v_exp_f32 v229, v229
    v_add_f32 v222, v222, v228
    v_sub_f32 v200, v200, v228
    v_sub_f32 v36, v36, v228
    v_sub_f32 v56, v56, v228
    v_sub_f32 v201, v201, v228
    v_sub_f32 v37, v37, v228
    v_sub_f32 v57, v57, v228
    v_sub_f32 v202, v202, v228
    v_sub_f32 v38, v38, v228
    v_sub_f32 v58, v58, v228
    v_sub_f32 v203, v203, v228
    v_sub_f32 v39, v39, v228
    v_sub_f32 v59, v59, v228
    v_mul_f32 v217, v217, v229
    v_accvgpr_read_b32 v230, a4
    v_accvgpr_read_b32 v231, a5
    v_accvgpr_read_b32 v232, a6
    v_accvgpr_read_b32 v233, a7
    v_mul_f32 v230, v230, v229
    v_mul_f32 v231, v231, v229
    v_mul_f32 v232, v232, v229
    v_mul_f32 v233, v233, v229
    v_accvgpr_write_b32 a4, v230
    v_accvgpr_write_b32 a5, v231
    v_accvgpr_write_b32 a6, v232
    v_accvgpr_write_b32 a7, v233
    v_accvgpr_read_b32 v230, a24
    v_accvgpr_read_b32 v231, a25
    v_accvgpr_read_b32 v232, a26
    v_accvgpr_read_b32 v233, a27
    v_mul_f32 v230, v230, v229
    v_mul_f32 v231, v231, v229
    v_mul_f32 v232, v232, v229
    v_mul_f32 v233, v233, v229
    v_accvgpr_write_b32 a24, v230
    v_accvgpr_write_b32 a25, v231
    v_accvgpr_write_b32 a26, v232
    v_accvgpr_write_b32 a27, v233
    v_accvgpr_read_b32 v230, a44
    v_accvgpr_read_b32 v231, a45
    v_accvgpr_read_b32 v232, a46
    v_accvgpr_read_b32 v233, a47
    v_mul_f32 v230, v230, v229
    v_mul_f32 v231, v231, v229
    v_mul_f32 v232, v232, v229
    v_mul_f32 v233, v233, v229
    v_accvgpr_write_b32 a44, v230
    v_accvgpr_write_b32 a45, v231
    v_accvgpr_write_b32 a46, v232
    v_accvgpr_write_b32 a47, v233
    v_accvgpr_read_b32 v230, a64
    v_accvgpr_read_b32 v231, a65
    v_accvgpr_read_b32 v232, a66
    v_accvgpr_read_b32 v233, a67
    v_mul_f32 v230, v230, v229
    v_mul_f32 v231, v231, v229
    v_mul_f32 v232, v232, v229
    v_mul_f32 v233, v233, v229
    v_accvgpr_write_b32 a64, v230
    v_accvgpr_write_b32 a65, v231
    v_accvgpr_write_b32 a66, v232
    v_accvgpr_write_b32 a67, v233
    v_accvgpr_read_b32 v230, a84
    v_accvgpr_read_b32 v231, a85
    v_accvgpr_read_b32 v232, a86
    v_accvgpr_read_b32 v233, a87
    v_mul_f32 v230, v230, v229
    v_mul_f32 v231, v231, v229
    v_mul_f32 v232, v232, v229
    v_mul_f32 v233, v233, v229
    v_accvgpr_write_b32 a84, v230
    v_accvgpr_write_b32 a85, v231
    v_accvgpr_write_b32 a86, v232
    v_accvgpr_write_b32 a87, v233
    v_accvgpr_read_b32 v230, a104
    v_accvgpr_read_b32 v231, a105
    v_accvgpr_read_b32 v232, a106
    v_accvgpr_read_b32 v233, a107
    v_mul_f32 v230, v230, v229
    v_mul_f32 v231, v231, v229
    v_mul_f32 v232, v232, v229
    v_mul_f32 v233, v233, v229
    v_accvgpr_write_b32 a104, v230
    v_accvgpr_write_b32 a105, v231
    v_accvgpr_write_b32 a106, v232
    v_accvgpr_write_b32 a107, v233
    v_accvgpr_read_b32 v230, a124
    v_accvgpr_read_b32 v231, a125
    v_accvgpr_read_b32 v232, a126
    v_accvgpr_read_b32 v233, a127
    v_mul_f32 v230, v230, v229
    v_mul_f32 v231, v231, v229
    v_mul_f32 v232, v232, v229
    v_mul_f32 v233, v233, v229
    v_accvgpr_write_b32 a124, v230
    v_accvgpr_write_b32 a125, v231
    v_accvgpr_write_b32 a126, v232
    v_accvgpr_write_b32 a127, v233
    v_accvgpr_read_b32 v230, a144
    v_accvgpr_read_b32 v231, a145
    v_accvgpr_read_b32 v232, a146
    v_accvgpr_read_b32 v233, a147
    v_mul_f32 v230, v230, v229
    v_mul_f32 v231, v231, v229
    v_mul_f32 v232, v232, v229
    v_mul_f32 v233, v233, v229
    v_accvgpr_write_b32 a144, v230
    v_accvgpr_write_b32 a145, v231
    v_accvgpr_write_b32 a146, v232
    v_accvgpr_write_b32 a147, v233
    v_max3_f32 v228, v40, v41, v42
    v_max3_f32 v228, v228, v43, v60
    v_max3_f32 v228, v228, v61, v62
    v_max_f32 v228, v228, v63
    v_mov_b32 v229, v228
    s_nop 1
    v_permlane32_swap_b32 v228, v229
    s_nop 1
    v_max_f32 v228, v228, v229
    v_mov_b32 v229, v228
    s_nop 1
    v_permlane16_swap_b32 v228, v229
    s_nop 1
    v_max_f32 v228, v228, v229
    v_max_f32 v228, s51, v228
    v_sub_f32 v229, 0, v228
    v_exp_f32 v229, v229
    v_add_f32 v223, v223, v228
    v_sub_f32 v204, v204, v228
    v_sub_f32 v40, v40, v228
    v_sub_f32 v60, v60, v228
    v_sub_f32 v205, v205, v228
    v_sub_f32 v41, v41, v228
    v_sub_f32 v61, v61, v228
    v_sub_f32 v206, v206, v228
    v_sub_f32 v42, v42, v228
    v_sub_f32 v62, v62, v228
    v_sub_f32 v207, v207, v228
    v_sub_f32 v43, v43, v228
    v_sub_f32 v63, v63, v228
    v_mul_f32 v218, v218, v229
    v_accvgpr_read_b32 v230, a8
    v_accvgpr_read_b32 v231, a9
    v_accvgpr_read_b32 v232, a10
    v_accvgpr_read_b32 v233, a11
    v_mul_f32 v230, v230, v229
    v_mul_f32 v231, v231, v229
    v_mul_f32 v232, v232, v229
    v_mul_f32 v233, v233, v229
    v_accvgpr_write_b32 a8, v230
    v_accvgpr_write_b32 a9, v231
    v_accvgpr_write_b32 a10, v232
    v_accvgpr_write_b32 a11, v233
    v_accvgpr_read_b32 v230, a28
    v_accvgpr_read_b32 v231, a29
    v_accvgpr_read_b32 v232, a30
    v_accvgpr_read_b32 v233, a31
    v_mul_f32 v230, v230, v229
    v_mul_f32 v231, v231, v229
    v_mul_f32 v232, v232, v229
    v_mul_f32 v233, v233, v229
    v_accvgpr_write_b32 a28, v230
    v_accvgpr_write_b32 a29, v231
    v_accvgpr_write_b32 a30, v232
    v_accvgpr_write_b32 a31, v233
    v_accvgpr_read_b32 v230, a48
    v_accvgpr_read_b32 v231, a49
    v_accvgpr_read_b32 v232, a50
    v_accvgpr_read_b32 v233, a51
    v_mul_f32 v230, v230, v229
    v_mul_f32 v231, v231, v229
    v_mul_f32 v232, v232, v229
    v_mul_f32 v233, v233, v229
    v_accvgpr_write_b32 a48, v230
    v_accvgpr_write_b32 a49, v231
    v_accvgpr_write_b32 a50, v232
    v_accvgpr_write_b32 a51, v233
    v_accvgpr_read_b32 v230, a68
    v_accvgpr_read_b32 v231, a69
    v_accvgpr_read_b32 v232, a70
    v_accvgpr_read_b32 v233, a71
    v_mul_f32 v230, v230, v229
    v_mul_f32 v231, v231, v229
    v_mul_f32 v232, v232, v229
    v_mul_f32 v233, v233, v229
    v_accvgpr_write_b32 a68, v230
    v_accvgpr_write_b32 a69, v231
    v_accvgpr_write_b32 a70, v232
    v_accvgpr_write_b32 a71, v233
    v_accvgpr_read_b32 v230, a88
    v_accvgpr_read_b32 v231, a89
    v_accvgpr_read_b32 v232, a90
    v_accvgpr_read_b32 v233, a91
    v_mul_f32 v230, v230, v229
    v_mul_f32 v231, v231, v229
    v_mul_f32 v232, v232, v229
    v_mul_f32 v233, v233, v229
    v_accvgpr_write_b32 a88, v230
    v_accvgpr_write_b32 a89, v231
    v_accvgpr_write_b32 a90, v232
    v_accvgpr_write_b32 a91, v233
    v_accvgpr_read_b32 v230, a108
    v_accvgpr_read_b32 v231, a109
    v_accvgpr_read_b32 v232, a110
    v_accvgpr_read_b32 v233, a111
    v_mul_f32 v230, v230, v229
    v_mul_f32 v231, v231, v229
    v_mul_f32 v232, v232, v229
    v_mul_f32 v233, v233, v229
    v_accvgpr_write_b32 a108, v230
    v_accvgpr_write_b32 a109, v231
    v_accvgpr_write_b32 a110, v232
    v_accvgpr_write_b32 a111, v233
    v_accvgpr_read_b32 v230, a128
    v_accvgpr_read_b32 v231, a129
    v_accvgpr_read_b32 v232, a130
    v_accvgpr_read_b32 v233, a131
    v_mul_f32 v230, v230, v229
    v_mul_f32 v231, v231, v229
    v_mul_f32 v232, v232, v229
    v_mul_f32 v233, v233, v229
    v_accvgpr_write_b32 a128, v230
    v_accvgpr_write_b32 a129, v231
    v_accvgpr_write_b32 a130, v232
    v_accvgpr_write_b32 a131, v233
    v_accvgpr_read_b32 v230, a148
    v_accvgpr_read_b32 v231, a149
    v_accvgpr_read_b32 v232, a150
    v_accvgpr_read_b32 v233, a151
    v_mul_f32 v230, v230, v229
    v_mul_f32 v231, v231, v229
    v_mul_f32 v232, v232, v229
    v_mul_f32 v233, v233, v229
    v_accvgpr_write_b32 a148, v230
    v_accvgpr_write_b32 a149, v231
    v_accvgpr_write_b32 a150, v232
    v_accvgpr_write_b32 a151, v233
    v_max3_f32 v228, v44, v45, v46
    v_max3_f32 v228, v228, v47, v64
    v_max3_f32 v228, v228, v65, v66
    v_max_f32 v228, v228, v67
    v_mov_b32 v229, v228
    s_nop 1
    v_permlane32_swap_b32 v228, v229
    s_nop 1
    v_max_f32 v228, v228, v229
    v_mov_b32 v229, v228
    s_nop 1
    v_permlane16_swap_b32 v228, v229
    s_nop 1
    v_max_f32 v228, v228, v229
    v_max_f32 v228, s51, v228
    v_sub_f32 v229, 0, v228
    v_exp_f32 v229, v229
    v_add_f32 v224, v224, v228
    v_sub_f32 v208, v208, v228
    v_sub_f32 v44, v44, v228
    v_sub_f32 v64, v64, v228
    v_sub_f32 v209, v209, v228
    v_sub_f32 v45, v45, v228
    v_sub_f32 v65, v65, v228
    v_sub_f32 v210, v210, v228
    v_sub_f32 v46, v46, v228
    v_sub_f32 v66, v66, v228
    v_sub_f32 v211, v211, v228
    v_sub_f32 v47, v47, v228
    v_sub_f32 v67, v67, v228
    v_mul_f32 v219, v219, v229
    v_accvgpr_read_b32 v230, a12
    v_accvgpr_read_b32 v231, a13
    v_accvgpr_read_b32 v232, a14
    v_accvgpr_read_b32 v233, a15
    v_mul_f32 v230, v230, v229
    v_mul_f32 v231, v231, v229
    v_mul_f32 v232, v232, v229
    v_mul_f32 v233, v233, v229
    v_accvgpr_write_b32 a12, v230
    v_accvgpr_write_b32 a13, v231
    v_accvgpr_write_b32 a14, v232
    v_accvgpr_write_b32 a15, v233
    v_accvgpr_read_b32 v230, a32
    v_accvgpr_read_b32 v231, a33
    v_accvgpr_read_b32 v232, a34
    v_accvgpr_read_b32 v233, a35
    v_mul_f32 v230, v230, v229
    v_mul_f32 v231, v231, v229
    v_mul_f32 v232, v232, v229
    v_mul_f32 v233, v233, v229
    v_accvgpr_write_b32 a32, v230
    v_accvgpr_write_b32 a33, v231
    v_accvgpr_write_b32 a34, v232
    v_accvgpr_write_b32 a35, v233
    v_accvgpr_read_b32 v230, a52
    v_accvgpr_read_b32 v231, a53
    v_accvgpr_read_b32 v232, a54
    v_accvgpr_read_b32 v233, a55
    v_mul_f32 v230, v230, v229
    v_mul_f32 v231, v231, v229
    v_mul_f32 v232, v232, v229
    v_mul_f32 v233, v233, v229
    v_accvgpr_write_b32 a52, v230
    v_accvgpr_write_b32 a53, v231
    v_accvgpr_write_b32 a54, v232
    v_accvgpr_write_b32 a55, v233
    v_accvgpr_read_b32 v230, a72
    v_accvgpr_read_b32 v231, a73
    v_accvgpr_read_b32 v232, a74
    v_accvgpr_read_b32 v233, a75
    v_mul_f32 v230, v230, v229
    v_mul_f32 v231, v231, v229
    v_mul_f32 v232, v232, v229
    v_mul_f32 v233, v233, v229
    v_accvgpr_write_b32 a72, v230
    v_accvgpr_write_b32 a73, v231
    v_accvgpr_write_b32 a74, v232
    v_accvgpr_write_b32 a75, v233
    v_accvgpr_read_b32 v230, a92
    v_accvgpr_read_b32 v231, a93
    v_accvgpr_read_b32 v232, a94
    v_accvgpr_read_b32 v233, a95
    v_mul_f32 v230, v230, v229
    v_mul_f32 v231, v231, v229
    v_mul_f32 v232, v232, v229
    v_mul_f32 v233, v233, v229
    v_accvgpr_write_b32 a92, v230
    v_accvgpr_write_b32 a93, v231
    v_accvgpr_write_b32 a94, v232
    v_accvgpr_write_b32 a95, v233
    v_accvgpr_read_b32 v230, a112
    v_accvgpr_read_b32 v231, a113
    v_accvgpr_read_b32 v232, a114
    v_accvgpr_read_b32 v233, a115
    v_mul_f32 v230, v230, v229
    v_mul_f32 v231, v231, v229
    v_mul_f32 v232, v232, v229
    v_mul_f32 v233, v233, v229
    v_accvgpr_write_b32 a112, v230
    v_accvgpr_write_b32 a113, v231
    v_accvgpr_write_b32 a114, v232
    v_accvgpr_write_b32 a115, v233
    v_accvgpr_read_b32 v230, a132
    v_accvgpr_read_b32 v231, a133
    v_accvgpr_read_b32 v232, a134
    v_accvgpr_read_b32 v233, a135
    v_mul_f32 v230, v230, v229
    v_mul_f32 v231, v231, v229
    v_mul_f32 v232, v232, v229
    v_mul_f32 v233, v233, v229
    v_accvgpr_write_b32 a132, v230
    v_accvgpr_write_b32 a133, v231
    v_accvgpr_write_b32 a134, v232
    v_accvgpr_write_b32 a135, v233
    v_accvgpr_read_b32 v230, a152
    v_accvgpr_read_b32 v231, a153
    v_accvgpr_read_b32 v232, a154
    v_accvgpr_read_b32 v233, a155
    v_mul_f32 v230, v230, v229
    v_mul_f32 v231, v231, v229
    v_mul_f32 v232, v232, v229
    v_mul_f32 v233, v233, v229
    v_accvgpr_write_b32 a152, v230
    v_accvgpr_write_b32 a153, v231
    v_accvgpr_write_b32 a154, v232
    v_accvgpr_write_b32 a155, v233
    v_max3_f32 v228, v48, v49, v50
    v_max3_f32 v228, v228, v51, v68
    v_max3_f32 v228, v228, v69, v70
    v_max_f32 v228, v228, v71
    v_mov_b32 v229, v228
    s_nop 1
    v_permlane32_swap_b32 v228, v229
    s_nop 1
    v_max_f32 v228, v228, v229
    v_mov_b32 v229, v228
    s_nop 1
    v_permlane16_swap_b32 v228, v229
    s_nop 1
    v_max_f32 v228, v228, v229
    v_max_f32 v228, s51, v228
    v_sub_f32 v229, 0, v228
    v_exp_f32 v229, v229
    v_add_f32 v225, v225, v228
    v_sub_f32 v212, v212, v228
    v_sub_f32 v48, v48, v228
    v_sub_f32 v68, v68, v228
    v_sub_f32 v213, v213, v228
    v_sub_f32 v49, v49, v228
    v_sub_f32 v69, v69, v228
    v_sub_f32 v214, v214, v228
    v_sub_f32 v50, v50, v228
    v_sub_f32 v70, v70, v228
    v_sub_f32 v215, v215, v228
    v_sub_f32 v51, v51, v228
    v_sub_f32 v71, v71, v228
    v_mul_f32 v220, v220, v229
    v_accvgpr_read_b32 v230, a16
    v_accvgpr_read_b32 v231, a17
    v_accvgpr_read_b32 v232, a18
    v_accvgpr_read_b32 v233, a19
    v_mul_f32 v230, v230, v229
    v_mul_f32 v231, v231, v229
    v_mul_f32 v232, v232, v229
    v_mul_f32 v233, v233, v229
    v_accvgpr_write_b32 a16, v230
    v_accvgpr_write_b32 a17, v231
    v_accvgpr_write_b32 a18, v232
    v_accvgpr_write_b32 a19, v233
    v_accvgpr_read_b32 v230, a36
    v_accvgpr_read_b32 v231, a37
    v_accvgpr_read_b32 v232, a38
    v_accvgpr_read_b32 v233, a39
    v_mul_f32 v230, v230, v229
    v_mul_f32 v231, v231, v229
    v_mul_f32 v232, v232, v229
    v_mul_f32 v233, v233, v229
    v_accvgpr_write_b32 a36, v230
    v_accvgpr_write_b32 a37, v231
    v_accvgpr_write_b32 a38, v232
    v_accvgpr_write_b32 a39, v233
    v_accvgpr_read_b32 v230, a56
    v_accvgpr_read_b32 v231, a57
    v_accvgpr_read_b32 v232, a58
    v_accvgpr_read_b32 v233, a59
    v_mul_f32 v230, v230, v229
    v_mul_f32 v231, v231, v229
    v_mul_f32 v232, v232, v229
    v_mul_f32 v233, v233, v229
    v_accvgpr_write_b32 a56, v230
    v_accvgpr_write_b32 a57, v231
    v_accvgpr_write_b32 a58, v232
    v_accvgpr_write_b32 a59, v233
    v_accvgpr_read_b32 v230, a76
    v_accvgpr_read_b32 v231, a77
    v_accvgpr_read_b32 v232, a78
    v_accvgpr_read_b32 v233, a79
    v_mul_f32 v230, v230, v229
    v_mul_f32 v231, v231, v229
    v_mul_f32 v232, v232, v229
    v_mul_f32 v233, v233, v229
    v_accvgpr_write_b32 a76, v230
    v_accvgpr_write_b32 a77, v231
    v_accvgpr_write_b32 a78, v232
    v_accvgpr_write_b32 a79, v233
    v_accvgpr_read_b32 v230, a96
    v_accvgpr_read_b32 v231, a97
    v_accvgpr_read_b32 v232, a98
    v_accvgpr_read_b32 v233, a99
    v_mul_f32 v230, v230, v229
    v_mul_f32 v231, v231, v229
    v_mul_f32 v232, v232, v229
    v_mul_f32 v233, v233, v229
    v_accvgpr_write_b32 a96, v230
    v_accvgpr_write_b32 a97, v231
    v_accvgpr_write_b32 a98, v232
    v_accvgpr_write_b32 a99, v233
    v_accvgpr_read_b32 v230, a116
    v_accvgpr_read_b32 v231, a117
    v_accvgpr_read_b32 v232, a118
    v_accvgpr_read_b32 v233, a119
    v_mul_f32 v230, v230, v229
    v_mul_f32 v231, v231, v229
    v_mul_f32 v232, v232, v229
    v_mul_f32 v233, v233, v229
    v_accvgpr_write_b32 a116, v230
    v_accvgpr_write_b32 a117, v231
    v_accvgpr_write_b32 a118, v232
    v_accvgpr_write_b32 a119, v233
    v_accvgpr_read_b32 v230, a136
    v_accvgpr_read_b32 v231, a137
    v_accvgpr_read_b32 v232, a138
    v_accvgpr_read_b32 v233, a139
    v_mul_f32 v230, v230, v229
    v_mul_f32 v231, v231, v229
    v_mul_f32 v232, v232, v229
    v_mul_f32 v233, v233, v229
    v_accvgpr_write_b32 a136, v230
    v_accvgpr_write_b32 a137, v231
    v_accvgpr_write_b32 a138, v232
    v_accvgpr_write_b32 a139, v233
    v_accvgpr_read_b32 v230, a156
    v_accvgpr_read_b32 v231, a157
    v_accvgpr_read_b32 v232, a158
    v_accvgpr_read_b32 v233, a159
    v_mul_f32 v230, v230, v229
    v_mul_f32 v231, v231, v229
    v_mul_f32 v232, v232, v229
    v_mul_f32 v233, v233, v229
    v_accvgpr_write_b32 a156, v230
    v_accvgpr_write_b32 a157, v231
    v_accvgpr_write_b32 a158, v232
    v_accvgpr_write_b32 a159, v233
    s_mov_b32 s50, 0x41000000
    s_mov_b32 s51, 0
    s_nop 1
    s_branch k1_kernel_L12
k1_kernel_L13:
    s_nop 7
    v_max3_f32 v228, v72, v73, v74
    v_max3_f32 v228, v228, v75, v92
    v_max3_f32 v228, v228, v93, v94
    v_max_f32 v228, v228, v95
    v_mov_b32 v229, v228
    s_nop 1
    v_permlane32_swap_b32 v228, v229
    s_nop 1
    v_max_f32 v228, v228, v229
    v_mov_b32 v229, v228
    s_nop 1
    v_permlane16_swap_b32 v228, v229
    s_nop 1
    v_max_f32 v228, v228, v229
    v_max_f32 v228, s51, v228
    v_sub_f32 v229, 0, v228
    v_exp_f32 v229, v229
    v_add_f32 v221, v221, v228
    v_sub_f32 v196, v196, v228
    v_sub_f32 v72, v72, v228
    v_sub_f32 v92, v92, v228
    v_sub_f32 v197, v197, v228
    v_sub_f32 v73, v73, v228
    v_sub_f32 v93, v93, v228
    v_sub_f32 v198, v198, v228
    v_sub_f32 v74, v74, v228
    v_sub_f32 v94, v94, v228
    v_sub_f32 v199, v199, v228
    v_sub_f32 v75, v75, v228
    v_sub_f32 v95, v95, v228
    v_mul_f32 v216, v216, v229
    v_accvgpr_read_b32 v230, a0
    v_accvgpr_read_b32 v231, a1
    v_accvgpr_read_b32 v232, a2
    v_accvgpr_read_b32 v233, a3
    v_mul_f32 v230, v230, v229
    v_mul_f32 v231, v231, v229
    v_mul_f32 v232, v232, v229
    v_mul_f32 v233, v233, v229
    v_accvgpr_write_b32 a0, v230
    v_accvgpr_write_b32 a1, v231
    v_accvgpr_write_b32 a2, v232
    v_accvgpr_write_b32 a3, v233
    v_accvgpr_read_b32 v230, a20
    v_accvgpr_read_b32 v231, a21
    v_accvgpr_read_b32 v232, a22
    v_accvgpr_read_b32 v233, a23
    v_mul_f32 v230, v230, v229
    v_mul_f32 v231, v231, v229
    v_mul_f32 v232, v232, v229
    v_mul_f32 v233, v233, v229
    v_accvgpr_write_b32 a20, v230
    v_accvgpr_write_b32 a21, v231
    v_accvgpr_write_b32 a22, v232
    v_accvgpr_write_b32 a23, v233
    v_accvgpr_read_b32 v230, a40
    v_accvgpr_read_b32 v231, a41
    v_accvgpr_read_b32 v232, a42
    v_accvgpr_read_b32 v233, a43
    v_mul_f32 v230, v230, v229
    v_mul_f32 v231, v231, v229
    v_mul_f32 v232, v232, v229
    v_mul_f32 v233, v233, v229
    v_accvgpr_write_b32 a40, v230
    v_accvgpr_write_b32 a41, v231
    v_accvgpr_write_b32 a42, v232
    v_accvgpr_write_b32 a43, v233
    v_accvgpr_read_b32 v230, a60
    v_accvgpr_read_b32 v231, a61
    v_accvgpr_read_b32 v232, a62
    v_accvgpr_read_b32 v233, a63
    v_mul_f32 v230, v230, v229
    v_mul_f32 v231, v231, v229
    v_mul_f32 v232, v232, v229
    v_mul_f32 v233, v233, v229
    v_accvgpr_write_b32 a60, v230
    v_accvgpr_write_b32 a61, v231
    v_accvgpr_write_b32 a62, v232
    v_accvgpr_write_b32 a63, v233
    v_accvgpr_read_b32 v230, a80
    v_accvgpr_read_b32 v231, a81
    v_accvgpr_read_b32 v232, a82
    v_accvgpr_read_b32 v233, a83
    v_mul_f32 v230, v230, v229
    v_mul_f32 v231, v231, v229
    v_mul_f32 v232, v232, v229
    v_mul_f32 v233, v233, v229
    v_accvgpr_write_b32 a80, v230
    v_accvgpr_write_b32 a81, v231
    v_accvgpr_write_b32 a82, v232
    v_accvgpr_write_b32 a83, v233
    v_accvgpr_read_b32 v230, a100
    v_accvgpr_read_b32 v231, a101
    v_accvgpr_read_b32 v232, a102
    v_accvgpr_read_b32 v233, a103
    v_mul_f32 v230, v230, v229
    v_mul_f32 v231, v231, v229
    v_mul_f32 v232, v232, v229
    v_mul_f32 v233, v233, v229
    v_accvgpr_write_b32 a100, v230
    v_accvgpr_write_b32 a101, v231
    v_accvgpr_write_b32 a102, v232
    v_accvgpr_write_b32 a103, v233
    v_accvgpr_read_b32 v230, a120
    v_accvgpr_read_b32 v231, a121
    v_accvgpr_read_b32 v232, a122
    v_accvgpr_read_b32 v233, a123
    v_mul_f32 v230, v230, v229
    v_mul_f32 v231, v231, v229
    v_mul_f32 v232, v232, v229
    v_mul_f32 v233, v233, v229
    v_accvgpr_write_b32 a120, v230
    v_accvgpr_write_b32 a121, v231
    v_accvgpr_write_b32 a122, v232
    v_accvgpr_write_b32 a123, v233
    v_accvgpr_read_b32 v230, a140
    v_accvgpr_read_b32 v231, a141
    v_accvgpr_read_b32 v232, a142
    v_accvgpr_read_b32 v233, a143
    v_mul_f32 v230, v230, v229
    v_mul_f32 v231, v231, v229
    v_mul_f32 v232, v232, v229
    v_mul_f32 v233, v233, v229
    v_accvgpr_write_b32 a140, v230
    v_accvgpr_write_b32 a141, v231
    v_accvgpr_write_b32 a142, v232
    v_accvgpr_write_b32 a143, v233
    v_max3_f32 v228, v76, v77, v78
    v_max3_f32 v228, v228, v79, v96
    v_max3_f32 v228, v228, v97, v98
    v_max_f32 v228, v228, v99
    v_mov_b32 v229, v228
    s_nop 1
    v_permlane32_swap_b32 v228, v229
    s_nop 1
    v_max_f32 v228, v228, v229
    v_mov_b32 v229, v228
    s_nop 1
    v_permlane16_swap_b32 v228, v229
    s_nop 1
    v_max_f32 v228, v228, v229
    v_max_f32 v228, s51, v228
    v_sub_f32 v229, 0, v228
    v_exp_f32 v229, v229
    v_add_f32 v222, v222, v228
    v_sub_f32 v200, v200, v228
    v_sub_f32 v76, v76, v228
    v_sub_f32 v96, v96, v228
    v_sub_f32 v201, v201, v228
    v_sub_f32 v77, v77, v228
    v_sub_f32 v97, v97, v228
    v_sub_f32 v202, v202, v228
    v_sub_f32 v78, v78, v228
    v_sub_f32 v98, v98, v228
    v_sub_f32 v203, v203, v228
    v_sub_f32 v79, v79, v228
    v_sub_f32 v99, v99, v228
    v_mul_f32 v217, v217, v229
    v_accvgpr_read_b32 v230, a4
    v_accvgpr_read_b32 v231, a5
    v_accvgpr_read_b32 v232, a6
    v_accvgpr_read_b32 v233, a7
    v_mul_f32 v230, v230, v229
    v_mul_f32 v231, v231, v229
    v_mul_f32 v232, v232, v229
    v_mul_f32 v233, v233, v229
    v_accvgpr_write_b32 a4, v230
    v_accvgpr_write_b32 a5, v231
    v_accvgpr_write_b32 a6, v232
    v_accvgpr_write_b32 a7, v233
    v_accvgpr_read_b32 v230, a24
    v_accvgpr_read_b32 v231, a25
    v_accvgpr_read_b32 v232, a26
    v_accvgpr_read_b32 v233, a27
    v_mul_f32 v230, v230, v229
    v_mul_f32 v231, v231, v229
    v_mul_f32 v232, v232, v229
    v_mul_f32 v233, v233, v229
    v_accvgpr_write_b32 a24, v230
    v_accvgpr_write_b32 a25, v231
    v_accvgpr_write_b32 a26, v232
    v_accvgpr_write_b32 a27, v233
    v_accvgpr_read_b32 v230, a44
    v_accvgpr_read_b32 v231, a45
    v_accvgpr_read_b32 v232, a46
    v_accvgpr_read_b32 v233, a47
    v_mul_f32 v230, v230, v229
    v_mul_f32 v231, v231, v229
    v_mul_f32 v232, v232, v229
    v_mul_f32 v233, v233, v229
    v_accvgpr_write_b32 a44, v230
    v_accvgpr_write_b32 a45, v231
    v_accvgpr_write_b32 a46, v232
    v_accvgpr_write_b32 a47, v233
    v_accvgpr_read_b32 v230, a64
    v_accvgpr_read_b32 v231, a65
    v_accvgpr_read_b32 v232, a66
    v_accvgpr_read_b32 v233, a67
    v_mul_f32 v230, v230, v229
    v_mul_f32 v231, v231, v229
    v_mul_f32 v232, v232, v229
    v_mul_f32 v233, v233, v229
    v_accvgpr_write_b32 a64, v230
    v_accvgpr_write_b32 a65, v231
    v_accvgpr_write_b32 a66, v232
    v_accvgpr_write_b32 a67, v233
    v_accvgpr_read_b32 v230, a84
    v_accvgpr_read_b32 v231, a85
    v_accvgpr_read_b32 v232, a86
    v_accvgpr_read_b32 v233, a87
    v_mul_f32 v230, v230, v229
    v_mul_f32 v231, v231, v229
    v_mul_f32 v232, v232, v229
    v_mul_f32 v233, v233, v229
    v_accvgpr_write_b32 a84, v230
    v_accvgpr_write_b32 a85, v231
    v_accvgpr_write_b32 a86, v232
    v_accvgpr_write_b32 a87, v233
    v_accvgpr_read_b32 v230, a104
    v_accvgpr_read_b32 v231, a105
    v_accvgpr_read_b32 v232, a106
    v_accvgpr_read_b32 v233, a107
    v_mul_f32 v230, v230, v229
    v_mul_f32 v231, v231, v229
    v_mul_f32 v232, v232, v229
    v_mul_f32 v233, v233, v229
    v_accvgpr_write_b32 a104, v230
    v_accvgpr_write_b32 a105, v231
    v_accvgpr_write_b32 a106, v232
    v_accvgpr_write_b32 a107, v233
    v_accvgpr_read_b32 v230, a124
    v_accvgpr_read_b32 v231, a125
    v_accvgpr_read_b32 v232, a126
    v_accvgpr_read_b32 v233, a127
    v_mul_f32 v230, v230, v229
    v_mul_f32 v231, v231, v229
    v_mul_f32 v232, v232, v229
    v_mul_f32 v233, v233, v229
    v_accvgpr_write_b32 a124, v230
    v_accvgpr_write_b32 a125, v231
    v_accvgpr_write_b32 a126, v232
    v_accvgpr_write_b32 a127, v233
    v_accvgpr_read_b32 v230, a144
    v_accvgpr_read_b32 v231, a145
    v_accvgpr_read_b32 v232, a146
    v_accvgpr_read_b32 v233, a147
    v_mul_f32 v230, v230, v229
    v_mul_f32 v231, v231, v229
    v_mul_f32 v232, v232, v229
    v_mul_f32 v233, v233, v229
    v_accvgpr_write_b32 a144, v230
    v_accvgpr_write_b32 a145, v231
    v_accvgpr_write_b32 a146, v232
    v_accvgpr_write_b32 a147, v233
    v_max3_f32 v228, v80, v81, v82
    v_max3_f32 v228, v228, v83, v100
    v_max3_f32 v228, v228, v101, v102
    v_max_f32 v228, v228, v103
    v_mov_b32 v229, v228
    s_nop 1
    v_permlane32_swap_b32 v228, v229
    s_nop 1
    v_max_f32 v228, v228, v229
    v_mov_b32 v229, v228
    s_nop 1
    v_permlane16_swap_b32 v228, v229
    s_nop 1
    v_max_f32 v228, v228, v229
    v_max_f32 v228, s51, v228
    v_sub_f32 v229, 0, v228
    v_exp_f32 v229, v229
    v_add_f32 v223, v223, v228
    v_sub_f32 v204, v204, v228
    v_sub_f32 v80, v80, v228
    v_sub_f32 v100, v100, v228
    v_sub_f32 v205, v205, v228
    v_sub_f32 v81, v81, v228
    v_sub_f32 v101, v101, v228
    v_sub_f32 v206, v206, v228
    v_sub_f32 v82, v82, v228
    v_sub_f32 v102, v102, v228
    v_sub_f32 v207, v207, v228
    v_sub_f32 v83, v83, v228
    v_sub_f32 v103, v103, v228
    v_mul_f32 v218, v218, v229
    v_accvgpr_read_b32 v230, a8
    v_accvgpr_read_b32 v231, a9
    v_accvgpr_read_b32 v232, a10
    v_accvgpr_read_b32 v233, a11
    v_mul_f32 v230, v230, v229
    v_mul_f32 v231, v231, v229
    v_mul_f32 v232, v232, v229
    v_mul_f32 v233, v233, v229
    v_accvgpr_write_b32 a8, v230
    v_accvgpr_write_b32 a9, v231
    v_accvgpr_write_b32 a10, v232
    v_accvgpr_write_b32 a11, v233
    v_accvgpr_read_b32 v230, a28
    v_accvgpr_read_b32 v231, a29
    v_accvgpr_read_b32 v232, a30
    v_accvgpr_read_b32 v233, a31
    v_mul_f32 v230, v230, v229
    v_mul_f32 v231, v231, v229
    v_mul_f32 v232, v232, v229
    v_mul_f32 v233, v233, v229
    v_accvgpr_write_b32 a28, v230
    v_accvgpr_write_b32 a29, v231
    v_accvgpr_write_b32 a30, v232
    v_accvgpr_write_b32 a31, v233
    v_accvgpr_read_b32 v230, a48
    v_accvgpr_read_b32 v231, a49
    v_accvgpr_read_b32 v232, a50
    v_accvgpr_read_b32 v233, a51
    v_mul_f32 v230, v230, v229
    v_mul_f32 v231, v231, v229
    v_mul_f32 v232, v232, v229
    v_mul_f32 v233, v233, v229
    v_accvgpr_write_b32 a48, v230
    v_accvgpr_write_b32 a49, v231
    v_accvgpr_write_b32 a50, v232
    v_accvgpr_write_b32 a51, v233
    v_accvgpr_read_b32 v230, a68
    v_accvgpr_read_b32 v231, a69
    v_accvgpr_read_b32 v232, a70
    v_accvgpr_read_b32 v233, a71
    v_mul_f32 v230, v230, v229
    v_mul_f32 v231, v231, v229
    v_mul_f32 v232, v232, v229
    v_mul_f32 v233, v233, v229
    v_accvgpr_write_b32 a68, v230
    v_accvgpr_write_b32 a69, v231
    v_accvgpr_write_b32 a70, v232
    v_accvgpr_write_b32 a71, v233
    v_accvgpr_read_b32 v230, a88
    v_accvgpr_read_b32 v231, a89
    v_accvgpr_read_b32 v232, a90
    v_accvgpr_read_b32 v233, a91
    v_mul_f32 v230, v230, v229
    v_mul_f32 v231, v231, v229
    v_mul_f32 v232, v232, v229
    v_mul_f32 v233, v233, v229
    v_accvgpr_write_b32 a88, v230
    v_accvgpr_write_b32 a89, v231
    v_accvgpr_write_b32 a90, v232
    v_accvgpr_write_b32 a91, v233
    v_accvgpr_read_b32 v230, a108
    v_accvgpr_read_b32 v231, a109
    v_accvgpr_read_b32 v232, a110
    v_accvgpr_read_b32 v233, a111
    v_mul_f32 v230, v230, v229
    v_mul_f32 v231, v231, v229
    v_mul_f32 v232, v232, v229
    v_mul_f32 v233, v233, v229
    v_accvgpr_write_b32 a108, v230
    v_accvgpr_write_b32 a109, v231
    v_accvgpr_write_b32 a110, v232
    v_accvgpr_write_b32 a111, v233
    v_accvgpr_read_b32 v230, a128
    v_accvgpr_read_b32 v231, a129
    v_accvgpr_read_b32 v232, a130
    v_accvgpr_read_b32 v233, a131
    v_mul_f32 v230, v230, v229
    v_mul_f32 v231, v231, v229
    v_mul_f32 v232, v232, v229
    v_mul_f32 v233, v233, v229
    v_accvgpr_write_b32 a128, v230
    v_accvgpr_write_b32 a129, v231
    v_accvgpr_write_b32 a130, v232
    v_accvgpr_write_b32 a131, v233
    v_accvgpr_read_b32 v230, a148
    v_accvgpr_read_b32 v231, a149
    v_accvgpr_read_b32 v232, a150
    v_accvgpr_read_b32 v233, a151
    v_mul_f32 v230, v230, v229
    v_mul_f32 v231, v231, v229
    v_mul_f32 v232, v232, v229
    v_mul_f32 v233, v233, v229
    v_accvgpr_write_b32 a148, v230
    v_accvgpr_write_b32 a149, v231
    v_accvgpr_write_b32 a150, v232
    v_accvgpr_write_b32 a151, v233
    v_max3_f32 v228, v84, v85, v86
    v_max3_f32 v228, v228, v87, v104
    v_max3_f32 v228, v228, v105, v106
    v_max_f32 v228, v228, v107
    v_mov_b32 v229, v228
    s_nop 1
    v_permlane32_swap_b32 v228, v229
    s_nop 1
    v_max_f32 v228, v228, v229
    v_mov_b32 v229, v228
    s_nop 1
    v_permlane16_swap_b32 v228, v229
    s_nop 1
    v_max_f32 v228, v228, v229
    v_max_f32 v228, s51, v228
    v_sub_f32 v229, 0, v228
    v_exp_f32 v229, v229
    v_add_f32 v224, v224, v228
    v_sub_f32 v208, v208, v228
    v_sub_f32 v84, v84, v228
    v_sub_f32 v104, v104, v228
    v_sub_f32 v209, v209, v228
    v_sub_f32 v85, v85, v228
    v_sub_f32 v105, v105, v228
    v_sub_f32 v210, v210, v228
    v_sub_f32 v86, v86, v228
    v_sub_f32 v106, v106, v228
    v_sub_f32 v211, v211, v228
    v_sub_f32 v87, v87, v228
    v_sub_f32 v107, v107, v228
    v_mul_f32 v219, v219, v229
    v_accvgpr_read_b32 v230, a12
    v_accvgpr_read_b32 v231, a13
    v_accvgpr_read_b32 v232, a14
    v_accvgpr_read_b32 v233, a15
    v_mul_f32 v230, v230, v229
    v_mul_f32 v231, v231, v229
    v_mul_f32 v232, v232, v229
    v_mul_f32 v233, v233, v229
    v_accvgpr_write_b32 a12, v230
    v_accvgpr_write_b32 a13, v231
    v_accvgpr_write_b32 a14, v232
    v_accvgpr_write_b32 a15, v233
    v_accvgpr_read_b32 v230, a32
    v_accvgpr_read_b32 v231, a33
    v_accvgpr_read_b32 v232, a34
    v_accvgpr_read_b32 v233, a35
    v_mul_f32 v230, v230, v229
    v_mul_f32 v231, v231, v229
    v_mul_f32 v232, v232, v229
    v_mul_f32 v233, v233, v229
    v_accvgpr_write_b32 a32, v230
    v_accvgpr_write_b32 a33, v231
    v_accvgpr_write_b32 a34, v232
    v_accvgpr_write_b32 a35, v233
    v_accvgpr_read_b32 v230, a52
    v_accvgpr_read_b32 v231, a53
    v_accvgpr_read_b32 v232, a54
    v_accvgpr_read_b32 v233, a55
    v_mul_f32 v230, v230, v229
    v_mul_f32 v231, v231, v229
    v_mul_f32 v232, v232, v229
    v_mul_f32 v233, v233, v229
    v_accvgpr_write_b32 a52, v230
    v_accvgpr_write_b32 a53, v231
    v_accvgpr_write_b32 a54, v232
    v_accvgpr_write_b32 a55, v233
    v_accvgpr_read_b32 v230, a72
    v_accvgpr_read_b32 v231, a73
    v_accvgpr_read_b32 v232, a74
    v_accvgpr_read_b32 v233, a75
    v_mul_f32 v230, v230, v229
    v_mul_f32 v231, v231, v229
    v_mul_f32 v232, v232, v229
    v_mul_f32 v233, v233, v229
    v_accvgpr_write_b32 a72, v230
    v_accvgpr_write_b32 a73, v231
    v_accvgpr_write_b32 a74, v232
    v_accvgpr_write_b32 a75, v233
    v_accvgpr_read_b32 v230, a92
    v_accvgpr_read_b32 v231, a93
    v_accvgpr_read_b32 v232, a94
    v_accvgpr_read_b32 v233, a95
    v_mul_f32 v230, v230, v229
    v_mul_f32 v231, v231, v229
    v_mul_f32 v232, v232, v229
    v_mul_f32 v233, v233, v229
    v_accvgpr_write_b32 a92, v230
    v_accvgpr_write_b32 a93, v231
    v_accvgpr_write_b32 a94, v232
    v_accvgpr_write_b32 a95, v233
    v_accvgpr_read_b32 v230, a112
    v_accvgpr_read_b32 v231, a113
    v_accvgpr_read_b32 v232, a114
    v_accvgpr_read_b32 v233, a115
    v_mul_f32 v230, v230, v229
    v_mul_f32 v231, v231, v229
    v_mul_f32 v232, v232, v229
    v_mul_f32 v233, v233, v229
    v_accvgpr_write_b32 a112, v230
    v_accvgpr_write_b32 a113, v231
    v_accvgpr_write_b32 a114, v232
    v_accvgpr_write_b32 a115, v233
    v_accvgpr_read_b32 v230, a132
    v_accvgpr_read_b32 v231, a133
    v_accvgpr_read_b32 v232, a134
    v_accvgpr_read_b32 v233, a135
    v_mul_f32 v230, v230, v229
    v_mul_f32 v231, v231, v229
    v_mul_f32 v232, v232, v229
    v_mul_f32 v233, v233, v229
    v_accvgpr_write_b32 a132, v230
    v_accvgpr_write_b32 a133, v231
    v_accvgpr_write_b32 a134, v232
    v_accvgpr_write_b32 a135, v233
    v_accvgpr_read_b32 v230, a152
    v_accvgpr_read_b32 v231, a153
    v_accvgpr_read_b32 v232, a154
    v_accvgpr_read_b32 v233, a155
    v_mul_f32 v230, v230, v229
    v_mul_f32 v231, v231, v229
    v_mul_f32 v232, v232, v229
    v_mul_f32 v233, v233, v229
    v_accvgpr_write_b32 a152, v230
    v_accvgpr_write_b32 a153, v231
    v_accvgpr_write_b32 a154, v232
    v_accvgpr_write_b32 a155, v233
    v_max3_f32 v228, v88, v89, v90
    v_max3_f32 v228, v228, v91, v108
    v_max3_f32 v228, v228, v109, v110
    v_max_f32 v228, v228, v111
    v_mov_b32 v229, v228
    s_nop 1
    v_permlane32_swap_b32 v228, v229
    s_nop 1
    v_max_f32 v228, v228, v229
    v_mov_b32 v229, v228
    s_nop 1
    v_permlane16_swap_b32 v228, v229
    s_nop 1
    v_max_f32 v228, v228, v229
    v_max_f32 v228, s51, v228
    v_sub_f32 v229, 0, v228
    v_exp_f32 v229, v229
    v_add_f32 v225, v225, v228
    v_sub_f32 v212, v212, v228
    v_sub_f32 v88, v88, v228
    v_sub_f32 v108, v108, v228
    v_sub_f32 v213, v213, v228
    v_sub_f32 v89, v89, v228
    v_sub_f32 v109, v109, v228
    v_sub_f32 v214, v214, v228
    v_sub_f32 v90, v90, v228
    v_sub_f32 v110, v110, v228
    v_sub_f32 v215, v215, v228
    v_sub_f32 v91, v91, v228
    v_sub_f32 v111, v111, v228
    v_mul_f32 v220, v220, v229
    v_accvgpr_read_b32 v230, a16
    v_accvgpr_read_b32 v231, a17
    v_accvgpr_read_b32 v232, a18
    v_accvgpr_read_b32 v233, a19
    v_mul_f32 v230, v230, v229
    v_mul_f32 v231, v231, v229
    v_mul_f32 v232, v232, v229
    v_mul_f32 v233, v233, v229
    v_accvgpr_write_b32 a16, v230
    v_accvgpr_write_b32 a17, v231
    v_accvgpr_write_b32 a18, v232
    v_accvgpr_write_b32 a19, v233
    v_accvgpr_read_b32 v230, a36
    v_accvgpr_read_b32 v231, a37
    v_accvgpr_read_b32 v232, a38
    v_accvgpr_read_b32 v233, a39
    v_mul_f32 v230, v230, v229
    v_mul_f32 v231, v231, v229
    v_mul_f32 v232, v232, v229
    v_mul_f32 v233, v233, v229
    v_accvgpr_write_b32 a36, v230
    v_accvgpr_write_b32 a37, v231
    v_accvgpr_write_b32 a38, v232
    v_accvgpr_write_b32 a39, v233
    v_accvgpr_read_b32 v230, a56
    v_accvgpr_read_b32 v231, a57
    v_accvgpr_read_b32 v232, a58
    v_accvgpr_read_b32 v233, a59
    v_mul_f32 v230, v230, v229
    v_mul_f32 v231, v231, v229
    v_mul_f32 v232, v232, v229
    v_mul_f32 v233, v233, v229
    v_accvgpr_write_b32 a56, v230
    v_accvgpr_write_b32 a57, v231
    v_accvgpr_write_b32 a58, v232
    v_accvgpr_write_b32 a59, v233
    v_accvgpr_read_b32 v230, a76
    v_accvgpr_read_b32 v231, a77
    v_accvgpr_read_b32 v232, a78
    v_accvgpr_read_b32 v233, a79
    v_mul_f32 v230, v230, v229
    v_mul_f32 v231, v231, v229
    v_mul_f32 v232, v232, v229
    v_mul_f32 v233, v233, v229
    v_accvgpr_write_b32 a76, v230
    v_accvgpr_write_b32 a77, v231
    v_accvgpr_write_b32 a78, v232
    v_accvgpr_write_b32 a79, v233
    v_accvgpr_read_b32 v230, a96
    v_accvgpr_read_b32 v231, a97
    v_accvgpr_read_b32 v232, a98
    v_accvgpr_read_b32 v233, a99
    v_mul_f32 v230, v230, v229
    v_mul_f32 v231, v231, v229
    v_mul_f32 v232, v232, v229
    v_mul_f32 v233, v233, v229
    v_accvgpr_write_b32 a96, v230
    v_accvgpr_write_b32 a97, v231
    v_accvgpr_write_b32 a98, v232
    v_accvgpr_write_b32 a99, v233
    v_accvgpr_read_b32 v230, a116
    v_accvgpr_read_b32 v231, a117
    v_accvgpr_read_b32 v232, a118
    v_accvgpr_read_b32 v233, a119
    v_mul_f32 v230, v230, v229
    v_mul_f32 v231, v231, v229
    v_mul_f32 v232, v232, v229
    v_mul_f32 v233, v233, v229
    v_accvgpr_write_b32 a116, v230
    v_accvgpr_write_b32 a117, v231
    v_accvgpr_write_b32 a118, v232
    v_accvgpr_write_b32 a119, v233
    v_accvgpr_read_b32 v230, a136
    v_accvgpr_read_b32 v231, a137
    v_accvgpr_read_b32 v232, a138
    v_accvgpr_read_b32 v233, a139
    v_mul_f32 v230, v230, v229
    v_mul_f32 v231, v231, v229
    v_mul_f32 v232, v232, v229
    v_mul_f32 v233, v233, v229
    v_accvgpr_write_b32 a136, v230
    v_accvgpr_write_b32 a137, v231
    v_accvgpr_write_b32 a138, v232
    v_accvgpr_write_b32 a139, v233
    v_accvgpr_read_b32 v230, a156
    v_accvgpr_read_b32 v231, a157
    v_accvgpr_read_b32 v232, a158
    v_accvgpr_read_b32 v233, a159
    v_mul_f32 v230, v230, v229
    v_mul_f32 v231, v231, v229
    v_mul_f32 v232, v232, v229
    v_mul_f32 v233, v233, v229
    v_accvgpr_write_b32 a156, v230
    v_accvgpr_write_b32 a157, v231
    v_accvgpr_write_b32 a158, v232
    v_accvgpr_write_b32 a159, v233
    s_mov_b32 s50, 0x41000000
    s_mov_b32 s51, 0
    s_nop 1
    s_branch k1_kernel_L14
k1_kernel_L15:
    s_nop 7
    v_max3_f32 v228, v32, v33, v34
    v_max3_f32 v228, v228, v35, v52
    v_max3_f32 v228, v228, v53, v54
    v_max_f32 v228, v228, v55
    v_mov_b32 v229, v228
    s_nop 1
    v_permlane32_swap_b32 v228, v229
    s_nop 1
    v_max_f32 v228, v228, v229
    v_mov_b32 v229, v228
    s_nop 1
    v_permlane16_swap_b32 v228, v229
    s_nop 1
    v_max_f32 v228, v228, v229
    v_max_f32 v228, s51, v228
    v_sub_f32 v229, 0, v228
    v_exp_f32 v229, v229
    v_add_f32 v221, v221, v228
    v_sub_f32 v196, v196, v228
    v_sub_f32 v32, v32, v228
    v_sub_f32 v52, v52, v228
    v_sub_f32 v197, v197, v228
    v_sub_f32 v33, v33, v228
    v_sub_f32 v53, v53, v228
    v_sub_f32 v198, v198, v228
    v_sub_f32 v34, v34, v228
    v_sub_f32 v54, v54, v228
    v_sub_f32 v199, v199, v228
    v_sub_f32 v35, v35, v228
    v_sub_f32 v55, v55, v228
    v_mul_f32 v216, v216, v229
    v_accvgpr_read_b32 v230, a0
    v_accvgpr_read_b32 v231, a1
    v_accvgpr_read_b32 v232, a2
    v_accvgpr_read_b32 v233, a3
    v_mul_f32 v230, v230, v229
    v_mul_f32 v231, v231, v229
    v_mul_f32 v232, v232, v229
    v_mul_f32 v233, v233, v229
    v_accvgpr_write_b32 a0, v230
    v_accvgpr_write_b32 a1, v231
    v_accvgpr_write_b32 a2, v232
    v_accvgpr_write_b32 a3, v233
    v_accvgpr_read_b32 v230, a20
    v_accvgpr_read_b32 v231, a21
    v_accvgpr_read_b32 v232, a22
    v_accvgpr_read_b32 v233, a23
    v_mul_f32 v230, v230, v229
    v_mul_f32 v231, v231, v229
    v_mul_f32 v232, v232, v229
    v_mul_f32 v233, v233, v229
    v_accvgpr_write_b32 a20, v230
    v_accvgpr_write_b32 a21, v231
    v_accvgpr_write_b32 a22, v232
    v_accvgpr_write_b32 a23, v233
    v_accvgpr_read_b32 v230, a40
    v_accvgpr_read_b32 v231, a41
    v_accvgpr_read_b32 v232, a42
    v_accvgpr_read_b32 v233, a43
    v_mul_f32 v230, v230, v229
    v_mul_f32 v231, v231, v229
    v_mul_f32 v232, v232, v229
    v_mul_f32 v233, v233, v229
    v_accvgpr_write_b32 a40, v230
    v_accvgpr_write_b32 a41, v231
    v_accvgpr_write_b32 a42, v232
    v_accvgpr_write_b32 a43, v233
    v_accvgpr_read_b32 v230, a60
    v_accvgpr_read_b32 v231, a61
    v_accvgpr_read_b32 v232, a62
    v_accvgpr_read_b32 v233, a63
    v_mul_f32 v230, v230, v229
    v_mul_f32 v231, v231, v229
    v_mul_f32 v232, v232, v229
    v_mul_f32 v233, v233, v229
    v_accvgpr_write_b32 a60, v230
    v_accvgpr_write_b32 a61, v231
    v_accvgpr_write_b32 a62, v232
    v_accvgpr_write_b32 a63, v233
    v_accvgpr_read_b32 v230, a80
    v_accvgpr_read_b32 v231, a81
    v_accvgpr_read_b32 v232, a82
    v_accvgpr_read_b32 v233, a83
    v_mul_f32 v230, v230, v229
    v_mul_f32 v231, v231, v229
    v_mul_f32 v232, v232, v229
    v_mul_f32 v233, v233, v229
    v_accvgpr_write_b32 a80, v230
    v_accvgpr_write_b32 a81, v231
    v_accvgpr_write_b32 a82, v232
    v_accvgpr_write_b32 a83, v233
    v_accvgpr_read_b32 v230, a100
    v_accvgpr_read_b32 v231, a101
    v_accvgpr_read_b32 v232, a102
    v_accvgpr_read_b32 v233, a103
    v_mul_f32 v230, v230, v229
    v_mul_f32 v231, v231, v229
    v_mul_f32 v232, v232, v229
    v_mul_f32 v233, v233, v229
    v_accvgpr_write_b32 a100, v230
    v_accvgpr_write_b32 a101, v231
    v_accvgpr_write_b32 a102, v232
    v_accvgpr_write_b32 a103, v233
    v_accvgpr_read_b32 v230, a120
    v_accvgpr_read_b32 v231, a121
    v_accvgpr_read_b32 v232, a122
    v_accvgpr_read_b32 v233, a123
    v_mul_f32 v230, v230, v229
    v_mul_f32 v231, v231, v229
    v_mul_f32 v232, v232, v229
    v_mul_f32 v233, v233, v229
    v_accvgpr_write_b32 a120, v230
    v_accvgpr_write_b32 a121, v231
    v_accvgpr_write_b32 a122, v232
    v_accvgpr_write_b32 a123, v233
    v_accvgpr_read_b32 v230, a140
    v_accvgpr_read_b32 v231, a141
    v_accvgpr_read_b32 v232, a142
    v_accvgpr_read_b32 v233, a143
    v_mul_f32 v230, v230, v229
    v_mul_f32 v231, v231, v229
    v_mul_f32 v232, v232, v229
    v_mul_f32 v233, v233, v229
    v_accvgpr_write_b32 a140, v230
    v_accvgpr_write_b32 a141, v231
    v_accvgpr_write_b32 a142, v232
    v_accvgpr_write_b32 a143, v233
    v_max3_f32 v228, v36, v37, v38
    v_max3_f32 v228, v228, v39, v56
    v_max3_f32 v228, v228, v57, v58
    v_max_f32 v228, v228, v59
    v_mov_b32 v229, v228
    s_nop 1
    v_permlane32_swap_b32 v228, v229
    s_nop 1
    v_max_f32 v228, v228, v229
    v_mov_b32 v229, v228
    s_nop 1
    v_permlane16_swap_b32 v228, v229
    s_nop 1
    v_max_f32 v228, v228, v229
    v_max_f32 v228, s51, v228
    v_sub_f32 v229, 0, v228
    v_exp_f32 v229, v229
    v_add_f32 v222, v222, v228
    v_sub_f32 v200, v200, v228
    v_sub_f32 v36, v36, v228
    v_sub_f32 v56, v56, v228
    v_sub_f32 v201, v201, v228
    v_sub_f32 v37, v37, v228
    v_sub_f32 v57, v57, v228
    v_sub_f32 v202, v202, v228
    v_sub_f32 v38, v38, v228
    v_sub_f32 v58, v58, v228
    v_sub_f32 v203, v203, v228
    v_sub_f32 v39, v39, v228
    v_sub_f32 v59, v59, v228
    v_mul_f32 v217, v217, v229
    v_accvgpr_read_b32 v230, a4
    v_accvgpr_read_b32 v231, a5
    v_accvgpr_read_b32 v232, a6
    v_accvgpr_read_b32 v233, a7
    v_mul_f32 v230, v230, v229
    v_mul_f32 v231, v231, v229
    v_mul_f32 v232, v232, v229
    v_mul_f32 v233, v233, v229
    v_accvgpr_write_b32 a4, v230
    v_accvgpr_write_b32 a5, v231
    v_accvgpr_write_b32 a6, v232
    v_accvgpr_write_b32 a7, v233
    v_accvgpr_read_b32 v230, a24
    v_accvgpr_read_b32 v231, a25
    v_accvgpr_read_b32 v232, a26
    v_accvgpr_read_b32 v233, a27
    v_mul_f32 v230, v230, v229
    v_mul_f32 v231, v231, v229
    v_mul_f32 v232, v232, v229
    v_mul_f32 v233, v233, v229
    v_accvgpr_write_b32 a24, v230
    v_accvgpr_write_b32 a25, v231
    v_accvgpr_write_b32 a26, v232
    v_accvgpr_write_b32 a27, v233
    v_accvgpr_read_b32 v230, a44
    v_accvgpr_read_b32 v231, a45
    v_accvgpr_read_b32 v232, a46
    v_accvgpr_read_b32 v233, a47
    v_mul_f32 v230, v230, v229
    v_mul_f32 v231, v231, v229
    v_mul_f32 v232, v232, v229
    v_mul_f32 v233, v233, v229
    v_accvgpr_write_b32 a44, v230
    v_accvgpr_write_b32 a45, v231
    v_accvgpr_write_b32 a46, v232
    v_accvgpr_write_b32 a47, v233
    v_accvgpr_read_b32 v230, a64
    v_accvgpr_read_b32 v231, a65
    v_accvgpr_read_b32 v232, a66
    v_accvgpr_read_b32 v233, a67
    v_mul_f32 v230, v230, v229
    v_mul_f32 v231, v231, v229
    v_mul_f32 v232, v232, v229
    v_mul_f32 v233, v233, v229
    v_accvgpr_write_b32 a64, v230
    v_accvgpr_write_b32 a65, v231
    v_accvgpr_write_b32 a66, v232
    v_accvgpr_write_b32 a67, v233
    v_accvgpr_read_b32 v230, a84
    v_accvgpr_read_b32 v231, a85
    v_accvgpr_read_b32 v232, a86
    v_accvgpr_read_b32 v233, a87
    v_mul_f32 v230, v230, v229
    v_mul_f32 v231, v231, v229
    v_mul_f32 v232, v232, v229
    v_mul_f32 v233, v233, v229
    v_accvgpr_write_b32 a84, v230
    v_accvgpr_write_b32 a85, v231
    v_accvgpr_write_b32 a86, v232
    v_accvgpr_write_b32 a87, v233
    v_accvgpr_read_b32 v230, a104
    v_accvgpr_read_b32 v231, a105
    v_accvgpr_read_b32 v232, a106
    v_accvgpr_read_b32 v233, a107
    v_mul_f32 v230, v230, v229
    v_mul_f32 v231, v231, v229
    v_mul_f32 v232, v232, v229
    v_mul_f32 v233, v233, v229
    v_accvgpr_write_b32 a104, v230
    v_accvgpr_write_b32 a105, v231
    v_accvgpr_write_b32 a106, v232
    v_accvgpr_write_b32 a107, v233
    v_accvgpr_read_b32 v230, a124
    v_accvgpr_read_b32 v231, a125
    v_accvgpr_read_b32 v232, a126
    v_accvgpr_read_b32 v233, a127
    v_mul_f32 v230, v230, v229
    v_mul_f32 v231, v231, v229
    v_mul_f32 v232, v232, v229
    v_mul_f32 v233, v233, v229
    v_accvgpr_write_b32 a124, v230
    v_accvgpr_write_b32 a125, v231
    v_accvgpr_write_b32 a126, v232
    v_accvgpr_write_b32 a127, v233
    v_accvgpr_read_b32 v230, a144
    v_accvgpr_read_b32 v231, a145
    v_accvgpr_read_b32 v232, a146
    v_accvgpr_read_b32 v233, a147
    v_mul_f32 v230, v230, v229
    v_mul_f32 v231, v231, v229
    v_mul_f32 v232, v232, v229
    v_mul_f32 v233, v233, v229
    v_accvgpr_write_b32 a144, v230
    v_accvgpr_write_b32 a145, v231
    v_accvgpr_write_b32 a146, v232
    v_accvgpr_write_b32 a147, v233
    v_max3_f32 v228, v40, v41, v42
    v_max3_f32 v228, v228, v43, v60
    v_max3_f32 v228, v228, v61, v62
    v_max_f32 v228, v228, v63
    v_mov_b32 v229, v228
    s_nop 1
    v_permlane32_swap_b32 v228, v229
    s_nop 1
    v_max_f32 v228, v228, v229
    v_mov_b32 v229, v228
    s_nop 1
    v_permlane16_swap_b32 v228, v229
    s_nop 1
    v_max_f32 v228, v228, v229
    v_max_f32 v228, s51, v228
    v_sub_f32 v229, 0, v228
    v_exp_f32 v229, v229
    v_add_f32 v223, v223, v228
    v_sub_f32 v204, v204, v228
    v_sub_f32 v40, v40, v228
    v_sub_f32 v60, v60, v228
    v_sub_f32 v205, v205, v228
    v_sub_f32 v41, v41, v228
    v_sub_f32 v61, v61, v228
    v_sub_f32 v206, v206, v228
    v_sub_f32 v42, v42, v228
    v_sub_f32 v62, v62, v228
    v_sub_f32 v207, v207, v228
    v_sub_f32 v43, v43, v228
    v_sub_f32 v63, v63, v228
    v_mul_f32 v218, v218, v229
    v_accvgpr_read_b32 v230, a8
    v_accvgpr_read_b32 v231, a9
    v_accvgpr_read_b32 v232, a10
    v_accvgpr_read_b32 v233, a11
    v_mul_f32 v230, v230, v229
    v_mul_f32 v231, v231, v229
    v_mul_f32 v232, v232, v229
    v_mul_f32 v233, v233, v229
    v_accvgpr_write_b32 a8, v230
    v_accvgpr_write_b32 a9, v231
    v_accvgpr_write_b32 a10, v232
    v_accvgpr_write_b32 a11, v233
    v_accvgpr_read_b32 v230, a28
    v_accvgpr_read_b32 v231, a29
    v_accvgpr_read_b32 v232, a30
    v_accvgpr_read_b32 v233, a31
    v_mul_f32 v230, v230, v229
    v_mul_f32 v231, v231, v229
    v_mul_f32 v232, v232, v229
    v_mul_f32 v233, v233, v229
    v_accvgpr_write_b32 a28, v230
    v_accvgpr_write_b32 a29, v231
    v_accvgpr_write_b32 a30, v232
    v_accvgpr_write_b32 a31, v233
    v_accvgpr_read_b32 v230, a48
    v_accvgpr_read_b32 v231, a49
    v_accvgpr_read_b32 v232, a50
    v_accvgpr_read_b32 v233, a51
    v_mul_f32 v230, v230, v229
    v_mul_f32 v231, v231, v229
    v_mul_f32 v232, v232, v229
    v_mul_f32 v233, v233, v229
    v_accvgpr_write_b32 a48, v230
    v_accvgpr_write_b32 a49, v231
    v_accvgpr_write_b32 a50, v232
    v_accvgpr_write_b32 a51, v233
    v_accvgpr_read_b32 v230, a68
    v_accvgpr_read_b32 v231, a69
    v_accvgpr_read_b32 v232, a70
    v_accvgpr_read_b32 v233, a71
    v_mul_f32 v230, v230, v229
    v_mul_f32 v231, v231, v229
    v_mul_f32 v232, v232, v229
    v_mul_f32 v233, v233, v229
    v_accvgpr_write_b32 a68, v230
    v_accvgpr_write_b32 a69, v231
    v_accvgpr_write_b32 a70, v232
    v_accvgpr_write_b32 a71, v233
    v_accvgpr_read_b32 v230, a88
    v_accvgpr_read_b32 v231, a89
    v_accvgpr_read_b32 v232, a90
    v_accvgpr_read_b32 v233, a91
    v_mul_f32 v230, v230, v229
    v_mul_f32 v231, v231, v229
    v_mul_f32 v232, v232, v229
    v_mul_f32 v233, v233, v229
    v_accvgpr_write_b32 a88, v230
    v_accvgpr_write_b32 a89, v231
    v_accvgpr_write_b32 a90, v232
    v_accvgpr_write_b32 a91, v233
    v_accvgpr_read_b32 v230, a108
    v_accvgpr_read_b32 v231, a109
    v_accvgpr_read_b32 v232, a110
    v_accvgpr_read_b32 v233, a111
    v_mul_f32 v230, v230, v229
    v_mul_f32 v231, v231, v229
    v_mul_f32 v232, v232, v229
    v_mul_f32 v233, v233, v229
    v_accvgpr_write_b32 a108, v230
    v_accvgpr_write_b32 a109, v231
    v_accvgpr_write_b32 a110, v232
    v_accvgpr_write_b32 a111, v233
    v_accvgpr_read_b32 v230, a128
    v_accvgpr_read_b32 v231, a129
    v_accvgpr_read_b32 v232, a130
    v_accvgpr_read_b32 v233, a131
    v_mul_f32 v230, v230, v229
    v_mul_f32 v231, v231, v229
    v_mul_f32 v232, v232, v229
    v_mul_f32 v233, v233, v229
    v_accvgpr_write_b32 a128, v230
    v_accvgpr_write_b32 a129, v231
    v_accvgpr_write_b32 a130, v232
    v_accvgpr_write_b32 a131, v233
    v_accvgpr_read_b32 v230, a148
    v_accvgpr_read_b32 v231, a149
    v_accvgpr_read_b32 v232, a150
    v_accvgpr_read_b32 v233, a151
    v_mul_f32 v230, v230, v229
    v_mul_f32 v231, v231, v229
    v_mul_f32 v232, v232, v229
    v_mul_f32 v233, v233, v229
    v_accvgpr_write_b32 a148, v230
    v_accvgpr_write_b32 a149, v231
    v_accvgpr_write_b32 a150, v232
    v_accvgpr_write_b32 a151, v233
    v_max3_f32 v228, v44, v45, v46
    v_max3_f32 v228, v228, v47, v64
    v_max3_f32 v228, v228, v65, v66
    v_max_f32 v228, v228, v67
    v_mov_b32 v229, v228
    s_nop 1
    v_permlane32_swap_b32 v228, v229
    s_nop 1
    v_max_f32 v228, v228, v229
    v_mov_b32 v229, v228
    s_nop 1
    v_permlane16_swap_b32 v228, v229
    s_nop 1
    v_max_f32 v228, v228, v229
    v_max_f32 v228, s51, v228
    v_sub_f32 v229, 0, v228
    v_exp_f32 v229, v229
    v_add_f32 v224, v224, v228
    v_sub_f32 v208, v208, v228
    v_sub_f32 v44, v44, v228
    v_sub_f32 v64, v64, v228
    v_sub_f32 v209, v209, v228
    v_sub_f32 v45, v45, v228
    v_sub_f32 v65, v65, v228
    v_sub_f32 v210, v210, v228
    v_sub_f32 v46, v46, v228
    v_sub_f32 v66, v66, v228
    v_sub_f32 v211, v211, v228
    v_sub_f32 v47, v47, v228
    v_sub_f32 v67, v67, v228
    v_mul_f32 v219, v219, v229
    v_accvgpr_read_b32 v230, a12
    v_accvgpr_read_b32 v231, a13
    v_accvgpr_read_b32 v232, a14
    v_accvgpr_read_b32 v233, a15
    v_mul_f32 v230, v230, v229
    v_mul_f32 v231, v231, v229
    v_mul_f32 v232, v232, v229
    v_mul_f32 v233, v233, v229
    v_accvgpr_write_b32 a12, v230
    v_accvgpr_write_b32 a13, v231
    v_accvgpr_write_b32 a14, v232
    v_accvgpr_write_b32 a15, v233
    v_accvgpr_read_b32 v230, a32
    v_accvgpr_read_b32 v231, a33
    v_accvgpr_read_b32 v232, a34
    v_accvgpr_read_b32 v233, a35
    v_mul_f32 v230, v230, v229
    v_mul_f32 v231, v231, v229
    v_mul_f32 v232, v232, v229
    v_mul_f32 v233, v233, v229
    v_accvgpr_write_b32 a32, v230
    v_accvgpr_write_b32 a33, v231
    v_accvgpr_write_b32 a34, v232
    v_accvgpr_write_b32 a35, v233
    v_accvgpr_read_b32 v230, a52
    v_accvgpr_read_b32 v231, a53
    v_accvgpr_read_b32 v232, a54
    v_accvgpr_read_b32 v233, a55
    v_mul_f32 v230, v230, v229
    v_mul_f32 v231, v231, v229
    v_mul_f32 v232, v232, v229
    v_mul_f32 v233, v233, v229
    v_accvgpr_write_b32 a52, v230
    v_accvgpr_write_b32 a53, v231
    v_accvgpr_write_b32 a54, v232
    v_accvgpr_write_b32 a55, v233
    v_accvgpr_read_b32 v230, a72
    v_accvgpr_read_b32 v231, a73
    v_accvgpr_read_b32 v232, a74
    v_accvgpr_read_b32 v233, a75
    v_mul_f32 v230, v230, v229
    v_mul_f32 v231, v231, v229
    v_mul_f32 v232, v232, v229
    v_mul_f32 v233, v233, v229
    v_accvgpr_write_b32 a72, v230
    v_accvgpr_write_b32 a73, v231
    v_accvgpr_write_b32 a74, v232
    v_accvgpr_write_b32 a75, v233
    v_accvgpr_read_b32 v230, a92
    v_accvgpr_read_b32 v231, a93
    v_accvgpr_read_b32 v232, a94
    v_accvgpr_read_b32 v233, a95
    v_mul_f32 v230, v230, v229
    v_mul_f32 v231, v231, v229
    v_mul_f32 v232, v232, v229
    v_mul_f32 v233, v233, v229
    v_accvgpr_write_b32 a92, v230
    v_accvgpr_write_b32 a93, v231
    v_accvgpr_write_b32 a94, v232
    v_accvgpr_write_b32 a95, v233
    v_accvgpr_read_b32 v230, a112
    v_accvgpr_read_b32 v231, a113
    v_accvgpr_read_b32 v232, a114
    v_accvgpr_read_b32 v233, a115
    v_mul_f32 v230, v230, v229
    v_mul_f32 v231, v231, v229
    v_mul_f32 v232, v232, v229
    v_mul_f32 v233, v233, v229
    v_accvgpr_write_b32 a112, v230
    v_accvgpr_write_b32 a113, v231
    v_accvgpr_write_b32 a114, v232
    v_accvgpr_write_b32 a115, v233
    v_accvgpr_read_b32 v230, a132
    v_accvgpr_read_b32 v231, a133
    v_accvgpr_read_b32 v232, a134
    v_accvgpr_read_b32 v233, a135
    v_mul_f32 v230, v230, v229
    v_mul_f32 v231, v231, v229
    v_mul_f32 v232, v232, v229
    v_mul_f32 v233, v233, v229
    v_accvgpr_write_b32 a132, v230
    v_accvgpr_write_b32 a133, v231
    v_accvgpr_write_b32 a134, v232
    v_accvgpr_write_b32 a135, v233
    v_accvgpr_read_b32 v230, a152
    v_accvgpr_read_b32 v231, a153
    v_accvgpr_read_b32 v232, a154
    v_accvgpr_read_b32 v233, a155
    v_mul_f32 v230, v230, v229
    v_mul_f32 v231, v231, v229
    v_mul_f32 v232, v232, v229
    v_mul_f32 v233, v233, v229
    v_accvgpr_write_b32 a152, v230
    v_accvgpr_write_b32 a153, v231
    v_accvgpr_write_b32 a154, v232
    v_accvgpr_write_b32 a155, v233
    v_max3_f32 v228, v48, v49, v50
    v_max3_f32 v228, v228, v51, v68
    v_max3_f32 v228, v228, v69, v70
    v_max_f32 v228, v228, v71
    v_mov_b32 v229, v228
    s_nop 1
    v_permlane32_swap_b32 v228, v229
    s_nop 1
    v_max_f32 v228, v228, v229
    v_mov_b32 v229, v228
    s_nop 1
    v_permlane16_swap_b32 v228, v229
    s_nop 1
    v_max_f32 v228, v228, v229
    v_max_f32 v228, s51, v228
    v_sub_f32 v229, 0, v228
    v_exp_f32 v229, v229
    v_add_f32 v225, v225, v228
    v_sub_f32 v212, v212, v228
    v_sub_f32 v48, v48, v228
    v_sub_f32 v68, v68, v228
    v_sub_f32 v213, v213, v228
    v_sub_f32 v49, v49, v228
    v_sub_f32 v69, v69, v228
    v_sub_f32 v214, v214, v228
    v_sub_f32 v50, v50, v228
    v_sub_f32 v70, v70, v228
    v_sub_f32 v215, v215, v228
    v_sub_f32 v51, v51, v228
    v_sub_f32 v71, v71, v228
    v_mul_f32 v220, v220, v229
    v_accvgpr_read_b32 v230, a16
    v_accvgpr_read_b32 v231, a17
    v_accvgpr_read_b32 v232, a18
    v_accvgpr_read_b32 v233, a19
    v_mul_f32 v230, v230, v229
    v_mul_f32 v231, v231, v229
    v_mul_f32 v232, v232, v229
    v_mul_f32 v233, v233, v229
    v_accvgpr_write_b32 a16, v230
    v_accvgpr_write_b32 a17, v231
    v_accvgpr_write_b32 a18, v232
    v_accvgpr_write_b32 a19, v233
    v_accvgpr_read_b32 v230, a36
    v_accvgpr_read_b32 v231, a37
    v_accvgpr_read_b32 v232, a38
    v_accvgpr_read_b32 v233, a39
    v_mul_f32 v230, v230, v229
    v_mul_f32 v231, v231, v229
    v_mul_f32 v232, v232, v229
    v_mul_f32 v233, v233, v229
    v_accvgpr_write_b32 a36, v230
    v_accvgpr_write_b32 a37, v231
    v_accvgpr_write_b32 a38, v232
    v_accvgpr_write_b32 a39, v233
    v_accvgpr_read_b32 v230, a56
    v_accvgpr_read_b32 v231, a57
    v_accvgpr_read_b32 v232, a58
    v_accvgpr_read_b32 v233, a59
    v_mul_f32 v230, v230, v229
    v_mul_f32 v231, v231, v229
    v_mul_f32 v232, v232, v229
    v_mul_f32 v233, v233, v229
    v_accvgpr_write_b32 a56, v230
    v_accvgpr_write_b32 a57, v231
    v_accvgpr_write_b32 a58, v232
    v_accvgpr_write_b32 a59, v233
    v_accvgpr_read_b32 v230, a76
    v_accvgpr_read_b32 v231, a77
    v_accvgpr_read_b32 v232, a78
    v_accvgpr_read_b32 v233, a79
    v_mul_f32 v230, v230, v229
    v_mul_f32 v231, v231, v229
    v_mul_f32 v232, v232, v229
    v_mul_f32 v233, v233, v229
    v_accvgpr_write_b32 a76, v230
    v_accvgpr_write_b32 a77, v231
    v_accvgpr_write_b32 a78, v232
    v_accvgpr_write_b32 a79, v233
    v_accvgpr_read_b32 v230, a96
    v_accvgpr_read_b32 v231, a97
    v_accvgpr_read_b32 v232, a98
    v_accvgpr_read_b32 v233, a99
    v_mul_f32 v230, v230, v229
    v_mul_f32 v231, v231, v229
    v_mul_f32 v232, v232, v229
    v_mul_f32 v233, v233, v229
    v_accvgpr_write_b32 a96, v230
    v_accvgpr_write_b32 a97, v231
    v_accvgpr_write_b32 a98, v232
    v_accvgpr_write_b32 a99, v233
    v_accvgpr_read_b32 v230, a116
    v_accvgpr_read_b32 v231, a117
    v_accvgpr_read_b32 v232, a118
    v_accvgpr_read_b32 v233, a119
    v_mul_f32 v230, v230, v229
    v_mul_f32 v231, v231, v229
    v_mul_f32 v232, v232, v229
    v_mul_f32 v233, v233, v229
    v_accvgpr_write_b32 a116, v230
    v_accvgpr_write_b32 a117, v231
    v_accvgpr_write_b32 a118, v232
    v_accvgpr_write_b32 a119, v233
    v_accvgpr_read_b32 v230, a136
    v_accvgpr_read_b32 v231, a137
    v_accvgpr_read_b32 v232, a138
    v_accvgpr_read_b32 v233, a139
    v_mul_f32 v230, v230, v229
    v_mul_f32 v231, v231, v229
    v_mul_f32 v232, v232, v229
    v_mul_f32 v233, v233, v229
    v_accvgpr_write_b32 a136, v230
    v_accvgpr_write_b32 a137, v231
    v_accvgpr_write_b32 a138, v232
    v_accvgpr_write_b32 a139, v233
    v_accvgpr_read_b32 v230, a156
    v_accvgpr_read_b32 v231, a157
    v_accvgpr_read_b32 v232, a158
    v_accvgpr_read_b32 v233, a159
    v_mul_f32 v230, v230, v229
    v_mul_f32 v231, v231, v229
    v_mul_f32 v232, v232, v229
    v_mul_f32 v233, v233, v229
    v_accvgpr_write_b32 a156, v230
    v_accvgpr_write_b32 a157, v231
    v_accvgpr_write_b32 a158, v232
    v_accvgpr_write_b32 a159, v233
    s_mov_b32 s50, 0x41000000
    s_mov_b32 s51, 0
    s_nop 1
    s_branch k1_kernel_L16
k1_kernel_L17:
    s_nop 7
    v_max3_f32 v228, v72, v73, v74
    v_max3_f32 v228, v228, v75, v92
    v_max3_f32 v228, v228, v93, v94
    v_max_f32 v228, v228, v95
    v_mov_b32 v229, v228
    s_nop 1
    v_permlane32_swap_b32 v228, v229
    s_nop 1
    v_max_f32 v228, v228, v229
    v_mov_b32 v229, v228
    s_nop 1
    v_permlane16_swap_b32 v228, v229
    s_nop 1
    v_max_f32 v228, v228, v229
    v_max_f32 v228, s51, v228
    v_sub_f32 v229, 0, v228
    v_exp_f32 v229, v229
    v_add_f32 v221, v221, v228
    v_sub_f32 v196, v196, v228
    v_sub_f32 v72, v72, v228
    v_sub_f32 v92, v92, v228
    v_sub_f32 v197, v197, v228
    v_sub_f32 v73, v73, v228
    v_sub_f32 v93, v93, v228
    v_sub_f32 v198, v198, v228
    v_sub_f32 v74, v74, v228
    v_sub_f32 v94, v94, v228
    v_sub_f32 v199, v199, v228
    v_sub_f32 v75, v75, v228
    v_sub_f32 v95, v95, v228
    v_mul_f32 v216, v216, v229
    v_accvgpr_read_b32 v230, a0
    v_accvgpr_read_b32 v231, a1
    v_accvgpr_read_b32 v232, a2
    v_accvgpr_read_b32 v233, a3
    v_mul_f32 v230, v230, v229
    v_mul_f32 v231, v231, v229
    v_mul_f32 v232, v232, v229
    v_mul_f32 v233, v233, v229
    v_accvgpr_write_b32 a0, v230
    v_accvgpr_write_b32 a1, v231
    v_accvgpr_write_b32 a2, v232
    v_accvgpr_write_b32 a3, v233
    v_accvgpr_read_b32 v230, a20
    v_accvgpr_read_b32 v231, a21
    v_accvgpr_read_b32 v232, a22
    v_accvgpr_read_b32 v233, a23
    v_mul_f32 v230, v230, v229
    v_mul_f32 v231, v231, v229
    v_mul_f32 v232, v232, v229
    v_mul_f32 v233, v233, v229
    v_accvgpr_write_b32 a20, v230
    v_accvgpr_write_b32 a21, v231
    v_accvgpr_write_b32 a22, v232
    v_accvgpr_write_b32 a23, v233
    v_accvgpr_read_b32 v230, a40
    v_accvgpr_read_b32 v231, a41
    v_accvgpr_read_b32 v232, a42
    v_accvgpr_read_b32 v233, a43
    v_mul_f32 v230, v230, v229
    v_mul_f32 v231, v231, v229
    v_mul_f32 v232, v232, v229
    v_mul_f32 v233, v233, v229
    v_accvgpr_write_b32 a40, v230
    v_accvgpr_write_b32 a41, v231
    v_accvgpr_write_b32 a42, v232
    v_accvgpr_write_b32 a43, v233
    v_accvgpr_read_b32 v230, a60
    v_accvgpr_read_b32 v231, a61
    v_accvgpr_read_b32 v232, a62
    v_accvgpr_read_b32 v233, a63
    v_mul_f32 v230, v230, v229
    v_mul_f32 v231, v231, v229
    v_mul_f32 v232, v232, v229
    v_mul_f32 v233, v233, v229
    v_accvgpr_write_b32 a60, v230
    v_accvgpr_write_b32 a61, v231
    v_accvgpr_write_b32 a62, v232
    v_accvgpr_write_b32 a63, v233
    v_accvgpr_read_b32 v230, a80
    v_accvgpr_read_b32 v231, a81
    v_accvgpr_read_b32 v232, a82
    v_accvgpr_read_b32 v233, a83
    v_mul_f32 v230, v230, v229
    v_mul_f32 v231, v231, v229
    v_mul_f32 v232, v232, v229
    v_mul_f32 v233, v233, v229
    v_accvgpr_write_b32 a80, v230
    v_accvgpr_write_b32 a81, v231
    v_accvgpr_write_b32 a82, v232
    v_accvgpr_write_b32 a83, v233
    v_accvgpr_read_b32 v230, a100
    v_accvgpr_read_b32 v231, a101
    v_accvgpr_read_b32 v232, a102
    v_accvgpr_read_b32 v233, a103
    v_mul_f32 v230, v230, v229
    v_mul_f32 v231, v231, v229
    v_mul_f32 v232, v232, v229
    v_mul_f32 v233, v233, v229
    v_accvgpr_write_b32 a100, v230
    v_accvgpr_write_b32 a101, v231
    v_accvgpr_write_b32 a102, v232
    v_accvgpr_write_b32 a103, v233
    v_accvgpr_read_b32 v230, a120
    v_accvgpr_read_b32 v231, a121
    v_accvgpr_read_b32 v232, a122
    v_accvgpr_read_b32 v233, a123
    v_mul_f32 v230, v230, v229
    v_mul_f32 v231, v231, v229
    v_mul_f32 v232, v232, v229
    v_mul_f32 v233, v233, v229
    v_accvgpr_write_b32 a120, v230
    v_accvgpr_write_b32 a121, v231
    v_accvgpr_write_b32 a122, v232
    v_accvgpr_write_b32 a123, v233
    v_accvgpr_read_b32 v230, a140
    v_accvgpr_read_b32 v231, a141
    v_accvgpr_read_b32 v232, a142
    v_accvgpr_read_b32 v233, a143
    v_mul_f32 v230, v230, v229
    v_mul_f32 v231, v231, v229
    v_mul_f32 v232, v232, v229
    v_mul_f32 v233, v233, v229
    v_accvgpr_write_b32 a140, v230
    v_accvgpr_write_b32 a141, v231
    v_accvgpr_write_b32 a142, v232
    v_accvgpr_write_b32 a143, v233
    v_max3_f32 v228, v76, v77, v78
    v_max3_f32 v228, v228, v79, v96
    v_max3_f32 v228, v228, v97, v98
    v_max_f32 v228, v228, v99
    v_mov_b32 v229, v228
    s_nop 1
    v_permlane32_swap_b32 v228, v229
    s_nop 1
    v_max_f32 v228, v228, v229
    v_mov_b32 v229, v228
    s_nop 1
    v_permlane16_swap_b32 v228, v229
    s_nop 1
    v_max_f32 v228, v228, v229
    v_max_f32 v228, s51, v228
    v_sub_f32 v229, 0, v228
    v_exp_f32 v229, v229
    v_add_f32 v222, v222, v228
    v_sub_f32 v200, v200, v228
    v_sub_f32 v76, v76, v228
    v_sub_f32 v96, v96, v228
    v_sub_f32 v201, v201, v228
    v_sub_f32 v77, v77, v228
    v_sub_f32 v97, v97, v228
    v_sub_f32 v202, v202, v228
    v_sub_f32 v78, v78, v228
    v_sub_f32 v98, v98, v228
    v_sub_f32 v203, v203, v228
    v_sub_f32 v79, v79, v228
    v_sub_f32 v99, v99, v228
    v_mul_f32 v217, v217, v229
    v_accvgpr_read_b32 v230, a4
    v_accvgpr_read_b32 v231, a5
    v_accvgpr_read_b32 v232, a6
    v_accvgpr_read_b32 v233, a7
    v_mul_f32 v230, v230, v229
    v_mul_f32 v231, v231, v229
    v_mul_f32 v232, v232, v229
    v_mul_f32 v233, v233, v229
    v_accvgpr_write_b32 a4, v230
    v_accvgpr_write_b32 a5, v231
    v_accvgpr_write_b32 a6, v232
    v_accvgpr_write_b32 a7, v233
    v_accvgpr_read_b32 v230, a24
    v_accvgpr_read_b32 v231, a25
    v_accvgpr_read_b32 v232, a26
    v_accvgpr_read_b32 v233, a27
    v_mul_f32 v230, v230, v229
    v_mul_f32 v231, v231, v229
    v_mul_f32 v232, v232, v229
    v_mul_f32 v233, v233, v229
    v_accvgpr_write_b32 a24, v230
    v_accvgpr_write_b32 a25, v231
    v_accvgpr_write_b32 a26, v232
    v_accvgpr_write_b32 a27, v233
    v_accvgpr_read_b32 v230, a44
    v_accvgpr_read_b32 v231, a45
    v_accvgpr_read_b32 v232, a46
    v_accvgpr_read_b32 v233, a47
    v_mul_f32 v230, v230, v229
    v_mul_f32 v231, v231, v229
    v_mul_f32 v232, v232, v229
    v_mul_f32 v233, v233, v229
    v_accvgpr_write_b32 a44, v230
    v_accvgpr_write_b32 a45, v231
    v_accvgpr_write_b32 a46, v232
    v_accvgpr_write_b32 a47, v233
    v_accvgpr_read_b32 v230, a64
    v_accvgpr_read_b32 v231, a65
    v_accvgpr_read_b32 v232, a66
    v_accvgpr_read_b32 v233, a67
    v_mul_f32 v230, v230, v229
    v_mul_f32 v231, v231, v229
    v_mul_f32 v232, v232, v229
    v_mul_f32 v233, v233, v229
    v_accvgpr_write_b32 a64, v230
    v_accvgpr_write_b32 a65, v231
    v_accvgpr_write_b32 a66, v232
    v_accvgpr_write_b32 a67, v233
    v_accvgpr_read_b32 v230, a84
    v_accvgpr_read_b32 v231, a85
    v_accvgpr_read_b32 v232, a86
    v_accvgpr_read_b32 v233, a87
    v_mul_f32 v230, v230, v229
    v_mul_f32 v231, v231, v229
    v_mul_f32 v232, v232, v229
    v_mul_f32 v233, v233, v229
    v_accvgpr_write_b32 a84, v230
    v_accvgpr_write_b32 a85, v231
    v_accvgpr_write_b32 a86, v232
    v_accvgpr_write_b32 a87, v233
    v_accvgpr_read_b32 v230, a104
    v_accvgpr_read_b32 v231, a105
    v_accvgpr_read_b32 v232, a106
    v_accvgpr_read_b32 v233, a107
    v_mul_f32 v230, v230, v229
    v_mul_f32 v231, v231, v229
    v_mul_f32 v232, v232, v229
    v_mul_f32 v233, v233, v229
    v_accvgpr_write_b32 a104, v230
    v_accvgpr_write_b32 a105, v231
    v_accvgpr_write_b32 a106, v232
    v_accvgpr_write_b32 a107, v233
    v_accvgpr_read_b32 v230, a124
    v_accvgpr_read_b32 v231, a125
    v_accvgpr_read_b32 v232, a126
    v_accvgpr_read_b32 v233, a127
    v_mul_f32 v230, v230, v229
    v_mul_f32 v231, v231, v229
    v_mul_f32 v232, v232, v229
    v_mul_f32 v233, v233, v229
    v_accvgpr_write_b32 a124, v230
    v_accvgpr_write_b32 a125, v231
    v_accvgpr_write_b32 a126, v232
    v_accvgpr_write_b32 a127, v233
    v_accvgpr_read_b32 v230, a144
    v_accvgpr_read_b32 v231, a145
    v_accvgpr_read_b32 v232, a146
    v_accvgpr_read_b32 v233, a147
    v_mul_f32 v230, v230, v229
    v_mul_f32 v231, v231, v229
    v_mul_f32 v232, v232, v229
    v_mul_f32 v233, v233, v229
    v_accvgpr_write_b32 a144, v230
    v_accvgpr_write_b32 a145, v231
    v_accvgpr_write_b32 a146, v232
    v_accvgpr_write_b32 a147, v233
    v_max3_f32 v228, v80, v81, v82
    v_max3_f32 v228, v228, v83, v100
    v_max3_f32 v228, v228, v101, v102
    v_max_f32 v228, v228, v103
    v_mov_b32 v229, v228
    s_nop 1
    v_permlane32_swap_b32 v228, v229
    s_nop 1
    v_max_f32 v228, v228, v229
    v_mov_b32 v229, v228
    s_nop 1
    v_permlane16_swap_b32 v228, v229
    s_nop 1
    v_max_f32 v228, v228, v229
    v_max_f32 v228, s51, v228
    v_sub_f32 v229, 0, v228
    v_exp_f32 v229, v229
    v_add_f32 v223, v223, v228
    v_sub_f32 v204, v204, v228
    v_sub_f32 v80, v80, v228
    v_sub_f32 v100, v100, v228
    v_sub_f32 v205, v205, v228
    v_sub_f32 v81, v81, v228
    v_sub_f32 v101, v101, v228
    v_sub_f32 v206, v206, v228
    v_sub_f32 v82, v82, v228
    v_sub_f32 v102, v102, v228
    v_sub_f32 v207, v207, v228
    v_sub_f32 v83, v83, v228
    v_sub_f32 v103, v103, v228
    v_mul_f32 v218, v218, v229
    v_accvgpr_read_b32 v230, a8
    v_accvgpr_read_b32 v231, a9
    v_accvgpr_read_b32 v232, a10
    v_accvgpr_read_b32 v233, a11
    v_mul_f32 v230, v230, v229
    v_mul_f32 v231, v231, v229
    v_mul_f32 v232, v232, v229
    v_mul_f32 v233, v233, v229
    v_accvgpr_write_b32 a8, v230
    v_accvgpr_write_b32 a9, v231
    v_accvgpr_write_b32 a10, v232
    v_accvgpr_write_b32 a11, v233
    v_accvgpr_read_b32 v230, a28
    v_accvgpr_read_b32 v231, a29
    v_accvgpr_read_b32 v232, a30
    v_accvgpr_read_b32 v233, a31
    v_mul_f32 v230, v230, v229
    v_mul_f32 v231, v231, v229
    v_mul_f32 v232, v232, v229
    v_mul_f32 v233, v233, v229
    v_accvgpr_write_b32 a28, v230
    v_accvgpr_write_b32 a29, v231
    v_accvgpr_write_b32 a30, v232
    v_accvgpr_write_b32 a31, v233
    v_accvgpr_read_b32 v230, a48
    v_accvgpr_read_b32 v231, a49
    v_accvgpr_read_b32 v232, a50
    v_accvgpr_read_b32 v233, a51
    v_mul_f32 v230, v230, v229
    v_mul_f32 v231, v231, v229
    v_mul_f32 v232, v232, v229
    v_mul_f32 v233, v233, v229
    v_accvgpr_write_b32 a48, v230
    v_accvgpr_write_b32 a49, v231
    v_accvgpr_write_b32 a50, v232
    v_accvgpr_write_b32 a51, v233
    v_accvgpr_read_b32 v230, a68
    v_accvgpr_read_b32 v231, a69
    v_accvgpr_read_b32 v232, a70
    v_accvgpr_read_b32 v233, a71
    v_mul_f32 v230, v230, v229
    v_mul_f32 v231, v231, v229
    v_mul_f32 v232, v232, v229
    v_mul_f32 v233, v233, v229
    v_accvgpr_write_b32 a68, v230
    v_accvgpr_write_b32 a69, v231
    v_accvgpr_write_b32 a70, v232
    v_accvgpr_write_b32 a71, v233
    v_accvgpr_read_b32 v230, a88
    v_accvgpr_read_b32 v231, a89
    v_accvgpr_read_b32 v232, a90
    v_accvgpr_read_b32 v233, a91
    v_mul_f32 v230, v230, v229
    v_mul_f32 v231, v231, v229
    v_mul_f32 v232, v232, v229
    v_mul_f32 v233, v233, v229
    v_accvgpr_write_b32 a88, v230
    v_accvgpr_write_b32 a89, v231
    v_accvgpr_write_b32 a90, v232
    v_accvgpr_write_b32 a91, v233
    v_accvgpr_read_b32 v230, a108
    v_accvgpr_read_b32 v231, a109
    v_accvgpr_read_b32 v232, a110
    v_accvgpr_read_b32 v233, a111
    v_mul_f32 v230, v230, v229
    v_mul_f32 v231, v231, v229
    v_mul_f32 v232, v232, v229
    v_mul_f32 v233, v233, v229
    v_accvgpr_write_b32 a108, v230
    v_accvgpr_write_b32 a109, v231
    v_accvgpr_write_b32 a110, v232
    v_accvgpr_write_b32 a111, v233
    v_accvgpr_read_b32 v230, a128
    v_accvgpr_read_b32 v231, a129
    v_accvgpr_read_b32 v232, a130
    v_accvgpr_read_b32 v233, a131
    v_mul_f32 v230, v230, v229
    v_mul_f32 v231, v231, v229
    v_mul_f32 v232, v232, v229
    v_mul_f32 v233, v233, v229
    v_accvgpr_write_b32 a128, v230
    v_accvgpr_write_b32 a129, v231
    v_accvgpr_write_b32 a130, v232
    v_accvgpr_write_b32 a131, v233
    v_accvgpr_read_b32 v230, a148
    v_accvgpr_read_b32 v231, a149
    v_accvgpr_read_b32 v232, a150
    v_accvgpr_read_b32 v233, a151
    v_mul_f32 v230, v230, v229
    v_mul_f32 v231, v231, v229
    v_mul_f32 v232, v232, v229
    v_mul_f32 v233, v233, v229
    v_accvgpr_write_b32 a148, v230
    v_accvgpr_write_b32 a149, v231
    v_accvgpr_write_b32 a150, v232
    v_accvgpr_write_b32 a151, v233
    v_max3_f32 v228, v84, v85, v86
    v_max3_f32 v228, v228, v87, v104
    v_max3_f32 v228, v228, v105, v106
    v_max_f32 v228, v228, v107
    v_mov_b32 v229, v228
    s_nop 1
    v_permlane32_swap_b32 v228, v229
    s_nop 1
    v_max_f32 v228, v228, v229
    v_mov_b32 v229, v228
    s_nop 1
    v_permlane16_swap_b32 v228, v229
    s_nop 1
    v_max_f32 v228, v228, v229
    v_max_f32 v228, s51, v228
    v_sub_f32 v229, 0, v228
    v_exp_f32 v229, v229
    v_add_f32 v224, v224, v228
    v_sub_f32 v208, v208, v228
    v_sub_f32 v84, v84, v228
    v_sub_f32 v104, v104, v228
    v_sub_f32 v209, v209, v228
    v_sub_f32 v85, v85, v228
    v_sub_f32 v105, v105, v228
    v_sub_f32 v210, v210, v228
    v_sub_f32 v86, v86, v228
    v_sub_f32 v106, v106, v228
    v_sub_f32 v211, v211, v228
    v_sub_f32 v87, v87, v228
    v_sub_f32 v107, v107, v228
    v_mul_f32 v219, v219, v229
    v_accvgpr_read_b32 v230, a12
    v_accvgpr_read_b32 v231, a13
    v_accvgpr_read_b32 v232, a14
    v_accvgpr_read_b32 v233, a15
    v_mul_f32 v230, v230, v229
    v_mul_f32 v231, v231, v229
    v_mul_f32 v232, v232, v229
    v_mul_f32 v233, v233, v229
    v_accvgpr_write_b32 a12, v230
    v_accvgpr_write_b32 a13, v231
    v_accvgpr_write_b32 a14, v232
    v_accvgpr_write_b32 a15, v233
    v_accvgpr_read_b32 v230, a32
    v_accvgpr_read_b32 v231, a33
    v_accvgpr_read_b32 v232, a34
    v_accvgpr_read_b32 v233, a35
    v_mul_f32 v230, v230, v229
    v_mul_f32 v231, v231, v229
    v_mul_f32 v232, v232, v229
    v_mul_f32 v233, v233, v229
    v_accvgpr_write_b32 a32, v230
    v_accvgpr_write_b32 a33, v231
    v_accvgpr_write_b32 a34, v232
    v_accvgpr_write_b32 a35, v233
    v_accvgpr_read_b32 v230, a52
    v_accvgpr_read_b32 v231, a53
    v_accvgpr_read_b32 v232, a54
    v_accvgpr_read_b32 v233, a55
    v_mul_f32 v230, v230, v229
    v_mul_f32 v231, v231, v229
    v_mul_f32 v232, v232, v229
    v_mul_f32 v233, v233, v229
    v_accvgpr_write_b32 a52, v230
    v_accvgpr_write_b32 a53, v231
    v_accvgpr_write_b32 a54, v232
    v_accvgpr_write_b32 a55, v233
    v_accvgpr_read_b32 v230, a72
    v_accvgpr_read_b32 v231, a73
    v_accvgpr_read_b32 v232, a74
    v_accvgpr_read_b32 v233, a75
    v_mul_f32 v230, v230, v229
    v_mul_f32 v231, v231, v229
    v_mul_f32 v232, v232, v229
    v_mul_f32 v233, v233, v229
    v_accvgpr_write_b32 a72, v230
    v_accvgpr_write_b32 a73, v231
    v_accvgpr_write_b32 a74, v232
    v_accvgpr_write_b32 a75, v233
    v_accvgpr_read_b32 v230, a92
    v_accvgpr_read_b32 v231, a93
    v_accvgpr_read_b32 v232, a94
    v_accvgpr_read_b32 v233, a95
    v_mul_f32 v230, v230, v229
    v_mul_f32 v231, v231, v229
    v_mul_f32 v232, v232, v229
    v_mul_f32 v233, v233, v229
    v_accvgpr_write_b32 a92, v230
    v_accvgpr_write_b32 a93, v231
    v_accvgpr_write_b32 a94, v232
    v_accvgpr_write_b32 a95, v233
    v_accvgpr_read_b32 v230, a112
    v_accvgpr_read_b32 v231, a113
    v_accvgpr_read_b32 v232, a114
    v_accvgpr_read_b32 v233, a115
    v_mul_f32 v230, v230, v229
    v_mul_f32 v231, v231, v229
    v_mul_f32 v232, v232, v229
    v_mul_f32 v233, v233, v229
    v_accvgpr_write_b32 a112, v230
    v_accvgpr_write_b32 a113, v231
    v_accvgpr_write_b32 a114, v232
    v_accvgpr_write_b32 a115, v233
    v_accvgpr_read_b32 v230, a132
    v_accvgpr_read_b32 v231, a133
    v_accvgpr_read_b32 v232, a134
    v_accvgpr_read_b32 v233, a135
    v_mul_f32 v230, v230, v229
    v_mul_f32 v231, v231, v229
    v_mul_f32 v232, v232, v229
    v_mul_f32 v233, v233, v229
    v_accvgpr_write_b32 a132, v230
    v_accvgpr_write_b32 a133, v231
    v_accvgpr_write_b32 a134, v232
    v_accvgpr_write_b32 a135, v233
    v_accvgpr_read_b32 v230, a152
    v_accvgpr_read_b32 v231, a153
    v_accvgpr_read_b32 v232, a154
    v_accvgpr_read_b32 v233, a155
    v_mul_f32 v230, v230, v229
    v_mul_f32 v231, v231, v229
    v_mul_f32 v232, v232, v229
    v_mul_f32 v233, v233, v229
    v_accvgpr_write_b32 a152, v230
    v_accvgpr_write_b32 a153, v231
    v_accvgpr_write_b32 a154, v232
    v_accvgpr_write_b32 a155, v233
    v_max3_f32 v228, v88, v89, v90
    v_max3_f32 v228, v228, v91, v108
    v_max3_f32 v228, v228, v109, v110
    v_max_f32 v228, v228, v111
    v_mov_b32 v229, v228
    s_nop 1
    v_permlane32_swap_b32 v228, v229
    s_nop 1
    v_max_f32 v228, v228, v229
    v_mov_b32 v229, v228
    s_nop 1
    v_permlane16_swap_b32 v228, v229
    s_nop 1
    v_max_f32 v228, v228, v229
    v_max_f32 v228, s51, v228
    v_sub_f32 v229, 0, v228
    v_exp_f32 v229, v229
    v_add_f32 v225, v225, v228
    v_sub_f32 v212, v212, v228
    v_sub_f32 v88, v88, v228
    v_sub_f32 v108, v108, v228
    v_sub_f32 v213, v213, v228
    v_sub_f32 v89, v89, v228
    v_sub_f32 v109, v109, v228
    v_sub_f32 v214, v214, v228
    v_sub_f32 v90, v90, v228
    v_sub_f32 v110, v110, v228
    v_sub_f32 v215, v215, v228
    v_sub_f32 v91, v91, v228
    v_sub_f32 v111, v111, v228
    v_mul_f32 v220, v220, v229
    v_accvgpr_read_b32 v230, a16
    v_accvgpr_read_b32 v231, a17
    v_accvgpr_read_b32 v232, a18
    v_accvgpr_read_b32 v233, a19
    v_mul_f32 v230, v230, v229
    v_mul_f32 v231, v231, v229
    v_mul_f32 v232, v232, v229
    v_mul_f32 v233, v233, v229
    v_accvgpr_write_b32 a16, v230
    v_accvgpr_write_b32 a17, v231
    v_accvgpr_write_b32 a18, v232
    v_accvgpr_write_b32 a19, v233
    v_accvgpr_read_b32 v230, a36
    v_accvgpr_read_b32 v231, a37
    v_accvgpr_read_b32 v232, a38
    v_accvgpr_read_b32 v233, a39
    v_mul_f32 v230, v230, v229
    v_mul_f32 v231, v231, v229
    v_mul_f32 v232, v232, v229
    v_mul_f32 v233, v233, v229
    v_accvgpr_write_b32 a36, v230
    v_accvgpr_write_b32 a37, v231
    v_accvgpr_write_b32 a38, v232
    v_accvgpr_write_b32 a39, v233
    v_accvgpr_read_b32 v230, a56
    v_accvgpr_read_b32 v231, a57
    v_accvgpr_read_b32 v232, a58
    v_accvgpr_read_b32 v233, a59
    v_mul_f32 v230, v230, v229
    v_mul_f32 v231, v231, v229
    v_mul_f32 v232, v232, v229
    v_mul_f32 v233, v233, v229
    v_accvgpr_write_b32 a56, v230
    v_accvgpr_write_b32 a57, v231
    v_accvgpr_write_b32 a58, v232
    v_accvgpr_write_b32 a59, v233
    v_accvgpr_read_b32 v230, a76
    v_accvgpr_read_b32 v231, a77
    v_accvgpr_read_b32 v232, a78
    v_accvgpr_read_b32 v233, a79
    v_mul_f32 v230, v230, v229
    v_mul_f32 v231, v231, v229
    v_mul_f32 v232, v232, v229
    v_mul_f32 v233, v233, v229
    v_accvgpr_write_b32 a76, v230
    v_accvgpr_write_b32 a77, v231
    v_accvgpr_write_b32 a78, v232
    v_accvgpr_write_b32 a79, v233
    v_accvgpr_read_b32 v230, a96
    v_accvgpr_read_b32 v231, a97
    v_accvgpr_read_b32 v232, a98
    v_accvgpr_read_b32 v233, a99
    v_mul_f32 v230, v230, v229
    v_mul_f32 v231, v231, v229
    v_mul_f32 v232, v232, v229
    v_mul_f32 v233, v233, v229
    v_accvgpr_write_b32 a96, v230
    v_accvgpr_write_b32 a97, v231
    v_accvgpr_write_b32 a98, v232
    v_accvgpr_write_b32 a99, v233
    v_accvgpr_read_b32 v230, a116
    v_accvgpr_read_b32 v231, a117
    v_accvgpr_read_b32 v232, a118
    v_accvgpr_read_b32 v233, a119
    v_mul_f32 v230, v230, v229
    v_mul_f32 v231, v231, v229
    v_mul_f32 v232, v232, v229
    v_mul_f32 v233, v233, v229
    v_accvgpr_write_b32 a116, v230
    v_accvgpr_write_b32 a117, v231
    v_accvgpr_write_b32 a118, v232
    v_accvgpr_write_b32 a119, v233
    v_accvgpr_read_b32 v230, a136
    v_accvgpr_read_b32 v231, a137
    v_accvgpr_read_b32 v232, a138
    v_accvgpr_read_b32 v233, a139
    v_mul_f32 v230, v230, v229
    v_mul_f32 v231, v231, v229
    v_mul_f32 v232, v232, v229
    v_mul_f32 v233, v233, v229
    v_accvgpr_write_b32 a136, v230
    v_accvgpr_write_b32 a137, v231
    v_accvgpr_write_b32 a138, v232
    v_accvgpr_write_b32 a139, v233
    v_accvgpr_read_b32 v230, a156
    v_accvgpr_read_b32 v231, a157
    v_accvgpr_read_b32 v232, a158
    v_accvgpr_read_b32 v233, a159
    v_mul_f32 v230, v230, v229
    v_mul_f32 v231, v231, v229
    v_mul_f32 v232, v232, v229
    v_mul_f32 v233, v233, v229
    v_accvgpr_write_b32 a156, v230
    v_accvgpr_write_b32 a157, v231
    v_accvgpr_write_b32 a158, v232
    v_accvgpr_write_b32 a159, v233
    s_mov_b32 s50, 0x41000000
    s_mov_b32 s51, 0
    s_nop 1
    s_branch k1_kernel_L18
k1_kernel_L19:
    s_nop 7
    v_max3_f32 v228, v32, v33, v34
    v_max3_f32 v228, v228, v35, v52
    v_max3_f32 v228, v228, v53, v54
    v_max_f32 v228, v228, v55
    v_mov_b32 v229, v228
    s_nop 1
    v_permlane32_swap_b32 v228, v229
    s_nop 1
    v_max_f32 v228, v228, v229
    v_mov_b32 v229, v228
    s_nop 1
    v_permlane16_swap_b32 v228, v229
    s_nop 1
    v_max_f32 v228, v228, v229
    v_max_f32 v228, s51, v228
    v_sub_f32 v229, 0, v228
    v_exp_f32 v229, v229
    v_add_f32 v221, v221, v228
    v_sub_f32 v196, v196, v228
    v_sub_f32 v32, v32, v228
    v_sub_f32 v52, v52, v228
    v_sub_f32 v197, v197, v228
    v_sub_f32 v33, v33, v228
    v_sub_f32 v53, v53, v228
    v_sub_f32 v198, v198, v228
    v_sub_f32 v34, v34, v228
    v_sub_f32 v54, v54, v228
    v_sub_f32 v199, v199, v228
    v_sub_f32 v35, v35, v228
    v_sub_f32 v55, v55, v228
    v_mul_f32 v216, v216, v229
    v_accvgpr_read_b32 v230, a0
    v_accvgpr_read_b32 v231, a1
    v_accvgpr_read_b32 v232, a2
    v_accvgpr_read_b32 v233, a3
    v_mul_f32 v230, v230, v229
    v_mul_f32 v231, v231, v229
    v_mul_f32 v232, v232, v229
    v_mul_f32 v233, v233, v229
    v_accvgpr_write_b32 a0, v230
    v_accvgpr_write_b32 a1, v231
    v_accvgpr_write_b32 a2, v232
    v_accvgpr_write_b32 a3, v233
    v_accvgpr_read_b32 v230, a20
    v_accvgpr_read_b32 v231, a21
    v_accvgpr_read_b32 v232, a22
    v_accvgpr_read_b32 v233, a23
    v_mul_f32 v230, v230, v229
    v_mul_f32 v231, v231, v229
    v_mul_f32 v232, v232, v229
    v_mul_f32 v233, v233, v229
    v_accvgpr_write_b32 a20, v230
    v_accvgpr_write_b32 a21, v231
    v_accvgpr_write_b32 a22, v232
    v_accvgpr_write_b32 a23, v233
    v_accvgpr_read_b32 v230, a40
    v_accvgpr_read_b32 v231, a41
    v_accvgpr_read_b32 v232, a42
    v_accvgpr_read_b32 v233, a43
    v_mul_f32 v230, v230, v229
    v_mul_f32 v231, v231, v229
    v_mul_f32 v232, v232, v229
    v_mul_f32 v233, v233, v229
    v_accvgpr_write_b32 a40, v230
    v_accvgpr_write_b32 a41, v231
    v_accvgpr_write_b32 a42, v232
    v_accvgpr_write_b32 a43, v233
    v_accvgpr_read_b32 v230, a60
    v_accvgpr_read_b32 v231, a61
    v_accvgpr_read_b32 v232, a62
    v_accvgpr_read_b32 v233, a63
    v_mul_f32 v230, v230, v229
    v_mul_f32 v231, v231, v229
    v_mul_f32 v232, v232, v229
    v_mul_f32 v233, v233, v229
    v_accvgpr_write_b32 a60, v230
    v_accvgpr_write_b32 a61, v231
    v_accvgpr_write_b32 a62, v232
    v_accvgpr_write_b32 a63, v233
    v_accvgpr_read_b32 v230, a80
    v_accvgpr_read_b32 v231, a81
    v_accvgpr_read_b32 v232, a82
    v_accvgpr_read_b32 v233, a83
    v_mul_f32 v230, v230, v229
    v_mul_f32 v231, v231, v229
    v_mul_f32 v232, v232, v229
    v_mul_f32 v233, v233, v229
    v_accvgpr_write_b32 a80, v230
    v_accvgpr_write_b32 a81, v231
    v_accvgpr_write_b32 a82, v232
    v_accvgpr_write_b32 a83, v233
    v_accvgpr_read_b32 v230, a100
    v_accvgpr_read_b32 v231, a101
    v_accvgpr_read_b32 v232, a102
    v_accvgpr_read_b32 v233, a103
    v_mul_f32 v230, v230, v229
    v_mul_f32 v231, v231, v229
    v_mul_f32 v232, v232, v229
    v_mul_f32 v233, v233, v229
    v_accvgpr_write_b32 a100, v230
    v_accvgpr_write_b32 a101, v231
    v_accvgpr_write_b32 a102, v232
    v_accvgpr_write_b32 a103, v233
    v_accvgpr_read_b32 v230, a120
    v_accvgpr_read_b32 v231, a121
    v_accvgpr_read_b32 v232, a122
    v_accvgpr_read_b32 v233, a123
    v_mul_f32 v230, v230, v229
    v_mul_f32 v231, v231, v229
    v_mul_f32 v232, v232, v229
    v_mul_f32 v233, v233, v229
    v_accvgpr_write_b32 a120, v230
    v_accvgpr_write_b32 a121, v231
    v_accvgpr_write_b32 a122, v232
    v_accvgpr_write_b32 a123, v233
    v_accvgpr_read_b32 v230, a140
    v_accvgpr_read_b32 v231, a141
    v_accvgpr_read_b32 v232, a142
    v_accvgpr_read_b32 v233, a143
    v_mul_f32 v230, v230, v229
    v_mul_f32 v231, v231, v229
    v_mul_f32 v232, v232, v229
    v_mul_f32 v233, v233, v229
    v_accvgpr_write_b32 a140, v230
    v_accvgpr_write_b32 a141, v231
    v_accvgpr_write_b32 a142, v232
    v_accvgpr_write_b32 a143, v233
    v_max3_f32 v228, v36, v37, v38
    v_max3_f32 v228, v228, v39, v56
    v_max3_f32 v228, v228, v57, v58
    v_max_f32 v228, v228, v59
    v_mov_b32 v229, v228
    s_nop 1
    v_permlane32_swap_b32 v228, v229
    s_nop 1
    v_max_f32 v228, v228, v229
    v_mov_b32 v229, v228
    s_nop 1
    v_permlane16_swap_b32 v228, v229
    s_nop 1
    v_max_f32 v228, v228, v229
    v_max_f32 v228, s51, v228
    v_sub_f32 v229, 0, v228
    v_exp_f32 v229, v229
    v_add_f32 v222, v222, v228
    v_sub_f32 v200, v200, v228
    v_sub_f32 v36, v36, v228
    v_sub_f32 v56, v56, v228
    v_sub_f32 v201, v201, v228
    v_sub_f32 v37, v37, v228
    v_sub_f32 v57, v57, v228
    v_sub_f32 v202, v202, v228
    v_sub_f32 v38, v38, v228
    v_sub_f32 v58, v58, v228
    v_sub_f32 v203, v203, v228
    v_sub_f32 v39, v39, v228
    v_sub_f32 v59, v59, v228
    v_mul_f32 v217, v217, v229
    v_accvgpr_read_b32 v230, a4
    v_accvgpr_read_b32 v231, a5
    v_accvgpr_read_b32 v232, a6
    v_accvgpr_read_b32 v233, a7
    v_mul_f32 v230, v230, v229
    v_mul_f32 v231, v231, v229
    v_mul_f32 v232, v232, v229
    v_mul_f32 v233, v233, v229
    v_accvgpr_write_b32 a4, v230
    v_accvgpr_write_b32 a5, v231
    v_accvgpr_write_b32 a6, v232
    v_accvgpr_write_b32 a7, v233
    v_accvgpr_read_b32 v230, a24
    v_accvgpr_read_b32 v231, a25
    v_accvgpr_read_b32 v232, a26
    v_accvgpr_read_b32 v233, a27
    v_mul_f32 v230, v230, v229
    v_mul_f32 v231, v231, v229
    v_mul_f32 v232, v232, v229
    v_mul_f32 v233, v233, v229
    v_accvgpr_write_b32 a24, v230
    v_accvgpr_write_b32 a25, v231
    v_accvgpr_write_b32 a26, v232
    v_accvgpr_write_b32 a27, v233
    v_accvgpr_read_b32 v230, a44
    v_accvgpr_read_b32 v231, a45
    v_accvgpr_read_b32 v232, a46
    v_accvgpr_read_b32 v233, a47
    v_mul_f32 v230, v230, v229
    v_mul_f32 v231, v231, v229
    v_mul_f32 v232, v232, v229
    v_mul_f32 v233, v233, v229
    v_accvgpr_write_b32 a44, v230
    v_accvgpr_write_b32 a45, v231
    v_accvgpr_write_b32 a46, v232
    v_accvgpr_write_b32 a47, v233
    v_accvgpr_read_b32 v230, a64
    v_accvgpr_read_b32 v231, a65
    v_accvgpr_read_b32 v232, a66
    v_accvgpr_read_b32 v233, a67
    v_mul_f32 v230, v230, v229
    v_mul_f32 v231, v231, v229
    v_mul_f32 v232, v232, v229
    v_mul_f32 v233, v233, v229
    v_accvgpr_write_b32 a64, v230
    v_accvgpr_write_b32 a65, v231
    v_accvgpr_write_b32 a66, v232
    v_accvgpr_write_b32 a67, v233
    v_accvgpr_read_b32 v230, a84
    v_accvgpr_read_b32 v231, a85
    v_accvgpr_read_b32 v232, a86
    v_accvgpr_read_b32 v233, a87
    v_mul_f32 v230, v230, v229
    v_mul_f32 v231, v231, v229
    v_mul_f32 v232, v232, v229
    v_mul_f32 v233, v233, v229
    v_accvgpr_write_b32 a84, v230
    v_accvgpr_write_b32 a85, v231
    v_accvgpr_write_b32 a86, v232
    v_accvgpr_write_b32 a87, v233
    v_accvgpr_read_b32 v230, a104
    v_accvgpr_read_b32 v231, a105
    v_accvgpr_read_b32 v232, a106
    v_accvgpr_read_b32 v233, a107
    v_mul_f32 v230, v230, v229
    v_mul_f32 v231, v231, v229
    v_mul_f32 v232, v232, v229
    v_mul_f32 v233, v233, v229
    v_accvgpr_write_b32 a104, v230
    v_accvgpr_write_b32 a105, v231
    v_accvgpr_write_b32 a106, v232
    v_accvgpr_write_b32 a107, v233
    v_accvgpr_read_b32 v230, a124
    v_accvgpr_read_b32 v231, a125
    v_accvgpr_read_b32 v232, a126
    v_accvgpr_read_b32 v233, a127
    v_mul_f32 v230, v230, v229
    v_mul_f32 v231, v231, v229
    v_mul_f32 v232, v232, v229
    v_mul_f32 v233, v233, v229
    v_accvgpr_write_b32 a124, v230
    v_accvgpr_write_b32 a125, v231
    v_accvgpr_write_b32 a126, v232
    v_accvgpr_write_b32 a127, v233
    v_accvgpr_read_b32 v230, a144
    v_accvgpr_read_b32 v231, a145
    v_accvgpr_read_b32 v232, a146
    v_accvgpr_read_b32 v233, a147
    v_mul_f32 v230, v230, v229
    v_mul_f32 v231, v231, v229
    v_mul_f32 v232, v232, v229
    v_mul_f32 v233, v233, v229
    v_accvgpr_write_b32 a144, v230
    v_accvgpr_write_b32 a145, v231
    v_accvgpr_write_b32 a146, v232
    v_accvgpr_write_b32 a147, v233
    v_max3_f32 v228, v40, v41, v42
    v_max3_f32 v228, v228, v43, v60
    v_max3_f32 v228, v228, v61, v62
    v_max_f32 v228, v228, v63
    v_mov_b32 v229, v228
    s_nop 1
    v_permlane32_swap_b32 v228, v229
    s_nop 1
    v_max_f32 v228, v228, v229
    v_mov_b32 v229, v228
    s_nop 1
    v_permlane16_swap_b32 v228, v229
    s_nop 1
    v_max_f32 v228, v228, v229
    v_max_f32 v228, s51, v228
    v_sub_f32 v229, 0, v228
    v_exp_f32 v229, v229
    v_add_f32 v223, v223, v228
    v_sub_f32 v204, v204, v228
    v_sub_f32 v40, v40, v228
    v_sub_f32 v60, v60, v228
    v_sub_f32 v205, v205, v228
    v_sub_f32 v41, v41, v228
    v_sub_f32 v61, v61, v228
    v_sub_f32 v206, v206, v228
    v_sub_f32 v42, v42, v228
    v_sub_f32 v62, v62, v228
    v_sub_f32 v207, v207, v228
    v_sub_f32 v43, v43, v228
    v_sub_f32 v63, v63, v228
    v_mul_f32 v218, v218, v229
    v_accvgpr_read_b32 v230, a8
    v_accvgpr_read_b32 v231, a9
    v_accvgpr_read_b32 v232, a10
    v_accvgpr_read_b32 v233, a11
    v_mul_f32 v230, v230, v229
    v_mul_f32 v231, v231, v229
    v_mul_f32 v232, v232, v229
    v_mul_f32 v233, v233, v229
    v_accvgpr_write_b32 a8, v230
    v_accvgpr_write_b32 a9, v231
    v_accvgpr_write_b32 a10, v232
    v_accvgpr_write_b32 a11, v233
    v_accvgpr_read_b32 v230, a28
    v_accvgpr_read_b32 v231, a29
    v_accvgpr_read_b32 v232, a30
    v_accvgpr_read_b32 v233, a31
    v_mul_f32 v230, v230, v229
    v_mul_f32 v231, v231, v229
    v_mul_f32 v232, v232, v229
    v_mul_f32 v233, v233, v229
    v_accvgpr_write_b32 a28, v230
    v_accvgpr_write_b32 a29, v231
    v_accvgpr_write_b32 a30, v232
    v_accvgpr_write_b32 a31, v233
    v_accvgpr_read_b32 v230, a48
    v_accvgpr_read_b32 v231, a49
    v_accvgpr_read_b32 v232, a50
    v_accvgpr_read_b32 v233, a51
    v_mul_f32 v230, v230, v229
    v_mul_f32 v231, v231, v229
    v_mul_f32 v232, v232, v229
    v_mul_f32 v233, v233, v229
    v_accvgpr_write_b32 a48, v230
    v_accvgpr_write_b32 a49, v231
    v_accvgpr_write_b32 a50, v232
    v_accvgpr_write_b32 a51, v233
    v_accvgpr_read_b32 v230, a68
    v_accvgpr_read_b32 v231, a69
    v_accvgpr_read_b32 v232, a70
    v_accvgpr_read_b32 v233, a71
    v_mul_f32 v230, v230, v229
    v_mul_f32 v231, v231, v229
    v_mul_f32 v232, v232, v229
    v_mul_f32 v233, v233, v229
    v_accvgpr_write_b32 a68, v230
    v_accvgpr_write_b32 a69, v231
    v_accvgpr_write_b32 a70, v232
    v_accvgpr_write_b32 a71, v233
    v_accvgpr_read_b32 v230, a88
    v_accvgpr_read_b32 v231, a89
    v_accvgpr_read_b32 v232, a90
    v_accvgpr_read_b32 v233, a91
    v_mul_f32 v230, v230, v229
    v_mul_f32 v231, v231, v229
    v_mul_f32 v232, v232, v229
    v_mul_f32 v233, v233, v229
    v_accvgpr_write_b32 a88, v230
    v_accvgpr_write_b32 a89, v231
    v_accvgpr_write_b32 a90, v232
    v_accvgpr_write_b32 a91, v233
    v_accvgpr_read_b32 v230, a108
    v_accvgpr_read_b32 v231, a109
    v_accvgpr_read_b32 v232, a110
    v_accvgpr_read_b32 v233, a111
    v_mul_f32 v230, v230, v229
    v_mul_f32 v231, v231, v229
    v_mul_f32 v232, v232, v229
    v_mul_f32 v233, v233, v229
    v_accvgpr_write_b32 a108, v230
    v_accvgpr_write_b32 a109, v231
    v_accvgpr_write_b32 a110, v232
    v_accvgpr_write_b32 a111, v233
    v_accvgpr_read_b32 v230, a128
    v_accvgpr_read_b32 v231, a129
    v_accvgpr_read_b32 v232, a130
    v_accvgpr_read_b32 v233, a131
    v_mul_f32 v230, v230, v229
    v_mul_f32 v231, v231, v229
    v_mul_f32 v232, v232, v229
    v_mul_f32 v233, v233, v229
    v_accvgpr_write_b32 a128, v230
    v_accvgpr_write_b32 a129, v231
    v_accvgpr_write_b32 a130, v232
    v_accvgpr_write_b32 a131, v233
    v_accvgpr_read_b32 v230, a148
    v_accvgpr_read_b32 v231, a149
    v_accvgpr_read_b32 v232, a150
    v_accvgpr_read_b32 v233, a151
    v_mul_f32 v230, v230, v229
    v_mul_f32 v231, v231, v229
    v_mul_f32 v232, v232, v229
    v_mul_f32 v233, v233, v229
    v_accvgpr_write_b32 a148, v230
    v_accvgpr_write_b32 a149, v231
    v_accvgpr_write_b32 a150, v232
    v_accvgpr_write_b32 a151, v233
    v_max3_f32 v228, v44, v45, v46
    v_max3_f32 v228, v228, v47, v64
    v_max3_f32 v228, v228, v65, v66
    v_max_f32 v228, v228, v67
    v_mov_b32 v229, v228
    s_nop 1
    v_permlane32_swap_b32 v228, v229
    s_nop 1
    v_max_f32 v228, v228, v229
    v_mov_b32 v229, v228
    s_nop 1
    v_permlane16_swap_b32 v228, v229
    s_nop 1
    v_max_f32 v228, v228, v229
    v_max_f32 v228, s51, v228
    v_sub_f32 v229, 0, v228
    v_exp_f32 v229, v229
    v_add_f32 v224, v224, v228
    v_sub_f32 v208, v208, v228
    v_sub_f32 v44, v44, v228
    v_sub_f32 v64, v64, v228
    v_sub_f32 v209, v209, v228
    v_sub_f32 v45, v45, v228
    v_sub_f32 v65, v65, v228
    v_sub_f32 v210, v210, v228
    v_sub_f32 v46, v46, v228
    v_sub_f32 v66, v66, v228
    v_sub_f32 v211, v211, v228
    v_sub_f32 v47, v47, v228
    v_sub_f32 v67, v67, v228
    v_mul_f32 v219, v219, v229
    v_accvgpr_read_b32 v230, a12
    v_accvgpr_read_b32 v231, a13
    v_accvgpr_read_b32 v232, a14
    v_accvgpr_read_b32 v233, a15
    v_mul_f32 v230, v230, v229
    v_mul_f32 v231, v231, v229
    v_mul_f32 v232, v232, v229
    v_mul_f32 v233, v233, v229
    v_accvgpr_write_b32 a12, v230
    v_accvgpr_write_b32 a13, v231
    v_accvgpr_write_b32 a14, v232
    v_accvgpr_write_b32 a15, v233
    v_accvgpr_read_b32 v230, a32
    v_accvgpr_read_b32 v231, a33
    v_accvgpr_read_b32 v232, a34
    v_accvgpr_read_b32 v233, a35
    v_mul_f32 v230, v230, v229
    v_mul_f32 v231, v231, v229
    v_mul_f32 v232, v232, v229
    v_mul_f32 v233, v233, v229
    v_accvgpr_write_b32 a32, v230
    v_accvgpr_write_b32 a33, v231
    v_accvgpr_write_b32 a34, v232
    v_accvgpr_write_b32 a35, v233
    v_accvgpr_read_b32 v230, a52
    v_accvgpr_read_b32 v231, a53
    v_accvgpr_read_b32 v232, a54
    v_accvgpr_read_b32 v233, a55
    v_mul_f32 v230, v230, v229
    v_mul_f32 v231, v231, v229
    v_mul_f32 v232, v232, v229
    v_mul_f32 v233, v233, v229
    v_accvgpr_write_b32 a52, v230
    v_accvgpr_write_b32 a53, v231
    v_accvgpr_write_b32 a54, v232
    v_accvgpr_write_b32 a55, v233
    v_accvgpr_read_b32 v230, a72
    v_accvgpr_read_b32 v231, a73
    v_accvgpr_read_b32 v232, a74
    v_accvgpr_read_b32 v233, a75
    v_mul_f32 v230, v230, v229
    v_mul_f32 v231, v231, v229
    v_mul_f32 v232, v232, v229
    v_mul_f32 v233, v233, v229
    v_accvgpr_write_b32 a72, v230
    v_accvgpr_write_b32 a73, v231
    v_accvgpr_write_b32 a74, v232
    v_accvgpr_write_b32 a75, v233
    v_accvgpr_read_b32 v230, a92
    v_accvgpr_read_b32 v231, a93
    v_accvgpr_read_b32 v232, a94
    v_accvgpr_read_b32 v233, a95
    v_mul_f32 v230, v230, v229
    v_mul_f32 v231, v231, v229
    v_mul_f32 v232, v232, v229
    v_mul_f32 v233, v233, v229
    v_accvgpr_write_b32 a92, v230
    v_accvgpr_write_b32 a93, v231
    v_accvgpr_write_b32 a94, v232
    v_accvgpr_write_b32 a95, v233
    v_accvgpr_read_b32 v230, a112
    v_accvgpr_read_b32 v231, a113
    v_accvgpr_read_b32 v232, a114
    v_accvgpr_read_b32 v233, a115
    v_mul_f32 v230, v230, v229
    v_mul_f32 v231, v231, v229
    v_mul_f32 v232, v232, v229
    v_mul_f32 v233, v233, v229
    v_accvgpr_write_b32 a112, v230
    v_accvgpr_write_b32 a113, v231
    v_accvgpr_write_b32 a114, v232
    v_accvgpr_write_b32 a115, v233
    v_accvgpr_read_b32 v230, a132
    v_accvgpr_read_b32 v231, a133
    v_accvgpr_read_b32 v232, a134
    v_accvgpr_read_b32 v233, a135
    v_mul_f32 v230, v230, v229
    v_mul_f32 v231, v231, v229
    v_mul_f32 v232, v232, v229
    v_mul_f32 v233, v233, v229
    v_accvgpr_write_b32 a132, v230
    v_accvgpr_write_b32 a133, v231
    v_accvgpr_write_b32 a134, v232
    v_accvgpr_write_b32 a135, v233
    v_accvgpr_read_b32 v230, a152
    v_accvgpr_read_b32 v231, a153
    v_accvgpr_read_b32 v232, a154
    v_accvgpr_read_b32 v233, a155
    v_mul_f32 v230, v230, v229
    v_mul_f32 v231, v231, v229
    v_mul_f32 v232, v232, v229
    v_mul_f32 v233, v233, v229
    v_accvgpr_write_b32 a152, v230
    v_accvgpr_write_b32 a153, v231
    v_accvgpr_write_b32 a154, v232
    v_accvgpr_write_b32 a155, v233
    v_max3_f32 v228, v48, v49, v50
    v_max3_f32 v228, v228, v51, v68
    v_max3_f32 v228, v228, v69, v70
    v_max_f32 v228, v228, v71
    v_mov_b32 v229, v228
    s_nop 1
    v_permlane32_swap_b32 v228, v229
    s_nop 1
    v_max_f32 v228, v228, v229
    v_mov_b32 v229, v228
    s_nop 1
    v_permlane16_swap_b32 v228, v229
    s_nop 1
    v_max_f32 v228, v228, v229
    v_max_f32 v228, s51, v228
    v_sub_f32 v229, 0, v228
    v_exp_f32 v229, v229
    v_add_f32 v225, v225, v228
    v_sub_f32 v212, v212, v228
    v_sub_f32 v48, v48, v228
    v_sub_f32 v68, v68, v228
    v_sub_f32 v213, v213, v228
    v_sub_f32 v49, v49, v228
    v_sub_f32 v69, v69, v228
    v_sub_f32 v214, v214, v228
    v_sub_f32 v50, v50, v228
    v_sub_f32 v70, v70, v228
    v_sub_f32 v215, v215, v228
    v_sub_f32 v51, v51, v228
    v_sub_f32 v71, v71, v228
    v_mul_f32 v220, v220, v229
    v_accvgpr_read_b32 v230, a16
    v_accvgpr_read_b32 v231, a17
    v_accvgpr_read_b32 v232, a18
    v_accvgpr_read_b32 v233, a19
    v_mul_f32 v230, v230, v229
    v_mul_f32 v231, v231, v229
    v_mul_f32 v232, v232, v229
    v_mul_f32 v233, v233, v229
    v_accvgpr_write_b32 a16, v230
    v_accvgpr_write_b32 a17, v231
    v_accvgpr_write_b32 a18, v232
    v_accvgpr_write_b32 a19, v233
    v_accvgpr_read_b32 v230, a36
    v_accvgpr_read_b32 v231, a37
    v_accvgpr_read_b32 v232, a38
    v_accvgpr_read_b32 v233, a39
    v_mul_f32 v230, v230, v229
    v_mul_f32 v231, v231, v229
    v_mul_f32 v232, v232, v229
    v_mul_f32 v233, v233, v229
    v_accvgpr_write_b32 a36, v230
    v_accvgpr_write_b32 a37, v231
    v_accvgpr_write_b32 a38, v232
    v_accvgpr_write_b32 a39, v233
    v_accvgpr_read_b32 v230, a56
    v_accvgpr_read_b32 v231, a57
    v_accvgpr_read_b32 v232, a58
    v_accvgpr_read_b32 v233, a59
    v_mul_f32 v230, v230, v229
    v_mul_f32 v231, v231, v229
    v_mul_f32 v232, v232, v229
    v_mul_f32 v233, v233, v229
    v_accvgpr_write_b32 a56, v230
    v_accvgpr_write_b32 a57, v231
    v_accvgpr_write_b32 a58, v232
    v_accvgpr_write_b32 a59, v233
    v_accvgpr_read_b32 v230, a76
    v_accvgpr_read_b32 v231, a77
    v_accvgpr_read_b32 v232, a78
    v_accvgpr_read_b32 v233, a79
    v_mul_f32 v230, v230, v229
    v_mul_f32 v231, v231, v229
    v_mul_f32 v232, v232, v229
    v_mul_f32 v233, v233, v229
    v_accvgpr_write_b32 a76, v230
    v_accvgpr_write_b32 a77, v231
    v_accvgpr_write_b32 a78, v232
    v_accvgpr_write_b32 a79, v233
    v_accvgpr_read_b32 v230, a96
    v_accvgpr_read_b32 v231, a97
    v_accvgpr_read_b32 v232, a98
    v_accvgpr_read_b32 v233, a99
    v_mul_f32 v230, v230, v229
    v_mul_f32 v231, v231, v229
    v_mul_f32 v232, v232, v229
    v_mul_f32 v233, v233, v229
    v_accvgpr_write_b32 a96, v230
    v_accvgpr_write_b32 a97, v231
    v_accvgpr_write_b32 a98, v232
    v_accvgpr_write_b32 a99, v233
    v_accvgpr_read_b32 v230, a116
    v_accvgpr_read_b32 v231, a117
    v_accvgpr_read_b32 v232, a118
    v_accvgpr_read_b32 v233, a119
    v_mul_f32 v230, v230, v229
    v_mul_f32 v231, v231, v229
    v_mul_f32 v232, v232, v229
    v_mul_f32 v233, v233, v229
    v_accvgpr_write_b32 a116, v230
    v_accvgpr_write_b32 a117, v231
    v_accvgpr_write_b32 a118, v232
    v_accvgpr_write_b32 a119, v233
    v_accvgpr_read_b32 v230, a136
    v_accvgpr_read_b32 v231, a137
    v_accvgpr_read_b32 v232, a138
    v_accvgpr_read_b32 v233, a139
    v_mul_f32 v230, v230, v229
    v_mul_f32 v231, v231, v229
    v_mul_f32 v232, v232, v229
    v_mul_f32 v233, v233, v229
    v_accvgpr_write_b32 a136, v230
    v_accvgpr_write_b32 a137, v231
    v_accvgpr_write_b32 a138, v232
    v_accvgpr_write_b32 a139, v233
    v_accvgpr_read_b32 v230, a156
    v_accvgpr_read_b32 v231, a157
    v_accvgpr_read_b32 v232, a158
    v_accvgpr_read_b32 v233, a159
    v_mul_f32 v230, v230, v229
    v_mul_f32 v231, v231, v229
    v_mul_f32 v232, v232, v229
    v_mul_f32 v233, v233, v229
    v_accvgpr_write_b32 a156, v230
    v_accvgpr_write_b32 a157, v231
    v_accvgpr_write_b32 a158, v232
    v_accvgpr_write_b32 a159, v233
    s_mov_b32 s50, 0x41000000
    s_mov_b32 s51, 0
    s_nop 1
    s_branch k1_kernel_L20
k1_kernel_L21:
    s_nop 7
    v_max3_f32 v228, v72, v73, v74
    v_max3_f32 v228, v228, v75, v92
    v_max3_f32 v228, v228, v93, v94
    v_max_f32 v228, v228, v95
    v_mov_b32 v229, v228
    s_nop 1
    v_permlane32_swap_b32 v228, v229
    s_nop 1
    v_max_f32 v228, v228, v229
    v_mov_b32 v229, v228
    s_nop 1
    v_permlane16_swap_b32 v228, v229
    s_nop 1
    v_max_f32 v228, v228, v229
    v_max_f32 v228, s51, v228
    v_sub_f32 v229, 0, v228
    v_exp_f32 v229, v229
    v_add_f32 v221, v221, v228
    v_sub_f32 v196, v196, v228
    v_sub_f32 v72, v72, v228
    v_sub_f32 v92, v92, v228
    v_sub_f32 v197, v197, v228
    v_sub_f32 v73, v73, v228
    v_sub_f32 v93, v93, v228
    v_sub_f32 v198, v198, v228
    v_sub_f32 v74, v74, v228
    v_sub_f32 v94, v94, v228
    v_sub_f32 v199, v199, v228
    v_sub_f32 v75, v75, v228
    v_sub_f32 v95, v95, v228
    v_mul_f32 v216, v216, v229
    v_accvgpr_read_b32 v230, a0
    v_accvgpr_read_b32 v231, a1
    v_accvgpr_read_b32 v232, a2
    v_accvgpr_read_b32 v233, a3
    v_mul_f32 v230, v230, v229
    v_mul_f32 v231, v231, v229
    v_mul_f32 v232, v232, v229
    v_mul_f32 v233, v233, v229
    v_accvgpr_write_b32 a0, v230
    v_accvgpr_write_b32 a1, v231
    v_accvgpr_write_b32 a2, v232
    v_accvgpr_write_b32 a3, v233
    v_accvgpr_read_b32 v230, a20
    v_accvgpr_read_b32 v231, a21
    v_accvgpr_read_b32 v232, a22
    v_accvgpr_read_b32 v233, a23
    v_mul_f32 v230, v230, v229
    v_mul_f32 v231, v231, v229
    v_mul_f32 v232, v232, v229
    v_mul_f32 v233, v233, v229
    v_accvgpr_write_b32 a20, v230
    v_accvgpr_write_b32 a21, v231
    v_accvgpr_write_b32 a22, v232
    v_accvgpr_write_b32 a23, v233
    v_accvgpr_read_b32 v230, a40
    v_accvgpr_read_b32 v231, a41
    v_accvgpr_read_b32 v232, a42
    v_accvgpr_read_b32 v233, a43
    v_mul_f32 v230, v230, v229
    v_mul_f32 v231, v231, v229
    v_mul_f32 v232, v232, v229
    v_mul_f32 v233, v233, v229
    v_accvgpr_write_b32 a40, v230
    v_accvgpr_write_b32 a41, v231
    v_accvgpr_write_b32 a42, v232
    v_accvgpr_write_b32 a43, v233
    v_accvgpr_read_b32 v230, a60
    v_accvgpr_read_b32 v231, a61
    v_accvgpr_read_b32 v232, a62
    v_accvgpr_read_b32 v233, a63
    v_mul_f32 v230, v230, v229
    v_mul_f32 v231, v231, v229
    v_mul_f32 v232, v232, v229
    v_mul_f32 v233, v233, v229
    v_accvgpr_write_b32 a60, v230
    v_accvgpr_write_b32 a61, v231
    v_accvgpr_write_b32 a62, v232
    v_accvgpr_write_b32 a63, v233
    v_accvgpr_read_b32 v230, a80
    v_accvgpr_read_b32 v231, a81
    v_accvgpr_read_b32 v232, a82
    v_accvgpr_read_b32 v233, a83
    v_mul_f32 v230, v230, v229
    v_mul_f32 v231, v231, v229
    v_mul_f32 v232, v232, v229
    v_mul_f32 v233, v233, v229
    v_accvgpr_write_b32 a80, v230
    v_accvgpr_write_b32 a81, v231
    v_accvgpr_write_b32 a82, v232
    v_accvgpr_write_b32 a83, v233
    v_accvgpr_read_b32 v230, a100
    v_accvgpr_read_b32 v231, a101
    v_accvgpr_read_b32 v232, a102
    v_accvgpr_read_b32 v233, a103
    v_mul_f32 v230, v230, v229
    v_mul_f32 v231, v231, v229
    v_mul_f32 v232, v232, v229
    v_mul_f32 v233, v233, v229
    v_accvgpr_write_b32 a100, v230
    v_accvgpr_write_b32 a101, v231
    v_accvgpr_write_b32 a102, v232
    v_accvgpr_write_b32 a103, v233
    v_accvgpr_read_b32 v230, a120
    v_accvgpr_read_b32 v231, a121
    v_accvgpr_read_b32 v232, a122
    v_accvgpr_read_b32 v233, a123
    v_mul_f32 v230, v230, v229
    v_mul_f32 v231, v231, v229
    v_mul_f32 v232, v232, v229
    v_mul_f32 v233, v233, v229
    v_accvgpr_write_b32 a120, v230
    v_accvgpr_write_b32 a121, v231
    v_accvgpr_write_b32 a122, v232
    v_accvgpr_write_b32 a123, v233
    v_accvgpr_read_b32 v230, a140
    v_accvgpr_read_b32 v231, a141
    v_accvgpr_read_b32 v232, a142
    v_accvgpr_read_b32 v233, a143
    v_mul_f32 v230, v230, v229
    v_mul_f32 v231, v231, v229
    v_mul_f32 v232, v232, v229
    v_mul_f32 v233, v233, v229
    v_accvgpr_write_b32 a140, v230
    v_accvgpr_write_b32 a141, v231
    v_accvgpr_write_b32 a142, v232
    v_accvgpr_write_b32 a143, v233
    v_max3_f32 v228, v76, v77, v78
    v_max3_f32 v228, v228, v79, v96
    v_max3_f32 v228, v228, v97, v98
    v_max_f32 v228, v228, v99
    v_mov_b32 v229, v228
    s_nop 1
    v_permlane32_swap_b32 v228, v229
    s_nop 1
    v_max_f32 v228, v228, v229
    v_mov_b32 v229, v228
    s_nop 1
    v_permlane16_swap_b32 v228, v229
    s_nop 1
    v_max_f32 v228, v228, v229
    v_max_f32 v228, s51, v228
    v_sub_f32 v229, 0, v228
    v_exp_f32 v229, v229
    v_add_f32 v222, v222, v228
    v_sub_f32 v200, v200, v228
    v_sub_f32 v76, v76, v228
    v_sub_f32 v96, v96, v228
    v_sub_f32 v201, v201, v228
    v_sub_f32 v77, v77, v228
    v_sub_f32 v97, v97, v228
    v_sub_f32 v202, v202, v228
    v_sub_f32 v78, v78, v228
    v_sub_f32 v98, v98, v228
    v_sub_f32 v203, v203, v228
    v_sub_f32 v79, v79, v228
    v_sub_f32 v99, v99, v228
    v_mul_f32 v217, v217, v229
    v_accvgpr_read_b32 v230, a4
    v_accvgpr_read_b32 v231, a5
    v_accvgpr_read_b32 v232, a6
    v_accvgpr_read_b32 v233, a7
    v_mul_f32 v230, v230, v229
    v_mul_f32 v231, v231, v229
    v_mul_f32 v232, v232, v229
    v_mul_f32 v233, v233, v229
    v_accvgpr_write_b32 a4, v230
    v_accvgpr_write_b32 a5, v231
    v_accvgpr_write_b32 a6, v232
    v_accvgpr_write_b32 a7, v233
    v_accvgpr_read_b32 v230, a24
    v_accvgpr_read_b32 v231, a25
    v_accvgpr_read_b32 v232, a26
    v_accvgpr_read_b32 v233, a27
    v_mul_f32 v230, v230, v229
    v_mul_f32 v231, v231, v229
    v_mul_f32 v232, v232, v229
    v_mul_f32 v233, v233, v229
    v_accvgpr_write_b32 a24, v230
    v_accvgpr_write_b32 a25, v231
    v_accvgpr_write_b32 a26, v232
    v_accvgpr_write_b32 a27, v233
    v_accvgpr_read_b32 v230, a44
    v_accvgpr_read_b32 v231, a45
    v_accvgpr_read_b32 v232, a46
    v_accvgpr_read_b32 v233, a47
    v_mul_f32 v230, v230, v229
    v_mul_f32 v231, v231, v229
    v_mul_f32 v232, v232, v229
    v_mul_f32 v233, v233, v229
    v_accvgpr_write_b32 a44, v230
    v_accvgpr_write_b32 a45, v231
    v_accvgpr_write_b32 a46, v232
    v_accvgpr_write_b32 a47, v233
    v_accvgpr_read_b32 v230, a64
    v_accvgpr_read_b32 v231, a65
    v_accvgpr_read_b32 v232, a66
    v_accvgpr_read_b32 v233, a67
    v_mul_f32 v230, v230, v229
    v_mul_f32 v231, v231, v229
    v_mul_f32 v232, v232, v229
    v_mul_f32 v233, v233, v229
    v_accvgpr_write_b32 a64, v230
    v_accvgpr_write_b32 a65, v231
    v_accvgpr_write_b32 a66, v232
    v_accvgpr_write_b32 a67, v233
    v_accvgpr_read_b32 v230, a84
    v_accvgpr_read_b32 v231, a85
    v_accvgpr_read_b32 v232, a86
    v_accvgpr_read_b32 v233, a87
    v_mul_f32 v230, v230, v229
    v_mul_f32 v231, v231, v229
    v_mul_f32 v232, v232, v229
    v_mul_f32 v233, v233, v229
    v_accvgpr_write_b32 a84, v230
    v_accvgpr_write_b32 a85, v231
    v_accvgpr_write_b32 a86, v232
    v_accvgpr_write_b32 a87, v233
    v_accvgpr_read_b32 v230, a104
    v_accvgpr_read_b32 v231, a105
    v_accvgpr_read_b32 v232, a106
    v_accvgpr_read_b32 v233, a107
    v_mul_f32 v230, v230, v229
    v_mul_f32 v231, v231, v229
    v_mul_f32 v232, v232, v229
    v_mul_f32 v233, v233, v229
    v_accvgpr_write_b32 a104, v230
    v_accvgpr_write_b32 a105, v231
    v_accvgpr_write_b32 a106, v232
    v_accvgpr_write_b32 a107, v233
    v_accvgpr_read_b32 v230, a124
    v_accvgpr_read_b32 v231, a125
    v_accvgpr_read_b32 v232, a126
    v_accvgpr_read_b32 v233, a127
    v_mul_f32 v230, v230, v229
    v_mul_f32 v231, v231, v229
    v_mul_f32 v232, v232, v229
    v_mul_f32 v233, v233, v229
    v_accvgpr_write_b32 a124, v230
    v_accvgpr_write_b32 a125, v231
    v_accvgpr_write_b32 a126, v232
    v_accvgpr_write_b32 a127, v233
    v_accvgpr_read_b32 v230, a144
    v_accvgpr_read_b32 v231, a145
    v_accvgpr_read_b32 v232, a146
    v_accvgpr_read_b32 v233, a147
    v_mul_f32 v230, v230, v229
    v_mul_f32 v231, v231, v229
    v_mul_f32 v232, v232, v229
    v_mul_f32 v233, v233, v229
    v_accvgpr_write_b32 a144, v230
    v_accvgpr_write_b32 a145, v231
    v_accvgpr_write_b32 a146, v232
    v_accvgpr_write_b32 a147, v233
    v_max3_f32 v228, v80, v81, v82
    v_max3_f32 v228, v228, v83, v100
    v_max3_f32 v228, v228, v101, v102
    v_max_f32 v228, v228, v103
    v_mov_b32 v229, v228
    s_nop 1
    v_permlane32_swap_b32 v228, v229
    s_nop 1
    v_max_f32 v228, v228, v229
    v_mov_b32 v229, v228
    s_nop 1
    v_permlane16_swap_b32 v228, v229
    s_nop 1
    v_max_f32 v228, v228, v229
    v_max_f32 v228, s51, v228
    v_sub_f32 v229, 0, v228
    v_exp_f32 v229, v229
    v_add_f32 v223, v223, v228
    v_sub_f32 v204, v204, v228
    v_sub_f32 v80, v80, v228
    v_sub_f32 v100, v100, v228
    v_sub_f32 v205, v205, v228
    v_sub_f32 v81, v81, v228
    v_sub_f32 v101, v101, v228
    v_sub_f32 v206, v206, v228
    v_sub_f32 v82, v82, v228
    v_sub_f32 v102, v102, v228
    v_sub_f32 v207, v207, v228
    v_sub_f32 v83, v83, v228
    v_sub_f32 v103, v103, v228
    v_mul_f32 v218, v218, v229
    v_accvgpr_read_b32 v230, a8
    v_accvgpr_read_b32 v231, a9
    v_accvgpr_read_b32 v232, a10
    v_accvgpr_read_b32 v233, a11
    v_mul_f32 v230, v230, v229
    v_mul_f32 v231, v231, v229
    v_mul_f32 v232, v232, v229
    v_mul_f32 v233, v233, v229
    v_accvgpr_write_b32 a8, v230
    v_accvgpr_write_b32 a9, v231
    v_accvgpr_write_b32 a10, v232
    v_accvgpr_write_b32 a11, v233
    v_accvgpr_read_b32 v230, a28
    v_accvgpr_read_b32 v231, a29
    v_accvgpr_read_b32 v232, a30
    v_accvgpr_read_b32 v233, a31
    v_mul_f32 v230, v230, v229
    v_mul_f32 v231, v231, v229
    v_mul_f32 v232, v232, v229
    v_mul_f32 v233, v233, v229
    v_accvgpr_write_b32 a28, v230
    v_accvgpr_write_b32 a29, v231
    v_accvgpr_write_b32 a30, v232
    v_accvgpr_write_b32 a31, v233
    v_accvgpr_read_b32 v230, a48
    v_accvgpr_read_b32 v231, a49
    v_accvgpr_read_b32 v232, a50
    v_accvgpr_read_b32 v233, a51
    v_mul_f32 v230, v230, v229
    v_mul_f32 v231, v231, v229
    v_mul_f32 v232, v232, v229
    v_mul_f32 v233, v233, v229
    v_accvgpr_write_b32 a48, v230
    v_accvgpr_write_b32 a49, v231
    v_accvgpr_write_b32 a50, v232
    v_accvgpr_write_b32 a51, v233
    v_accvgpr_read_b32 v230, a68
    v_accvgpr_read_b32 v231, a69
    v_accvgpr_read_b32 v232, a70
    v_accvgpr_read_b32 v233, a71
    v_mul_f32 v230, v230, v229
    v_mul_f32 v231, v231, v229
    v_mul_f32 v232, v232, v229
    v_mul_f32 v233, v233, v229
    v_accvgpr_write_b32 a68, v230
    v_accvgpr_write_b32 a69, v231
    v_accvgpr_write_b32 a70, v232
    v_accvgpr_write_b32 a71, v233
    v_accvgpr_read_b32 v230, a88
    v_accvgpr_read_b32 v231, a89
    v_accvgpr_read_b32 v232, a90
    v_accvgpr_read_b32 v233, a91
    v_mul_f32 v230, v230, v229
    v_mul_f32 v231, v231, v229
    v_mul_f32 v232, v232, v229
    v_mul_f32 v233, v233, v229
    v_accvgpr_write_b32 a88, v230
    v_accvgpr_write_b32 a89, v231
    v_accvgpr_write_b32 a90, v232
    v_accvgpr_write_b32 a91, v233
    v_accvgpr_read_b32 v230, a108
    v_accvgpr_read_b32 v231, a109
    v_accvgpr_read_b32 v232, a110
    v_accvgpr_read_b32 v233, a111
    v_mul_f32 v230, v230, v229
    v_mul_f32 v231, v231, v229
    v_mul_f32 v232, v232, v229
    v_mul_f32 v233, v233, v229
    v_accvgpr_write_b32 a108, v230
    v_accvgpr_write_b32 a109, v231
    v_accvgpr_write_b32 a110, v232
    v_accvgpr_write_b32 a111, v233
    v_accvgpr_read_b32 v230, a128
    v_accvgpr_read_b32 v231, a129
    v_accvgpr_read_b32 v232, a130
    v_accvgpr_read_b32 v233, a131
    v_mul_f32 v230, v230, v229
    v_mul_f32 v231, v231, v229
    v_mul_f32 v232, v232, v229
    v_mul_f32 v233, v233, v229
    v_accvgpr_write_b32 a128, v230
    v_accvgpr_write_b32 a129, v231
    v_accvgpr_write_b32 a130, v232
    v_accvgpr_write_b32 a131, v233
    v_accvgpr_read_b32 v230, a148
    v_accvgpr_read_b32 v231, a149
    v_accvgpr_read_b32 v232, a150
    v_accvgpr_read_b32 v233, a151
    v_mul_f32 v230, v230, v229
    v_mul_f32 v231, v231, v229
    v_mul_f32 v232, v232, v229
    v_mul_f32 v233, v233, v229
    v_accvgpr_write_b32 a148, v230
    v_accvgpr_write_b32 a149, v231
    v_accvgpr_write_b32 a150, v232
    v_accvgpr_write_b32 a151, v233
    v_max3_f32 v228, v84, v85, v86
    v_max3_f32 v228, v228, v87, v104
    v_max3_f32 v228, v228, v105, v106
    v_max_f32 v228, v228, v107
    v_mov_b32 v229, v228
    s_nop 1
    v_permlane32_swap_b32 v228, v229
    s_nop 1
    v_max_f32 v228, v228, v229
    v_mov_b32 v229, v228
    s_nop 1
    v_permlane16_swap_b32 v228, v229
    s_nop 1
    v_max_f32 v228, v228, v229
    v_max_f32 v228, s51, v228
    v_sub_f32 v229, 0, v228
    v_exp_f32 v229, v229
    v_add_f32 v224, v224, v228
    v_sub_f32 v208, v208, v228
    v_sub_f32 v84, v84, v228
    v_sub_f32 v104, v104, v228
    v_sub_f32 v209, v209, v228
    v_sub_f32 v85, v85, v228
    v_sub_f32 v105, v105, v228
    v_sub_f32 v210, v210, v228
    v_sub_f32 v86, v86, v228
    v_sub_f32 v106, v106, v228
    v_sub_f32 v211, v211, v228
    v_sub_f32 v87, v87, v228
    v_sub_f32 v107, v107, v228
    v_mul_f32 v219, v219, v229
    v_accvgpr_read_b32 v230, a12
    v_accvgpr_read_b32 v231, a13
    v_accvgpr_read_b32 v232, a14
    v_accvgpr_read_b32 v233, a15
    v_mul_f32 v230, v230, v229
    v_mul_f32 v231, v231, v229
    v_mul_f32 v232, v232, v229
    v_mul_f32 v233, v233, v229
    v_accvgpr_write_b32 a12, v230
    v_accvgpr_write_b32 a13, v231
    v_accvgpr_write_b32 a14, v232
    v_accvgpr_write_b32 a15, v233
    v_accvgpr_read_b32 v230, a32
    v_accvgpr_read_b32 v231, a33
    v_accvgpr_read_b32 v232, a34
    v_accvgpr_read_b32 v233, a35
    v_mul_f32 v230, v230, v229
    v_mul_f32 v231, v231, v229
    v_mul_f32 v232, v232, v229
    v_mul_f32 v233, v233, v229
    v_accvgpr_write_b32 a32, v230
    v_accvgpr_write_b32 a33, v231
    v_accvgpr_write_b32 a34, v232
    v_accvgpr_write_b32 a35, v233
    v_accvgpr_read_b32 v230, a52
    v_accvgpr_read_b32 v231, a53
    v_accvgpr_read_b32 v232, a54
    v_accvgpr_read_b32 v233, a55
    v_mul_f32 v230, v230, v229
    v_mul_f32 v231, v231, v229
    v_mul_f32 v232, v232, v229
    v_mul_f32 v233, v233, v229
    v_accvgpr_write_b32 a52, v230
    v_accvgpr_write_b32 a53, v231
    v_accvgpr_write_b32 a54, v232
    v_accvgpr_write_b32 a55, v233
    v_accvgpr_read_b32 v230, a72
    v_accvgpr_read_b32 v231, a73
    v_accvgpr_read_b32 v232, a74
    v_accvgpr_read_b32 v233, a75
    v_mul_f32 v230, v230, v229
    v_mul_f32 v231, v231, v229
    v_mul_f32 v232, v232, v229
    v_mul_f32 v233, v233, v229
    v_accvgpr_write_b32 a72, v230
    v_accvgpr_write_b32 a73, v231
    v_accvgpr_write_b32 a74, v232
    v_accvgpr_write_b32 a75, v233
    v_accvgpr_read_b32 v230, a92
    v_accvgpr_read_b32 v231, a93
    v_accvgpr_read_b32 v232, a94
    v_accvgpr_read_b32 v233, a95
    v_mul_f32 v230, v230, v229
    v_mul_f32 v231, v231, v229
    v_mul_f32 v232, v232, v229
    v_mul_f32 v233, v233, v229
    v_accvgpr_write_b32 a92, v230
    v_accvgpr_write_b32 a93, v231
    v_accvgpr_write_b32 a94, v232
    v_accvgpr_write_b32 a95, v233
    v_accvgpr_read_b32 v230, a112
    v_accvgpr_read_b32 v231, a113
    v_accvgpr_read_b32 v232, a114
    v_accvgpr_read_b32 v233, a115
    v_mul_f32 v230, v230, v229
    v_mul_f32 v231, v231, v229
    v_mul_f32 v232, v232, v229
    v_mul_f32 v233, v233, v229
    v_accvgpr_write_b32 a112, v230
    v_accvgpr_write_b32 a113, v231
    v_accvgpr_write_b32 a114, v232
    v_accvgpr_write_b32 a115, v233
    v_accvgpr_read_b32 v230, a132
    v_accvgpr_read_b32 v231, a133
    v_accvgpr_read_b32 v232, a134
    v_accvgpr_read_b32 v233, a135
    v_mul_f32 v230, v230, v229
    v_mul_f32 v231, v231, v229
    v_mul_f32 v232, v232, v229
    v_mul_f32 v233, v233, v229
    v_accvgpr_write_b32 a132, v230
    v_accvgpr_write_b32 a133, v231
    v_accvgpr_write_b32 a134, v232
    v_accvgpr_write_b32 a135, v233
    v_accvgpr_read_b32 v230, a152
    v_accvgpr_read_b32 v231, a153
    v_accvgpr_read_b32 v232, a154
    v_accvgpr_read_b32 v233, a155
    v_mul_f32 v230, v230, v229
    v_mul_f32 v231, v231, v229
    v_mul_f32 v232, v232, v229
    v_mul_f32 v233, v233, v229
    v_accvgpr_write_b32 a152, v230
    v_accvgpr_write_b32 a153, v231
    v_accvgpr_write_b32 a154, v232
    v_accvgpr_write_b32 a155, v233
    v_max3_f32 v228, v88, v89, v90
    v_max3_f32 v228, v228, v91, v108
    v_max3_f32 v228, v228, v109, v110
    v_max_f32 v228, v228, v111
    v_mov_b32 v229, v228
    s_nop 1
    v_permlane32_swap_b32 v228, v229
    s_nop 1
    v_max_f32 v228, v228, v229
    v_mov_b32 v229, v228
    s_nop 1
    v_permlane16_swap_b32 v228, v229
    s_nop 1
    v_max_f32 v228, v228, v229
    v_max_f32 v228, s51, v228
    v_sub_f32 v229, 0, v228
    v_exp_f32 v229, v229
    v_add_f32 v225, v225, v228
    v_sub_f32 v212, v212, v228
    v_sub_f32 v88, v88, v228
    v_sub_f32 v108, v108, v228
    v_sub_f32 v213, v213, v228
    v_sub_f32 v89, v89, v228
    v_sub_f32 v109, v109, v228
    v_sub_f32 v214, v214, v228
    v_sub_f32 v90, v90, v228
    v_sub_f32 v110, v110, v228
    v_sub_f32 v215, v215, v228
    v_sub_f32 v91, v91, v228
    v_sub_f32 v111, v111, v228
    v_mul_f32 v220, v220, v229
    v_accvgpr_read_b32 v230, a16
    v_accvgpr_read_b32 v231, a17
    v_accvgpr_read_b32 v232, a18
    v_accvgpr_read_b32 v233, a19
    v_mul_f32 v230, v230, v229
    v_mul_f32 v231, v231, v229
    v_mul_f32 v232, v232, v229
    v_mul_f32 v233, v233, v229
    v_accvgpr_write_b32 a16, v230
    v_accvgpr_write_b32 a17, v231
    v_accvgpr_write_b32 a18, v232
    v_accvgpr_write_b32 a19, v233
    v_accvgpr_read_b32 v230, a36
    v_accvgpr_read_b32 v231, a37
    v_accvgpr_read_b32 v232, a38
    v_accvgpr_read_b32 v233, a39
    v_mul_f32 v230, v230, v229
    v_mul_f32 v231, v231, v229
    v_mul_f32 v232, v232, v229
    v_mul_f32 v233, v233, v229
    v_accvgpr_write_b32 a36, v230
    v_accvgpr_write_b32 a37, v231
    v_accvgpr_write_b32 a38, v232
    v_accvgpr_write_b32 a39, v233
    v_accvgpr_read_b32 v230, a56
    v_accvgpr_read_b32 v231, a57
    v_accvgpr_read_b32 v232, a58
    v_accvgpr_read_b32 v233, a59
    v_mul_f32 v230, v230, v229
    v_mul_f32 v231, v231, v229
    v_mul_f32 v232, v232, v229
    v_mul_f32 v233, v233, v229
    v_accvgpr_write_b32 a56, v230
    v_accvgpr_write_b32 a57, v231
    v_accvgpr_write_b32 a58, v232
    v_accvgpr_write_b32 a59, v233
    v_accvgpr_read_b32 v230, a76
    v_accvgpr_read_b32 v231, a77
    v_accvgpr_read_b32 v232, a78
    v_accvgpr_read_b32 v233, a79
    v_mul_f32 v230, v230, v229
    v_mul_f32 v231, v231, v229
    v_mul_f32 v232, v232, v229
    v_mul_f32 v233, v233, v229
    v_accvgpr_write_b32 a76, v230
    v_accvgpr_write_b32 a77, v231
    v_accvgpr_write_b32 a78, v232
    v_accvgpr_write_b32 a79, v233
    v_accvgpr_read_b32 v230, a96
    v_accvgpr_read_b32 v231, a97
    v_accvgpr_read_b32 v232, a98
    v_accvgpr_read_b32 v233, a99
    v_mul_f32 v230, v230, v229
    v_mul_f32 v231, v231, v229
    v_mul_f32 v232, v232, v229
    v_mul_f32 v233, v233, v229
    v_accvgpr_write_b32 a96, v230
    v_accvgpr_write_b32 a97, v231
    v_accvgpr_write_b32 a98, v232
    v_accvgpr_write_b32 a99, v233
    v_accvgpr_read_b32 v230, a116
    v_accvgpr_read_b32 v231, a117
    v_accvgpr_read_b32 v232, a118
    v_accvgpr_read_b32 v233, a119
    v_mul_f32 v230, v230, v229
    v_mul_f32 v231, v231, v229
    v_mul_f32 v232, v232, v229
    v_mul_f32 v233, v233, v229
    v_accvgpr_write_b32 a116, v230
    v_accvgpr_write_b32 a117, v231
    v_accvgpr_write_b32 a118, v232
    v_accvgpr_write_b32 a119, v233
    v_accvgpr_read_b32 v230, a136
    v_accvgpr_read_b32 v231, a137
    v_accvgpr_read_b32 v232, a138
    v_accvgpr_read_b32 v233, a139
    v_mul_f32 v230, v230, v229
    v_mul_f32 v231, v231, v229
    v_mul_f32 v232, v232, v229
    v_mul_f32 v233, v233, v229
    v_accvgpr_write_b32 a136, v230
    v_accvgpr_write_b32 a137, v231
    v_accvgpr_write_b32 a138, v232
    v_accvgpr_write_b32 a139, v233
    v_accvgpr_read_b32 v230, a156
    v_accvgpr_read_b32 v231, a157
    v_accvgpr_read_b32 v232, a158
    v_accvgpr_read_b32 v233, a159
    v_mul_f32 v230, v230, v229
    v_mul_f32 v231, v231, v229
    v_mul_f32 v232, v232, v229
    v_mul_f32 v233, v233, v229
    v_accvgpr_write_b32 a156, v230
    v_accvgpr_write_b32 a157, v231
    v_accvgpr_write_b32 a158, v232
    v_accvgpr_write_b32 a159, v233
    s_mov_b32 s50, 0x41000000
    s_mov_b32 s51, 0
    s_nop 1
    s_branch k1_kernel_L22
k1_kernel_L23:
    s_nop 7
    v_max3_f32 v228, v32, v33, v34
    v_max3_f32 v228, v228, v35, v52
    v_max3_f32 v228, v228, v53, v54
    v_max_f32 v228, v228, v55
    v_mov_b32 v229, v228
    s_nop 1
    v_permlane32_swap_b32 v228, v229
    s_nop 1
    v_max_f32 v228, v228, v229
    v_mov_b32 v229, v228
    s_nop 1
    v_permlane16_swap_b32 v228, v229
    s_nop 1
    v_max_f32 v228, v228, v229
    v_max_f32 v228, s51, v228
    v_sub_f32 v229, 0, v228
    v_exp_f32 v229, v229
    v_add_f32 v221, v221, v228
    v_sub_f32 v196, v196, v228
    v_sub_f32 v32, v32, v228
    v_sub_f32 v52, v52, v228
    v_sub_f32 v197, v197, v228
    v_sub_f32 v33, v33, v228
    v_sub_f32 v53, v53, v228
    v_sub_f32 v198, v198, v228
    v_sub_f32 v34, v34, v228
    v_sub_f32 v54, v54, v228
    v_sub_f32 v199, v199, v228
    v_sub_f32 v35, v35, v228
    v_sub_f32 v55, v55, v228
    v_mul_f32 v216, v216, v229
    v_accvgpr_read_b32 v230, a0
    v_accvgpr_read_b32 v231, a1
    v_accvgpr_read_b32 v232, a2
    v_accvgpr_read_b32 v233, a3
    v_mul_f32 v230, v230, v229
    v_mul_f32 v231, v231, v229
    v_mul_f32 v232, v232, v229
    v_mul_f32 v233, v233, v229
    v_accvgpr_write_b32 a0, v230
    v_accvgpr_write_b32 a1, v231
    v_accvgpr_write_b32 a2, v232
    v_accvgpr_write_b32 a3, v233
    v_accvgpr_read_b32 v230, a20
    v_accvgpr_read_b32 v231, a21
    v_accvgpr_read_b32 v232, a22
    v_accvgpr_read_b32 v233, a23
    v_mul_f32 v230, v230, v229
    v_mul_f32 v231, v231, v229
    v_mul_f32 v232, v232, v229
    v_mul_f32 v233, v233, v229
    v_accvgpr_write_b32 a20, v230
    v_accvgpr_write_b32 a21, v231
    v_accvgpr_write_b32 a22, v232
    v_accvgpr_write_b32 a23, v233
    v_accvgpr_read_b32 v230, a40
    v_accvgpr_read_b32 v231, a41
    v_accvgpr_read_b32 v232, a42
    v_accvgpr_read_b32 v233, a43
    v_mul_f32 v230, v230, v229
    v_mul_f32 v231, v231, v229
    v_mul_f32 v232, v232, v229
    v_mul_f32 v233, v233, v229
    v_accvgpr_write_b32 a40, v230
    v_accvgpr_write_b32 a41, v231
    v_accvgpr_write_b32 a42, v232
    v_accvgpr_write_b32 a43, v233
    v_accvgpr_read_b32 v230, a60
    v_accvgpr_read_b32 v231, a61
    v_accvgpr_read_b32 v232, a62
    v_accvgpr_read_b32 v233, a63
    v_mul_f32 v230, v230, v229
    v_mul_f32 v231, v231, v229
    v_mul_f32 v232, v232, v229
    v_mul_f32 v233, v233, v229
    v_accvgpr_write_b32 a60, v230
    v_accvgpr_write_b32 a61, v231
    v_accvgpr_write_b32 a62, v232
    v_accvgpr_write_b32 a63, v233
    v_accvgpr_read_b32 v230, a80
    v_accvgpr_read_b32 v231, a81
    v_accvgpr_read_b32 v232, a82
    v_accvgpr_read_b32 v233, a83
    v_mul_f32 v230, v230, v229
    v_mul_f32 v231, v231, v229
    v_mul_f32 v232, v232, v229
    v_mul_f32 v233, v233, v229
    v_accvgpr_write_b32 a80, v230
    v_accvgpr_write_b32 a81, v231
    v_accvgpr_write_b32 a82, v232
    v_accvgpr_write_b32 a83, v233
    v_accvgpr_read_b32 v230, a100
    v_accvgpr_read_b32 v231, a101
    v_accvgpr_read_b32 v232, a102
    v_accvgpr_read_b32 v233, a103
    v_mul_f32 v230, v230, v229
    v_mul_f32 v231, v231, v229
    v_mul_f32 v232, v232, v229
    v_mul_f32 v233, v233, v229
    v_accvgpr_write_b32 a100, v230
    v_accvgpr_write_b32 a101, v231
    v_accvgpr_write_b32 a102, v232
    v_accvgpr_write_b32 a103, v233
    v_accvgpr_read_b32 v230, a120
    v_accvgpr_read_b32 v231, a121
    v_accvgpr_read_b32 v232, a122
    v_accvgpr_read_b32 v233, a123
    v_mul_f32 v230, v230, v229
    v_mul_f32 v231, v231, v229
    v_mul_f32 v232, v232, v229
    v_mul_f32 v233, v233, v229
    v_accvgpr_write_b32 a120, v230
    v_accvgpr_write_b32 a121, v231
    v_accvgpr_write_b32 a122, v232
    v_accvgpr_write_b32 a123, v233
    v_accvgpr_read_b32 v230, a140
    v_accvgpr_read_b32 v231, a141
    v_accvgpr_read_b32 v232, a142
    v_accvgpr_read_b32 v233, a143
    v_mul_f32 v230, v230, v229
    v_mul_f32 v231, v231, v229
    v_mul_f32 v232, v232, v229
    v_mul_f32 v233, v233, v229
    v_accvgpr_write_b32 a140, v230
    v_accvgpr_write_b32 a141, v231
    v_accvgpr_write_b32 a142, v232
    v_accvgpr_write_b32 a143, v233
    v_max3_f32 v228, v36, v37, v38
    v_max3_f32 v228, v228, v39, v56
    v_max3_f32 v228, v228, v57, v58
    v_max_f32 v228, v228, v59
    v_mov_b32 v229, v228
    s_nop 1
    v_permlane32_swap_b32 v228, v229
    s_nop 1
    v_max_f32 v228, v228, v229
    v_mov_b32 v229, v228
    s_nop 1
    v_permlane16_swap_b32 v228, v229
    s_nop 1
    v_max_f32 v228, v228, v229
    v_max_f32 v228, s51, v228
    v_sub_f32 v229, 0, v228
    v_exp_f32 v229, v229
    v_add_f32 v222, v222, v228
    v_sub_f32 v200, v200, v228
    v_sub_f32 v36, v36, v228
    v_sub_f32 v56, v56, v228
    v_sub_f32 v201, v201, v228
    v_sub_f32 v37, v37, v228
    v_sub_f32 v57, v57, v228
    v_sub_f32 v202, v202, v228
    v_sub_f32 v38, v38, v228
    v_sub_f32 v58, v58, v228
    v_sub_f32 v203, v203, v228
    v_sub_f32 v39, v39, v228
    v_sub_f32 v59, v59, v228
    v_mul_f32 v217, v217, v229
    v_accvgpr_read_b32 v230, a4
    v_accvgpr_read_b32 v231, a5
    v_accvgpr_read_b32 v232, a6
    v_accvgpr_read_b32 v233, a7
    v_mul_f32 v230, v230, v229
    v_mul_f32 v231, v231, v229
    v_mul_f32 v232, v232, v229
    v_mul_f32 v233, v233, v229
    v_accvgpr_write_b32 a4, v230
    v_accvgpr_write_b32 a5, v231
    v_accvgpr_write_b32 a6, v232
    v_accvgpr_write_b32 a7, v233
    v_accvgpr_read_b32 v230, a24
    v_accvgpr_read_b32 v231, a25
    v_accvgpr_read_b32 v232, a26
    v_accvgpr_read_b32 v233, a27
    v_mul_f32 v230, v230, v229
    v_mul_f32 v231, v231, v229
    v_mul_f32 v232, v232, v229
    v_mul_f32 v233, v233, v229
    v_accvgpr_write_b32 a24, v230
    v_accvgpr_write_b32 a25, v231
    v_accvgpr_write_b32 a26, v232
    v_accvgpr_write_b32 a27, v233
    v_accvgpr_read_b32 v230, a44
    v_accvgpr_read_b32 v231, a45
    v_accvgpr_read_b32 v232, a46
    v_accvgpr_read_b32 v233, a47
    v_mul_f32 v230, v230, v229
    v_mul_f32 v231, v231, v229
    v_mul_f32 v232, v232, v229
    v_mul_f32 v233, v233, v229
    v_accvgpr_write_b32 a44, v230
    v_accvgpr_write_b32 a45, v231
    v_accvgpr_write_b32 a46, v232
    v_accvgpr_write_b32 a47, v233
    v_accvgpr_read_b32 v230, a64
    v_accvgpr_read_b32 v231, a65
    v_accvgpr_read_b32 v232, a66
    v_accvgpr_read_b32 v233, a67
    v_mul_f32 v230, v230, v229
    v_mul_f32 v231, v231, v229
    v_mul_f32 v232, v232, v229
    v_mul_f32 v233, v233, v229
    v_accvgpr_write_b32 a64, v230
    v_accvgpr_write_b32 a65, v231
    v_accvgpr_write_b32 a66, v232
    v_accvgpr_write_b32 a67, v233
    v_accvgpr_read_b32 v230, a84
    v_accvgpr_read_b32 v231, a85
    v_accvgpr_read_b32 v232, a86
    v_accvgpr_read_b32 v233, a87
    v_mul_f32 v230, v230, v229
    v_mul_f32 v231, v231, v229
    v_mul_f32 v232, v232, v229
    v_mul_f32 v233, v233, v229
    v_accvgpr_write_b32 a84, v230
    v_accvgpr_write_b32 a85, v231
    v_accvgpr_write_b32 a86, v232
    v_accvgpr_write_b32 a87, v233
    v_accvgpr_read_b32 v230, a104
    v_accvgpr_read_b32 v231, a105
    v_accvgpr_read_b32 v232, a106
    v_accvgpr_read_b32 v233, a107
    v_mul_f32 v230, v230, v229
    v_mul_f32 v231, v231, v229
    v_mul_f32 v232, v232, v229
    v_mul_f32 v233, v233, v229
    v_accvgpr_write_b32 a104, v230
    v_accvgpr_write_b32 a105, v231
    v_accvgpr_write_b32 a106, v232
    v_accvgpr_write_b32 a107, v233
    v_accvgpr_read_b32 v230, a124
    v_accvgpr_read_b32 v231, a125
    v_accvgpr_read_b32 v232, a126
    v_accvgpr_read_b32 v233, a127
    v_mul_f32 v230, v230, v229
    v_mul_f32 v231, v231, v229
    v_mul_f32 v232, v232, v229
    v_mul_f32 v233, v233, v229
    v_accvgpr_write_b32 a124, v230
    v_accvgpr_write_b32 a125, v231
    v_accvgpr_write_b32 a126, v232
    v_accvgpr_write_b32 a127, v233
    v_accvgpr_read_b32 v230, a144
    v_accvgpr_read_b32 v231, a145
    v_accvgpr_read_b32 v232, a146
    v_accvgpr_read_b32 v233, a147
    v_mul_f32 v230, v230, v229
    v_mul_f32 v231, v231, v229
    v_mul_f32 v232, v232, v229
    v_mul_f32 v233, v233, v229
    v_accvgpr_write_b32 a144, v230
    v_accvgpr_write_b32 a145, v231
    v_accvgpr_write_b32 a146, v232
    v_accvgpr_write_b32 a147, v233
    v_max3_f32 v228, v40, v41, v42
    v_max3_f32 v228, v228, v43, v60
    v_max3_f32 v228, v228, v61, v62
    v_max_f32 v228, v228, v63
    v_mov_b32 v229, v228
    s_nop 1
    v_permlane32_swap_b32 v228, v229
    s_nop 1
    v_max_f32 v228, v228, v229
    v_mov_b32 v229, v228
    s_nop 1
    v_permlane16_swap_b32 v228, v229
    s_nop 1
    v_max_f32 v228, v228, v229
    v_max_f32 v228, s51, v228
    v_sub_f32 v229, 0, v228
    v_exp_f32 v229, v229
    v_add_f32 v223, v223, v228
    v_sub_f32 v204, v204, v228
    v_sub_f32 v40, v40, v228
    v_sub_f32 v60, v60, v228
    v_sub_f32 v205, v205, v228
    v_sub_f32 v41, v41, v228
    v_sub_f32 v61, v61, v228
    v_sub_f32 v206, v206, v228
    v_sub_f32 v42, v42, v228
    v_sub_f32 v62, v62, v228
    v_sub_f32 v207, v207, v228
    v_sub_f32 v43, v43, v228
    v_sub_f32 v63, v63, v228
    v_mul_f32 v218, v218, v229
    v_accvgpr_read_b32 v230, a8
    v_accvgpr_read_b32 v231, a9
    v_accvgpr_read_b32 v232, a10
    v_accvgpr_read_b32 v233, a11
    v_mul_f32 v230, v230, v229
    v_mul_f32 v231, v231, v229
    v_mul_f32 v232, v232, v229
    v_mul_f32 v233, v233, v229
    v_accvgpr_write_b32 a8, v230
    v_accvgpr_write_b32 a9, v231
    v_accvgpr_write_b32 a10, v232
    v_accvgpr_write_b32 a11, v233
    v_accvgpr_read_b32 v230, a28
    v_accvgpr_read_b32 v231, a29
    v_accvgpr_read_b32 v232, a30
    v_accvgpr_read_b32 v233, a31
    v_mul_f32 v230, v230, v229
    v_mul_f32 v231, v231, v229
    v_mul_f32 v232, v232, v229
    v_mul_f32 v233, v233, v229
    v_accvgpr_write_b32 a28, v230
    v_accvgpr_write_b32 a29, v231
    v_accvgpr_write_b32 a30, v232
    v_accvgpr_write_b32 a31, v233
    v_accvgpr_read_b32 v230, a48
    v_accvgpr_read_b32 v231, a49
    v_accvgpr_read_b32 v232, a50
    v_accvgpr_read_b32 v233, a51
    v_mul_f32 v230, v230, v229
    v_mul_f32 v231, v231, v229
    v_mul_f32 v232, v232, v229
    v_mul_f32 v233, v233, v229
    v_accvgpr_write_b32 a48, v230
    v_accvgpr_write_b32 a49, v231
    v_accvgpr_write_b32 a50, v232
    v_accvgpr_write_b32 a51, v233
    v_accvgpr_read_b32 v230, a68
    v_accvgpr_read_b32 v231, a69
    v_accvgpr_read_b32 v232, a70
    v_accvgpr_read_b32 v233, a71
    v_mul_f32 v230, v230, v229
    v_mul_f32 v231, v231, v229
    v_mul_f32 v232, v232, v229
    v_mul_f32 v233, v233, v229
    v_accvgpr_write_b32 a68, v230
    v_accvgpr_write_b32 a69, v231
    v_accvgpr_write_b32 a70, v232
    v_accvgpr_write_b32 a71, v233
    v_accvgpr_read_b32 v230, a88
    v_accvgpr_read_b32 v231, a89
    v_accvgpr_read_b32 v232, a90
    v_accvgpr_read_b32 v233, a91
    v_mul_f32 v230, v230, v229
    v_mul_f32 v231, v231, v229
    v_mul_f32 v232, v232, v229
    v_mul_f32 v233, v233, v229
    v_accvgpr_write_b32 a88, v230
    v_accvgpr_write_b32 a89, v231
    v_accvgpr_write_b32 a90, v232
    v_accvgpr_write_b32 a91, v233
    v_accvgpr_read_b32 v230, a108
    v_accvgpr_read_b32 v231, a109
    v_accvgpr_read_b32 v232, a110
    v_accvgpr_read_b32 v233, a111
    v_mul_f32 v230, v230, v229
    v_mul_f32 v231, v231, v229
    v_mul_f32 v232, v232, v229
    v_mul_f32 v233, v233, v229
    v_accvgpr_write_b32 a108, v230
    v_accvgpr_write_b32 a109, v231
    v_accvgpr_write_b32 a110, v232
    v_accvgpr_write_b32 a111, v233
    v_accvgpr_read_b32 v230, a128
    v_accvgpr_read_b32 v231, a129
    v_accvgpr_read_b32 v232, a130
    v_accvgpr_read_b32 v233, a131
    v_mul_f32 v230, v230, v229
    v_mul_f32 v231, v231, v229
    v_mul_f32 v232, v232, v229
    v_mul_f32 v233, v233, v229
    v_accvgpr_write_b32 a128, v230
    v_accvgpr_write_b32 a129, v231
    v_accvgpr_write_b32 a130, v232
    v_accvgpr_write_b32 a131, v233
    v_accvgpr_read_b32 v230, a148
    v_accvgpr_read_b32 v231, a149
    v_accvgpr_read_b32 v232, a150
    v_accvgpr_read_b32 v233, a151
    v_mul_f32 v230, v230, v229
    v_mul_f32 v231, v231, v229
    v_mul_f32 v232, v232, v229
    v_mul_f32 v233, v233, v229
    v_accvgpr_write_b32 a148, v230
    v_accvgpr_write_b32 a149, v231
    v_accvgpr_write_b32 a150, v232
    v_accvgpr_write_b32 a151, v233
    v_max3_f32 v228, v44, v45, v46
    v_max3_f32 v228, v228, v47, v64
    v_max3_f32 v228, v228, v65, v66
    v_max_f32 v228, v228, v67
    v_mov_b32 v229, v228
    s_nop 1
    v_permlane32_swap_b32 v228, v229
    s_nop 1
    v_max_f32 v228, v228, v229
    v_mov_b32 v229, v228
    s_nop 1
    v_permlane16_swap_b32 v228, v229
    s_nop 1
    v_max_f32 v228, v228, v229
    v_max_f32 v228, s51, v228
    v_sub_f32 v229, 0, v228
    v_exp_f32 v229, v229
    v_add_f32 v224, v224, v228
    v_sub_f32 v208, v208, v228
    v_sub_f32 v44, v44, v228
    v_sub_f32 v64, v64, v228
    v_sub_f32 v209, v209, v228
    v_sub_f32 v45, v45, v228
    v_sub_f32 v65, v65, v228
    v_sub_f32 v210, v210, v228
    v_sub_f32 v46, v46, v228
    v_sub_f32 v66, v66, v228
    v_sub_f32 v211, v211, v228
    v_sub_f32 v47, v47, v228
    v_sub_f32 v67, v67, v228
    v_mul_f32 v219, v219, v229
    v_accvgpr_read_b32 v230, a12
    v_accvgpr_read_b32 v231, a13
    v_accvgpr_read_b32 v232, a14
    v_accvgpr_read_b32 v233, a15
    v_mul_f32 v230, v230, v229
    v_mul_f32 v231, v231, v229
    v_mul_f32 v232, v232, v229
    v_mul_f32 v233, v233, v229
    v_accvgpr_write_b32 a12, v230
    v_accvgpr_write_b32 a13, v231
    v_accvgpr_write_b32 a14, v232
    v_accvgpr_write_b32 a15, v233
    v_accvgpr_read_b32 v230, a32
    v_accvgpr_read_b32 v231, a33
    v_accvgpr_read_b32 v232, a34
    v_accvgpr_read_b32 v233, a35
    v_mul_f32 v230, v230, v229
    v_mul_f32 v231, v231, v229
    v_mul_f32 v232, v232, v229
    v_mul_f32 v233, v233, v229
    v_accvgpr_write_b32 a32, v230
    v_accvgpr_write_b32 a33, v231
    v_accvgpr_write_b32 a34, v232
    v_accvgpr_write_b32 a35, v233
    v_accvgpr_read_b32 v230, a52
    v_accvgpr_read_b32 v231, a53
    v_accvgpr_read_b32 v232, a54
    v_accvgpr_read_b32 v233, a55
    v_mul_f32 v230, v230, v229
    v_mul_f32 v231, v231, v229
    v_mul_f32 v232, v232, v229
    v_mul_f32 v233, v233, v229
    v_accvgpr_write_b32 a52, v230
    v_accvgpr_write_b32 a53, v231
    v_accvgpr_write_b32 a54, v232
    v_accvgpr_write_b32 a55, v233
    v_accvgpr_read_b32 v230, a72
    v_accvgpr_read_b32 v231, a73
    v_accvgpr_read_b32 v232, a74
    v_accvgpr_read_b32 v233, a75
    v_mul_f32 v230, v230, v229
    v_mul_f32 v231, v231, v229
    v_mul_f32 v232, v232, v229
    v_mul_f32 v233, v233, v229
    v_accvgpr_write_b32 a72, v230
    v_accvgpr_write_b32 a73, v231
    v_accvgpr_write_b32 a74, v232
    v_accvgpr_write_b32 a75, v233
    v_accvgpr_read_b32 v230, a92
    v_accvgpr_read_b32 v231, a93
    v_accvgpr_read_b32 v232, a94
    v_accvgpr_read_b32 v233, a95
    v_mul_f32 v230, v230, v229
    v_mul_f32 v231, v231, v229
    v_mul_f32 v232, v232, v229
    v_mul_f32 v233, v233, v229
    v_accvgpr_write_b32 a92, v230
    v_accvgpr_write_b32 a93, v231
    v_accvgpr_write_b32 a94, v232
    v_accvgpr_write_b32 a95, v233
    v_accvgpr_read_b32 v230, a112
    v_accvgpr_read_b32 v231, a113
    v_accvgpr_read_b32 v232, a114
    v_accvgpr_read_b32 v233, a115
    v_mul_f32 v230, v230, v229
    v_mul_f32 v231, v231, v229
    v_mul_f32 v232, v232, v229
    v_mul_f32 v233, v233, v229
    v_accvgpr_write_b32 a112, v230
    v_accvgpr_write_b32 a113, v231
    v_accvgpr_write_b32 a114, v232
    v_accvgpr_write_b32 a115, v233
    v_accvgpr_read_b32 v230, a132
    v_accvgpr_read_b32 v231, a133
    v_accvgpr_read_b32 v232, a134
    v_accvgpr_read_b32 v233, a135
    v_mul_f32 v230, v230, v229
    v_mul_f32 v231, v231, v229
    v_mul_f32 v232, v232, v229
    v_mul_f32 v233, v233, v229
    v_accvgpr_write_b32 a132, v230
    v_accvgpr_write_b32 a133, v231
    v_accvgpr_write_b32 a134, v232
    v_accvgpr_write_b32 a135, v233
    v_accvgpr_read_b32 v230, a152
    v_accvgpr_read_b32 v231, a153
    v_accvgpr_read_b32 v232, a154
    v_accvgpr_read_b32 v233, a155
    v_mul_f32 v230, v230, v229
    v_mul_f32 v231, v231, v229
    v_mul_f32 v232, v232, v229
    v_mul_f32 v233, v233, v229
    v_accvgpr_write_b32 a152, v230
    v_accvgpr_write_b32 a153, v231
    v_accvgpr_write_b32 a154, v232
    v_accvgpr_write_b32 a155, v233
    v_max3_f32 v228, v48, v49, v50
    v_max3_f32 v228, v228, v51, v68
    v_max3_f32 v228, v228, v69, v70
    v_max_f32 v228, v228, v71
    v_mov_b32 v229, v228
    s_nop 1
    v_permlane32_swap_b32 v228, v229
    s_nop 1
    v_max_f32 v228, v228, v229
    v_mov_b32 v229, v228
    s_nop 1
    v_permlane16_swap_b32 v228, v229
    s_nop 1
    v_max_f32 v228, v228, v229
    v_max_f32 v228, s51, v228
    v_sub_f32 v229, 0, v228
    v_exp_f32 v229, v229
    v_add_f32 v225, v225, v228
    v_sub_f32 v212, v212, v228
    v_sub_f32 v48, v48, v228
    v_sub_f32 v68, v68, v228
    v_sub_f32 v213, v213, v228
    v_sub_f32 v49, v49, v228
    v_sub_f32 v69, v69, v228
    v_sub_f32 v214, v214, v228
    v_sub_f32 v50, v50, v228
    v_sub_f32 v70, v70, v228
    v_sub_f32 v215, v215, v228
    v_sub_f32 v51, v51, v228
    v_sub_f32 v71, v71, v228
    v_mul_f32 v220, v220, v229
    v_accvgpr_read_b32 v230, a16
    v_accvgpr_read_b32 v231, a17
    v_accvgpr_read_b32 v232, a18
    v_accvgpr_read_b32 v233, a19
    v_mul_f32 v230, v230, v229
    v_mul_f32 v231, v231, v229
    v_mul_f32 v232, v232, v229
    v_mul_f32 v233, v233, v229
    v_accvgpr_write_b32 a16, v230
    v_accvgpr_write_b32 a17, v231
    v_accvgpr_write_b32 a18, v232
    v_accvgpr_write_b32 a19, v233
    v_accvgpr_read_b32 v230, a36
    v_accvgpr_read_b32 v231, a37
    v_accvgpr_read_b32 v232, a38
    v_accvgpr_read_b32 v233, a39
    v_mul_f32 v230, v230, v229
    v_mul_f32 v231, v231, v229
    v_mul_f32 v232, v232, v229
    v_mul_f32 v233, v233, v229
    v_accvgpr_write_b32 a36, v230
    v_accvgpr_write_b32 a37, v231
    v_accvgpr_write_b32 a38, v232
    v_accvgpr_write_b32 a39, v233
    v_accvgpr_read_b32 v230, a56
    v_accvgpr_read_b32 v231, a57
    v_accvgpr_read_b32 v232, a58
    v_accvgpr_read_b32 v233, a59
    v_mul_f32 v230, v230, v229
    v_mul_f32 v231, v231, v229
    v_mul_f32 v232, v232, v229
    v_mul_f32 v233, v233, v229
    v_accvgpr_write_b32 a56, v230
    v_accvgpr_write_b32 a57, v231
    v_accvgpr_write_b32 a58, v232
    v_accvgpr_write_b32 a59, v233
    v_accvgpr_read_b32 v230, a76
    v_accvgpr_read_b32 v231, a77
    v_accvgpr_read_b32 v232, a78
    v_accvgpr_read_b32 v233, a79
    v_mul_f32 v230, v230, v229
    v_mul_f32 v231, v231, v229
    v_mul_f32 v232, v232, v229
    v_mul_f32 v233, v233, v229
    v_accvgpr_write_b32 a76, v230
    v_accvgpr_write_b32 a77, v231
    v_accvgpr_write_b32 a78, v232
    v_accvgpr_write_b32 a79, v233
    v_accvgpr_read_b32 v230, a96
    v_accvgpr_read_b32 v231, a97
    v_accvgpr_read_b32 v232, a98
    v_accvgpr_read_b32 v233, a99
    v_mul_f32 v230, v230, v229
    v_mul_f32 v231, v231, v229
    v_mul_f32 v232, v232, v229
    v_mul_f32 v233, v233, v229
    v_accvgpr_write_b32 a96, v230
    v_accvgpr_write_b32 a97, v231
    v_accvgpr_write_b32 a98, v232
    v_accvgpr_write_b32 a99, v233
    v_accvgpr_read_b32 v230, a116
    v_accvgpr_read_b32 v231, a117
    v_accvgpr_read_b32 v232, a118
    v_accvgpr_read_b32 v233, a119
    v_mul_f32 v230, v230, v229
    v_mul_f32 v231, v231, v229
    v_mul_f32 v232, v232, v229
    v_mul_f32 v233, v233, v229
    v_accvgpr_write_b32 a116, v230
    v_accvgpr_write_b32 a117, v231
    v_accvgpr_write_b32 a118, v232
    v_accvgpr_write_b32 a119, v233
    v_accvgpr_read_b32 v230, a136
    v_accvgpr_read_b32 v231, a137
    v_accvgpr_read_b32 v232, a138
    v_accvgpr_read_b32 v233, a139
    v_mul_f32 v230, v230, v229
    v_mul_f32 v231, v231, v229
    v_mul_f32 v232, v232, v229
    v_mul_f32 v233, v233, v229
    v_accvgpr_write_b32 a136, v230
    v_accvgpr_write_b32 a137, v231
    v_accvgpr_write_b32 a138, v232
    v_accvgpr_write_b32 a139, v233
    v_accvgpr_read_b32 v230, a156
    v_accvgpr_read_b32 v231, a157
    v_accvgpr_read_b32 v232, a158
    v_accvgpr_read_b32 v233, a159
    v_mul_f32 v230, v230, v229
    v_mul_f32 v231, v231, v229
    v_mul_f32 v232, v232, v229
    v_mul_f32 v233, v233, v229
    v_accvgpr_write_b32 a156, v230
    v_accvgpr_write_b32 a157, v231
    v_accvgpr_write_b32 a158, v232
    v_accvgpr_write_b32 a159, v233
    s_mov_b32 s50, 0x41000000
    s_mov_b32 s51, 0
    s_nop 1
    s_branch k1_kernel_L24
k1_kernel_L25:
    s_nop 7
    v_max3_f32 v228, v72, v73, v74
    v_max3_f32 v228, v228, v75, v92
    v_max3_f32 v228, v228, v93, v94
    v_max_f32 v228, v228, v95
    v_mov_b32 v229, v228
    s_nop 1
    v_permlane32_swap_b32 v228, v229
    s_nop 1
    v_max_f32 v228, v228, v229
    v_mov_b32 v229, v228
    s_nop 1
    v_permlane16_swap_b32 v228, v229
    s_nop 1
    v_max_f32 v228, v228, v229
    v_max_f32 v228, s51, v228
    v_sub_f32 v229, 0, v228
    v_exp_f32 v229, v229
    v_add_f32 v221, v221, v228
    v_sub_f32 v196, v196, v228
    v_sub_f32 v72, v72, v228
    v_sub_f32 v92, v92, v228
    v_sub_f32 v197, v197, v228
    v_sub_f32 v73, v73, v228
    v_sub_f32 v93, v93, v228
    v_sub_f32 v198, v198, v228
    v_sub_f32 v74, v74, v228
    v_sub_f32 v94, v94, v228
    v_sub_f32 v199, v199, v228
    v_sub_f32 v75, v75, v228
    v_sub_f32 v95, v95, v228
    v_mul_f32 v216, v216, v229
    v_accvgpr_read_b32 v230, a0
    v_accvgpr_read_b32 v231, a1
    v_accvgpr_read_b32 v232, a2
    v_accvgpr_read_b32 v233, a3
    v_mul_f32 v230, v230, v229
    v_mul_f32 v231, v231, v229
    v_mul_f32 v232, v232, v229
    v_mul_f32 v233, v233, v229
    v_accvgpr_write_b32 a0, v230
    v_accvgpr_write_b32 a1, v231
    v_accvgpr_write_b32 a2, v232
    v_accvgpr_write_b32 a3, v233
    v_accvgpr_read_b32 v230, a20
    v_accvgpr_read_b32 v231, a21
    v_accvgpr_read_b32 v232, a22
    v_accvgpr_read_b32 v233, a23
    v_mul_f32 v230, v230, v229
    v_mul_f32 v231, v231, v229
    v_mul_f32 v232, v232, v229
    v_mul_f32 v233, v233, v229
    v_accvgpr_write_b32 a20, v230
    v_accvgpr_write_b32 a21, v231
    v_accvgpr_write_b32 a22, v232
    v_accvgpr_write_b32 a23, v233
    v_accvgpr_read_b32 v230, a40
    v_accvgpr_read_b32 v231, a41
    v_accvgpr_read_b32 v232, a42
    v_accvgpr_read_b32 v233, a43
    v_mul_f32 v230, v230, v229
    v_mul_f32 v231, v231, v229
    v_mul_f32 v232, v232, v229
    v_mul_f32 v233, v233, v229
    v_accvgpr_write_b32 a40, v230
    v_accvgpr_write_b32 a41, v231
    v_accvgpr_write_b32 a42, v232
    v_accvgpr_write_b32 a43, v233
    v_accvgpr_read_b32 v230, a60
    v_accvgpr_read_b32 v231, a61
    v_accvgpr_read_b32 v232, a62
    v_accvgpr_read_b32 v233, a63
    v_mul_f32 v230, v230, v229
    v_mul_f32 v231, v231, v229
    v_mul_f32 v232, v232, v229
    v_mul_f32 v233, v233, v229
    v_accvgpr_write_b32 a60, v230
    v_accvgpr_write_b32 a61, v231
    v_accvgpr_write_b32 a62, v232
    v_accvgpr_write_b32 a63, v233
    v_accvgpr_read_b32 v230, a80
    v_accvgpr_read_b32 v231, a81
    v_accvgpr_read_b32 v232, a82
    v_accvgpr_read_b32 v233, a83
    v_mul_f32 v230, v230, v229
    v_mul_f32 v231, v231, v229
    v_mul_f32 v232, v232, v229
    v_mul_f32 v233, v233, v229
    v_accvgpr_write_b32 a80, v230
    v_accvgpr_write_b32 a81, v231
    v_accvgpr_write_b32 a82, v232
    v_accvgpr_write_b32 a83, v233
    v_accvgpr_read_b32 v230, a100
    v_accvgpr_read_b32 v231, a101
    v_accvgpr_read_b32 v232, a102
    v_accvgpr_read_b32 v233, a103
    v_mul_f32 v230, v230, v229
    v_mul_f32 v231, v231, v229
    v_mul_f32 v232, v232, v229
    v_mul_f32 v233, v233, v229
    v_accvgpr_write_b32 a100, v230
    v_accvgpr_write_b32 a101, v231
    v_accvgpr_write_b32 a102, v232
    v_accvgpr_write_b32 a103, v233
    v_accvgpr_read_b32 v230, a120
    v_accvgpr_read_b32 v231, a121
    v_accvgpr_read_b32 v232, a122
    v_accvgpr_read_b32 v233, a123
    v_mul_f32 v230, v230, v229
    v_mul_f32 v231, v231, v229
    v_mul_f32 v232, v232, v229
    v_mul_f32 v233, v233, v229
    v_accvgpr_write_b32 a120, v230
    v_accvgpr_write_b32 a121, v231
    v_accvgpr_write_b32 a122, v232
    v_accvgpr_write_b32 a123, v233
    v_accvgpr_read_b32 v230, a140
    v_accvgpr_read_b32 v231, a141
    v_accvgpr_read_b32 v232, a142
    v_accvgpr_read_b32 v233, a143
    v_mul_f32 v230, v230, v229
    v_mul_f32 v231, v231, v229
    v_mul_f32 v232, v232, v229
    v_mul_f32 v233, v233, v229
    v_accvgpr_write_b32 a140, v230
    v_accvgpr_write_b32 a141, v231
    v_accvgpr_write_b32 a142, v232
    v_accvgpr_write_b32 a143, v233
    v_max3_f32 v228, v76, v77, v78
    v_max3_f32 v228, v228, v79, v96
    v_max3_f32 v228, v228, v97, v98
    v_max_f32 v228, v228, v99
    v_mov_b32 v229, v228
    s_nop 1
    v_permlane32_swap_b32 v228, v229
    s_nop 1
    v_max_f32 v228, v228, v229
    v_mov_b32 v229, v228
    s_nop 1
    v_permlane16_swap_b32 v228, v229
    s_nop 1
    v_max_f32 v228, v228, v229
    v_max_f32 v228, s51, v228
    v_sub_f32 v229, 0, v228
    v_exp_f32 v229, v229
    v_add_f32 v222, v222, v228
    v_sub_f32 v200, v200, v228
    v_sub_f32 v76, v76, v228
    v_sub_f32 v96, v96, v228
    v_sub_f32 v201, v201, v228
    v_sub_f32 v77, v77, v228
    v_sub_f32 v97, v97, v228
    v_sub_f32 v202, v202, v228
    v_sub_f32 v78, v78, v228
    v_sub_f32 v98, v98, v228
    v_sub_f32 v203, v203, v228
    v_sub_f32 v79, v79, v228
    v_sub_f32 v99, v99, v228
    v_mul_f32 v217, v217, v229
    v_accvgpr_read_b32 v230, a4
    v_accvgpr_read_b32 v231, a5
    v_accvgpr_read_b32 v232, a6
    v_accvgpr_read_b32 v233, a7
    v_mul_f32 v230, v230, v229
    v_mul_f32 v231, v231, v229
    v_mul_f32 v232, v232, v229
    v_mul_f32 v233, v233, v229
    v_accvgpr_write_b32 a4, v230
    v_accvgpr_write_b32 a5, v231
    v_accvgpr_write_b32 a6, v232
    v_accvgpr_write_b32 a7, v233
    v_accvgpr_read_b32 v230, a24
    v_accvgpr_read_b32 v231, a25
    v_accvgpr_read_b32 v232, a26
    v_accvgpr_read_b32 v233, a27
    v_mul_f32 v230, v230, v229
    v_mul_f32 v231, v231, v229
    v_mul_f32 v232, v232, v229
    v_mul_f32 v233, v233, v229
    v_accvgpr_write_b32 a24, v230
    v_accvgpr_write_b32 a25, v231
    v_accvgpr_write_b32 a26, v232
    v_accvgpr_write_b32 a27, v233
    v_accvgpr_read_b32 v230, a44
    v_accvgpr_read_b32 v231, a45
    v_accvgpr_read_b32 v232, a46
    v_accvgpr_read_b32 v233, a47
    v_mul_f32 v230, v230, v229
    v_mul_f32 v231, v231, v229
    v_mul_f32 v232, v232, v229
    v_mul_f32 v233, v233, v229
    v_accvgpr_write_b32 a44, v230
    v_accvgpr_write_b32 a45, v231
    v_accvgpr_write_b32 a46, v232
    v_accvgpr_write_b32 a47, v233
    v_accvgpr_read_b32 v230, a64
    v_accvgpr_read_b32 v231, a65
    v_accvgpr_read_b32 v232, a66
    v_accvgpr_read_b32 v233, a67
    v_mul_f32 v230, v230, v229
    v_mul_f32 v231, v231, v229
    v_mul_f32 v232, v232, v229
    v_mul_f32 v233, v233, v229
    v_accvgpr_write_b32 a64, v230
    v_accvgpr_write_b32 a65, v231
    v_accvgpr_write_b32 a66, v232
    v_accvgpr_write_b32 a67, v233
    v_accvgpr_read_b32 v230, a84
    v_accvgpr_read_b32 v231, a85
    v_accvgpr_read_b32 v232, a86
    v_accvgpr_read_b32 v233, a87
    v_mul_f32 v230, v230, v229
    v_mul_f32 v231, v231, v229
    v_mul_f32 v232, v232, v229
    v_mul_f32 v233, v233, v229
    v_accvgpr_write_b32 a84, v230
    v_accvgpr_write_b32 a85, v231
    v_accvgpr_write_b32 a86, v232
    v_accvgpr_write_b32 a87, v233
    v_accvgpr_read_b32 v230, a104
    v_accvgpr_read_b32 v231, a105
    v_accvgpr_read_b32 v232, a106
    v_accvgpr_read_b32 v233, a107
    v_mul_f32 v230, v230, v229
    v_mul_f32 v231, v231, v229
    v_mul_f32 v232, v232, v229
    v_mul_f32 v233, v233, v229
    v_accvgpr_write_b32 a104, v230
    v_accvgpr_write_b32 a105, v231
    v_accvgpr_write_b32 a106, v232
    v_accvgpr_write_b32 a107, v233
    v_accvgpr_read_b32 v230, a124
    v_accvgpr_read_b32 v231, a125
    v_accvgpr_read_b32 v232, a126
    v_accvgpr_read_b32 v233, a127
    v_mul_f32 v230, v230, v229
    v_mul_f32 v231, v231, v229
    v_mul_f32 v232, v232, v229
    v_mul_f32 v233, v233, v229
    v_accvgpr_write_b32 a124, v230
    v_accvgpr_write_b32 a125, v231
    v_accvgpr_write_b32 a126, v232
    v_accvgpr_write_b32 a127, v233
    v_accvgpr_read_b32 v230, a144
    v_accvgpr_read_b32 v231, a145
    v_accvgpr_read_b32 v232, a146
    v_accvgpr_read_b32 v233, a147
    v_mul_f32 v230, v230, v229
    v_mul_f32 v231, v231, v229
    v_mul_f32 v232, v232, v229
    v_mul_f32 v233, v233, v229
    v_accvgpr_write_b32 a144, v230
    v_accvgpr_write_b32 a145, v231
    v_accvgpr_write_b32 a146, v232
    v_accvgpr_write_b32 a147, v233
    v_max3_f32 v228, v80, v81, v82
    v_max3_f32 v228, v228, v83, v100
    v_max3_f32 v228, v228, v101, v102
    v_max_f32 v228, v228, v103
    v_mov_b32 v229, v228
    s_nop 1
    v_permlane32_swap_b32 v228, v229
    s_nop 1
    v_max_f32 v228, v228, v229
    v_mov_b32 v229, v228
    s_nop 1
    v_permlane16_swap_b32 v228, v229
    s_nop 1
    v_max_f32 v228, v228, v229
    v_max_f32 v228, s51, v228
    v_sub_f32 v229, 0, v228
    v_exp_f32 v229, v229
    v_add_f32 v223, v223, v228
    v_sub_f32 v204, v204, v228
    v_sub_f32 v80, v80, v228
    v_sub_f32 v100, v100, v228
    v_sub_f32 v205, v205, v228
    v_sub_f32 v81, v81, v228
    v_sub_f32 v101, v101, v228
    v_sub_f32 v206, v206, v228
    v_sub_f32 v82, v82, v228
    v_sub_f32 v102, v102, v228
    v_sub_f32 v207, v207, v228
    v_sub_f32 v83, v83, v228
    v_sub_f32 v103, v103, v228
    v_mul_f32 v218, v218, v229
    v_accvgpr_read_b32 v230, a8
    v_accvgpr_read_b32 v231, a9
    v_accvgpr_read_b32 v232, a10
    v_accvgpr_read_b32 v233, a11
    v_mul_f32 v230, v230, v229
    v_mul_f32 v231, v231, v229
    v_mul_f32 v232, v232, v229
    v_mul_f32 v233, v233, v229
    v_accvgpr_write_b32 a8, v230
    v_accvgpr_write_b32 a9, v231
    v_accvgpr_write_b32 a10, v232
    v_accvgpr_write_b32 a11, v233
    v_accvgpr_read_b32 v230, a28
    v_accvgpr_read_b32 v231, a29
    v_accvgpr_read_b32 v232, a30
    v_accvgpr_read_b32 v233, a31
    v_mul_f32 v230, v230, v229
    v_mul_f32 v231, v231, v229
    v_mul_f32 v232, v232, v229
    v_mul_f32 v233, v233, v229
    v_accvgpr_write_b32 a28, v230
    v_accvgpr_write_b32 a29, v231
    v_accvgpr_write_b32 a30, v232
    v_accvgpr_write_b32 a31, v233
    v_accvgpr_read_b32 v230, a48
    v_accvgpr_read_b32 v231, a49
    v_accvgpr_read_b32 v232, a50
    v_accvgpr_read_b32 v233, a51
    v_mul_f32 v230, v230, v229
    v_mul_f32 v231, v231, v229
    v_mul_f32 v232, v232, v229
    v_mul_f32 v233, v233, v229
    v_accvgpr_write_b32 a48, v230
    v_accvgpr_write_b32 a49, v231
    v_accvgpr_write_b32 a50, v232
    v_accvgpr_write_b32 a51, v233
    v_accvgpr_read_b32 v230, a68
    v_accvgpr_read_b32 v231, a69
    v_accvgpr_read_b32 v232, a70
    v_accvgpr_read_b32 v233, a71
    v_mul_f32 v230, v230, v229
    v_mul_f32 v231, v231, v229
    v_mul_f32 v232, v232, v229
    v_mul_f32 v233, v233, v229
    v_accvgpr_write_b32 a68, v230
    v_accvgpr_write_b32 a69, v231
    v_accvgpr_write_b32 a70, v232
    v_accvgpr_write_b32 a71, v233
    v_accvgpr_read_b32 v230, a88
    v_accvgpr_read_b32 v231, a89
    v_accvgpr_read_b32 v232, a90
    v_accvgpr_read_b32 v233, a91
    v_mul_f32 v230, v230, v229
    v_mul_f32 v231, v231, v229
    v_mul_f32 v232, v232, v229
    v_mul_f32 v233, v233, v229
    v_accvgpr_write_b32 a88, v230
    v_accvgpr_write_b32 a89, v231
    v_accvgpr_write_b32 a90, v232
    v_accvgpr_write_b32 a91, v233
    v_accvgpr_read_b32 v230, a108
    v_accvgpr_read_b32 v231, a109
    v_accvgpr_read_b32 v232, a110
    v_accvgpr_read_b32 v233, a111
    v_mul_f32 v230, v230, v229
    v_mul_f32 v231, v231, v229
    v_mul_f32 v232, v232, v229
    v_mul_f32 v233, v233, v229
    v_accvgpr_write_b32 a108, v230
    v_accvgpr_write_b32 a109, v231
    v_accvgpr_write_b32 a110, v232
    v_accvgpr_write_b32 a111, v233
    v_accvgpr_read_b32 v230, a128
    v_accvgpr_read_b32 v231, a129
    v_accvgpr_read_b32 v232, a130
    v_accvgpr_read_b32 v233, a131
    v_mul_f32 v230, v230, v229
    v_mul_f32 v231, v231, v229
    v_mul_f32 v232, v232, v229
    v_mul_f32 v233, v233, v229
    v_accvgpr_write_b32 a128, v230
    v_accvgpr_write_b32 a129, v231
    v_accvgpr_write_b32 a130, v232
    v_accvgpr_write_b32 a131, v233
    v_accvgpr_read_b32 v230, a148
    v_accvgpr_read_b32 v231, a149
    v_accvgpr_read_b32 v232, a150
    v_accvgpr_read_b32 v233, a151
    v_mul_f32 v230, v230, v229
    v_mul_f32 v231, v231, v229
    v_mul_f32 v232, v232, v229
    v_mul_f32 v233, v233, v229
    v_accvgpr_write_b32 a148, v230
    v_accvgpr_write_b32 a149, v231
    v_accvgpr_write_b32 a150, v232
    v_accvgpr_write_b32 a151, v233
    v_max3_f32 v228, v84, v85, v86
    v_max3_f32 v228, v228, v87, v104
    v_max3_f32 v228, v228, v105, v106
    v_max_f32 v228, v228, v107
    v_mov_b32 v229, v228
    s_nop 1
    v_permlane32_swap_b32 v228, v229
    s_nop 1
    v_max_f32 v228, v228, v229
    v_mov_b32 v229, v228
    s_nop 1
    v_permlane16_swap_b32 v228, v229
    s_nop 1
    v_max_f32 v228, v228, v229
    v_max_f32 v228, s51, v228
    v_sub_f32 v229, 0, v228
    v_exp_f32 v229, v229
    v_add_f32 v224, v224, v228
    v_sub_f32 v208, v208, v228
    v_sub_f32 v84, v84, v228
    v_sub_f32 v104, v104, v228
    v_sub_f32 v209, v209, v228
    v_sub_f32 v85, v85, v228
    v_sub_f32 v105, v105, v228
    v_sub_f32 v210, v210, v228
    v_sub_f32 v86, v86, v228
    v_sub_f32 v106, v106, v228
    v_sub_f32 v211, v211, v228
    v_sub_f32 v87, v87, v228
    v_sub_f32 v107, v107, v228
    v_mul_f32 v219, v219, v229
    v_accvgpr_read_b32 v230, a12
    v_accvgpr_read_b32 v231, a13
    v_accvgpr_read_b32 v232, a14
    v_accvgpr_read_b32 v233, a15
    v_mul_f32 v230, v230, v229
    v_mul_f32 v231, v231, v229
    v_mul_f32 v232, v232, v229
    v_mul_f32 v233, v233, v229
    v_accvgpr_write_b32 a12, v230
    v_accvgpr_write_b32 a13, v231
    v_accvgpr_write_b32 a14, v232
    v_accvgpr_write_b32 a15, v233
    v_accvgpr_read_b32 v230, a32
    v_accvgpr_read_b32 v231, a33
    v_accvgpr_read_b32 v232, a34
    v_accvgpr_read_b32 v233, a35
    v_mul_f32 v230, v230, v229
    v_mul_f32 v231, v231, v229
    v_mul_f32 v232, v232, v229
    v_mul_f32 v233, v233, v229
    v_accvgpr_write_b32 a32, v230
    v_accvgpr_write_b32 a33, v231
    v_accvgpr_write_b32 a34, v232
    v_accvgpr_write_b32 a35, v233
    v_accvgpr_read_b32 v230, a52
    v_accvgpr_read_b32 v231, a53
    v_accvgpr_read_b32 v232, a54
    v_accvgpr_read_b32 v233, a55
    v_mul_f32 v230, v230, v229
    v_mul_f32 v231, v231, v229
    v_mul_f32 v232, v232, v229
    v_mul_f32 v233, v233, v229
    v_accvgpr_write_b32 a52, v230
    v_accvgpr_write_b32 a53, v231
    v_accvgpr_write_b32 a54, v232
    v_accvgpr_write_b32 a55, v233
    v_accvgpr_read_b32 v230, a72
    v_accvgpr_read_b32 v231, a73
    v_accvgpr_read_b32 v232, a74
    v_accvgpr_read_b32 v233, a75
    v_mul_f32 v230, v230, v229
    v_mul_f32 v231, v231, v229
    v_mul_f32 v232, v232, v229
    v_mul_f32 v233, v233, v229
    v_accvgpr_write_b32 a72, v230
    v_accvgpr_write_b32 a73, v231
    v_accvgpr_write_b32 a74, v232
    v_accvgpr_write_b32 a75, v233
    v_accvgpr_read_b32 v230, a92
    v_accvgpr_read_b32 v231, a93
    v_accvgpr_read_b32 v232, a94
    v_accvgpr_read_b32 v233, a95
    v_mul_f32 v230, v230, v229
    v_mul_f32 v231, v231, v229
    v_mul_f32 v232, v232, v229
    v_mul_f32 v233, v233, v229
    v_accvgpr_write_b32 a92, v230
    v_accvgpr_write_b32 a93, v231
    v_accvgpr_write_b32 a94, v232
    v_accvgpr_write_b32 a95, v233
    v_accvgpr_read_b32 v230, a112
    v_accvgpr_read_b32 v231, a113
    v_accvgpr_read_b32 v232, a114
    v_accvgpr_read_b32 v233, a115
    v_mul_f32 v230, v230, v229
    v_mul_f32 v231, v231, v229
    v_mul_f32 v232, v232, v229
    v_mul_f32 v233, v233, v229
    v_accvgpr_write_b32 a112, v230
    v_accvgpr_write_b32 a113, v231
    v_accvgpr_write_b32 a114, v232
    v_accvgpr_write_b32 a115, v233
    v_accvgpr_read_b32 v230, a132
    v_accvgpr_read_b32 v231, a133
    v_accvgpr_read_b32 v232, a134
    v_accvgpr_read_b32 v233, a135
    v_mul_f32 v230, v230, v229
    v_mul_f32 v231, v231, v229
    v_mul_f32 v232, v232, v229
    v_mul_f32 v233, v233, v229
    v_accvgpr_write_b32 a132, v230
    v_accvgpr_write_b32 a133, v231
    v_accvgpr_write_b32 a134, v232
    v_accvgpr_write_b32 a135, v233
    v_accvgpr_read_b32 v230, a152
    v_accvgpr_read_b32 v231, a153
    v_accvgpr_read_b32 v232, a154
    v_accvgpr_read_b32 v233, a155
    v_mul_f32 v230, v230, v229
    v_mul_f32 v231, v231, v229
    v_mul_f32 v232, v232, v229
    v_mul_f32 v233, v233, v229
    v_accvgpr_write_b32 a152, v230
    v_accvgpr_write_b32 a153, v231
    v_accvgpr_write_b32 a154, v232
    v_accvgpr_write_b32 a155, v233
    v_max3_f32 v228, v88, v89, v90
    v_max3_f32 v228, v228, v91, v108
    v_max3_f32 v228, v228, v109, v110
    v_max_f32 v228, v228, v111
    v_mov_b32 v229, v228
    s_nop 1
    v_permlane32_swap_b32 v228, v229
    s_nop 1
    v_max_f32 v228, v228, v229
    v_mov_b32 v229, v228
    s_nop 1
    v_permlane16_swap_b32 v228, v229
    s_nop 1
    v_max_f32 v228, v228, v229
    v_max_f32 v228, s51, v228
    v_sub_f32 v229, 0, v228
    v_exp_f32 v229, v229
    v_add_f32 v225, v225, v228
    v_sub_f32 v212, v212, v228
    v_sub_f32 v88, v88, v228
    v_sub_f32 v108, v108, v228
    v_sub_f32 v213, v213, v228
    v_sub_f32 v89, v89, v228
    v_sub_f32 v109, v109, v228
    v_sub_f32 v214, v214, v228
    v_sub_f32 v90, v90, v228
    v_sub_f32 v110, v110, v228
    v_sub_f32 v215, v215, v228
    v_sub_f32 v91, v91, v228
    v_sub_f32 v111, v111, v228
    v_mul_f32 v220, v220, v229
    v_accvgpr_read_b32 v230, a16
    v_accvgpr_read_b32 v231, a17
    v_accvgpr_read_b32 v232, a18
    v_accvgpr_read_b32 v233, a19
    v_mul_f32 v230, v230, v229
    v_mul_f32 v231, v231, v229
    v_mul_f32 v232, v232, v229
    v_mul_f32 v233, v233, v229
    v_accvgpr_write_b32 a16, v230
    v_accvgpr_write_b32 a17, v231
    v_accvgpr_write_b32 a18, v232
    v_accvgpr_write_b32 a19, v233
    v_accvgpr_read_b32 v230, a36
    v_accvgpr_read_b32 v231, a37
    v_accvgpr_read_b32 v232, a38
    v_accvgpr_read_b32 v233, a39
    v_mul_f32 v230, v230, v229
    v_mul_f32 v231, v231, v229
    v_mul_f32 v232, v232, v229
    v_mul_f32 v233, v233, v229
    v_accvgpr_write_b32 a36, v230
    v_accvgpr_write_b32 a37, v231
    v_accvgpr_write_b32 a38, v232
    v_accvgpr_write_b32 a39, v233
    v_accvgpr_read_b32 v230, a56
    v_accvgpr_read_b32 v231, a57
    v_accvgpr_read_b32 v232, a58
    v_accvgpr_read_b32 v233, a59
    v_mul_f32 v230, v230, v229
    v_mul_f32 v231, v231, v229
    v_mul_f32 v232, v232, v229
    v_mul_f32 v233, v233, v229
    v_accvgpr_write_b32 a56, v230
    v_accvgpr_write_b32 a57, v231
    v_accvgpr_write_b32 a58, v232
    v_accvgpr_write_b32 a59, v233
    v_accvgpr_read_b32 v230, a76
    v_accvgpr_read_b32 v231, a77
    v_accvgpr_read_b32 v232, a78
    v_accvgpr_read_b32 v233, a79
    v_mul_f32 v230, v230, v229
    v_mul_f32 v231, v231, v229
    v_mul_f32 v232, v232, v229
    v_mul_f32 v233, v233, v229
    v_accvgpr_write_b32 a76, v230
    v_accvgpr_write_b32 a77, v231
    v_accvgpr_write_b32 a78, v232
    v_accvgpr_write_b32 a79, v233
    v_accvgpr_read_b32 v230, a96
    v_accvgpr_read_b32 v231, a97
    v_accvgpr_read_b32 v232, a98
    v_accvgpr_read_b32 v233, a99
    v_mul_f32 v230, v230, v229
    v_mul_f32 v231, v231, v229
    v_mul_f32 v232, v232, v229
    v_mul_f32 v233, v233, v229
    v_accvgpr_write_b32 a96, v230
    v_accvgpr_write_b32 a97, v231
    v_accvgpr_write_b32 a98, v232
    v_accvgpr_write_b32 a99, v233
    v_accvgpr_read_b32 v230, a116
    v_accvgpr_read_b32 v231, a117
    v_accvgpr_read_b32 v232, a118
    v_accvgpr_read_b32 v233, a119
    v_mul_f32 v230, v230, v229
    v_mul_f32 v231, v231, v229
    v_mul_f32 v232, v232, v229
    v_mul_f32 v233, v233, v229
    v_accvgpr_write_b32 a116, v230
    v_accvgpr_write_b32 a117, v231
    v_accvgpr_write_b32 a118, v232
    v_accvgpr_write_b32 a119, v233
    v_accvgpr_read_b32 v230, a136
    v_accvgpr_read_b32 v231, a137
    v_accvgpr_read_b32 v232, a138
    v_accvgpr_read_b32 v233, a139
    v_mul_f32 v230, v230, v229
    v_mul_f32 v231, v231, v229
    v_mul_f32 v232, v232, v229
    v_mul_f32 v233, v233, v229
    v_accvgpr_write_b32 a136, v230
    v_accvgpr_write_b32 a137, v231
    v_accvgpr_write_b32 a138, v232
    v_accvgpr_write_b32 a139, v233
    v_accvgpr_read_b32 v230, a156
    v_accvgpr_read_b32 v231, a157
    v_accvgpr_read_b32 v232, a158
    v_accvgpr_read_b32 v233, a159
    v_mul_f32 v230, v230, v229
    v_mul_f32 v231, v231, v229
    v_mul_f32 v232, v232, v229
    v_mul_f32 v233, v233, v229
    v_accvgpr_write_b32 a156, v230
    v_accvgpr_write_b32 a157, v231
    v_accvgpr_write_b32 a158, v232
    v_accvgpr_write_b32 a159, v233
    s_mov_b32 s50, 0x41000000
    s_mov_b32 s51, 0
    s_nop 1
    s_branch k1_kernel_L26
k1_kernel_L28:
    s_nop 7
    v_max3_f32 v228, v32, v33, v34
    v_max3_f32 v228, v228, v35, v52
    v_max3_f32 v228, v228, v53, v54
    v_max_f32 v228, v228, v55
    v_mov_b32 v229, v228
    s_nop 1
    v_permlane32_swap_b32 v228, v229
    s_nop 1
    v_max_f32 v228, v228, v229
    v_mov_b32 v229, v228
    s_nop 1
    v_permlane16_swap_b32 v228, v229
    s_nop 1
    v_max_f32 v228, v228, v229
    v_max_f32 v228, s51, v228
    v_sub_f32 v229, 0, v228
    v_exp_f32 v229, v229
    v_add_f32 v221, v221, v228
    v_sub_f32 v196, v196, v228
    v_sub_f32 v32, v32, v228
    v_sub_f32 v52, v52, v228
    v_sub_f32 v197, v197, v228
    v_sub_f32 v33, v33, v228
    v_sub_f32 v53, v53, v228
    v_sub_f32 v198, v198, v228
    v_sub_f32 v34, v34, v228
    v_sub_f32 v54, v54, v228
    v_sub_f32 v199, v199, v228
    v_sub_f32 v35, v35, v228
    v_sub_f32 v55, v55, v228
    v_mul_f32 v216, v216, v229
    v_accvgpr_read_b32 v230, a0
    v_accvgpr_read_b32 v231, a1
    v_accvgpr_read_b32 v232, a2
    v_accvgpr_read_b32 v233, a3
    v_mul_f32 v230, v230, v229
    v_mul_f32 v231, v231, v229
    v_mul_f32 v232, v232, v229
    v_mul_f32 v233, v233, v229
    v_accvgpr_write_b32 a0, v230
    v_accvgpr_write_b32 a1, v231
    v_accvgpr_write_b32 a2, v232
    v_accvgpr_write_b32 a3, v233
    v_accvgpr_read_b32 v230, a20
    v_accvgpr_read_b32 v231, a21
    v_accvgpr_read_b32 v232, a22
    v_accvgpr_read_b32 v233, a23
    v_mul_f32 v230, v230, v229
    v_mul_f32 v231, v231, v229
    v_mul_f32 v232, v232, v229
    v_mul_f32 v233, v233, v229
    v_accvgpr_write_b32 a20, v230
    v_accvgpr_write_b32 a21, v231
    v_accvgpr_write_b32 a22, v232
    v_accvgpr_write_b32 a23, v233
    v_accvgpr_read_b32 v230, a40
    v_accvgpr_read_b32 v231, a41
    v_accvgpr_read_b32 v232, a42
    v_accvgpr_read_b32 v233, a43
    v_mul_f32 v230, v230, v229
    v_mul_f32 v231, v231, v229
    v_mul_f32 v232, v232, v229
    v_mul_f32 v233, v233, v229
    v_accvgpr_write_b32 a40, v230
    v_accvgpr_write_b32 a41, v231
    v_accvgpr_write_b32 a42, v232
    v_accvgpr_write_b32 a43, v233
    v_accvgpr_read_b32 v230, a60
    v_accvgpr_read_b32 v231, a61
    v_accvgpr_read_b32 v232, a62
    v_accvgpr_read_b32 v233, a63
    v_mul_f32 v230, v230, v229
    v_mul_f32 v231, v231, v229
    v_mul_f32 v232, v232, v229
    v_mul_f32 v233, v233, v229
    v_accvgpr_write_b32 a60, v230
    v_accvgpr_write_b32 a61, v231
    v_accvgpr_write_b32 a62, v232
    v_accvgpr_write_b32 a63, v233
    v_accvgpr_read_b32 v230, a80
    v_accvgpr_read_b32 v231, a81
    v_accvgpr_read_b32 v232, a82
    v_accvgpr_read_b32 v233, a83
    v_mul_f32 v230, v230, v229
    v_mul_f32 v231, v231, v229
    v_mul_f32 v232, v232, v229
    v_mul_f32 v233, v233, v229
    v_accvgpr_write_b32 a80, v230
    v_accvgpr_write_b32 a81, v231
    v_accvgpr_write_b32 a82, v232
    v_accvgpr_write_b32 a83, v233
    v_accvgpr_read_b32 v230, a100
    v_accvgpr_read_b32 v231, a101
    v_accvgpr_read_b32 v232, a102
    v_accvgpr_read_b32 v233, a103
    v_mul_f32 v230, v230, v229
    v_mul_f32 v231, v231, v229
    v_mul_f32 v232, v232, v229
    v_mul_f32 v233, v233, v229
    v_accvgpr_write_b32 a100, v230
    v_accvgpr_write_b32 a101, v231
    v_accvgpr_write_b32 a102, v232
    v_accvgpr_write_b32 a103, v233
    v_accvgpr_read_b32 v230, a120
    v_accvgpr_read_b32 v231, a121
    v_accvgpr_read_b32 v232, a122
    v_accvgpr_read_b32 v233, a123
    v_mul_f32 v230, v230, v229
    v_mul_f32 v231, v231, v229
    v_mul_f32 v232, v232, v229
    v_mul_f32 v233, v233, v229
    v_accvgpr_write_b32 a120, v230
    v_accvgpr_write_b32 a121, v231
    v_accvgpr_write_b32 a122, v232
    v_accvgpr_write_b32 a123, v233
    v_accvgpr_read_b32 v230, a140
    v_accvgpr_read_b32 v231, a141
    v_accvgpr_read_b32 v232, a142
    v_accvgpr_read_b32 v233, a143
    v_mul_f32 v230, v230, v229
    v_mul_f32 v231, v231, v229
    v_mul_f32 v232, v232, v229
    v_mul_f32 v233, v233, v229
    v_accvgpr_write_b32 a140, v230
    v_accvgpr_write_b32 a141, v231
    v_accvgpr_write_b32 a142, v232
    v_accvgpr_write_b32 a143, v233
    v_max3_f32 v228, v36, v37, v38
    v_max3_f32 v228, v228, v39, v56
    v_max3_f32 v228, v228, v57, v58
    v_max_f32 v228, v228, v59
    v_mov_b32 v229, v228
    s_nop 1
    v_permlane32_swap_b32 v228, v229
    s_nop 1
    v_max_f32 v228, v228, v229
    v_mov_b32 v229, v228
    s_nop 1
    v_permlane16_swap_b32 v228, v229
    s_nop 1
    v_max_f32 v228, v228, v229
    v_max_f32 v228, s51, v228
    v_sub_f32 v229, 0, v228
    v_exp_f32 v229, v229
    v_add_f32 v222, v222, v228
    v_sub_f32 v200, v200, v228
    v_sub_f32 v36, v36, v228
    v_sub_f32 v56, v56, v228
    v_sub_f32 v201, v201, v228
    v_sub_f32 v37, v37, v228
    v_sub_f32 v57, v57, v228
    v_sub_f32 v202, v202, v228
    v_sub_f32 v38, v38, v228
    v_sub_f32 v58, v58, v228
    v_sub_f32 v203, v203, v228
    v_sub_f32 v39, v39, v228
    v_sub_f32 v59, v59, v228
    v_mul_f32 v217, v217, v229
    v_accvgpr_read_b32 v230, a4
    v_accvgpr_read_b32 v231, a5
    v_accvgpr_read_b32 v232, a6
    v_accvgpr_read_b32 v233, a7
    v_mul_f32 v230, v230, v229
    v_mul_f32 v231, v231, v229
    v_mul_f32 v232, v232, v229
    v_mul_f32 v233, v233, v229
    v_accvgpr_write_b32 a4, v230
    v_accvgpr_write_b32 a5, v231
    v_accvgpr_write_b32 a6, v232
    v_accvgpr_write_b32 a7, v233
    v_accvgpr_read_b32 v230, a24
    v_accvgpr_read_b32 v231, a25
    v_accvgpr_read_b32 v232, a26
    v_accvgpr_read_b32 v233, a27
    v_mul_f32 v230, v230, v229
    v_mul_f32 v231, v231, v229
    v_mul_f32 v232, v232, v229
    v_mul_f32 v233, v233, v229
    v_accvgpr_write_b32 a24, v230
    v_accvgpr_write_b32 a25, v231
    v_accvgpr_write_b32 a26, v232
    v_accvgpr_write_b32 a27, v233
    v_accvgpr_read_b32 v230, a44
    v_accvgpr_read_b32 v231, a45
    v_accvgpr_read_b32 v232, a46
    v_accvgpr_read_b32 v233, a47
    v_mul_f32 v230, v230, v229
    v_mul_f32 v231, v231, v229
    v_mul_f32 v232, v232, v229
    v_mul_f32 v233, v233, v229
    v_accvgpr_write_b32 a44, v230
    v_accvgpr_write_b32 a45, v231
    v_accvgpr_write_b32 a46, v232
    v_accvgpr_write_b32 a47, v233
    v_accvgpr_read_b32 v230, a64
    v_accvgpr_read_b32 v231, a65
    v_accvgpr_read_b32 v232, a66
    v_accvgpr_read_b32 v233, a67
    v_mul_f32 v230, v230, v229
    v_mul_f32 v231, v231, v229
    v_mul_f32 v232, v232, v229
    v_mul_f32 v233, v233, v229
    v_accvgpr_write_b32 a64, v230
    v_accvgpr_write_b32 a65, v231
    v_accvgpr_write_b32 a66, v232
    v_accvgpr_write_b32 a67, v233
    v_accvgpr_read_b32 v230, a84
    v_accvgpr_read_b32 v231, a85
    v_accvgpr_read_b32 v232, a86
    v_accvgpr_read_b32 v233, a87
    v_mul_f32 v230, v230, v229
    v_mul_f32 v231, v231, v229
    v_mul_f32 v232, v232, v229
    v_mul_f32 v233, v233, v229
    v_accvgpr_write_b32 a84, v230
    v_accvgpr_write_b32 a85, v231
    v_accvgpr_write_b32 a86, v232
    v_accvgpr_write_b32 a87, v233
    v_accvgpr_read_b32 v230, a104
    v_accvgpr_read_b32 v231, a105
    v_accvgpr_read_b32 v232, a106
    v_accvgpr_read_b32 v233, a107
    v_mul_f32 v230, v230, v229
    v_mul_f32 v231, v231, v229
    v_mul_f32 v232, v232, v229
    v_mul_f32 v233, v233, v229
    v_accvgpr_write_b32 a104, v230
    v_accvgpr_write_b32 a105, v231
    v_accvgpr_write_b32 a106, v232
    v_accvgpr_write_b32 a107, v233
    v_accvgpr_read_b32 v230, a124
    v_accvgpr_read_b32 v231, a125
    v_accvgpr_read_b32 v232, a126
    v_accvgpr_read_b32 v233, a127
    v_mul_f32 v230, v230, v229
    v_mul_f32 v231, v231, v229
    v_mul_f32 v232, v232, v229
    v_mul_f32 v233, v233, v229
    v_accvgpr_write_b32 a124, v230
    v_accvgpr_write_b32 a125, v231
    v_accvgpr_write_b32 a126, v232
    v_accvgpr_write_b32 a127, v233
    v_accvgpr_read_b32 v230, a144
    v_accvgpr_read_b32 v231, a145
    v_accvgpr_read_b32 v232, a146
    v_accvgpr_read_b32 v233, a147
    v_mul_f32 v230, v230, v229
    v_mul_f32 v231, v231, v229
    v_mul_f32 v232, v232, v229
    v_mul_f32 v233, v233, v229
    v_accvgpr_write_b32 a144, v230
    v_accvgpr_write_b32 a145, v231
    v_accvgpr_write_b32 a146, v232
    v_accvgpr_write_b32 a147, v233
    v_max3_f32 v228, v40, v41, v42
    v_max3_f32 v228, v228, v43, v60
    v_max3_f32 v228, v228, v61, v62
    v_max_f32 v228, v228, v63
    v_mov_b32 v229, v228
    s_nop 1
    v_permlane32_swap_b32 v228, v229
    s_nop 1
    v_max_f32 v228, v228, v229
    v_mov_b32 v229, v228
    s_nop 1
    v_permlane16_swap_b32 v228, v229
    s_nop 1
    v_max_f32 v228, v228, v229
    v_max_f32 v228, s51, v228
    v_sub_f32 v229, 0, v228
    v_exp_f32 v229, v229
    v_add_f32 v223, v223, v228
    v_sub_f32 v204, v204, v228
    v_sub_f32 v40, v40, v228
    v_sub_f32 v60, v60, v228
    v_sub_f32 v205, v205, v228
    v_sub_f32 v41, v41, v228
    v_sub_f32 v61, v61, v228
    v_sub_f32 v206, v206, v228
    v_sub_f32 v42, v42, v228
    v_sub_f32 v62, v62, v228
    v_sub_f32 v207, v207, v228
    v_sub_f32 v43, v43, v228
    v_sub_f32 v63, v63, v228
    v_mul_f32 v218, v218, v229
    v_accvgpr_read_b32 v230, a8
    v_accvgpr_read_b32 v231, a9
    v_accvgpr_read_b32 v232, a10
    v_accvgpr_read_b32 v233, a11
    v_mul_f32 v230, v230, v229
    v_mul_f32 v231, v231, v229
    v_mul_f32 v232, v232, v229
    v_mul_f32 v233, v233, v229
    v_accvgpr_write_b32 a8, v230
    v_accvgpr_write_b32 a9, v231
    v_accvgpr_write_b32 a10, v232
    v_accvgpr_write_b32 a11, v233
    v_accvgpr_read_b32 v230, a28
    v_accvgpr_read_b32 v231, a29
    v_accvgpr_read_b32 v232, a30
    v_accvgpr_read_b32 v233, a31
    v_mul_f32 v230, v230, v229
    v_mul_f32 v231, v231, v229
    v_mul_f32 v232, v232, v229
    v_mul_f32 v233, v233, v229
    v_accvgpr_write_b32 a28, v230
    v_accvgpr_write_b32 a29, v231
    v_accvgpr_write_b32 a30, v232
    v_accvgpr_write_b32 a31, v233
    v_accvgpr_read_b32 v230, a48
    v_accvgpr_read_b32 v231, a49
    v_accvgpr_read_b32 v232, a50
    v_accvgpr_read_b32 v233, a51
    v_mul_f32 v230, v230, v229
    v_mul_f32 v231, v231, v229
    v_mul_f32 v232, v232, v229
    v_mul_f32 v233, v233, v229
    v_accvgpr_write_b32 a48, v230
    v_accvgpr_write_b32 a49, v231
    v_accvgpr_write_b32 a50, v232
    v_accvgpr_write_b32 a51, v233
    v_accvgpr_read_b32 v230, a68
    v_accvgpr_read_b32 v231, a69
    v_accvgpr_read_b32 v232, a70
    v_accvgpr_read_b32 v233, a71
    v_mul_f32 v230, v230, v229
    v_mul_f32 v231, v231, v229
    v_mul_f32 v232, v232, v229
    v_mul_f32 v233, v233, v229
    v_accvgpr_write_b32 a68, v230
    v_accvgpr_write_b32 a69, v231
    v_accvgpr_write_b32 a70, v232
    v_accvgpr_write_b32 a71, v233
    v_accvgpr_read_b32 v230, a88
    v_accvgpr_read_b32 v231, a89
    v_accvgpr_read_b32 v232, a90
    v_accvgpr_read_b32 v233, a91
    v_mul_f32 v230, v230, v229
    v_mul_f32 v231, v231, v229
    v_mul_f32 v232, v232, v229
    v_mul_f32 v233, v233, v229
    v_accvgpr_write_b32 a88, v230
    v_accvgpr_write_b32 a89, v231
    v_accvgpr_write_b32 a90, v232
    v_accvgpr_write_b32 a91, v233
    v_accvgpr_read_b32 v230, a108
    v_accvgpr_read_b32 v231, a109
    v_accvgpr_read_b32 v232, a110
    v_accvgpr_read_b32 v233, a111
    v_mul_f32 v230, v230, v229
    v_mul_f32 v231, v231, v229
    v_mul_f32 v232, v232, v229
    v_mul_f32 v233, v233, v229
    v_accvgpr_write_b32 a108, v230
    v_accvgpr_write_b32 a109, v231
    v_accvgpr_write_b32 a110, v232
    v_accvgpr_write_b32 a111, v233
    v_accvgpr_read_b32 v230, a128
    v_accvgpr_read_b32 v231, a129
    v_accvgpr_read_b32 v232, a130
    v_accvgpr_read_b32 v233, a131
    v_mul_f32 v230, v230, v229
    v_mul_f32 v231, v231, v229
    v_mul_f32 v232, v232, v229
    v_mul_f32 v233, v233, v229
    v_accvgpr_write_b32 a128, v230
    v_accvgpr_write_b32 a129, v231
    v_accvgpr_write_b32 a130, v232
    v_accvgpr_write_b32 a131, v233
    v_accvgpr_read_b32 v230, a148
    v_accvgpr_read_b32 v231, a149
    v_accvgpr_read_b32 v232, a150
    v_accvgpr_read_b32 v233, a151
    v_mul_f32 v230, v230, v229
    v_mul_f32 v231, v231, v229
    v_mul_f32 v232, v232, v229
    v_mul_f32 v233, v233, v229
    v_accvgpr_write_b32 a148, v230
    v_accvgpr_write_b32 a149, v231
    v_accvgpr_write_b32 a150, v232
    v_accvgpr_write_b32 a151, v233
    v_max3_f32 v228, v44, v45, v46
    v_max3_f32 v228, v228, v47, v64
    v_max3_f32 v228, v228, v65, v66
    v_max_f32 v228, v228, v67
    v_mov_b32 v229, v228
    s_nop 1
    v_permlane32_swap_b32 v228, v229
    s_nop 1
    v_max_f32 v228, v228, v229
    v_mov_b32 v229, v228
    s_nop 1
    v_permlane16_swap_b32 v228, v229
    s_nop 1
    v_max_f32 v228, v228, v229
    v_max_f32 v228, s51, v228
    v_sub_f32 v229, 0, v228
    v_exp_f32 v229, v229
    v_add_f32 v224, v224, v228
    v_sub_f32 v208, v208, v228
    v_sub_f32 v44, v44, v228
    v_sub_f32 v64, v64, v228
    v_sub_f32 v209, v209, v228
    v_sub_f32 v45, v45, v228
    v_sub_f32 v65, v65, v228
    v_sub_f32 v210, v210, v228
    v_sub_f32 v46, v46, v228
    v_sub_f32 v66, v66, v228
    v_sub_f32 v211, v211, v228
    v_sub_f32 v47, v47, v228
    v_sub_f32 v67, v67, v228
    v_mul_f32 v219, v219, v229
    v_accvgpr_read_b32 v230, a12
    v_accvgpr_read_b32 v231, a13
    v_accvgpr_read_b32 v232, a14
    v_accvgpr_read_b32 v233, a15
    v_mul_f32 v230, v230, v229
    v_mul_f32 v231, v231, v229
    v_mul_f32 v232, v232, v229
    v_mul_f32 v233, v233, v229
    v_accvgpr_write_b32 a12, v230
    v_accvgpr_write_b32 a13, v231
    v_accvgpr_write_b32 a14, v232
    v_accvgpr_write_b32 a15, v233
    v_accvgpr_read_b32 v230, a32
    v_accvgpr_read_b32 v231, a33
    v_accvgpr_read_b32 v232, a34
    v_accvgpr_read_b32 v233, a35
    v_mul_f32 v230, v230, v229
    v_mul_f32 v231, v231, v229
    v_mul_f32 v232, v232, v229
    v_mul_f32 v233, v233, v229
    v_accvgpr_write_b32 a32, v230
    v_accvgpr_write_b32 a33, v231
    v_accvgpr_write_b32 a34, v232
    v_accvgpr_write_b32 a35, v233
    v_accvgpr_read_b32 v230, a52
    v_accvgpr_read_b32 v231, a53
    v_accvgpr_read_b32 v232, a54
    v_accvgpr_read_b32 v233, a55
    v_mul_f32 v230, v230, v229
    v_mul_f32 v231, v231, v229
    v_mul_f32 v232, v232, v229
    v_mul_f32 v233, v233, v229
    v_accvgpr_write_b32 a52, v230
    v_accvgpr_write_b32 a53, v231
    v_accvgpr_write_b32 a54, v232
    v_accvgpr_write_b32 a55, v233
    v_accvgpr_read_b32 v230, a72
    v_accvgpr_read_b32 v231, a73
    v_accvgpr_read_b32 v232, a74
    v_accvgpr_read_b32 v233, a75
    v_mul_f32 v230, v230, v229
    v_mul_f32 v231, v231, v229
    v_mul_f32 v232, v232, v229
    v_mul_f32 v233, v233, v229
    v_accvgpr_write_b32 a72, v230
    v_accvgpr_write_b32 a73, v231
    v_accvgpr_write_b32 a74, v232
    v_accvgpr_write_b32 a75, v233
    v_accvgpr_read_b32 v230, a92
    v_accvgpr_read_b32 v231, a93
    v_accvgpr_read_b32 v232, a94
    v_accvgpr_read_b32 v233, a95
    v_mul_f32 v230, v230, v229
    v_mul_f32 v231, v231, v229
    v_mul_f32 v232, v232, v229
    v_mul_f32 v233, v233, v229
    v_accvgpr_write_b32 a92, v230
    v_accvgpr_write_b32 a93, v231
    v_accvgpr_write_b32 a94, v232
    v_accvgpr_write_b32 a95, v233
    v_accvgpr_read_b32 v230, a112
    v_accvgpr_read_b32 v231, a113
    v_accvgpr_read_b32 v232, a114
    v_accvgpr_read_b32 v233, a115
    v_mul_f32 v230, v230, v229
    v_mul_f32 v231, v231, v229
    v_mul_f32 v232, v232, v229
    v_mul_f32 v233, v233, v229
    v_accvgpr_write_b32 a112, v230
    v_accvgpr_write_b32 a113, v231
    v_accvgpr_write_b32 a114, v232
    v_accvgpr_write_b32 a115, v233
    v_accvgpr_read_b32 v230, a132
    v_accvgpr_read_b32 v231, a133
    v_accvgpr_read_b32 v232, a134
    v_accvgpr_read_b32 v233, a135
    v_mul_f32 v230, v230, v229
    v_mul_f32 v231, v231, v229
    v_mul_f32 v232, v232, v229
    v_mul_f32 v233, v233, v229
    v_accvgpr_write_b32 a132, v230
    v_accvgpr_write_b32 a133, v231
    v_accvgpr_write_b32 a134, v232
    v_accvgpr_write_b32 a135, v233
    v_accvgpr_read_b32 v230, a152
    v_accvgpr_read_b32 v231, a153
    v_accvgpr_read_b32 v232, a154
    v_accvgpr_read_b32 v233, a155
    v_mul_f32 v230, v230, v229
    v_mul_f32 v231, v231, v229
    v_mul_f32 v232, v232, v229
    v_mul_f32 v233, v233, v229
    v_accvgpr_write_b32 a152, v230
    v_accvgpr_write_b32 a153, v231
    v_accvgpr_write_b32 a154, v232
    v_accvgpr_write_b32 a155, v233
    v_max3_f32 v228, v48, v49, v50
    v_max3_f32 v228, v228, v51, v68
    v_max3_f32 v228, v228, v69, v70
    v_max_f32 v228, v228, v71
    v_mov_b32 v229, v228
    s_nop 1
    v_permlane32_swap_b32 v228, v229
    s_nop 1
    v_max_f32 v228, v228, v229
    v_mov_b32 v229, v228
    s_nop 1
    v_permlane16_swap_b32 v228, v229
    s_nop 1
    v_max_f32 v228, v228, v229
    v_max_f32 v228, s51, v228
    v_sub_f32 v229, 0, v228
    v_exp_f32 v229, v229
    v_add_f32 v225, v225, v228
    v_sub_f32 v212, v212, v228
    v_sub_f32 v48, v48, v228
    v_sub_f32 v68, v68, v228
    v_sub_f32 v213, v213, v228
    v_sub_f32 v49, v49, v228
    v_sub_f32 v69, v69, v228
    v_sub_f32 v214, v214, v228
    v_sub_f32 v50, v50, v228
    v_sub_f32 v70, v70, v228
    v_sub_f32 v215, v215, v228
    v_sub_f32 v51, v51, v228
    v_sub_f32 v71, v71, v228
    v_mul_f32 v220, v220, v229
    v_accvgpr_read_b32 v230, a16
    v_accvgpr_read_b32 v231, a17
    v_accvgpr_read_b32 v232, a18
    v_accvgpr_read_b32 v233, a19
    v_mul_f32 v230, v230, v229
    v_mul_f32 v231, v231, v229
    v_mul_f32 v232, v232, v229
    v_mul_f32 v233, v233, v229
    v_accvgpr_write_b32 a16, v230
    v_accvgpr_write_b32 a17, v231
    v_accvgpr_write_b32 a18, v232
    v_accvgpr_write_b32 a19, v233
    v_accvgpr_read_b32 v230, a36
    v_accvgpr_read_b32 v231, a37
    v_accvgpr_read_b32 v232, a38
    v_accvgpr_read_b32 v233, a39
    v_mul_f32 v230, v230, v229
    v_mul_f32 v231, v231, v229
    v_mul_f32 v232, v232, v229
    v_mul_f32 v233, v233, v229
    v_accvgpr_write_b32 a36, v230
    v_accvgpr_write_b32 a37, v231
    v_accvgpr_write_b32 a38, v232
    v_accvgpr_write_b32 a39, v233
    v_accvgpr_read_b32 v230, a56
    v_accvgpr_read_b32 v231, a57
    v_accvgpr_read_b32 v232, a58
    v_accvgpr_read_b32 v233, a59
    v_mul_f32 v230, v230, v229
    v_mul_f32 v231, v231, v229
    v_mul_f32 v232, v232, v229
    v_mul_f32 v233, v233, v229
    v_accvgpr_write_b32 a56, v230
    v_accvgpr_write_b32 a57, v231
    v_accvgpr_write_b32 a58, v232
    v_accvgpr_write_b32 a59, v233
    v_accvgpr_read_b32 v230, a76
    v_accvgpr_read_b32 v231, a77
    v_accvgpr_read_b32 v232, a78
    v_accvgpr_read_b32 v233, a79
    v_mul_f32 v230, v230, v229
    v_mul_f32 v231, v231, v229
    v_mul_f32 v232, v232, v229
    v_mul_f32 v233, v233, v229
    v_accvgpr_write_b32 a76, v230
    v_accvgpr_write_b32 a77, v231
    v_accvgpr_write_b32 a78, v232
    v_accvgpr_write_b32 a79, v233
    v_accvgpr_read_b32 v230, a96
    v_accvgpr_read_b32 v231, a97
    v_accvgpr_read_b32 v232, a98
    v_accvgpr_read_b32 v233, a99
    v_mul_f32 v230, v230, v229
    v_mul_f32 v231, v231, v229
    v_mul_f32 v232, v232, v229
    v_mul_f32 v233, v233, v229
    v_accvgpr_write_b32 a96, v230
    v_accvgpr_write_b32 a97, v231
    v_accvgpr_write_b32 a98, v232
    v_accvgpr_write_b32 a99, v233
    v_accvgpr_read_b32 v230, a116
    v_accvgpr_read_b32 v231, a117
    v_accvgpr_read_b32 v232, a118
    v_accvgpr_read_b32 v233, a119
    v_mul_f32 v230, v230, v229
    v_mul_f32 v231, v231, v229
    v_mul_f32 v232, v232, v229
    v_mul_f32 v233, v233, v229
    v_accvgpr_write_b32 a116, v230
    v_accvgpr_write_b32 a117, v231
    v_accvgpr_write_b32 a118, v232
    v_accvgpr_write_b32 a119, v233
    v_accvgpr_read_b32 v230, a136
    v_accvgpr_read_b32 v231, a137
    v_accvgpr_read_b32 v232, a138
    v_accvgpr_read_b32 v233, a139
    v_mul_f32 v230, v230, v229
    v_mul_f32 v231, v231, v229
    v_mul_f32 v232, v232, v229
    v_mul_f32 v233, v233, v229
    v_accvgpr_write_b32 a136, v230
    v_accvgpr_write_b32 a137, v231
    v_accvgpr_write_b32 a138, v232
    v_accvgpr_write_b32 a139, v233
    v_accvgpr_read_b32 v230, a156
    v_accvgpr_read_b32 v231, a157
    v_accvgpr_read_b32 v232, a158
    v_accvgpr_read_b32 v233, a159
    v_mul_f32 v230, v230, v229
    v_mul_f32 v231, v231, v229
    v_mul_f32 v232, v232, v229
    v_mul_f32 v233, v233, v229
    v_accvgpr_write_b32 a156, v230
    v_accvgpr_write_b32 a157, v231
    v_accvgpr_write_b32 a158, v232
    v_accvgpr_write_b32 a159, v233
    s_mov_b32 s50, 0x41000000
    s_mov_b32 s51, 0
    s_nop 1
    s_branch k1_kernel_L29
k1_kernel_L31:
    s_nop 7
    v_max3_f32 v228, v72, v73, v74
    v_max3_f32 v228, v228, v75, v92
    v_max3_f32 v228, v228, v93, v94
    v_max_f32 v228, v228, v95
    v_mov_b32 v229, v228
    s_nop 1
    v_permlane32_swap_b32 v228, v229
    s_nop 1
    v_max_f32 v228, v228, v229
    v_mov_b32 v229, v228
    s_nop 1
    v_permlane16_swap_b32 v228, v229
    s_nop 1
    v_max_f32 v228, v228, v229
    v_max_f32 v228, s51, v228
    v_sub_f32 v229, 0, v228
    v_exp_f32 v229, v229
    v_add_f32 v221, v221, v228
    v_sub_f32 v196, v196, v228
    v_sub_f32 v72, v72, v228
    v_sub_f32 v92, v92, v228
    v_sub_f32 v197, v197, v228
    v_sub_f32 v73, v73, v228
    v_sub_f32 v93, v93, v228
    v_sub_f32 v198, v198, v228
    v_sub_f32 v74, v74, v228
    v_sub_f32 v94, v94, v228
    v_sub_f32 v199, v199, v228
    v_sub_f32 v75, v75, v228
    v_sub_f32 v95, v95, v228
    v_mul_f32 v216, v216, v229
    v_accvgpr_read_b32 v230, a0
    v_accvgpr_read_b32 v231, a1
    v_accvgpr_read_b32 v232, a2
    v_accvgpr_read_b32 v233, a3
    v_mul_f32 v230, v230, v229
    v_mul_f32 v231, v231, v229
    v_mul_f32 v232, v232, v229
    v_mul_f32 v233, v233, v229
    v_accvgpr_write_b32 a0, v230
    v_accvgpr_write_b32 a1, v231
    v_accvgpr_write_b32 a2, v232
    v_accvgpr_write_b32 a3, v233
    v_accvgpr_read_b32 v230, a20
    v_accvgpr_read_b32 v231, a21
    v_accvgpr_read_b32 v232, a22
    v_accvgpr_read_b32 v233, a23
    v_mul_f32 v230, v230, v229
    v_mul_f32 v231, v231, v229
    v_mul_f32 v232, v232, v229
    v_mul_f32 v233, v233, v229
    v_accvgpr_write_b32 a20, v230
    v_accvgpr_write_b32 a21, v231
    v_accvgpr_write_b32 a22, v232
    v_accvgpr_write_b32 a23, v233
    v_accvgpr_read_b32 v230, a40
    v_accvgpr_read_b32 v231, a41
    v_accvgpr_read_b32 v232, a42
    v_accvgpr_read_b32 v233, a43
    v_mul_f32 v230, v230, v229
    v_mul_f32 v231, v231, v229
    v_mul_f32 v232, v232, v229
    v_mul_f32 v233, v233, v229
    v_accvgpr_write_b32 a40, v230
    v_accvgpr_write_b32 a41, v231
    v_accvgpr_write_b32 a42, v232
    v_accvgpr_write_b32 a43, v233
    v_accvgpr_read_b32 v230, a60
    v_accvgpr_read_b32 v231, a61
    v_accvgpr_read_b32 v232, a62
    v_accvgpr_read_b32 v233, a63
    v_mul_f32 v230, v230, v229
    v_mul_f32 v231, v231, v229
    v_mul_f32 v232, v232, v229
    v_mul_f32 v233, v233, v229
    v_accvgpr_write_b32 a60, v230
    v_accvgpr_write_b32 a61, v231
    v_accvgpr_write_b32 a62, v232
    v_accvgpr_write_b32 a63, v233
    v_accvgpr_read_b32 v230, a80
    v_accvgpr_read_b32 v231, a81
    v_accvgpr_read_b32 v232, a82
    v_accvgpr_read_b32 v233, a83
    v_mul_f32 v230, v230, v229
    v_mul_f32 v231, v231, v229
    v_mul_f32 v232, v232, v229
    v_mul_f32 v233, v233, v229
    v_accvgpr_write_b32 a80, v230
    v_accvgpr_write_b32 a81, v231
    v_accvgpr_write_b32 a82, v232
    v_accvgpr_write_b32 a83, v233
    v_accvgpr_read_b32 v230, a100
    v_accvgpr_read_b32 v231, a101
    v_accvgpr_read_b32 v232, a102
    v_accvgpr_read_b32 v233, a103
    v_mul_f32 v230, v230, v229
    v_mul_f32 v231, v231, v229
    v_mul_f32 v232, v232, v229
    v_mul_f32 v233, v233, v229
    v_accvgpr_write_b32 a100, v230
    v_accvgpr_write_b32 a101, v231
    v_accvgpr_write_b32 a102, v232
    v_accvgpr_write_b32 a103, v233
    v_accvgpr_read_b32 v230, a120
    v_accvgpr_read_b32 v231, a121
    v_accvgpr_read_b32 v232, a122
    v_accvgpr_read_b32 v233, a123
    v_mul_f32 v230, v230, v229
    v_mul_f32 v231, v231, v229
    v_mul_f32 v232, v232, v229
    v_mul_f32 v233, v233, v229
    v_accvgpr_write_b32 a120, v230
    v_accvgpr_write_b32 a121, v231
    v_accvgpr_write_b32 a122, v232
    v_accvgpr_write_b32 a123, v233
    v_accvgpr_read_b32 v230, a140
    v_accvgpr_read_b32 v231, a141
    v_accvgpr_read_b32 v232, a142
    v_accvgpr_read_b32 v233, a143
    v_mul_f32 v230, v230, v229
    v_mul_f32 v231, v231, v229
    v_mul_f32 v232, v232, v229
    v_mul_f32 v233, v233, v229
    v_accvgpr_write_b32 a140, v230
    v_accvgpr_write_b32 a141, v231
    v_accvgpr_write_b32 a142, v232
    v_accvgpr_write_b32 a143, v233
    v_max3_f32 v228, v76, v77, v78
    v_max3_f32 v228, v228, v79, v96
    v_max3_f32 v228, v228, v97, v98
    v_max_f32 v228, v228, v99
    v_mov_b32 v229, v228
    s_nop 1
    v_permlane32_swap_b32 v228, v229
    s_nop 1
    v_max_f32 v228, v228, v229
    v_mov_b32 v229, v228
    s_nop 1
    v_permlane16_swap_b32 v228, v229
    s_nop 1
    v_max_f32 v228, v228, v229
    v_max_f32 v228, s51, v228
    v_sub_f32 v229, 0, v228
    v_exp_f32 v229, v229
    v_add_f32 v222, v222, v228
    v_sub_f32 v200, v200, v228
    v_sub_f32 v76, v76, v228
    v_sub_f32 v96, v96, v228
    v_sub_f32 v201, v201, v228
    v_sub_f32 v77, v77, v228
    v_sub_f32 v97, v97, v228
    v_sub_f32 v202, v202, v228
    v_sub_f32 v78, v78, v228
    v_sub_f32 v98, v98, v228
    v_sub_f32 v203, v203, v228
    v_sub_f32 v79, v79, v228
    v_sub_f32 v99, v99, v228
    v_mul_f32 v217, v217, v229
    v_accvgpr_read_b32 v230, a4
    v_accvgpr_read_b32 v231, a5
    v_accvgpr_read_b32 v232, a6
    v_accvgpr_read_b32 v233, a7
    v_mul_f32 v230, v230, v229
    v_mul_f32 v231, v231, v229
    v_mul_f32 v232, v232, v229
    v_mul_f32 v233, v233, v229
    v_accvgpr_write_b32 a4, v230
    v_accvgpr_write_b32 a5, v231
    v_accvgpr_write_b32 a6, v232
    v_accvgpr_write_b32 a7, v233
    v_accvgpr_read_b32 v230, a24
    v_accvgpr_read_b32 v231, a25
    v_accvgpr_read_b32 v232, a26
    v_accvgpr_read_b32 v233, a27
    v_mul_f32 v230, v230, v229
    v_mul_f32 v231, v231, v229
    v_mul_f32 v232, v232, v229
    v_mul_f32 v233, v233, v229
    v_accvgpr_write_b32 a24, v230
    v_accvgpr_write_b32 a25, v231
    v_accvgpr_write_b32 a26, v232
    v_accvgpr_write_b32 a27, v233
    v_accvgpr_read_b32 v230, a44
    v_accvgpr_read_b32 v231, a45
    v_accvgpr_read_b32 v232, a46
    v_accvgpr_read_b32 v233, a47
    v_mul_f32 v230, v230, v229
    v_mul_f32 v231, v231, v229
    v_mul_f32 v232, v232, v229
    v_mul_f32 v233, v233, v229
    v_accvgpr_write_b32 a44, v230
    v_accvgpr_write_b32 a45, v231
    v_accvgpr_write_b32 a46, v232
    v_accvgpr_write_b32 a47, v233
    v_accvgpr_read_b32 v230, a64
    v_accvgpr_read_b32 v231, a65
    v_accvgpr_read_b32 v232, a66
    v_accvgpr_read_b32 v233, a67
    v_mul_f32 v230, v230, v229
    v_mul_f32 v231, v231, v229
    v_mul_f32 v232, v232, v229
    v_mul_f32 v233, v233, v229
    v_accvgpr_write_b32 a64, v230
    v_accvgpr_write_b32 a65, v231
    v_accvgpr_write_b32 a66, v232
    v_accvgpr_write_b32 a67, v233
    v_accvgpr_read_b32 v230, a84
    v_accvgpr_read_b32 v231, a85
    v_accvgpr_read_b32 v232, a86
    v_accvgpr_read_b32 v233, a87
    v_mul_f32 v230, v230, v229
    v_mul_f32 v231, v231, v229
    v_mul_f32 v232, v232, v229
    v_mul_f32 v233, v233, v229
    v_accvgpr_write_b32 a84, v230
    v_accvgpr_write_b32 a85, v231
    v_accvgpr_write_b32 a86, v232
    v_accvgpr_write_b32 a87, v233
    v_accvgpr_read_b32 v230, a104
    v_accvgpr_read_b32 v231, a105
    v_accvgpr_read_b32 v232, a106
    v_accvgpr_read_b32 v233, a107
    v_mul_f32 v230, v230, v229
    v_mul_f32 v231, v231, v229
    v_mul_f32 v232, v232, v229
    v_mul_f32 v233, v233, v229
    v_accvgpr_write_b32 a104, v230
    v_accvgpr_write_b32 a105, v231
    v_accvgpr_write_b32 a106, v232
    v_accvgpr_write_b32 a107, v233
    v_accvgpr_read_b32 v230, a124
    v_accvgpr_read_b32 v231, a125
    v_accvgpr_read_b32 v232, a126
    v_accvgpr_read_b32 v233, a127
    v_mul_f32 v230, v230, v229
    v_mul_f32 v231, v231, v229
    v_mul_f32 v232, v232, v229
    v_mul_f32 v233, v233, v229
    v_accvgpr_write_b32 a124, v230
    v_accvgpr_write_b32 a125, v231
    v_accvgpr_write_b32 a126, v232
    v_accvgpr_write_b32 a127, v233
    v_accvgpr_read_b32 v230, a144
    v_accvgpr_read_b32 v231, a145
    v_accvgpr_read_b32 v232, a146
    v_accvgpr_read_b32 v233, a147
    v_mul_f32 v230, v230, v229
    v_mul_f32 v231, v231, v229
    v_mul_f32 v232, v232, v229
    v_mul_f32 v233, v233, v229
    v_accvgpr_write_b32 a144, v230
    v_accvgpr_write_b32 a145, v231
    v_accvgpr_write_b32 a146, v232
    v_accvgpr_write_b32 a147, v233
    v_max3_f32 v228, v80, v81, v82
    v_max3_f32 v228, v228, v83, v100
    v_max3_f32 v228, v228, v101, v102
    v_max_f32 v228, v228, v103
    v_mov_b32 v229, v228
    s_nop 1
    v_permlane32_swap_b32 v228, v229
    s_nop 1
    v_max_f32 v228, v228, v229
    v_mov_b32 v229, v228
    s_nop 1
    v_permlane16_swap_b32 v228, v229
    s_nop 1
    v_max_f32 v228, v228, v229
    v_max_f32 v228, s51, v228
    v_sub_f32 v229, 0, v228
    v_exp_f32 v229, v229
    v_add_f32 v223, v223, v228
    v_sub_f32 v204, v204, v228
    v_sub_f32 v80, v80, v228
    v_sub_f32 v100, v100, v228
    v_sub_f32 v205, v205, v228
    v_sub_f32 v81, v81, v228
    v_sub_f32 v101, v101, v228
    v_sub_f32 v206, v206, v228
    v_sub_f32 v82, v82, v228
    v_sub_f32 v102, v102, v228
    v_sub_f32 v207, v207, v228
    v_sub_f32 v83, v83, v228
    v_sub_f32 v103, v103, v228
    v_mul_f32 v218, v218, v229
    v_accvgpr_read_b32 v230, a8
    v_accvgpr_read_b32 v231, a9
    v_accvgpr_read_b32 v232, a10
    v_accvgpr_read_b32 v233, a11
    v_mul_f32 v230, v230, v229
    v_mul_f32 v231, v231, v229
    v_mul_f32 v232, v232, v229
    v_mul_f32 v233, v233, v229
    v_accvgpr_write_b32 a8, v230
    v_accvgpr_write_b32 a9, v231
    v_accvgpr_write_b32 a10, v232
    v_accvgpr_write_b32 a11, v233
    v_accvgpr_read_b32 v230, a28
    v_accvgpr_read_b32 v231, a29
    v_accvgpr_read_b32 v232, a30
    v_accvgpr_read_b32 v233, a31
    v_mul_f32 v230, v230, v229
    v_mul_f32 v231, v231, v229
    v_mul_f32 v232, v232, v229
    v_mul_f32 v233, v233, v229
    v_accvgpr_write_b32 a28, v230
    v_accvgpr_write_b32 a29, v231
    v_accvgpr_write_b32 a30, v232
    v_accvgpr_write_b32 a31, v233
    v_accvgpr_read_b32 v230, a48
    v_accvgpr_read_b32 v231, a49
    v_accvgpr_read_b32 v232, a50
    v_accvgpr_read_b32 v233, a51
    v_mul_f32 v230, v230, v229
    v_mul_f32 v231, v231, v229
    v_mul_f32 v232, v232, v229
    v_mul_f32 v233, v233, v229
    v_accvgpr_write_b32 a48, v230
    v_accvgpr_write_b32 a49, v231
    v_accvgpr_write_b32 a50, v232
    v_accvgpr_write_b32 a51, v233
    v_accvgpr_read_b32 v230, a68
    v_accvgpr_read_b32 v231, a69
    v_accvgpr_read_b32 v232, a70
    v_accvgpr_read_b32 v233, a71
    v_mul_f32 v230, v230, v229
    v_mul_f32 v231, v231, v229
    v_mul_f32 v232, v232, v229
    v_mul_f32 v233, v233, v229
    v_accvgpr_write_b32 a68, v230
    v_accvgpr_write_b32 a69, v231
    v_accvgpr_write_b32 a70, v232
    v_accvgpr_write_b32 a71, v233
    v_accvgpr_read_b32 v230, a88
    v_accvgpr_read_b32 v231, a89
    v_accvgpr_read_b32 v232, a90
    v_accvgpr_read_b32 v233, a91
    v_mul_f32 v230, v230, v229
    v_mul_f32 v231, v231, v229
    v_mul_f32 v232, v232, v229
    v_mul_f32 v233, v233, v229
    v_accvgpr_write_b32 a88, v230
    v_accvgpr_write_b32 a89, v231
    v_accvgpr_write_b32 a90, v232
    v_accvgpr_write_b32 a91, v233
    v_accvgpr_read_b32 v230, a108
    v_accvgpr_read_b32 v231, a109
    v_accvgpr_read_b32 v232, a110
    v_accvgpr_read_b32 v233, a111
    v_mul_f32 v230, v230, v229
    v_mul_f32 v231, v231, v229
    v_mul_f32 v232, v232, v229
    v_mul_f32 v233, v233, v229
    v_accvgpr_write_b32 a108, v230
    v_accvgpr_write_b32 a109, v231
    v_accvgpr_write_b32 a110, v232
    v_accvgpr_write_b32 a111, v233
    v_accvgpr_read_b32 v230, a128
    v_accvgpr_read_b32 v231, a129
    v_accvgpr_read_b32 v232, a130
    v_accvgpr_read_b32 v233, a131
    v_mul_f32 v230, v230, v229
    v_mul_f32 v231, v231, v229
    v_mul_f32 v232, v232, v229
    v_mul_f32 v233, v233, v229
    v_accvgpr_write_b32 a128, v230
    v_accvgpr_write_b32 a129, v231
    v_accvgpr_write_b32 a130, v232
    v_accvgpr_write_b32 a131, v233
    v_accvgpr_read_b32 v230, a148
    v_accvgpr_read_b32 v231, a149
    v_accvgpr_read_b32 v232, a150
    v_accvgpr_read_b32 v233, a151
    v_mul_f32 v230, v230, v229
    v_mul_f32 v231, v231, v229
    v_mul_f32 v232, v232, v229
    v_mul_f32 v233, v233, v229
    v_accvgpr_write_b32 a148, v230
    v_accvgpr_write_b32 a149, v231
    v_accvgpr_write_b32 a150, v232
    v_accvgpr_write_b32 a151, v233
    v_max3_f32 v228, v84, v85, v86
    v_max3_f32 v228, v228, v87, v104
    v_max3_f32 v228, v228, v105, v106
    v_max_f32 v228, v228, v107
    v_mov_b32 v229, v228
    s_nop 1
    v_permlane32_swap_b32 v228, v229
    s_nop 1
    v_max_f32 v228, v228, v229
    v_mov_b32 v229, v228
    s_nop 1
    v_permlane16_swap_b32 v228, v229
    s_nop 1
    v_max_f32 v228, v228, v229
    v_max_f32 v228, s51, v228
    v_sub_f32 v229, 0, v228
    v_exp_f32 v229, v229
    v_add_f32 v224, v224, v228
    v_sub_f32 v208, v208, v228
    v_sub_f32 v84, v84, v228
    v_sub_f32 v104, v104, v228
    v_sub_f32 v209, v209, v228
    v_sub_f32 v85, v85, v228
    v_sub_f32 v105, v105, v228
    v_sub_f32 v210, v210, v228
    v_sub_f32 v86, v86, v228
    v_sub_f32 v106, v106, v228
    v_sub_f32 v211, v211, v228
    v_sub_f32 v87, v87, v228
    v_sub_f32 v107, v107, v228
    v_mul_f32 v219, v219, v229
    v_accvgpr_read_b32 v230, a12
    v_accvgpr_read_b32 v231, a13
    v_accvgpr_read_b32 v232, a14
    v_accvgpr_read_b32 v233, a15
    v_mul_f32 v230, v230, v229
    v_mul_f32 v231, v231, v229
    v_mul_f32 v232, v232, v229
    v_mul_f32 v233, v233, v229
    v_accvgpr_write_b32 a12, v230
    v_accvgpr_write_b32 a13, v231
    v_accvgpr_write_b32 a14, v232
    v_accvgpr_write_b32 a15, v233
    v_accvgpr_read_b32 v230, a32
    v_accvgpr_read_b32 v231, a33
    v_accvgpr_read_b32 v232, a34
    v_accvgpr_read_b32 v233, a35
    v_mul_f32 v230, v230, v229
    v_mul_f32 v231, v231, v229
    v_mul_f32 v232, v232, v229
    v_mul_f32 v233, v233, v229
    v_accvgpr_write_b32 a32, v230
    v_accvgpr_write_b32 a33, v231
    v_accvgpr_write_b32 a34, v232
    v_accvgpr_write_b32 a35, v233
    v_accvgpr_read_b32 v230, a52
    v_accvgpr_read_b32 v231, a53
    v_accvgpr_read_b32 v232, a54
    v_accvgpr_read_b32 v233, a55
    v_mul_f32 v230, v230, v229
    v_mul_f32 v231, v231, v229
    v_mul_f32 v232, v232, v229
    v_mul_f32 v233, v233, v229
    v_accvgpr_write_b32 a52, v230
    v_accvgpr_write_b32 a53, v231
    v_accvgpr_write_b32 a54, v232
    v_accvgpr_write_b32 a55, v233
    v_accvgpr_read_b32 v230, a72
    v_accvgpr_read_b32 v231, a73
    v_accvgpr_read_b32 v232, a74
    v_accvgpr_read_b32 v233, a75
    v_mul_f32 v230, v230, v229
    v_mul_f32 v231, v231, v229
    v_mul_f32 v232, v232, v229
    v_mul_f32 v233, v233, v229
    v_accvgpr_write_b32 a72, v230
    v_accvgpr_write_b32 a73, v231
    v_accvgpr_write_b32 a74, v232
    v_accvgpr_write_b32 a75, v233
    v_accvgpr_read_b32 v230, a92
    v_accvgpr_read_b32 v231, a93
    v_accvgpr_read_b32 v232, a94
    v_accvgpr_read_b32 v233, a95
    v_mul_f32 v230, v230, v229
    v_mul_f32 v231, v231, v229
    v_mul_f32 v232, v232, v229
    v_mul_f32 v233, v233, v229
    v_accvgpr_write_b32 a92, v230
    v_accvgpr_write_b32 a93, v231
    v_accvgpr_write_b32 a94, v232
    v_accvgpr_write_b32 a95, v233
    v_accvgpr_read_b32 v230, a112
    v_accvgpr_read_b32 v231, a113
    v_accvgpr_read_b32 v232, a114
    v_accvgpr_read_b32 v233, a115
    v_mul_f32 v230, v230, v229
    v_mul_f32 v231, v231, v229
    v_mul_f32 v232, v232, v229
    v_mul_f32 v233, v233, v229
    v_accvgpr_write_b32 a112, v230
    v_accvgpr_write_b32 a113, v231
    v_accvgpr_write_b32 a114, v232
    v_accvgpr_write_b32 a115, v233
    v_accvgpr_read_b32 v230, a132
    v_accvgpr_read_b32 v231, a133
    v_accvgpr_read_b32 v232, a134
    v_accvgpr_read_b32 v233, a135
    v_mul_f32 v230, v230, v229
    v_mul_f32 v231, v231, v229
    v_mul_f32 v232, v232, v229
    v_mul_f32 v233, v233, v229
    v_accvgpr_write_b32 a132, v230
    v_accvgpr_write_b32 a133, v231
    v_accvgpr_write_b32 a134, v232
    v_accvgpr_write_b32 a135, v233
    v_accvgpr_read_b32 v230, a152
    v_accvgpr_read_b32 v231, a153
    v_accvgpr_read_b32 v232, a154
    v_accvgpr_read_b32 v233, a155
    v_mul_f32 v230, v230, v229
    v_mul_f32 v231, v231, v229
    v_mul_f32 v232, v232, v229
    v_mul_f32 v233, v233, v229
    v_accvgpr_write_b32 a152, v230
    v_accvgpr_write_b32 a153, v231
    v_accvgpr_write_b32 a154, v232
    v_accvgpr_write_b32 a155, v233
    v_max3_f32 v228, v88, v89, v90
    v_max3_f32 v228, v228, v91, v108
    v_max3_f32 v228, v228, v109, v110
    v_max_f32 v228, v228, v111
    v_mov_b32 v229, v228
    s_nop 1
    v_permlane32_swap_b32 v228, v229
    s_nop 1
    v_max_f32 v228, v228, v229
    v_mov_b32 v229, v228
    s_nop 1
    v_permlane16_swap_b32 v228, v229
    s_nop 1
    v_max_f32 v228, v228, v229
    v_max_f32 v228, s51, v228
    v_sub_f32 v229, 0, v228
    v_exp_f32 v229, v229
    v_add_f32 v225, v225, v228
    v_sub_f32 v212, v212, v228
    v_sub_f32 v88, v88, v228
    v_sub_f32 v108, v108, v228
    v_sub_f32 v213, v213, v228
    v_sub_f32 v89, v89, v228
    v_sub_f32 v109, v109, v228
    v_sub_f32 v214, v214, v228
    v_sub_f32 v90, v90, v228
    v_sub_f32 v110, v110, v228
    v_sub_f32 v215, v215, v228
    v_sub_f32 v91, v91, v228
    v_sub_f32 v111, v111, v228
    v_mul_f32 v220, v220, v229
    v_accvgpr_read_b32 v230, a16
    v_accvgpr_read_b32 v231, a17
    v_accvgpr_read_b32 v232, a18
    v_accvgpr_read_b32 v233, a19
    v_mul_f32 v230, v230, v229
    v_mul_f32 v231, v231, v229
    v_mul_f32 v232, v232, v229
    v_mul_f32 v233, v233, v229
    v_accvgpr_write_b32 a16, v230
    v_accvgpr_write_b32 a17, v231
    v_accvgpr_write_b32 a18, v232
    v_accvgpr_write_b32 a19, v233
    v_accvgpr_read_b32 v230, a36
    v_accvgpr_read_b32 v231, a37
    v_accvgpr_read_b32 v232, a38
    v_accvgpr_read_b32 v233, a39
    v_mul_f32 v230, v230, v229
    v_mul_f32 v231, v231, v229
    v_mul_f32 v232, v232, v229
    v_mul_f32 v233, v233, v229
    v_accvgpr_write_b32 a36, v230
    v_accvgpr_write_b32 a37, v231
    v_accvgpr_write_b32 a38, v232
    v_accvgpr_write_b32 a39, v233
    v_accvgpr_read_b32 v230, a56
    v_accvgpr_read_b32 v231, a57
    v_accvgpr_read_b32 v232, a58
    v_accvgpr_read_b32 v233, a59
    v_mul_f32 v230, v230, v229
    v_mul_f32 v231, v231, v229
    v_mul_f32 v232, v232, v229
    v_mul_f32 v233, v233, v229
    v_accvgpr_write_b32 a56, v230
    v_accvgpr_write_b32 a57, v231
    v_accvgpr_write_b32 a58, v232
    v_accvgpr_write_b32 a59, v233
    v_accvgpr_read_b32 v230, a76
    v_accvgpr_read_b32 v231, a77
    v_accvgpr_read_b32 v232, a78
    v_accvgpr_read_b32 v233, a79
    v_mul_f32 v230, v230, v229
    v_mul_f32 v231, v231, v229
    v_mul_f32 v232, v232, v229
    v_mul_f32 v233, v233, v229
    v_accvgpr_write_b32 a76, v230
    v_accvgpr_write_b32 a77, v231
    v_accvgpr_write_b32 a78, v232
    v_accvgpr_write_b32 a79, v233
    v_accvgpr_read_b32 v230, a96
    v_accvgpr_read_b32 v231, a97
    v_accvgpr_read_b32 v232, a98
    v_accvgpr_read_b32 v233, a99
    v_mul_f32 v230, v230, v229
    v_mul_f32 v231, v231, v229
    v_mul_f32 v232, v232, v229
    v_mul_f32 v233, v233, v229
    v_accvgpr_write_b32 a96, v230
    v_accvgpr_write_b32 a97, v231
    v_accvgpr_write_b32 a98, v232
    v_accvgpr_write_b32 a99, v233
    v_accvgpr_read_b32 v230, a116
    v_accvgpr_read_b32 v231, a117
    v_accvgpr_read_b32 v232, a118
    v_accvgpr_read_b32 v233, a119
    v_mul_f32 v230, v230, v229
    v_mul_f32 v231, v231, v229
    v_mul_f32 v232, v232, v229
    v_mul_f32 v233, v233, v229
    v_accvgpr_write_b32 a116, v230
    v_accvgpr_write_b32 a117, v231
    v_accvgpr_write_b32 a118, v232
    v_accvgpr_write_b32 a119, v233
    v_accvgpr_read_b32 v230, a136
    v_accvgpr_read_b32 v231, a137
    v_accvgpr_read_b32 v232, a138
    v_accvgpr_read_b32 v233, a139
    v_mul_f32 v230, v230, v229
    v_mul_f32 v231, v231, v229
    v_mul_f32 v232, v232, v229
    v_mul_f32 v233, v233, v229
    v_accvgpr_write_b32 a136, v230
    v_accvgpr_write_b32 a137, v231
    v_accvgpr_write_b32 a138, v232
    v_accvgpr_write_b32 a139, v233
    v_accvgpr_read_b32 v230, a156
    v_accvgpr_read_b32 v231, a157
    v_accvgpr_read_b32 v232, a158
    v_accvgpr_read_b32 v233, a159
    v_mul_f32 v230, v230, v229
    v_mul_f32 v231, v231, v229
    v_mul_f32 v232, v232, v229
    v_mul_f32 v233, v233, v229
    v_accvgpr_write_b32 a156, v230
    v_accvgpr_write_b32 a157, v231
    v_accvgpr_write_b32 a158, v232
    v_accvgpr_write_b32 a159, v233
    s_mov_b32 s50, 0x41000000
    s_mov_b32 s51, 0
    s_nop 1
    s_branch k1_kernel_L32
k1_kernel_L33:
    s_nop 7
    v_max3_f32 v228, v32, v33, v34
    v_max3_f32 v228, v228, v35, v52
    v_max3_f32 v228, v228, v53, v54
    v_max_f32 v228, v228, v55
    v_mov_b32 v229, v228
    s_nop 1
    v_permlane32_swap_b32 v228, v229
    s_nop 1
    v_max_f32 v228, v228, v229
    v_mov_b32 v229, v228
    s_nop 1
    v_permlane16_swap_b32 v228, v229
    s_nop 1
    v_max_f32 v228, v228, v229
    v_max_f32 v228, s51, v228
    v_sub_f32 v229, 0, v228
    v_exp_f32 v229, v229
    v_add_f32 v221, v221, v228
    v_sub_f32 v196, v196, v228
    v_sub_f32 v32, v32, v228
    v_sub_f32 v52, v52, v228
    v_sub_f32 v197, v197, v228
    v_sub_f32 v33, v33, v228
    v_sub_f32 v53, v53, v228
    v_sub_f32 v198, v198, v228
    v_sub_f32 v34, v34, v228
    v_sub_f32 v54, v54, v228
    v_sub_f32 v199, v199, v228
    v_sub_f32 v35, v35, v228
    v_sub_f32 v55, v55, v228
    v_mul_f32 v216, v216, v229
    v_accvgpr_read_b32 v230, a0
    v_accvgpr_read_b32 v231, a1
    v_accvgpr_read_b32 v232, a2
    v_accvgpr_read_b32 v233, a3
    v_mul_f32 v230, v230, v229
    v_mul_f32 v231, v231, v229
    v_mul_f32 v232, v232, v229
    v_mul_f32 v233, v233, v229
    v_accvgpr_write_b32 a0, v230
    v_accvgpr_write_b32 a1, v231
    v_accvgpr_write_b32 a2, v232
    v_accvgpr_write_b32 a3, v233
    v_accvgpr_read_b32 v230, a20
    v_accvgpr_read_b32 v231, a21
    v_accvgpr_read_b32 v232, a22
    v_accvgpr_read_b32 v233, a23
    v_mul_f32 v230, v230, v229
    v_mul_f32 v231, v231, v229
    v_mul_f32 v232, v232, v229
    v_mul_f32 v233, v233, v229
    v_accvgpr_write_b32 a20, v230
    v_accvgpr_write_b32 a21, v231
    v_accvgpr_write_b32 a22, v232
    v_accvgpr_write_b32 a23, v233
    v_accvgpr_read_b32 v230, a40
    v_accvgpr_read_b32 v231, a41
    v_accvgpr_read_b32 v232, a42
    v_accvgpr_read_b32 v233, a43
    v_mul_f32 v230, v230, v229
    v_mul_f32 v231, v231, v229
    v_mul_f32 v232, v232, v229
    v_mul_f32 v233, v233, v229
    v_accvgpr_write_b32 a40, v230
    v_accvgpr_write_b32 a41, v231
    v_accvgpr_write_b32 a42, v232
    v_accvgpr_write_b32 a43, v233
    v_accvgpr_read_b32 v230, a60
    v_accvgpr_read_b32 v231, a61
    v_accvgpr_read_b32 v232, a62
    v_accvgpr_read_b32 v233, a63
    v_mul_f32 v230, v230, v229
    v_mul_f32 v231, v231, v229
    v_mul_f32 v232, v232, v229
    v_mul_f32 v233, v233, v229
    v_accvgpr_write_b32 a60, v230
    v_accvgpr_write_b32 a61, v231
    v_accvgpr_write_b32 a62, v232
    v_accvgpr_write_b32 a63, v233
    v_accvgpr_read_b32 v230, a80
    v_accvgpr_read_b32 v231, a81
    v_accvgpr_read_b32 v232, a82
    v_accvgpr_read_b32 v233, a83
    v_mul_f32 v230, v230, v229
    v_mul_f32 v231, v231, v229
    v_mul_f32 v232, v232, v229
    v_mul_f32 v233, v233, v229
    v_accvgpr_write_b32 a80, v230
    v_accvgpr_write_b32 a81, v231
    v_accvgpr_write_b32 a82, v232
    v_accvgpr_write_b32 a83, v233
    v_accvgpr_read_b32 v230, a100
    v_accvgpr_read_b32 v231, a101
    v_accvgpr_read_b32 v232, a102
    v_accvgpr_read_b32 v233, a103
    v_mul_f32 v230, v230, v229
    v_mul_f32 v231, v231, v229
    v_mul_f32 v232, v232, v229
    v_mul_f32 v233, v233, v229
    v_accvgpr_write_b32 a100, v230
    v_accvgpr_write_b32 a101, v231
    v_accvgpr_write_b32 a102, v232
    v_accvgpr_write_b32 a103, v233
    v_accvgpr_read_b32 v230, a120
    v_accvgpr_read_b32 v231, a121
    v_accvgpr_read_b32 v232, a122
    v_accvgpr_read_b32 v233, a123
    v_mul_f32 v230, v230, v229
    v_mul_f32 v231, v231, v229
    v_mul_f32 v232, v232, v229
    v_mul_f32 v233, v233, v229
    v_accvgpr_write_b32 a120, v230
    v_accvgpr_write_b32 a121, v231
    v_accvgpr_write_b32 a122, v232
    v_accvgpr_write_b32 a123, v233
    v_accvgpr_read_b32 v230, a140
    v_accvgpr_read_b32 v231, a141
    v_accvgpr_read_b32 v232, a142
    v_accvgpr_read_b32 v233, a143
    v_mul_f32 v230, v230, v229
    v_mul_f32 v231, v231, v229
    v_mul_f32 v232, v232, v229
    v_mul_f32 v233, v233, v229
    v_accvgpr_write_b32 a140, v230
    v_accvgpr_write_b32 a141, v231
    v_accvgpr_write_b32 a142, v232
    v_accvgpr_write_b32 a143, v233
    v_max3_f32 v228, v36, v37, v38
    v_max3_f32 v228, v228, v39, v56
    v_max3_f32 v228, v228, v57, v58
    v_max_f32 v228, v228, v59
    v_mov_b32 v229, v228
    s_nop 1
    v_permlane32_swap_b32 v228, v229
    s_nop 1
    v_max_f32 v228, v228, v229
    v_mov_b32 v229, v228
    s_nop 1
    v_permlane16_swap_b32 v228, v229
    s_nop 1
    v_max_f32 v228, v228, v229
    v_max_f32 v228, s51, v228
    v_sub_f32 v229, 0, v228
    v_exp_f32 v229, v229
    v_add_f32 v222, v222, v228
    v_sub_f32 v200, v200, v228
    v_sub_f32 v36, v36, v228
    v_sub_f32 v56, v56, v228
    v_sub_f32 v201, v201, v228
    v_sub_f32 v37, v37, v228
    v_sub_f32 v57, v57, v228
    v_sub_f32 v202, v202, v228
    v_sub_f32 v38, v38, v228
    v_sub_f32 v58, v58, v228
    v_sub_f32 v203, v203, v228
    v_sub_f32 v39, v39, v228
    v_sub_f32 v59, v59, v228
    v_mul_f32 v217, v217, v229
    v_accvgpr_read_b32 v230, a4
    v_accvgpr_read_b32 v231, a5
    v_accvgpr_read_b32 v232, a6
    v_accvgpr_read_b32 v233, a7
    v_mul_f32 v230, v230, v229
    v_mul_f32 v231, v231, v229
    v_mul_f32 v232, v232, v229
    v_mul_f32 v233, v233, v229
    v_accvgpr_write_b32 a4, v230
    v_accvgpr_write_b32 a5, v231
    v_accvgpr_write_b32 a6, v232
    v_accvgpr_write_b32 a7, v233
    v_accvgpr_read_b32 v230, a24
    v_accvgpr_read_b32 v231, a25
    v_accvgpr_read_b32 v232, a26
    v_accvgpr_read_b32 v233, a27
    v_mul_f32 v230, v230, v229
    v_mul_f32 v231, v231, v229
    v_mul_f32 v232, v232, v229
    v_mul_f32 v233, v233, v229
    v_accvgpr_write_b32 a24, v230
    v_accvgpr_write_b32 a25, v231
    v_accvgpr_write_b32 a26, v232
    v_accvgpr_write_b32 a27, v233
    v_accvgpr_read_b32 v230, a44
    v_accvgpr_read_b32 v231, a45
    v_accvgpr_read_b32 v232, a46
    v_accvgpr_read_b32 v233, a47
    v_mul_f32 v230, v230, v229
    v_mul_f32 v231, v231, v229
    v_mul_f32 v232, v232, v229
    v_mul_f32 v233, v233, v229
    v_accvgpr_write_b32 a44, v230
    v_accvgpr_write_b32 a45, v231
    v_accvgpr_write_b32 a46, v232
    v_accvgpr_write_b32 a47, v233
    v_accvgpr_read_b32 v230, a64
    v_accvgpr_read_b32 v231, a65
    v_accvgpr_read_b32 v232, a66
    v_accvgpr_read_b32 v233, a67
    v_mul_f32 v230, v230, v229
    v_mul_f32 v231, v231, v229
    v_mul_f32 v232, v232, v229
    v_mul_f32 v233, v233, v229
    v_accvgpr_write_b32 a64, v230
    v_accvgpr_write_b32 a65, v231
    v_accvgpr_write_b32 a66, v232
    v_accvgpr_write_b32 a67, v233
    v_accvgpr_read_b32 v230, a84
    v_accvgpr_read_b32 v231, a85
    v_accvgpr_read_b32 v232, a86
    v_accvgpr_read_b32 v233, a87
    v_mul_f32 v230, v230, v229
    v_mul_f32 v231, v231, v229
    v_mul_f32 v232, v232, v229
    v_mul_f32 v233, v233, v229
    v_accvgpr_write_b32 a84, v230
    v_accvgpr_write_b32 a85, v231
    v_accvgpr_write_b32 a86, v232
    v_accvgpr_write_b32 a87, v233
    v_accvgpr_read_b32 v230, a104
    v_accvgpr_read_b32 v231, a105
    v_accvgpr_read_b32 v232, a106
    v_accvgpr_read_b32 v233, a107
    v_mul_f32 v230, v230, v229
    v_mul_f32 v231, v231, v229
    v_mul_f32 v232, v232, v229
    v_mul_f32 v233, v233, v229
    v_accvgpr_write_b32 a104, v230
    v_accvgpr_write_b32 a105, v231
    v_accvgpr_write_b32 a106, v232
    v_accvgpr_write_b32 a107, v233
    v_accvgpr_read_b32 v230, a124
    v_accvgpr_read_b32 v231, a125
    v_accvgpr_read_b32 v232, a126
    v_accvgpr_read_b32 v233, a127
    v_mul_f32 v230, v230, v229
    v_mul_f32 v231, v231, v229
    v_mul_f32 v232, v232, v229
    v_mul_f32 v233, v233, v229
    v_accvgpr_write_b32 a124, v230
    v_accvgpr_write_b32 a125, v231
    v_accvgpr_write_b32 a126, v232
    v_accvgpr_write_b32 a127, v233
    v_accvgpr_read_b32 v230, a144
    v_accvgpr_read_b32 v231, a145
    v_accvgpr_read_b32 v232, a146
    v_accvgpr_read_b32 v233, a147
    v_mul_f32 v230, v230, v229
    v_mul_f32 v231, v231, v229
    v_mul_f32 v232, v232, v229
    v_mul_f32 v233, v233, v229
    v_accvgpr_write_b32 a144, v230
    v_accvgpr_write_b32 a145, v231
    v_accvgpr_write_b32 a146, v232
    v_accvgpr_write_b32 a147, v233
    v_max3_f32 v228, v40, v41, v42
    v_max3_f32 v228, v228, v43, v60
    v_max3_f32 v228, v228, v61, v62
    v_max_f32 v228, v228, v63
    v_mov_b32 v229, v228
    s_nop 1
    v_permlane32_swap_b32 v228, v229
    s_nop 1
    v_max_f32 v228, v228, v229
    v_mov_b32 v229, v228
    s_nop 1
    v_permlane16_swap_b32 v228, v229
    s_nop 1
    v_max_f32 v228, v228, v229
    v_max_f32 v228, s51, v228
    v_sub_f32 v229, 0, v228
    v_exp_f32 v229, v229
    v_add_f32 v223, v223, v228
    v_sub_f32 v204, v204, v228
    v_sub_f32 v40, v40, v228
    v_sub_f32 v60, v60, v228
    v_sub_f32 v205, v205, v228
    v_sub_f32 v41, v41, v228
    v_sub_f32 v61, v61, v228
    v_sub_f32 v206, v206, v228
    v_sub_f32 v42, v42, v228
    v_sub_f32 v62, v62, v228
    v_sub_f32 v207, v207, v228
    v_sub_f32 v43, v43, v228
    v_sub_f32 v63, v63, v228
    v_mul_f32 v218, v218, v229
    v_accvgpr_read_b32 v230, a8
    v_accvgpr_read_b32 v231, a9
    v_accvgpr_read_b32 v232, a10
    v_accvgpr_read_b32 v233, a11
    v_mul_f32 v230, v230, v229
    v_mul_f32 v231, v231, v229
    v_mul_f32 v232, v232, v229
    v_mul_f32 v233, v233, v229
    v_accvgpr_write_b32 a8, v230
    v_accvgpr_write_b32 a9, v231
    v_accvgpr_write_b32 a10, v232
    v_accvgpr_write_b32 a11, v233
    v_accvgpr_read_b32 v230, a28
    v_accvgpr_read_b32 v231, a29
    v_accvgpr_read_b32 v232, a30
    v_accvgpr_read_b32 v233, a31
    v_mul_f32 v230, v230, v229
    v_mul_f32 v231, v231, v229
    v_mul_f32 v232, v232, v229
    v_mul_f32 v233, v233, v229
    v_accvgpr_write_b32 a28, v230
    v_accvgpr_write_b32 a29, v231
    v_accvgpr_write_b32 a30, v232
    v_accvgpr_write_b32 a31, v233
    v_accvgpr_read_b32 v230, a48
    v_accvgpr_read_b32 v231, a49
    v_accvgpr_read_b32 v232, a50
    v_accvgpr_read_b32 v233, a51
    v_mul_f32 v230, v230, v229
    v_mul_f32 v231, v231, v229
    v_mul_f32 v232, v232, v229
    v_mul_f32 v233, v233, v229
    v_accvgpr_write_b32 a48, v230
    v_accvgpr_write_b32 a49, v231
    v_accvgpr_write_b32 a50, v232
    v_accvgpr_write_b32 a51, v233
    v_accvgpr_read_b32 v230, a68
    v_accvgpr_read_b32 v231, a69
    v_accvgpr_read_b32 v232, a70
    v_accvgpr_read_b32 v233, a71
    v_mul_f32 v230, v230, v229
    v_mul_f32 v231, v231, v229
    v_mul_f32 v232, v232, v229
    v_mul_f32 v233, v233, v229
    v_accvgpr_write_b32 a68, v230
    v_accvgpr_write_b32 a69, v231
    v_accvgpr_write_b32 a70, v232
    v_accvgpr_write_b32 a71, v233
    v_accvgpr_read_b32 v230, a88
    v_accvgpr_read_b32 v231, a89
    v_accvgpr_read_b32 v232, a90
    v_accvgpr_read_b32 v233, a91
    v_mul_f32 v230, v230, v229
    v_mul_f32 v231, v231, v229
    v_mul_f32 v232, v232, v229
    v_mul_f32 v233, v233, v229
    v_accvgpr_write_b32 a88, v230
    v_accvgpr_write_b32 a89, v231
    v_accvgpr_write_b32 a90, v232
    v_accvgpr_write_b32 a91, v233
    v_accvgpr_read_b32 v230, a108
    v_accvgpr_read_b32 v231, a109
    v_accvgpr_read_b32 v232, a110
    v_accvgpr_read_b32 v233, a111
    v_mul_f32 v230, v230, v229
    v_mul_f32 v231, v231, v229
    v_mul_f32 v232, v232, v229
    v_mul_f32 v233, v233, v229
    v_accvgpr_write_b32 a108, v230
    v_accvgpr_write_b32 a109, v231
    v_accvgpr_write_b32 a110, v232
    v_accvgpr_write_b32 a111, v233
    v_accvgpr_read_b32 v230, a128
    v_accvgpr_read_b32 v231, a129
    v_accvgpr_read_b32 v232, a130
    v_accvgpr_read_b32 v233, a131
    v_mul_f32 v230, v230, v229
    v_mul_f32 v231, v231, v229
    v_mul_f32 v232, v232, v229
    v_mul_f32 v233, v233, v229
    v_accvgpr_write_b32 a128, v230
    v_accvgpr_write_b32 a129, v231
    v_accvgpr_write_b32 a130, v232
    v_accvgpr_write_b32 a131, v233
    v_accvgpr_read_b32 v230, a148
    v_accvgpr_read_b32 v231, a149
    v_accvgpr_read_b32 v232, a150
    v_accvgpr_read_b32 v233, a151
    v_mul_f32 v230, v230, v229
    v_mul_f32 v231, v231, v229
    v_mul_f32 v232, v232, v229
    v_mul_f32 v233, v233, v229
    v_accvgpr_write_b32 a148, v230
    v_accvgpr_write_b32 a149, v231
    v_accvgpr_write_b32 a150, v232
    v_accvgpr_write_b32 a151, v233
    v_max3_f32 v228, v44, v45, v46
    v_max3_f32 v228, v228, v47, v64
    v_max3_f32 v228, v228, v65, v66
    v_max_f32 v228, v228, v67
    v_mov_b32 v229, v228
    s_nop 1
    v_permlane32_swap_b32 v228, v229
    s_nop 1
    v_max_f32 v228, v228, v229
    v_mov_b32 v229, v228
    s_nop 1
    v_permlane16_swap_b32 v228, v229
    s_nop 1
    v_max_f32 v228, v228, v229
    v_max_f32 v228, s51, v228
    v_sub_f32 v229, 0, v228
    v_exp_f32 v229, v229
    v_add_f32 v224, v224, v228
    v_sub_f32 v208, v208, v228
    v_sub_f32 v44, v44, v228
    v_sub_f32 v64, v64, v228
    v_sub_f32 v209, v209, v228
    v_sub_f32 v45, v45, v228
    v_sub_f32 v65, v65, v228
    v_sub_f32 v210, v210, v228
    v_sub_f32 v46, v46, v228
    v_sub_f32 v66, v66, v228
    v_sub_f32 v211, v211, v228
    v_sub_f32 v47, v47, v228
    v_sub_f32 v67, v67, v228
    v_mul_f32 v219, v219, v229
    v_accvgpr_read_b32 v230, a12
    v_accvgpr_read_b32 v231, a13
    v_accvgpr_read_b32 v232, a14
    v_accvgpr_read_b32 v233, a15
    v_mul_f32 v230, v230, v229
    v_mul_f32 v231, v231, v229
    v_mul_f32 v232, v232, v229
    v_mul_f32 v233, v233, v229
    v_accvgpr_write_b32 a12, v230
    v_accvgpr_write_b32 a13, v231
    v_accvgpr_write_b32 a14, v232
    v_accvgpr_write_b32 a15, v233
    v_accvgpr_read_b32 v230, a32
    v_accvgpr_read_b32 v231, a33
    v_accvgpr_read_b32 v232, a34
    v_accvgpr_read_b32 v233, a35
    v_mul_f32 v230, v230, v229
    v_mul_f32 v231, v231, v229
    v_mul_f32 v232, v232, v229
    v_mul_f32 v233, v233, v229
    v_accvgpr_write_b32 a32, v230
    v_accvgpr_write_b32 a33, v231
    v_accvgpr_write_b32 a34, v232
    v_accvgpr_write_b32 a35, v233
    v_accvgpr_read_b32 v230, a52
    v_accvgpr_read_b32 v231, a53
    v_accvgpr_read_b32 v232, a54
    v_accvgpr_read_b32 v233, a55
    v_mul_f32 v230, v230, v229
    v_mul_f32 v231, v231, v229
    v_mul_f32 v232, v232, v229
    v_mul_f32 v233, v233, v229
    v_accvgpr_write_b32 a52, v230
    v_accvgpr_write_b32 a53, v231
    v_accvgpr_write_b32 a54, v232
    v_accvgpr_write_b32 a55, v233
    v_accvgpr_read_b32 v230, a72
    v_accvgpr_read_b32 v231, a73
    v_accvgpr_read_b32 v232, a74
    v_accvgpr_read_b32 v233, a75
    v_mul_f32 v230, v230, v229
    v_mul_f32 v231, v231, v229
    v_mul_f32 v232, v232, v229
    v_mul_f32 v233, v233, v229
    v_accvgpr_write_b32 a72, v230
    v_accvgpr_write_b32 a73, v231
    v_accvgpr_write_b32 a74, v232
    v_accvgpr_write_b32 a75, v233
    v_accvgpr_read_b32 v230, a92
    v_accvgpr_read_b32 v231, a93
    v_accvgpr_read_b32 v232, a94
    v_accvgpr_read_b32 v233, a95
    v_mul_f32 v230, v230, v229
    v_mul_f32 v231, v231, v229
    v_mul_f32 v232, v232, v229
    v_mul_f32 v233, v233, v229
    v_accvgpr_write_b32 a92, v230
    v_accvgpr_write_b32 a93, v231
    v_accvgpr_write_b32 a94, v232
    v_accvgpr_write_b32 a95, v233
    v_accvgpr_read_b32 v230, a112
    v_accvgpr_read_b32 v231, a113
    v_accvgpr_read_b32 v232, a114
    v_accvgpr_read_b32 v233, a115
    v_mul_f32 v230, v230, v229
    v_mul_f32 v231, v231, v229
    v_mul_f32 v232, v232, v229
    v_mul_f32 v233, v233, v229
    v_accvgpr_write_b32 a112, v230
    v_accvgpr_write_b32 a113, v231
    v_accvgpr_write_b32 a114, v232
    v_accvgpr_write_b32 a115, v233
    v_accvgpr_read_b32 v230, a132
    v_accvgpr_read_b32 v231, a133
    v_accvgpr_read_b32 v232, a134
    v_accvgpr_read_b32 v233, a135
    v_mul_f32 v230, v230, v229
    v_mul_f32 v231, v231, v229
    v_mul_f32 v232, v232, v229
    v_mul_f32 v233, v233, v229
    v_accvgpr_write_b32 a132, v230
    v_accvgpr_write_b32 a133, v231
    v_accvgpr_write_b32 a134, v232
    v_accvgpr_write_b32 a135, v233
    v_accvgpr_read_b32 v230, a152
    v_accvgpr_read_b32 v231, a153
    v_accvgpr_read_b32 v232, a154
    v_accvgpr_read_b32 v233, a155
    v_mul_f32 v230, v230, v229
    v_mul_f32 v231, v231, v229
    v_mul_f32 v232, v232, v229
    v_mul_f32 v233, v233, v229
    v_accvgpr_write_b32 a152, v230
    v_accvgpr_write_b32 a153, v231
    v_accvgpr_write_b32 a154, v232
    v_accvgpr_write_b32 a155, v233
    v_max3_f32 v228, v48, v49, v50
    v_max3_f32 v228, v228, v51, v68
    v_max3_f32 v228, v228, v69, v70
    v_max_f32 v228, v228, v71
    v_mov_b32 v229, v228
    s_nop 1
    v_permlane32_swap_b32 v228, v229
    s_nop 1
    v_max_f32 v228, v228, v229
    v_mov_b32 v229, v228
    s_nop 1
    v_permlane16_swap_b32 v228, v229
    s_nop 1
    v_max_f32 v228, v228, v229
    v_max_f32 v228, s51, v228
    v_sub_f32 v229, 0, v228
    v_exp_f32 v229, v229
    v_add_f32 v225, v225, v228
    v_sub_f32 v212, v212, v228
    v_sub_f32 v48, v48, v228
    v_sub_f32 v68, v68, v228
    v_sub_f32 v213, v213, v228
    v_sub_f32 v49, v49, v228
    v_sub_f32 v69, v69, v228
    v_sub_f32 v214, v214, v228
    v_sub_f32 v50, v50, v228
    v_sub_f32 v70, v70, v228
    v_sub_f32 v215, v215, v228
    v_sub_f32 v51, v51, v228
    v_sub_f32 v71, v71, v228
    v_mul_f32 v220, v220, v229
    v_accvgpr_read_b32 v230, a16
    v_accvgpr_read_b32 v231, a17
    v_accvgpr_read_b32 v232, a18
    v_accvgpr_read_b32 v233, a19
    v_mul_f32 v230, v230, v229
    v_mul_f32 v231, v231, v229
    v_mul_f32 v232, v232, v229
    v_mul_f32 v233, v233, v229
    v_accvgpr_write_b32 a16, v230
    v_accvgpr_write_b32 a17, v231
    v_accvgpr_write_b32 a18, v232
    v_accvgpr_write_b32 a19, v233
    v_accvgpr_read_b32 v230, a36
    v_accvgpr_read_b32 v231, a37
    v_accvgpr_read_b32 v232, a38
    v_accvgpr_read_b32 v233, a39
    v_mul_f32 v230, v230, v229
    v_mul_f32 v231, v231, v229
    v_mul_f32 v232, v232, v229
    v_mul_f32 v233, v233, v229
    v_accvgpr_write_b32 a36, v230
    v_accvgpr_write_b32 a37, v231
    v_accvgpr_write_b32 a38, v232
    v_accvgpr_write_b32 a39, v233
    v_accvgpr_read_b32 v230, a56
    v_accvgpr_read_b32 v231, a57
    v_accvgpr_read_b32 v232, a58
    v_accvgpr_read_b32 v233, a59
    v_mul_f32 v230, v230, v229
    v_mul_f32 v231, v231, v229
    v_mul_f32 v232, v232, v229
    v_mul_f32 v233, v233, v229
    v_accvgpr_write_b32 a56, v230
    v_accvgpr_write_b32 a57, v231
    v_accvgpr_write_b32 a58, v232
    v_accvgpr_write_b32 a59, v233
    v_accvgpr_read_b32 v230, a76
    v_accvgpr_read_b32 v231, a77
    v_accvgpr_read_b32 v232, a78
    v_accvgpr_read_b32 v233, a79
    v_mul_f32 v230, v230, v229
    v_mul_f32 v231, v231, v229
    v_mul_f32 v232, v232, v229
    v_mul_f32 v233, v233, v229
    v_accvgpr_write_b32 a76, v230
    v_accvgpr_write_b32 a77, v231
    v_accvgpr_write_b32 a78, v232
    v_accvgpr_write_b32 a79, v233
    v_accvgpr_read_b32 v230, a96
    v_accvgpr_read_b32 v231, a97
    v_accvgpr_read_b32 v232, a98
    v_accvgpr_read_b32 v233, a99
    v_mul_f32 v230, v230, v229
    v_mul_f32 v231, v231, v229
    v_mul_f32 v232, v232, v229
    v_mul_f32 v233, v233, v229
    v_accvgpr_write_b32 a96, v230
    v_accvgpr_write_b32 a97, v231
    v_accvgpr_write_b32 a98, v232
    v_accvgpr_write_b32 a99, v233
    v_accvgpr_read_b32 v230, a116
    v_accvgpr_read_b32 v231, a117
    v_accvgpr_read_b32 v232, a118
    v_accvgpr_read_b32 v233, a119
    v_mul_f32 v230, v230, v229
    v_mul_f32 v231, v231, v229
    v_mul_f32 v232, v232, v229
    v_mul_f32 v233, v233, v229
    v_accvgpr_write_b32 a116, v230
    v_accvgpr_write_b32 a117, v231
    v_accvgpr_write_b32 a118, v232
    v_accvgpr_write_b32 a119, v233
    v_accvgpr_read_b32 v230, a136
    v_accvgpr_read_b32 v231, a137
    v_accvgpr_read_b32 v232, a138
    v_accvgpr_read_b32 v233, a139
    v_mul_f32 v230, v230, v229
    v_mul_f32 v231, v231, v229
    v_mul_f32 v232, v232, v229
    v_mul_f32 v233, v233, v229
    v_accvgpr_write_b32 a136, v230
    v_accvgpr_write_b32 a137, v231
    v_accvgpr_write_b32 a138, v232
    v_accvgpr_write_b32 a139, v233
    v_accvgpr_read_b32 v230, a156
    v_accvgpr_read_b32 v231, a157
    v_accvgpr_read_b32 v232, a158
    v_accvgpr_read_b32 v233, a159
    v_mul_f32 v230, v230, v229
    v_mul_f32 v231, v231, v229
    v_mul_f32 v232, v232, v229
    v_mul_f32 v233, v233, v229
    v_accvgpr_write_b32 a156, v230
    v_accvgpr_write_b32 a157, v231
    v_accvgpr_write_b32 a158, v232
    v_accvgpr_write_b32 a159, v233
    s_mov_b32 s50, 0x41000000
    s_mov_b32 s51, 0
    s_nop 1
    s_branch k1_kernel_L34
k1_kernel_L35:
    s_nop 7
    v_max3_f32 v228, v72, v73, v74
    v_max3_f32 v228, v228, v75, v92
    v_max3_f32 v228, v228, v93, v94
    v_max_f32 v228, v228, v95
    v_mov_b32 v229, v228
    s_nop 1
    v_permlane32_swap_b32 v228, v229
    s_nop 1
    v_max_f32 v228, v228, v229
    v_mov_b32 v229, v228
    s_nop 1
    v_permlane16_swap_b32 v228, v229
    s_nop 1
    v_max_f32 v228, v228, v229
    v_max_f32 v228, s51, v228
    v_sub_f32 v229, 0, v228
    v_exp_f32 v229, v229
    v_add_f32 v221, v221, v228
    v_sub_f32 v196, v196, v228
    v_sub_f32 v72, v72, v228
    v_sub_f32 v92, v92, v228
    v_sub_f32 v197, v197, v228
    v_sub_f32 v73, v73, v228
    v_sub_f32 v93, v93, v228
    v_sub_f32 v198, v198, v228
    v_sub_f32 v74, v74, v228
    v_sub_f32 v94, v94, v228
    v_sub_f32 v199, v199, v228
    v_sub_f32 v75, v75, v228
    v_sub_f32 v95, v95, v228
    v_mul_f32 v216, v216, v229
    v_accvgpr_read_b32 v230, a0
    v_accvgpr_read_b32 v231, a1
    v_accvgpr_read_b32 v232, a2
    v_accvgpr_read_b32 v233, a3
    v_mul_f32 v230, v230, v229
    v_mul_f32 v231, v231, v229
    v_mul_f32 v232, v232, v229
    v_mul_f32 v233, v233, v229
    v_accvgpr_write_b32 a0, v230
    v_accvgpr_write_b32 a1, v231
    v_accvgpr_write_b32 a2, v232
    v_accvgpr_write_b32 a3, v233
    v_accvgpr_read_b32 v230, a20
    v_accvgpr_read_b32 v231, a21
    v_accvgpr_read_b32 v232, a22
    v_accvgpr_read_b32 v233, a23
    v_mul_f32 v230, v230, v229
    v_mul_f32 v231, v231, v229
    v_mul_f32 v232, v232, v229
    v_mul_f32 v233, v233, v229
    v_accvgpr_write_b32 a20, v230
    v_accvgpr_write_b32 a21, v231
    v_accvgpr_write_b32 a22, v232
    v_accvgpr_write_b32 a23, v233
    v_accvgpr_read_b32 v230, a40
    v_accvgpr_read_b32 v231, a41
    v_accvgpr_read_b32 v232, a42
    v_accvgpr_read_b32 v233, a43
    v_mul_f32 v230, v230, v229
    v_mul_f32 v231, v231, v229
    v_mul_f32 v232, v232, v229
    v_mul_f32 v233, v233, v229
    v_accvgpr_write_b32 a40, v230
    v_accvgpr_write_b32 a41, v231
    v_accvgpr_write_b32 a42, v232
    v_accvgpr_write_b32 a43, v233
    v_accvgpr_read_b32 v230, a60
    v_accvgpr_read_b32 v231, a61
    v_accvgpr_read_b32 v232, a62
    v_accvgpr_read_b32 v233, a63
    v_mul_f32 v230, v230, v229
    v_mul_f32 v231, v231, v229
    v_mul_f32 v232, v232, v229
    v_mul_f32 v233, v233, v229
    v_accvgpr_write_b32 a60, v230
    v_accvgpr_write_b32 a61, v231
    v_accvgpr_write_b32 a62, v232
    v_accvgpr_write_b32 a63, v233
    v_accvgpr_read_b32 v230, a80
    v_accvgpr_read_b32 v231, a81
    v_accvgpr_read_b32 v232, a82
    v_accvgpr_read_b32 v233, a83
    v_mul_f32 v230, v230, v229
    v_mul_f32 v231, v231, v229
    v_mul_f32 v232, v232, v229
    v_mul_f32 v233, v233, v229
    v_accvgpr_write_b32 a80, v230
    v_accvgpr_write_b32 a81, v231
    v_accvgpr_write_b32 a82, v232
    v_accvgpr_write_b32 a83, v233
    v_accvgpr_read_b32 v230, a100
    v_accvgpr_read_b32 v231, a101
    v_accvgpr_read_b32 v232, a102
    v_accvgpr_read_b32 v233, a103
    v_mul_f32 v230, v230, v229
    v_mul_f32 v231, v231, v229
    v_mul_f32 v232, v232, v229
    v_mul_f32 v233, v233, v229
    v_accvgpr_write_b32 a100, v230
    v_accvgpr_write_b32 a101, v231
    v_accvgpr_write_b32 a102, v232
    v_accvgpr_write_b32 a103, v233
    v_accvgpr_read_b32 v230, a120
    v_accvgpr_read_b32 v231, a121
    v_accvgpr_read_b32 v232, a122
    v_accvgpr_read_b32 v233, a123
    v_mul_f32 v230, v230, v229
    v_mul_f32 v231, v231, v229
    v_mul_f32 v232, v232, v229
    v_mul_f32 v233, v233, v229
    v_accvgpr_write_b32 a120, v230
    v_accvgpr_write_b32 a121, v231
    v_accvgpr_write_b32 a122, v232
    v_accvgpr_write_b32 a123, v233
    v_accvgpr_read_b32 v230, a140
    v_accvgpr_read_b32 v231, a141
    v_accvgpr_read_b32 v232, a142
    v_accvgpr_read_b32 v233, a143
    v_mul_f32 v230, v230, v229
    v_mul_f32 v231, v231, v229
    v_mul_f32 v232, v232, v229
    v_mul_f32 v233, v233, v229
    v_accvgpr_write_b32 a140, v230
    v_accvgpr_write_b32 a141, v231
    v_accvgpr_write_b32 a142, v232
    v_accvgpr_write_b32 a143, v233
    v_max3_f32 v228, v76, v77, v78
    v_max3_f32 v228, v228, v79, v96
    v_max3_f32 v228, v228, v97, v98
    v_max_f32 v228, v228, v99
    v_mov_b32 v229, v228
    s_nop 1
    v_permlane32_swap_b32 v228, v229
    s_nop 1
    v_max_f32 v228, v228, v229
    v_mov_b32 v229, v228
    s_nop 1
    v_permlane16_swap_b32 v228, v229
    s_nop 1
    v_max_f32 v228, v228, v229
    v_max_f32 v228, s51, v228
    v_sub_f32 v229, 0, v228
    v_exp_f32 v229, v229
    v_add_f32 v222, v222, v228
    v_sub_f32 v200, v200, v228
    v_sub_f32 v76, v76, v228
    v_sub_f32 v96, v96, v228
    v_sub_f32 v201, v201, v228
    v_sub_f32 v77, v77, v228
    v_sub_f32 v97, v97, v228
    v_sub_f32 v202, v202, v228
    v_sub_f32 v78, v78, v228
    v_sub_f32 v98, v98, v228
    v_sub_f32 v203, v203, v228
    v_sub_f32 v79, v79, v228
    v_sub_f32 v99, v99, v228
    v_mul_f32 v217, v217, v229
    v_accvgpr_read_b32 v230, a4
    v_accvgpr_read_b32 v231, a5
    v_accvgpr_read_b32 v232, a6
    v_accvgpr_read_b32 v233, a7
    v_mul_f32 v230, v230, v229
    v_mul_f32 v231, v231, v229
    v_mul_f32 v232, v232, v229
    v_mul_f32 v233, v233, v229
    v_accvgpr_write_b32 a4, v230
    v_accvgpr_write_b32 a5, v231
    v_accvgpr_write_b32 a6, v232
    v_accvgpr_write_b32 a7, v233
    v_accvgpr_read_b32 v230, a24
    v_accvgpr_read_b32 v231, a25
    v_accvgpr_read_b32 v232, a26
    v_accvgpr_read_b32 v233, a27
    v_mul_f32 v230, v230, v229
    v_mul_f32 v231, v231, v229
    v_mul_f32 v232, v232, v229
    v_mul_f32 v233, v233, v229
    v_accvgpr_write_b32 a24, v230
    v_accvgpr_write_b32 a25, v231
    v_accvgpr_write_b32 a26, v232
    v_accvgpr_write_b32 a27, v233
    v_accvgpr_read_b32 v230, a44
    v_accvgpr_read_b32 v231, a45
    v_accvgpr_read_b32 v232, a46
    v_accvgpr_read_b32 v233, a47
    v_mul_f32 v230, v230, v229
    v_mul_f32 v231, v231, v229
    v_mul_f32 v232, v232, v229
    v_mul_f32 v233, v233, v229
    v_accvgpr_write_b32 a44, v230
    v_accvgpr_write_b32 a45, v231
    v_accvgpr_write_b32 a46, v232
    v_accvgpr_write_b32 a47, v233
    v_accvgpr_read_b32 v230, a64
    v_accvgpr_read_b32 v231, a65
    v_accvgpr_read_b32 v232, a66
    v_accvgpr_read_b32 v233, a67
    v_mul_f32 v230, v230, v229
    v_mul_f32 v231, v231, v229
    v_mul_f32 v232, v232, v229
    v_mul_f32 v233, v233, v229
    v_accvgpr_write_b32 a64, v230
    v_accvgpr_write_b32 a65, v231
    v_accvgpr_write_b32 a66, v232
    v_accvgpr_write_b32 a67, v233
    v_accvgpr_read_b32 v230, a84
    v_accvgpr_read_b32 v231, a85
    v_accvgpr_read_b32 v232, a86
    v_accvgpr_read_b32 v233, a87
    v_mul_f32 v230, v230, v229
    v_mul_f32 v231, v231, v229
    v_mul_f32 v232, v232, v229
    v_mul_f32 v233, v233, v229
    v_accvgpr_write_b32 a84, v230
    v_accvgpr_write_b32 a85, v231
    v_accvgpr_write_b32 a86, v232
    v_accvgpr_write_b32 a87, v233
    v_accvgpr_read_b32 v230, a104
    v_accvgpr_read_b32 v231, a105
    v_accvgpr_read_b32 v232, a106
    v_accvgpr_read_b32 v233, a107
    v_mul_f32 v230, v230, v229
    v_mul_f32 v231, v231, v229
    v_mul_f32 v232, v232, v229
    v_mul_f32 v233, v233, v229
    v_accvgpr_write_b32 a104, v230
    v_accvgpr_write_b32 a105, v231
    v_accvgpr_write_b32 a106, v232
    v_accvgpr_write_b32 a107, v233
    v_accvgpr_read_b32 v230, a124
    v_accvgpr_read_b32 v231, a125
    v_accvgpr_read_b32 v232, a126
    v_accvgpr_read_b32 v233, a127
    v_mul_f32 v230, v230, v229
    v_mul_f32 v231, v231, v229
    v_mul_f32 v232, v232, v229
    v_mul_f32 v233, v233, v229
    v_accvgpr_write_b32 a124, v230
    v_accvgpr_write_b32 a125, v231
    v_accvgpr_write_b32 a126, v232
    v_accvgpr_write_b32 a127, v233
    v_accvgpr_read_b32 v230, a144
    v_accvgpr_read_b32 v231, a145
    v_accvgpr_read_b32 v232, a146
    v_accvgpr_read_b32 v233, a147
    v_mul_f32 v230, v230, v229
    v_mul_f32 v231, v231, v229
    v_mul_f32 v232, v232, v229
    v_mul_f32 v233, v233, v229
    v_accvgpr_write_b32 a144, v230
    v_accvgpr_write_b32 a145, v231
    v_accvgpr_write_b32 a146, v232
    v_accvgpr_write_b32 a147, v233
    v_max3_f32 v228, v80, v81, v82
    v_max3_f32 v228, v228, v83, v100
    v_max3_f32 v228, v228, v101, v102
    v_max_f32 v228, v228, v103
    v_mov_b32 v229, v228
    s_nop 1
    v_permlane32_swap_b32 v228, v229
    s_nop 1
    v_max_f32 v228, v228, v229
    v_mov_b32 v229, v228
    s_nop 1
    v_permlane16_swap_b32 v228, v229
    s_nop 1
    v_max_f32 v228, v228, v229
    v_max_f32 v228, s51, v228
    v_sub_f32 v229, 0, v228
    v_exp_f32 v229, v229
    v_add_f32 v223, v223, v228
    v_sub_f32 v204, v204, v228
    v_sub_f32 v80, v80, v228
    v_sub_f32 v100, v100, v228
    v_sub_f32 v205, v205, v228
    v_sub_f32 v81, v81, v228
    v_sub_f32 v101, v101, v228
    v_sub_f32 v206, v206, v228
    v_sub_f32 v82, v82, v228
    v_sub_f32 v102, v102, v228
    v_sub_f32 v207, v207, v228
    v_sub_f32 v83, v83, v228
    v_sub_f32 v103, v103, v228
    v_mul_f32 v218, v218, v229
    v_accvgpr_read_b32 v230, a8
    v_accvgpr_read_b32 v231, a9
    v_accvgpr_read_b32 v232, a10
    v_accvgpr_read_b32 v233, a11
    v_mul_f32 v230, v230, v229
    v_mul_f32 v231, v231, v229
    v_mul_f32 v232, v232, v229
    v_mul_f32 v233, v233, v229
    v_accvgpr_write_b32 a8, v230
    v_accvgpr_write_b32 a9, v231
    v_accvgpr_write_b32 a10, v232
    v_accvgpr_write_b32 a11, v233
    v_accvgpr_read_b32 v230, a28
    v_accvgpr_read_b32 v231, a29
    v_accvgpr_read_b32 v232, a30
    v_accvgpr_read_b32 v233, a31
    v_mul_f32 v230, v230, v229
    v_mul_f32 v231, v231, v229
    v_mul_f32 v232, v232, v229
    v_mul_f32 v233, v233, v229
    v_accvgpr_write_b32 a28, v230
    v_accvgpr_write_b32 a29, v231
    v_accvgpr_write_b32 a30, v232
    v_accvgpr_write_b32 a31, v233
    v_accvgpr_read_b32 v230, a48
    v_accvgpr_read_b32 v231, a49
    v_accvgpr_read_b32 v232, a50
    v_accvgpr_read_b32 v233, a51
    v_mul_f32 v230, v230, v229
    v_mul_f32 v231, v231, v229
    v_mul_f32 v232, v232, v229
    v_mul_f32 v233, v233, v229
    v_accvgpr_write_b32 a48, v230
    v_accvgpr_write_b32 a49, v231
    v_accvgpr_write_b32 a50, v232
    v_accvgpr_write_b32 a51, v233
    v_accvgpr_read_b32 v230, a68
    v_accvgpr_read_b32 v231, a69
    v_accvgpr_read_b32 v232, a70
    v_accvgpr_read_b32 v233, a71
    v_mul_f32 v230, v230, v229
    v_mul_f32 v231, v231, v229
    v_mul_f32 v232, v232, v229
    v_mul_f32 v233, v233, v229
    v_accvgpr_write_b32 a68, v230
    v_accvgpr_write_b32 a69, v231
    v_accvgpr_write_b32 a70, v232
    v_accvgpr_write_b32 a71, v233
    v_accvgpr_read_b32 v230, a88
    v_accvgpr_read_b32 v231, a89
    v_accvgpr_read_b32 v232, a90
    v_accvgpr_read_b32 v233, a91
    v_mul_f32 v230, v230, v229
    v_mul_f32 v231, v231, v229
    v_mul_f32 v232, v232, v229
    v_mul_f32 v233, v233, v229
    v_accvgpr_write_b32 a88, v230
    v_accvgpr_write_b32 a89, v231
    v_accvgpr_write_b32 a90, v232
    v_accvgpr_write_b32 a91, v233
    v_accvgpr_read_b32 v230, a108
    v_accvgpr_read_b32 v231, a109
    v_accvgpr_read_b32 v232, a110
    v_accvgpr_read_b32 v233, a111
    v_mul_f32 v230, v230, v229
    v_mul_f32 v231, v231, v229
    v_mul_f32 v232, v232, v229
    v_mul_f32 v233, v233, v229
    v_accvgpr_write_b32 a108, v230
    v_accvgpr_write_b32 a109, v231
    v_accvgpr_write_b32 a110, v232
    v_accvgpr_write_b32 a111, v233
    v_accvgpr_read_b32 v230, a128
    v_accvgpr_read_b32 v231, a129
    v_accvgpr_read_b32 v232, a130
    v_accvgpr_read_b32 v233, a131
    v_mul_f32 v230, v230, v229
    v_mul_f32 v231, v231, v229
    v_mul_f32 v232, v232, v229
    v_mul_f32 v233, v233, v229
    v_accvgpr_write_b32 a128, v230
    v_accvgpr_write_b32 a129, v231
    v_accvgpr_write_b32 a130, v232
    v_accvgpr_write_b32 a131, v233
    v_accvgpr_read_b32 v230, a148
    v_accvgpr_read_b32 v231, a149
    v_accvgpr_read_b32 v232, a150
    v_accvgpr_read_b32 v233, a151
    v_mul_f32 v230, v230, v229
    v_mul_f32 v231, v231, v229
    v_mul_f32 v232, v232, v229
    v_mul_f32 v233, v233, v229
    v_accvgpr_write_b32 a148, v230
    v_accvgpr_write_b32 a149, v231
    v_accvgpr_write_b32 a150, v232
    v_accvgpr_write_b32 a151, v233
    v_max3_f32 v228, v84, v85, v86
    v_max3_f32 v228, v228, v87, v104
    v_max3_f32 v228, v228, v105, v106
    v_max_f32 v228, v228, v107
    v_mov_b32 v229, v228
    s_nop 1
    v_permlane32_swap_b32 v228, v229
    s_nop 1
    v_max_f32 v228, v228, v229
    v_mov_b32 v229, v228
    s_nop 1
    v_permlane16_swap_b32 v228, v229
    s_nop 1
    v_max_f32 v228, v228, v229
    v_max_f32 v228, s51, v228
    v_sub_f32 v229, 0, v228
    v_exp_f32 v229, v229
    v_add_f32 v224, v224, v228
    v_sub_f32 v208, v208, v228
    v_sub_f32 v84, v84, v228
    v_sub_f32 v104, v104, v228
    v_sub_f32 v209, v209, v228
    v_sub_f32 v85, v85, v228
    v_sub_f32 v105, v105, v228
    v_sub_f32 v210, v210, v228
    v_sub_f32 v86, v86, v228
    v_sub_f32 v106, v106, v228
    v_sub_f32 v211, v211, v228
    v_sub_f32 v87, v87, v228
    v_sub_f32 v107, v107, v228
    v_mul_f32 v219, v219, v229
    v_accvgpr_read_b32 v230, a12
    v_accvgpr_read_b32 v231, a13
    v_accvgpr_read_b32 v232, a14
    v_accvgpr_read_b32 v233, a15
    v_mul_f32 v230, v230, v229
    v_mul_f32 v231, v231, v229
    v_mul_f32 v232, v232, v229
    v_mul_f32 v233, v233, v229
    v_accvgpr_write_b32 a12, v230
    v_accvgpr_write_b32 a13, v231
    v_accvgpr_write_b32 a14, v232
    v_accvgpr_write_b32 a15, v233
    v_accvgpr_read_b32 v230, a32
    v_accvgpr_read_b32 v231, a33
    v_accvgpr_read_b32 v232, a34
    v_accvgpr_read_b32 v233, a35
    v_mul_f32 v230, v230, v229
    v_mul_f32 v231, v231, v229
    v_mul_f32 v232, v232, v229
    v_mul_f32 v233, v233, v229
    v_accvgpr_write_b32 a32, v230
    v_accvgpr_write_b32 a33, v231
    v_accvgpr_write_b32 a34, v232
    v_accvgpr_write_b32 a35, v233
    v_accvgpr_read_b32 v230, a52
    v_accvgpr_read_b32 v231, a53
    v_accvgpr_read_b32 v232, a54
    v_accvgpr_read_b32 v233, a55
    v_mul_f32 v230, v230, v229
    v_mul_f32 v231, v231, v229
    v_mul_f32 v232, v232, v229
    v_mul_f32 v233, v233, v229
    v_accvgpr_write_b32 a52, v230
    v_accvgpr_write_b32 a53, v231
    v_accvgpr_write_b32 a54, v232
    v_accvgpr_write_b32 a55, v233
    v_accvgpr_read_b32 v230, a72
    v_accvgpr_read_b32 v231, a73
    v_accvgpr_read_b32 v232, a74
    v_accvgpr_read_b32 v233, a75
    v_mul_f32 v230, v230, v229
    v_mul_f32 v231, v231, v229
    v_mul_f32 v232, v232, v229
    v_mul_f32 v233, v233, v229
    v_accvgpr_write_b32 a72, v230
    v_accvgpr_write_b32 a73, v231
    v_accvgpr_write_b32 a74, v232
    v_accvgpr_write_b32 a75, v233
    v_accvgpr_read_b32 v230, a92
    v_accvgpr_read_b32 v231, a93
    v_accvgpr_read_b32 v232, a94
    v_accvgpr_read_b32 v233, a95
    v_mul_f32 v230, v230, v229
    v_mul_f32 v231, v231, v229
    v_mul_f32 v232, v232, v229
    v_mul_f32 v233, v233, v229
    v_accvgpr_write_b32 a92, v230
    v_accvgpr_write_b32 a93, v231
    v_accvgpr_write_b32 a94, v232
    v_accvgpr_write_b32 a95, v233
    v_accvgpr_read_b32 v230, a112
    v_accvgpr_read_b32 v231, a113
    v_accvgpr_read_b32 v232, a114
    v_accvgpr_read_b32 v233, a115
    v_mul_f32 v230, v230, v229
    v_mul_f32 v231, v231, v229
    v_mul_f32 v232, v232, v229
    v_mul_f32 v233, v233, v229
    v_accvgpr_write_b32 a112, v230
    v_accvgpr_write_b32 a113, v231
    v_accvgpr_write_b32 a114, v232
    v_accvgpr_write_b32 a115, v233
    v_accvgpr_read_b32 v230, a132
    v_accvgpr_read_b32 v231, a133
    v_accvgpr_read_b32 v232, a134
    v_accvgpr_read_b32 v233, a135
    v_mul_f32 v230, v230, v229
    v_mul_f32 v231, v231, v229
    v_mul_f32 v232, v232, v229
    v_mul_f32 v233, v233, v229
    v_accvgpr_write_b32 a132, v230
    v_accvgpr_write_b32 a133, v231
    v_accvgpr_write_b32 a134, v232
    v_accvgpr_write_b32 a135, v233
    v_accvgpr_read_b32 v230, a152
    v_accvgpr_read_b32 v231, a153
    v_accvgpr_read_b32 v232, a154
    v_accvgpr_read_b32 v233, a155
    v_mul_f32 v230, v230, v229
    v_mul_f32 v231, v231, v229
    v_mul_f32 v232, v232, v229
    v_mul_f32 v233, v233, v229
    v_accvgpr_write_b32 a152, v230
    v_accvgpr_write_b32 a153, v231
    v_accvgpr_write_b32 a154, v232
    v_accvgpr_write_b32 a155, v233
    v_max3_f32 v228, v88, v89, v90
    v_max3_f32 v228, v228, v91, v108
    v_max3_f32 v228, v228, v109, v110
    v_max_f32 v228, v228, v111
    v_mov_b32 v229, v228
    s_nop 1
    v_permlane32_swap_b32 v228, v229
    s_nop 1
    v_max_f32 v228, v228, v229
    v_mov_b32 v229, v228
    s_nop 1
    v_permlane16_swap_b32 v228, v229
    s_nop 1
    v_max_f32 v228, v228, v229
    v_max_f32 v228, s51, v228
    v_sub_f32 v229, 0, v228
    v_exp_f32 v229, v229
    v_add_f32 v225, v225, v228
    v_sub_f32 v212, v212, v228
    v_sub_f32 v88, v88, v228
    v_sub_f32 v108, v108, v228
    v_sub_f32 v213, v213, v228
    v_sub_f32 v89, v89, v228
    v_sub_f32 v109, v109, v228
    v_sub_f32 v214, v214, v228
    v_sub_f32 v90, v90, v228
    v_sub_f32 v110, v110, v228
    v_sub_f32 v215, v215, v228
    v_sub_f32 v91, v91, v228
    v_sub_f32 v111, v111, v228
    v_mul_f32 v220, v220, v229
    v_accvgpr_read_b32 v230, a16
    v_accvgpr_read_b32 v231, a17
    v_accvgpr_read_b32 v232, a18
    v_accvgpr_read_b32 v233, a19
    v_mul_f32 v230, v230, v229
    v_mul_f32 v231, v231, v229
    v_mul_f32 v232, v232, v229
    v_mul_f32 v233, v233, v229
    v_accvgpr_write_b32 a16, v230
    v_accvgpr_write_b32 a17, v231
    v_accvgpr_write_b32 a18, v232
    v_accvgpr_write_b32 a19, v233
    v_accvgpr_read_b32 v230, a36
    v_accvgpr_read_b32 v231, a37
    v_accvgpr_read_b32 v232, a38
    v_accvgpr_read_b32 v233, a39
    v_mul_f32 v230, v230, v229
    v_mul_f32 v231, v231, v229
    v_mul_f32 v232, v232, v229
    v_mul_f32 v233, v233, v229
    v_accvgpr_write_b32 a36, v230
    v_accvgpr_write_b32 a37, v231
    v_accvgpr_write_b32 a38, v232
    v_accvgpr_write_b32 a39, v233
    v_accvgpr_read_b32 v230, a56
    v_accvgpr_read_b32 v231, a57
    v_accvgpr_read_b32 v232, a58
    v_accvgpr_read_b32 v233, a59
    v_mul_f32 v230, v230, v229
    v_mul_f32 v231, v231, v229
    v_mul_f32 v232, v232, v229
    v_mul_f32 v233, v233, v229
    v_accvgpr_write_b32 a56, v230
    v_accvgpr_write_b32 a57, v231
    v_accvgpr_write_b32 a58, v232
    v_accvgpr_write_b32 a59, v233
    v_accvgpr_read_b32 v230, a76
    v_accvgpr_read_b32 v231, a77
    v_accvgpr_read_b32 v232, a78
    v_accvgpr_read_b32 v233, a79
    v_mul_f32 v230, v230, v229
    v_mul_f32 v231, v231, v229
    v_mul_f32 v232, v232, v229
    v_mul_f32 v233, v233, v229
    v_accvgpr_write_b32 a76, v230
    v_accvgpr_write_b32 a77, v231
    v_accvgpr_write_b32 a78, v232
    v_accvgpr_write_b32 a79, v233
    v_accvgpr_read_b32 v230, a96
    v_accvgpr_read_b32 v231, a97
    v_accvgpr_read_b32 v232, a98
    v_accvgpr_read_b32 v233, a99
    v_mul_f32 v230, v230, v229
    v_mul_f32 v231, v231, v229
    v_mul_f32 v232, v232, v229
    v_mul_f32 v233, v233, v229
    v_accvgpr_write_b32 a96, v230
    v_accvgpr_write_b32 a97, v231
    v_accvgpr_write_b32 a98, v232
    v_accvgpr_write_b32 a99, v233
    v_accvgpr_read_b32 v230, a116
    v_accvgpr_read_b32 v231, a117
    v_accvgpr_read_b32 v232, a118
    v_accvgpr_read_b32 v233, a119
    v_mul_f32 v230, v230, v229
    v_mul_f32 v231, v231, v229
    v_mul_f32 v232, v232, v229
    v_mul_f32 v233, v233, v229
    v_accvgpr_write_b32 a116, v230
    v_accvgpr_write_b32 a117, v231
    v_accvgpr_write_b32 a118, v232
    v_accvgpr_write_b32 a119, v233
    v_accvgpr_read_b32 v230, a136
    v_accvgpr_read_b32 v231, a137
    v_accvgpr_read_b32 v232, a138
    v_accvgpr_read_b32 v233, a139
    v_mul_f32 v230, v230, v229
    v_mul_f32 v231, v231, v229
    v_mul_f32 v232, v232, v229
    v_mul_f32 v233, v233, v229
    v_accvgpr_write_b32 a136, v230
    v_accvgpr_write_b32 a137, v231
    v_accvgpr_write_b32 a138, v232
    v_accvgpr_write_b32 a139, v233
    v_accvgpr_read_b32 v230, a156
    v_accvgpr_read_b32 v231, a157
    v_accvgpr_read_b32 v232, a158
    v_accvgpr_read_b32 v233, a159
    v_mul_f32 v230, v230, v229
    v_mul_f32 v231, v231, v229
    v_mul_f32 v232, v232, v229
    v_mul_f32 v233, v233, v229
    v_accvgpr_write_b32 a156, v230
    v_accvgpr_write_b32 a157, v231
    v_accvgpr_write_b32 a158, v232
    v_accvgpr_write_b32 a159, v233
    s_mov_b32 s50, 0x41000000
    s_mov_b32 s51, 0
    s_nop 1
    s_branch k1_kernel_L36
k1_kernel_done:
    s_endpgm
.text
.globl k2_kernel
.p2align 8
.type k2_kernel,@function
k2_kernel:

    s_load_dwordx2 s[4:5], s[0:1], 40
    s_load_dwordx2 s[6:7], s[0:1], 56
    s_waitcnt lgkmcnt(0)
    s_mov_b32 s8, s4
    s_mov_b32 s9, s5
    s_mov_b32 s10, 1310720
    s_mov_b32 s11, 0x00020000
    s_mov_b32 s12, s6
    s_mov_b32 s13, s7
    s_mov_b32 s14, 52428800
    s_mov_b32 s15, 0x00020000
    s_lshl_b32 s3, s2, 8
    v_add_u32 v1, s3, v0
    v_lshlrev_b32 v2, 4, v1
    v_add_u32 v2, 10485760, v2
    s_mov_b32 s16, 0

    buffer_load_dwordx4 v[8:11], v2, s[12:15], s16 offen
    s_add_u32 s16, s16, 2621440
    buffer_load_dwordx4 v[12:15], v2, s[12:15], s16 offen
    s_add_u32 s16, s16, 2621440
    buffer_load_dwordx4 v[16:19], v2, s[12:15], s16 offen
    s_add_u32 s16, s16, 2621440
    buffer_load_dwordx4 v[20:23], v2, s[12:15], s16 offen
    s_add_u32 s16, s16, 2621440
    buffer_load_dwordx4 v[24:27], v2, s[12:15], s16 offen
    s_add_u32 s16, s16, 2621440
    buffer_load_dwordx4 v[28:31], v2, s[12:15], s16 offen
    s_add_u32 s16, s16, 2621440
    buffer_load_dwordx4 v[32:35], v2, s[12:15], s16 offen
    s_add_u32 s16, s16, 2621440
    buffer_load_dwordx4 v[36:39], v2, s[12:15], s16 offen
    s_add_u32 s16, s16, 2621440
    buffer_load_dwordx4 v[40:43], v2, s[12:15], s16 offen
    s_add_u32 s16, s16, 2621440
    buffer_load_dwordx4 v[44:47], v2, s[12:15], s16 offen
    s_add_u32 s16, s16, 2621440
    buffer_load_dwordx4 v[48:51], v2, s[12:15], s16 offen
    s_add_u32 s16, s16, 2621440
    buffer_load_dwordx4 v[52:55], v2, s[12:15], s16 offen
    s_add_u32 s16, s16, 2621440
    buffer_load_dwordx4 v[56:59], v2, s[12:15], s16 offen
    s_add_u32 s16, s16, 2621440
    buffer_load_dwordx4 v[60:63], v2, s[12:15], s16 offen
    s_add_u32 s16, s16, 2621440
    buffer_load_dwordx4 v[64:67], v2, s[12:15], s16 offen
    s_add_u32 s16, s16, 2621440
    buffer_load_dwordx4 v[68:71], v2, s[12:15], s16 offen
    s_add_u32 s16, s16, 2621440
    s_waitcnt vmcnt(14)
    v_add_f32 v8, v8, v12
    v_add_f32 v9, v9, v13
    v_add_f32 v10, v10, v14
    v_add_f32 v11, v11, v15
    s_waitcnt vmcnt(13)
    v_add_f32 v8, v8, v16
    v_add_f32 v9, v9, v17
    v_add_f32 v10, v10, v18
    v_add_f32 v11, v11, v19
    s_waitcnt vmcnt(12)
    v_add_f32 v8, v8, v20
    v_add_f32 v9, v9, v21
    v_add_f32 v10, v10, v22
    v_add_f32 v11, v11, v23
    s_waitcnt vmcnt(11)
    v_add_f32 v8, v8, v24
    v_add_f32 v9, v9, v25
    v_add_f32 v10, v10, v26
    v_add_f32 v11, v11, v27
    s_waitcnt vmcnt(10)
    v_add_f32 v8, v8, v28
    v_add_f32 v9, v9, v29
    v_add_f32 v10, v10, v30
    v_add_f32 v11, v11, v31
    s_waitcnt vmcnt(9)
    v_add_f32 v8, v8, v32
    v_add_f32 v9, v9, v33
    v_add_f32 v10, v10, v34
    v_add_f32 v11, v11, v35
    s_waitcnt vmcnt(8)
    v_add_f32 v8, v8, v36
    v_add_f32 v9, v9, v37
    v_add_f32 v10, v10, v38
    v_add_f32 v11, v11, v39
    s_waitcnt vmcnt(7)
    v_add_f32 v8, v8, v40
    v_add_f32 v9, v9, v41
    v_add_f32 v10, v10, v42
    v_add_f32 v11, v11, v43
    s_waitcnt vmcnt(6)
    v_add_f32 v8, v8, v44
    v_add_f32 v9, v9, v45
    v_add_f32 v10, v10, v46
    v_add_f32 v11, v11, v47
    s_waitcnt vmcnt(5)
    v_add_f32 v8, v8, v48
    v_add_f32 v9, v9, v49
    v_add_f32 v10, v10, v50
    v_add_f32 v11, v11, v51
    s_waitcnt vmcnt(4)
    v_add_f32 v8, v8, v52
    v_add_f32 v9, v9, v53
    v_add_f32 v10, v10, v54
    v_add_f32 v11, v11, v55
    s_waitcnt vmcnt(3)
    v_add_f32 v8, v8, v56
    v_add_f32 v9, v9, v57
    v_add_f32 v10, v10, v58
    v_add_f32 v11, v11, v59
    s_waitcnt vmcnt(2)
    v_add_f32 v8, v8, v60
    v_add_f32 v9, v9, v61
    v_add_f32 v10, v10, v62
    v_add_f32 v11, v11, v63
    s_waitcnt vmcnt(1)
    v_add_f32 v8, v8, v64
    v_add_f32 v9, v9, v65
    v_add_f32 v10, v10, v66
    v_add_f32 v11, v11, v67
    s_waitcnt vmcnt(0)
    v_add_f32 v8, v8, v68
    v_add_f32 v9, v9, v69
    v_add_f32 v10, v10, v70
    v_add_f32 v11, v11, v71
    v_cvt_pk_bf16_f32 v4, v8, v9
    v_cvt_pk_bf16_f32 v5, v10, v11
    v_lshlrev_b32 v3, 3, v1
    buffer_store_dwordx2 v[4:5], v3, s[8:11], 0 offen
    s_waitcnt vmcnt(0)
    s_endpgm

.section .rodata,"a"
.p2align 6
.amdhsa_kernel k0_kernel
  .amdhsa_next_free_vgpr 208
  .amdhsa_next_free_sgpr 64
  .amdhsa_accum_offset 208
  .amdhsa_group_segment_fixed_size 0
  .amdhsa_kernarg_size 64
  .amdhsa_user_sgpr_count 2
  .amdhsa_user_sgpr_kernarg_segment_ptr 1
  .amdhsa_system_sgpr_workgroup_id_x 1
.end_amdhsa_kernel
.section .rodata,"a"
.p2align 6
.amdhsa_kernel k1_kernel
  .amdhsa_next_free_vgpr 496
  .amdhsa_next_free_sgpr 72
  .amdhsa_accum_offset 256
  .amdhsa_group_segment_fixed_size 0
  .amdhsa_kernarg_size 64
  .amdhsa_user_sgpr_count 2
  .amdhsa_user_sgpr_kernarg_segment_ptr 1
  .amdhsa_system_sgpr_workgroup_id_x 1
.end_amdhsa_kernel
.section .rodata,"a"
.p2align 6
.amdhsa_kernel k2_kernel
  .amdhsa_next_free_vgpr 72
  .amdhsa_next_free_sgpr 32
  .amdhsa_accum_offset 72
  .amdhsa_group_segment_fixed_size 0
  .amdhsa_kernarg_size 64
  .amdhsa_user_sgpr_count 2
  .amdhsa_user_sgpr_kernarg_segment_ptr 1
  .amdhsa_system_sgpr_workgroup_id_x 1
.end_amdhsa_kernel
```
